```python
import torch

def _softmax(x, axis=-1):
    return torch.softmax(x, dim=axis)

def _gelu(x):
    return torch.nn.functional.gelu(x, approximate='tanh')

def _silu(x):
    return torch.nn.functional.silu(x)

def _sigmoid(x):
    return torch.sigmoid(x)

def _layernorm(x, axis=-1, eps=1e-05):
    m = x.mean(dim=axis, keepdim=True)
    v = x.var(dim=axis, keepdim=True, unbiased=False)
    return (x - m) / torch.sqrt(v + eps)

def _scatter_add(tgt, idx, src, axis=0):
    return tgt.clone().index_add_(axis, idx, src)

def _segment_sum(src, seg, n):
    out = torch.zeros((n,) + src.shape[1:], dtype=src.dtype)
    return out.index_add_(0, seg, src)

def _pad(x, pw):
    flat = tuple((v for pair in reversed(pw) for v in pair))
    return torch.nn.functional.pad(x, flat)
kernel_name = 'interleave_layers__memory_aug_recurrent_mem_tr__glu_gated_swiglu__prompt'

def setup_inputs():

    _w = lambda a: (lambda t: t.to(torch.bfloat16) if t.is_floating_point() else t)(torch.as_tensor(a))

    def _A_setup():
        B, S, Dm = (1, 2048, 512)
        H, Dh = (32, 128)
        M, seg = (8, 32)
        seg = min(seg, S)
        S = S // seg * seg
        return {'x': _w((lambda *s: torch.randn(*s, dtype=torch.bfloat16) * 0.05)(B, S, Dm)), 'mem0': _w((lambda *s: torch.randn(*s, dtype=torch.bfloat16) * 0.2)(B, M, Dm)), 'Wq': _w((lambda *s: torch.randn(*s, dtype=torch.bfloat16) * 1.6)(Dm, H, Dh) * Dm ** (-0.5)), 'Wk': _w((lambda *s: torch.randn(*s, dtype=torch.bfloat16) * 1.6)(Dm, H, Dh) * Dm ** (-0.5)), 'Wv': _w((lambda *s: torch.randn(*s, dtype=torch.bfloat16) * 0.2)(Dm, H, Dh) * Dm ** (-0.5)), 'Wo': _w((lambda *s: torch.randn(*s, dtype=torch.bfloat16) * 0.2)(H, Dh, Dm) * (H * Dh) ** (-0.5)), 'seg_len': seg}
    _A_in = _A_setup()

    def _B_setup():
        B, S, D, F = (1, 2048, 512, 1792)
        return {'x': _w((lambda *s: torch.randn(*s, dtype=torch.bfloat16) * 0.05)(B, S, D)), 'w1': _w((lambda *s: torch.randn(*s, dtype=torch.bfloat16) * 0.2)(D, F) * (2.0 / D) ** 0.5), 'w3': _w((lambda *s: torch.randn(*s, dtype=torch.bfloat16) * 0.2)(D, F) * (2.0 / D) ** 0.5), 'w2': _w((lambda *s: torch.randn(*s, dtype=torch.bfloat16) * 0.2)(F, D) * (2.0 / F) ** 0.5)}
    _B_in = _B_setup()
    return {'A_x': _A_in['x'], 'A_mem0': _A_in['mem0'], 'A_Wq': _A_in['Wq'], 'A_Wk': _A_in['Wk'], 'A_Wv': _A_in['Wv'], 'A_Wo': _A_in['Wo'], 'A_seg_len': _A_in['seg_len'], 'B_x': _B_in['x'], 'B_w1': _B_in['w1'], 'B_w3': _B_in['w3'], 'B_w2': _B_in['w2']}

def reference(A_x, A_mem0, A_Wq, A_Wk, A_Wv, A_Wo, A_seg_len, B_x, B_w1, B_w3, B_w2):

    def _A_ref(x, mem0, Wq, Wk, Wv, Wo, seg_len):
        B, S, Dm = x.shape
        H, Dh = (Wq.shape[1], Wq.shape[2])
        M = mem0.shape[1]
        scale = Dh ** (-0.5)
        n_seg = S // seg_len
        L = M + seg_len
        idx = torch.arange(L)
        mask = (idx[:, None] < M) | (idx[:, None] >= idx[None, :])
        mem = mem0
        outs = []
        for s in range(n_seg):
            xs = x[:, s * seg_len:(s + 1) * seg_len, :].clone()
            h = torch.concatenate([mem, xs], axis=1)
            q = torch.einsum('btd,dhe->bhte', h, Wq)
            k = torch.einsum('btd,dhe->bhte', h, Wk)
            v = torch.einsum('btd,dhe->bhte', h, Wv)
            scores = torch.einsum('bhqe,bhke->bhqk', q, k) * scale
            scores = torch.where(mask[None, None], scores, -1000000000.0)
            p = _softmax(scores, axis=-1)
            o = torch.einsum('bhqk,bhke->bhqe', p, v)
            o = torch.einsum('bhte,hed->btd', o, Wo)
            mem = o[:, :M, :].clone()
            outs.append(o[:, M:, :])
        return torch.concatenate(outs, axis=1)

    def _B_ref(x, w1, w3, w2):
        gate = torch.einsum('bsd,df->bsf', x, w1)
        up = torch.einsum('bsd,df->bsf', x, w3)
        h = _silu(gate) * up
        out = torch.einsum('bsf,fd->bsd', h, w2)
        return out
    x = A_x
    x = x + _A_ref(_layernorm(x, axis=-1), A_mem0, A_Wq, A_Wk, A_Wv, A_Wo, A_seg_len)
    x = x + _B_ref(_layernorm(x, axis=-1), B_w1, B_w3, B_w2)
    x = x + _A_ref(_layernorm(x, axis=-1), A_mem0, A_Wq, A_Wk, A_Wv, A_Wo, A_seg_len)
    x = x + _B_ref(_layernorm(x, axis=-1), B_w1, B_w3, B_w2)
    return x
```

```asm
; @launch grid=(256,1,1) block=(256,1,1) lds=163840
.amdgcn_target "amdgcn-amd-amdhsa--gfx950"
.text
.globl interleave_layers__memory_aug_recurrent_mem_tr__glu_gated_swiglu__prompt_kernel
.p2align 8
.type interleave_layers__memory_aug_recurrent_mem_tr__glu_gated_swiglu__prompt_kernel,@function
interleave_layers__memory_aug_recurrent_mem_tr__glu_gated_swiglu__prompt_kernel:
    s_cmp_ge_u32 s2, 256
    s_cbranch_scc1 L_end
    s_load_dwordx16 s[64:79], s[0:1], 0
    s_load_dwordx8 s[80:87], s[0:1], 64
    s_load_dwordx4 s[88:91], s[0:1], 96
    s_getreg_b32 s25, hwreg(HW_REG_XCC_ID, 0, 4)
    v_lshrrev_b32 v1, 6, v0
    v_and_b32 v0, 63, v0
    s_nop 0
    v_readfirstlane_b32 s24, v1
    s_waitcnt lgkmcnt(0)
    s_mov_b32 s8, s90
    s_mov_b32 s9, s91
    s_mov_b32 s10, 268435456
    s_mov_b32 s11, 0x00020000
    s_mov_b32 s12, s88
    s_mov_b32 s13, s89
    s_mov_b32 s14, 256
    s_mov_b32 s15, 0x00020000
    s_and_b32 s25, s25, 7
    s_cmp_lg_u32 s24, 0
    s_cbranch_scc1 L_norank
    v_mov_b32 v3, 1
    s_lshl_b32 s27, s25, 5
    v_mov_b32 v4, s27
    v_mov_b32 v5, 0
    s_mov_b64 exec, 1
    buffer_atomic_add v3, v4, s[12:15], 0 offen sc0
    s_waitcnt vmcnt(0)
    ds_write_b32 v5, v3
    s_waitcnt lgkmcnt(0)
    s_mov_b64 exec, -1
L_norank:
    s_barrier
    v_mov_b32 v5, 0
    ds_read_b32 v3, v5
    s_waitcnt lgkmcnt(0)
    v_readfirstlane_b32 s26, v3
    s_barrier
    s_mov_b32 s52, 0
    s_cmp_lt_u32 s26, 32
    s_cbranch_scc1 L_slot
    v_min_u32 v1, 7, v0
    v_lshlrev_b32 v1, 5, v1
L_ovf:
    s_sleep 4
    buffer_load_dword v2, v1, s[12:15], 0 offen sc1
    s_waitcnt vmcnt(0)
    s_mov_b32 s42, 0
    v_readlane_b32 s43, v2, 0
    s_nop 3
    s_add_u32 s42, s42, s43
    v_readlane_b32 s43, v2, 1
    s_nop 3
    s_add_u32 s42, s42, s43
    v_readlane_b32 s43, v2, 2
    s_nop 3
    s_add_u32 s42, s42, s43
    v_readlane_b32 s43, v2, 3
    s_nop 3
    s_add_u32 s42, s42, s43
    v_readlane_b32 s43, v2, 4
    s_nop 3
    s_add_u32 s42, s42, s43
    v_readlane_b32 s43, v2, 5
    s_nop 3
    s_add_u32 s42, s42, s43
    v_readlane_b32 s43, v2, 6
    s_nop 3
    s_add_u32 s42, s42, s43
    v_readlane_b32 s43, v2, 7
    s_nop 3
    s_add_u32 s42, s42, s43
    s_add_u32 s52, s52, 0x1000
    s_cmp_ge_u32 s52, 2147418112
    s_cbranch_scc1 L_fail
    s_cmp_lt_u32 s42, 256
    s_cbranch_scc1 L_ovf
    s_sub_u32 s42, s26, 32
    v_readlane_b32 s43, v2, 0
    s_nop 3
    s_max_u32 s43, s43, 32
    s_sub_u32 s43, s43, 32
    s_cmp_gt_u32 s25, 0
    s_cselect_b32 s43, s43, 0
    s_add_u32 s42, s42, s43
    v_readlane_b32 s43, v2, 1
    s_nop 3
    s_max_u32 s43, s43, 32
    s_sub_u32 s43, s43, 32
    s_cmp_gt_u32 s25, 1
    s_cselect_b32 s43, s43, 0
    s_add_u32 s42, s42, s43
    v_readlane_b32 s43, v2, 2
    s_nop 3
    s_max_u32 s43, s43, 32
    s_sub_u32 s43, s43, 32
    s_cmp_gt_u32 s25, 2
    s_cselect_b32 s43, s43, 0
    s_add_u32 s42, s42, s43
    v_readlane_b32 s43, v2, 3
    s_nop 3
    s_max_u32 s43, s43, 32
    s_sub_u32 s43, s43, 32
    s_cmp_gt_u32 s25, 3
    s_cselect_b32 s43, s43, 0
    s_add_u32 s42, s42, s43
    v_readlane_b32 s43, v2, 4
    s_nop 3
    s_max_u32 s43, s43, 32
    s_sub_u32 s43, s43, 32
    s_cmp_gt_u32 s25, 4
    s_cselect_b32 s43, s43, 0
    s_add_u32 s42, s42, s43
    v_readlane_b32 s43, v2, 5
    s_nop 3
    s_max_u32 s43, s43, 32
    s_sub_u32 s43, s43, 32
    s_cmp_gt_u32 s25, 5
    s_cselect_b32 s43, s43, 0
    s_add_u32 s42, s42, s43
    v_readlane_b32 s43, v2, 6
    s_nop 3
    s_max_u32 s43, s43, 32
    s_sub_u32 s43, s43, 32
    s_cmp_gt_u32 s25, 6
    s_cselect_b32 s43, s43, 0
    s_add_u32 s42, s42, s43
    v_readlane_b32 s43, v2, 7
    s_nop 3
    s_max_u32 s43, s43, 32
    s_sub_u32 s43, s43, 32
    s_cmp_gt_u32 s25, 7
    s_cselect_b32 s43, s43, 0
    s_add_u32 s42, s42, s43
    v_readlane_b32 s43, v2, 0
    s_nop 3
    s_min_u32 s43, s43, 32
    s_add_u32 s26, s43, s42
    s_mov_b32 s25, 0
    s_cmp_lt_u32 s26, 32
    s_cbranch_scc1 L_slot
    s_sub_u32 s42, s26, 32
    v_readlane_b32 s43, v2, 1
    s_nop 3
    s_min_u32 s43, s43, 32
    s_add_u32 s26, s43, s42
    s_mov_b32 s25, 1
    s_cmp_lt_u32 s26, 32
    s_cbranch_scc1 L_slot
    s_sub_u32 s42, s26, 32
    v_readlane_b32 s43, v2, 2
    s_nop 3
    s_min_u32 s43, s43, 32
    s_add_u32 s26, s43, s42
    s_mov_b32 s25, 2
    s_cmp_lt_u32 s26, 32
    s_cbranch_scc1 L_slot
    s_sub_u32 s42, s26, 32
    v_readlane_b32 s43, v2, 3
    s_nop 3
    s_min_u32 s43, s43, 32
    s_add_u32 s26, s43, s42
    s_mov_b32 s25, 3
    s_cmp_lt_u32 s26, 32
    s_cbranch_scc1 L_slot
    s_sub_u32 s42, s26, 32
    v_readlane_b32 s43, v2, 4
    s_nop 3
    s_min_u32 s43, s43, 32
    s_add_u32 s26, s43, s42
    s_mov_b32 s25, 4
    s_cmp_lt_u32 s26, 32
    s_cbranch_scc1 L_slot
    s_sub_u32 s42, s26, 32
    v_readlane_b32 s43, v2, 5
    s_nop 3
    s_min_u32 s43, s43, 32
    s_add_u32 s26, s43, s42
    s_mov_b32 s25, 5
    s_cmp_lt_u32 s26, 32
    s_cbranch_scc1 L_slot
    s_sub_u32 s42, s26, 32
    v_readlane_b32 s43, v2, 6
    s_nop 3
    s_min_u32 s43, s43, 32
    s_add_u32 s26, s43, s42
    s_mov_b32 s25, 6
    s_cmp_lt_u32 s26, 32
    s_cbranch_scc1 L_slot
    s_sub_u32 s42, s26, 32
    v_readlane_b32 s43, v2, 7
    s_nop 3
    s_min_u32 s43, s43, 32
    s_add_u32 s26, s43, s42
    s_mov_b32 s25, 7
    s_cmp_lt_u32 s26, 32
    s_cbranch_scc1 L_slot
    s_sub_u32 s42, s26, 32
    s_branch L_fail
L_slot:
    s_lshl_b32 s4, s25, 5
    s_add_u32 s4, s4, s26
    s_lshr_b32 s27, s25, 2
    s_and_b32 s42, s25, 3
    s_cmp_eq_u32 s42, 0
    s_cbranch_scc1 L_chain
    s_cmp_eq_u32 s42, 3
    s_cbranch_scc1 L_g3
    s_sub_u32 s42, s42, 1
    s_lshl_b32 s42, s42, 3
    s_cmp_lt_u32 s26, 16
    s_cbranch_scc0 L_g12
    s_add_u32 s26, s26, s42
    s_add_u32 s26, s26, s42
    s_branch L_qkv
L_g12:
    s_cmp_lt_u32 s26, 24
    s_cselect_b32 s43, 16, 24
    s_sub_u32 s43, s43, s42
    s_cmp_lt_u32 s26, 24
    s_cbranch_scc0 L_g12w
    s_sub_u32 s26, s26, s43
    s_branch L_att
L_g12w:
    s_sub_u32 s26, s26, s43
    s_branch L_w
L_g3:
    s_cmp_lt_u32 s26, 14
    s_cbranch_scc1 L_u
    s_sub_u32 s26, s26, 14
    s_cmp_lt_u32 s26, 8
    s_cbranch_scc1 L_d
    s_sub_u32 s26, s26, 8
    s_cmp_lt_u32 s26, 4
    s_cbranch_scc1 L_r1
    s_sub_u32 s26, s26, 4
    s_cmp_lt_u32 s26, 4
    s_cbranch_scc1 L_r2
    s_sub_u32 s26, s26, 4
    s_lshl_b32 s42, s27, 1
    s_add_u32 s26, s26, s42
    s_branch L_r0
L_fail:
    s_mov_b64 exec, -1
    v_mov_b32 v1, 60
    v_mov_b32 v2, 1
    s_mov_b64 exec, 1
    buffer_atomic_add v2, v1, s[12:15], 0 offen
L_done:
    s_and_b32 s42, s4, 127
    s_cmp_eq_u32 s42, 0
    s_cselect_b32 s43, 1, 0
    s_cmp_eq_u32 s42, 56
    s_cselect_b32 s43, 1, s43
    s_cmp_eq_u32 s42, 88
    s_cselect_b32 s43, 1, s43
    s_cmp_eq_u32 s4, 122
    s_cselect_b32 s43, 1, s43
    s_cmp_eq_u32 s4, 999
    s_cselect_b32 s43, 1, s43
    s_cmp_eq_u32 s24, 0
    s_cselect_b32 s43, s43, 0
    s_cmp_eq_u32 s43, 0
    s_cbranch_scc1 L_nowb
    buffer_wbl2 sc1
    s_waitcnt vmcnt(0)
L_nowb:
L_end:
    s_endpgm
    .p2align 6
L_r0:
    v_mov_b32 v100, v0
    v_mov_b32 v4, 0
    s_mov_b32 s52, 0
    v_mov_b32 v1, 0
    v_bfe_i32 v101, v100, 0, 1
    v_and_b32 v101, 16, v101
    v_xor_b32 v1, v1, v101
    v_bfe_i32 v101, v100, 1, 1
    v_and_b32 v101, 32, v101
    v_xor_b32 v1, v1, v101
    v_bfe_i32 v101, v100, 2, 1
    v_and_b32 v101, 64, v101
    v_xor_b32 v1, v1, v101
    v_bfe_i32 v101, v100, 3, 1
    v_and_b32 v101, 512, v101
    v_xor_b32 v1, v1, v101
    v_bfe_i32 v101, v100, 4, 1
    v_and_b32 v101, 4096, v101
    v_xor_b32 v1, v1, v101
    v_bfe_i32 v101, v100, 5, 1
    v_and_b32 v101, 8192, v101
    v_xor_b32 v1, v1, v101
    v_mov_b32 v2, 0
    v_bfe_i32 v101, v100, 0, 1
    v_and_b32 v101, 16, v101
    v_xor_b32 v2, v2, v101
    v_bfe_i32 v101, v100, 1, 1
    v_and_b32 v101, 32, v101
    v_xor_b32 v2, v2, v101
    v_bfe_i32 v101, v100, 2, 1
    v_and_b32 v101, 64, v101
    v_xor_b32 v2, v2, v101
    v_bfe_i32 v101, v100, 3, 1
    v_and_b32 v101, 512, v101
    v_xor_b32 v2, v2, v101
    v_bfe_i32 v101, v100, 4, 1
    v_and_b32 v101, 2048, v101
    v_xor_b32 v2, v2, v101
    v_bfe_i32 v101, v100, 5, 1
    v_and_b32 v101, 4096, v101
    v_xor_b32 v2, v2, v101
    v_mov_b32 v3, 0
    v_bfe_i32 v101, v100, 0, 1
    v_and_b32 v101, 1024, v101
    v_xor_b32 v3, v3, v101
    v_bfe_i32 v101, v100, 1, 1
    v_and_b32 v101, 2048, v101
    v_xor_b32 v3, v3, v101
    v_bfe_i32 v101, v100, 2, 1
    v_and_b32 v101, 4096, v101
    v_xor_b32 v3, v3, v101
    v_bfe_i32 v101, v100, 3, 1
    v_and_b32 v101, 8, v101
    v_xor_b32 v3, v3, v101
    v_bfe_i32 v101, v100, 4, 1
    v_and_b32 v101, 64, v101
    v_xor_b32 v3, v3, v101
    v_bfe_i32 v101, v100, 5, 1
    v_and_b32 v101, 128, v101
    v_xor_b32 v3, v3, v101
    v_and_b32 v9, 7, v100
    v_lshlrev_b32 v9, 5, v9
    s_lshl_b32 s42, s24, 3
    v_add_u32 v8, s42, v9
    s_lshl_b32 s42, s24, 13
    s_lshl_b32 s43, s26, 7
    s_add_u32 s31, s42, s43
    s_mov_b32 s30, s31
    s_lshl_b32 s36, s26, 13
    s_lshl_b32 s42, s24, 8
    s_add_u32 s36, s36, s42
    s_lshl_b32 s35, s26, 2
    s_add_u32 s35, s35, s24
    s_lshl_b32 s35, s35, 2
    s_add_u32 s32, s31, 247463936
    s_add_u32 s33, s31, 243269632
    s_lshl_b32 s35, 0, 15
    s_add_u32 s35, s35, 65536
    s_mul_i32 s44, s26, 1024
    s_add_u32 s35, s35, s44
    s_lshl_b32 s44, s24, 2
    s_add_u32 s35, s35, s44
    s_mov_b32 s16, s64
    s_mov_b32 s17, s65
    s_mov_b32 s18, 2097152
    s_mov_b32 s19, 0x00020000
    v_mov_b32 v7, 0
    s_mov_b64 exec, 1
    buffer_store_dword v7, v4, s[8:11], s35 offen sc1
    s_mov_b64 exec, -1
    s_mov_b32 s48, s30
    s_mov_b32 s49, s31
    s_mov_b32 s50, s32
    s_mov_b32 s51, s33
    s_mov_b32 s53, 98304
    s_mov_b32 s54, 0
    v_mov_b32 v96, 0
    v_mov_b32 v112, 0
    v_lshrrev_b32 v97, 2, v100
    v_and_b32 v97, 3, v97
    v_mul_u32_u24 v97, 1024, v97
    v_and_b32 v101, 3, v100
    v_lshl_add_u32 v97, v101, 2, v97
    s_waitcnt vmcnt(0)
    s_barrier
    s_cmp_lg_u32 s24, 0
    s_cbranch_scc1 L_na_1
    v_mov_b32 v126, 1
    v_mov_b32 v127, 4
    s_mov_b64 exec, 1
    buffer_atomic_add v126, v127, s[12:15], 0 offen
    s_mov_b64 exec, -1
L_na_1:
    s_mov_b32 s40, 1006632960
    s_mov_b32 s41, 925353388
    s_mov_b32 s38, 0xffff0000
    s_mov_b32 s39, 1124073472
    s_mov_b32 s28, 0
    s_mov_b32 s29, 1
    buffer_load_dwordx2 v[104:105], v3, s[16:19], s36 offen offset:0 nt
    buffer_load_dwordx2 v[106:107], v3, s[16:19], s36 offen offset:16 nt
    buffer_load_dwordx2 v[108:109], v3, s[16:19], s36 offen offset:32 nt
    buffer_load_dwordx2 v[110:111], v3, s[16:19], s36 offen offset:48 nt
    s_waitcnt vmcnt(0)
L_item_2:
L_ld_3:
    s_cmp_lg_u32 s28, 4
    s_cbranch_scc1 L_r0w_9
L_r0w_9:
    v_mov_b64 v[80:81], v[104:105]
    v_mov_b64 v[82:83], v[106:107]
    v_mov_b64 v[84:85], v[108:109]
    v_mov_b64 v[86:87], v[110:111]
    s_cmp_lt_u32 s29, 64
    s_cselect_b32 s42, 32768, 0
    s_add_u32 s36, s36, s42
    buffer_load_dwordx2 v[104:105], v3, s[16:19], s36 offen offset:0 nt
    buffer_load_dwordx2 v[106:107], v3, s[16:19], s36 offen offset:16 nt
    buffer_load_dwordx2 v[108:109], v3, s[16:19], s36 offen offset:32 nt
    buffer_load_dwordx2 v[110:111], v3, s[16:19], s36 offen offset:48 nt
    v_lshlrev_b32 v16, 16, v80
    v_and_b32 v17, s38, v80
    v_lshlrev_b32 v18, 16, v81
    v_and_b32 v19, s38, v81
    v_lshlrev_b32 v20, 16, v82
    v_and_b32 v21, s38, v82
    v_lshlrev_b32 v22, 16, v83
    v_and_b32 v23, s38, v83
    v_lshlrev_b32 v24, 16, v84
    v_and_b32 v25, s38, v84
    v_lshlrev_b32 v26, 16, v85
    v_and_b32 v27, s38, v85
    v_lshlrev_b32 v28, 16, v86
    v_and_b32 v29, s38, v86
    v_lshlrev_b32 v30, 16, v87
    v_and_b32 v31, s38, v87
    v_pk_add_f32 v[118:119], v[16:17], v[24:25]
    v_pk_add_f32 v[120:121], v[18:19], v[26:27]
    v_pk_add_f32 v[122:123], v[20:21], v[28:29]
    v_pk_add_f32 v[124:125], v[22:23], v[30:31]
    v_pk_add_f32 v[118:119], v[118:119], v[122:123]
    v_pk_add_f32 v[120:121], v[120:121], v[124:125]
    v_pk_add_f32 v[118:119], v[118:119], v[120:121]
    v_add_f32 v10, v118, v119
    s_nop 1
    v_add_f32_dpp v10, v10, v10 row_ror:8 row_mask:0xf bank_mask:0xf
    v_mov_b32 v11, v10
    s_nop 1
    v_permlane16_swap_b32 v10, v11
    v_add_f32 v12, v10, v11
    v_add_f32 v13, v10, v11
    s_nop 1
    v_permlane32_swap_b32 v12, v13
    v_add_f32 v10, v12, v13
    v_mul_f32 v14, s40, v10
    v_pk_add_f32 v[32:33], v[16:17], v[14:15] op_sel_hi:[1,0] neg_lo:[0,1] neg_hi:[0,1]
    v_pk_add_f32 v[34:35], v[18:19], v[14:15] op_sel_hi:[1,0] neg_lo:[0,1] neg_hi:[0,1]
    v_pk_add_f32 v[36:37], v[20:21], v[14:15] op_sel_hi:[1,0] neg_lo:[0,1] neg_hi:[0,1]
    v_pk_add_f32 v[38:39], v[22:23], v[14:15] op_sel_hi:[1,0] neg_lo:[0,1] neg_hi:[0,1]
    v_pk_add_f32 v[40:41], v[24:25], v[14:15] op_sel_hi:[1,0] neg_lo:[0,1] neg_hi:[0,1]
    v_pk_add_f32 v[42:43], v[26:27], v[14:15] op_sel_hi:[1,0] neg_lo:[0,1] neg_hi:[0,1]
    v_pk_add_f32 v[44:45], v[28:29], v[14:15] op_sel_hi:[1,0] neg_lo:[0,1] neg_hi:[0,1]
    v_pk_add_f32 v[46:47], v[30:31], v[14:15] op_sel_hi:[1,0] neg_lo:[0,1] neg_hi:[0,1]
    v_pk_mul_f32 v[32:33], v[32:33], v[32:33]
    v_pk_mul_f32 v[34:35], v[34:35], v[34:35]
    v_pk_mul_f32 v[36:37], v[36:37], v[36:37]
    v_pk_mul_f32 v[38:39], v[38:39], v[38:39]
    v_pk_mul_f32 v[40:41], v[40:41], v[40:41]
    v_pk_mul_f32 v[42:43], v[42:43], v[42:43]
    v_pk_mul_f32 v[44:45], v[44:45], v[44:45]
    v_pk_mul_f32 v[46:47], v[46:47], v[46:47]
    v_pk_add_f32 v[118:119], v[32:33], v[40:41]
    v_pk_add_f32 v[120:121], v[34:35], v[42:43]
    v_pk_add_f32 v[122:123], v[36:37], v[44:45]
    v_pk_add_f32 v[124:125], v[38:39], v[46:47]
    v_pk_add_f32 v[118:119], v[118:119], v[122:123]
    v_pk_add_f32 v[120:121], v[120:121], v[124:125]
    v_pk_add_f32 v[118:119], v[118:119], v[120:121]
    v_add_f32 v10, v118, v119
    s_nop 1
    v_add_f32_dpp v10, v10, v10 row_ror:8 row_mask:0xf bank_mask:0xf
    v_mov_b32 v11, v10
    s_nop 1
    v_permlane16_swap_b32 v10, v11
    v_add_f32 v12, v10, v11
    v_add_f32 v13, v10, v11
    s_nop 1
    v_permlane32_swap_b32 v12, v13
    v_add_f32 v10, v12, v13
    v_mov_b32 v15, v10
    s_mov_b64 exec, 0xff
    ds_write_b64 v8, v[14:15]
    s_mov_b64 exec, -1
    s_waitcnt lgkmcnt(0)
    s_barrier
    ds_read_b128 v[118:121], v9
    ds_read_b128 v[122:125], v9 offset:16
    v_xor_b32 v8, 256, v8
    v_xor_b32 v9, 256, v9
    s_waitcnt lgkmcnt(0)
    v_add_f32 v10, v118, v120
    v_add_f32 v11, v122, v124
    v_add_f32 v12, v119, v121
    v_add_f32 v13, v123, v125
    v_add_f32 v10, v10, v11
    v_add_f32 v12, v12, v13
    v_mul_f32 v10, 1048576000, v10
    v_sub_f32 v118, v118, v10
    v_sub_f32 v120, v120, v10
    v_sub_f32 v122, v122, v10
    v_sub_f32 v124, v124, v10
    v_mul_f32 v118, v118, v118
    v_fmac_f32 v118, v120, v120
    v_fmac_f32 v118, v122, v122
    v_fmac_f32 v118, v124, v124
    v_fmac_f32 v12, s39, v118
    v_mov_b32 v13, s41
    v_fmac_f32 v13, 989855744, v12
    v_rsq_f32 v12, v13
    s_nop 0
    v_mul_f32 v10, v10, v12
    v_pk_fma_f32 v[16:17], v[16:17], v[12:13], v[10:11] op_sel_hi:[1,0,0] neg_lo:[0,0,1] neg_hi:[0,0,1]
    v_pk_fma_f32 v[18:19], v[18:19], v[12:13], v[10:11] op_sel_hi:[1,0,0] neg_lo:[0,0,1] neg_hi:[0,0,1]
    v_pk_fma_f32 v[20:21], v[20:21], v[12:13], v[10:11] op_sel_hi:[1,0,0] neg_lo:[0,0,1] neg_hi:[0,0,1]
    v_pk_fma_f32 v[22:23], v[22:23], v[12:13], v[10:11] op_sel_hi:[1,0,0] neg_lo:[0,0,1] neg_hi:[0,0,1]
    v_pk_fma_f32 v[24:25], v[24:25], v[12:13], v[10:11] op_sel_hi:[1,0,0] neg_lo:[0,0,1] neg_hi:[0,0,1]
    v_pk_fma_f32 v[26:27], v[26:27], v[12:13], v[10:11] op_sel_hi:[1,0,0] neg_lo:[0,0,1] neg_hi:[0,0,1]
    v_pk_fma_f32 v[28:29], v[28:29], v[12:13], v[10:11] op_sel_hi:[1,0,0] neg_lo:[0,0,1] neg_hi:[0,0,1]
    v_pk_fma_f32 v[30:31], v[30:31], v[12:13], v[10:11] op_sel_hi:[1,0,0] neg_lo:[0,0,1] neg_hi:[0,0,1]
    v_cvt_pk_bf16_f32 v88, v16, v17
    v_cvt_pk_bf16_f32 v89, v18, v19
    v_cvt_pk_bf16_f32 v90, v20, v21
    v_cvt_pk_bf16_f32 v91, v22, v23
    v_cvt_pk_bf16_f32 v92, v24, v25
    v_cvt_pk_bf16_f32 v93, v26, v27
    v_cvt_pk_bf16_f32 v94, v28, v29
    v_cvt_pk_bf16_f32 v95, v30, v31
    v_lshrrev_b32 v10, 16, v16
    v_or_b32 v10, 1, v10
    v_and_or_b32 v88, v88, s38, v10
    v_lshrrev_b32 v10, 16, v24
    v_or_b32 v10, 1, v10
    v_and_or_b32 v92, v92, s38, v10
    s_add_u32 s28, s28, 1
    s_add_u32 s29, s29, 1
    buffer_store_dwordx4 v[88:91], v2, s[8:11], s33 offen offset:0 sc1
    buffer_store_dwordx4 v[92:95], v2, s[8:11], s33 offen offset:1024 sc1
    buffer_store_dwordx4 v[80:83], v2, s[8:11], s32 offen offset:0 sc1
    buffer_store_dwordx4 v[84:87], v2, s[8:11], s32 offen offset:1024 sc1
    s_sub_u32 s54, s29, 64
    s_max_i32 s54, s54, 0
    s_and_b32 s42, s28, 63
    s_mul_i32 s32, s42, 32768
    s_add_u32 s32, s32, s50
    s_mul_i32 s33, s42, 32768
    s_add_u32 s33, s33, s51
    s_waitcnt vmcnt(0)
    v_mov_b32 v7, s28
    s_mov_b64 exec, 1
    buffer_store_dword v7, v4, s[8:11], s35 offen sc1
    s_mov_b64 exec, -1
    s_cmp_eq_u32 s28, 64
    s_cbranch_scc1 L_fin_4
    s_branch L_item_2
L_fin_4:
    s_branch L_done
    .p2align 6
L_r1:
    v_mov_b32 v100, v0
    v_mov_b32 v4, 0
    s_mov_b32 s52, 0
    v_mov_b32 v1, 0
    v_bfe_i32 v101, v100, 0, 1
    v_and_b32 v101, 16, v101
    v_xor_b32 v1, v1, v101
    v_bfe_i32 v101, v100, 1, 1
    v_and_b32 v101, 32, v101
    v_xor_b32 v1, v1, v101
    v_bfe_i32 v101, v100, 2, 1
    v_and_b32 v101, 64, v101
    v_xor_b32 v1, v1, v101
    v_bfe_i32 v101, v100, 3, 1
    v_and_b32 v101, 512, v101
    v_xor_b32 v1, v1, v101
    v_bfe_i32 v101, v100, 4, 1
    v_and_b32 v101, 4096, v101
    v_xor_b32 v1, v1, v101
    v_bfe_i32 v101, v100, 5, 1
    v_and_b32 v101, 8192, v101
    v_xor_b32 v1, v1, v101
    v_mov_b32 v2, 0
    v_bfe_i32 v101, v100, 0, 1
    v_and_b32 v101, 16, v101
    v_xor_b32 v2, v2, v101
    v_bfe_i32 v101, v100, 1, 1
    v_and_b32 v101, 32, v101
    v_xor_b32 v2, v2, v101
    v_bfe_i32 v101, v100, 2, 1
    v_and_b32 v101, 64, v101
    v_xor_b32 v2, v2, v101
    v_bfe_i32 v101, v100, 3, 1
    v_and_b32 v101, 512, v101
    v_xor_b32 v2, v2, v101
    v_bfe_i32 v101, v100, 4, 1
    v_and_b32 v101, 2048, v101
    v_xor_b32 v2, v2, v101
    v_bfe_i32 v101, v100, 5, 1
    v_and_b32 v101, 4096, v101
    v_xor_b32 v2, v2, v101
    v_mov_b32 v3, 0
    v_bfe_i32 v101, v100, 0, 1
    v_and_b32 v101, 1024, v101
    v_xor_b32 v3, v3, v101
    v_bfe_i32 v101, v100, 1, 1
    v_and_b32 v101, 2048, v101
    v_xor_b32 v3, v3, v101
    v_bfe_i32 v101, v100, 2, 1
    v_and_b32 v101, 4096, v101
    v_xor_b32 v3, v3, v101
    v_bfe_i32 v101, v100, 3, 1
    v_and_b32 v101, 8, v101
    v_xor_b32 v3, v3, v101
    v_bfe_i32 v101, v100, 4, 1
    v_and_b32 v101, 64, v101
    v_xor_b32 v3, v3, v101
    v_bfe_i32 v101, v100, 5, 1
    v_and_b32 v101, 128, v101
    v_xor_b32 v3, v3, v101
    v_and_b32 v9, 7, v100
    v_lshlrev_b32 v9, 5, v9
    s_lshl_b32 s42, s24, 3
    v_add_u32 v8, s42, v9
    s_lshl_b32 s42, s24, 13
    s_lshl_b32 s43, s26, 7
    s_add_u32 s31, s42, s43
    s_mov_b32 s30, s31
    s_lshl_b32 s36, s26, 13
    s_lshl_b32 s42, s24, 8
    s_add_u32 s36, s36, s42
    s_lshl_b32 s35, s26, 2
    s_add_u32 s35, s35, s24
    s_lshl_b32 s35, s35, 2
    s_lshl_b32 s43, s27, 21
    s_add_u32 s31, s31, s43
    s_add_u32 s32, s31, 251658240
    s_add_u32 s33, s31, 255852544
    s_add_u32 s31, s31, 247463936
    s_lshl_b32 s43, s27, 23
    s_add_u32 s30, s30, s43
    s_add_u32 s30, s30, 176160768
    s_lshl_b32 s43, s27, 8
    s_lshl_b32 s34, s27, 15
    s_add_u32 s34, s34, 163840
    s_lshl_b32 s35, s27, 15
    s_add_u32 s35, s35, 229376
    s_mul_i32 s44, s26, 128
    s_add_u32 s35, s35, s44
    s_lshl_b32 s44, s24, 2
    s_add_u32 s35, s35, s44
    v_lshrrev_b32 v5, 2, v100
    v_and_b32 v5, 15, v5
    v_mul_u32_u24 v5, 1024, v5
    v_and_b32 v101, 3, v100
    v_lshl_add_u32 v5, v101, 2, v5
    v_mov_b32 v7, 0
    s_mov_b64 exec, 1
    buffer_store_dword v7, v4, s[8:11], s35 offen sc1
    s_mov_b64 exec, -1
    s_mov_b32 s48, s30
    s_mov_b32 s49, s31
    s_mov_b32 s50, s32
    s_mov_b32 s51, s33
    s_mov_b32 s53, 98304
    s_mov_b32 s54, 0
    v_mov_b32 v96, 0
    v_mov_b32 v112, 0
    v_lshrrev_b32 v97, 2, v100
    v_and_b32 v97, 3, v97
    v_mul_u32_u24 v97, 1024, v97
    v_and_b32 v101, 3, v100
    v_lshl_add_u32 v97, v101, 2, v97
    s_waitcnt vmcnt(0)
    s_barrier
    s_cmp_lg_u32 s24, 0
    s_cbranch_scc1 L_na_10
    v_mov_b32 v126, 1
    v_mov_b32 v127, 4
    s_mov_b64 exec, 1
    buffer_atomic_add v126, v127, s[12:15], 0 offen
    s_mov_b64 exec, -1
L_na_10:
    s_cmp_eq_u32 s27, 0
    s_cselect_b32 s99, 0, 64
    v_mov_b32 v126, 132
    s_cmp_eq_u32 s99, 0
    s_cbranch_scc1 L_gate_11_ok
L_gate_11:
    s_sleep 8
    buffer_load_dword v127, v126, s[12:15], 0 offen sc1
    s_add_u32 s52, s52, 0x1000
    s_cmp_ge_u32 s52, 2147418112
    s_cbranch_scc1 L_fail
    s_waitcnt vmcnt(0)
    v_cmp_gt_u32 vcc, s99, v127
    s_cbranch_vccnz L_gate_11
L_gate_11_ok:
    v_mov_b64 v[16:17], 0
    v_mov_b64 v[18:19], 0
    s_mov_b32 s44, s33
    s_mov_b32 s45, 8
L_clr_12:
    buffer_store_dwordx4 v[16:19], v2, s[8:11], s44 offen sc1
    buffer_store_dwordx4 v[16:19], v2, s[8:11], s44 offen offset:1024 sc1
    s_add_u32 s44, s44, 32768
    s_sub_u32 s45, s45, 1
    s_cmp_lg_u32 s45, 0
    s_cbranch_scc1 L_clr_12
    s_waitcnt vmcnt(0)
L_clr_12_e:
    s_mov_b32 s42, s32
    s_mov_b32 s99, 8
L_warm_13:
    buffer_load_dwordx4 v[16:19], v2, s[8:11], s42 offen offset:0 sc1
    buffer_load_dwordx4 v[20:23], v2, s[8:11], s42 offen offset:1024 sc1
    s_add_u32 s42, s42, 32768
    s_sub_u32 s99, s99, 1
    s_cmp_lg_u32 s99, 0
    s_cbranch_scc1 L_warm_13
    s_waitcnt vmcnt(0)
    s_mov_b32 s42, s33
    s_mov_b32 s99, 8
L_warm_14:
    buffer_load_dwordx4 v[16:19], v2, s[8:11], s42 offen offset:0 sc1
    buffer_load_dwordx4 v[20:23], v2, s[8:11], s42 offen offset:1024 sc1
    s_add_u32 s42, s42, 32768
    s_sub_u32 s99, s99, 1
    s_cmp_lg_u32 s99, 0
    s_cbranch_scc1 L_warm_14
    s_waitcnt vmcnt(0)
    v_mbcnt_lo_u32_b32 v126, -1, 0
    v_mbcnt_hi_u32_b32 v126, -1, v126
    v_lshlrev_b32 v126, 5, v126
    v_cmp_gt_u32 vcc, 256, v126
    s_nop 1
    v_cndmask_b32 v126, 4, v126, vcc
    buffer_load_dword v127, v126, s[12:15], 0 offen sc1
    s_waitcnt vmcnt(0)
    v_readlane_b32 s98, v127, 8
    v_cmp_ne_u32 vcc, 32, v127
    s_nop 3
    s_and_b32 s5, vcc_lo, 0xff
    s_cmp_lt_u32 s98, 256
    s_cselect_b32 s98, 1, s5
    s_cmp_eq_u32 s98, 0
    s_cbranch_scc1 L_gw_15_done
L_gw_15:
    buffer_load_dword v127, v126, s[12:15], 0 offen sc1
    s_add_u32 s52, s52, 0x1000
    s_cmp_ge_u32 s52, 2147418112
    s_cbranch_scc1 L_fail
    s_waitcnt vmcnt(0)
    v_readlane_b32 s98, v127, 8
    s_nop 3
    s_cmp_ge_u32 s98, 256
    s_cbranch_scc1 L_gw_15_ok
    s_sleep 4
    s_branch L_gw_15
L_gw_15_ok:
    buffer_load_dword v127, v126, s[12:15], 0 offen sc1
    s_waitcnt vmcnt(0)
    v_cmp_ne_u32 vcc, 32, v127
    s_nop 3
    s_and_b32 s5, vcc_lo, 0xff
L_gw_15_done:
    s_mov_b32 s40, 1006632960
    s_mov_b32 s41, 925353388
    s_mov_b32 s38, 0xffff0000
    s_mov_b32 s39, 1124073472
    s_mov_b32 s28, 0
    s_mov_b32 s29, 1
    s_cmp_lg_u32 s5, 0
    s_cbranch_scc1 L_nonlocal_16
L_item_17:
L_poll_24:
    buffer_load_dword v6, v5, s[8:11], s34 offen sc1
    s_waitcnt vmcnt(0)
    v_cmp_gt_u32 vcc, s29, v6
    s_add_u32 s52, s52, 0x1000
    s_cmp_lt_u32 s52, 2147418112
    s_cbranch_vccz L_poll_24_ok
    s_cbranch_scc1 L_poll_24
    s_branch L_fail
L_poll_24_ok:
L_ld_18:
    buffer_load_dwordx4 v[104:107], v2, s[8:11], s31 offen offset:0 sc1
    buffer_load_dwordx4 v[108:111], v2, s[8:11], s31 offen offset:1024 sc1
    s_add_u32 s44, s30, 0
    buffer_load_dwordx4 v[48:51], v2, s[8:11], s44 offen offset:0 sc1
    buffer_load_dwordx4 v[52:55], v2, s[8:11], s44 offen offset:1024 sc1
    s_add_u32 s45, s30, 32768
    buffer_load_dwordx4 v[56:59], v2, s[8:11], s45 offen offset:0 sc1
    buffer_load_dwordx4 v[60:63], v2, s[8:11], s45 offen offset:1024 sc1
    s_add_u32 s46, s30, 65536
    buffer_load_dwordx4 v[64:67], v2, s[8:11], s46 offen offset:0 sc1
    buffer_load_dwordx4 v[68:71], v2, s[8:11], s46 offen offset:1024 sc1
    s_add_u32 s47, s30, 98304
    buffer_load_dwordx4 v[72:75], v2, s[8:11], s47 offen offset:0 sc1
    buffer_load_dwordx4 v[76:79], v2, s[8:11], s47 offen offset:1024 sc1
    s_bfe_u32 s55, s28, 65539
    s_waitcnt vmcnt(8)
    v_lshlrev_b32 v16, 16, v104
    v_and_b32 v17, s38, v104
    v_lshlrev_b32 v18, 16, v105
    v_and_b32 v19, s38, v105
    v_lshlrev_b32 v20, 16, v106
    v_and_b32 v21, s38, v106
    v_lshlrev_b32 v22, 16, v107
    v_and_b32 v23, s38, v107
    v_lshlrev_b32 v24, 16, v108
    v_and_b32 v25, s38, v108
    v_lshlrev_b32 v26, 16, v109
    v_and_b32 v27, s38, v109
    v_lshlrev_b32 v28, 16, v110
    v_and_b32 v29, s38, v110
    v_lshlrev_b32 v30, 16, v111
    v_and_b32 v31, s38, v111
    s_waitcnt vmcnt(6)
    v_bitop3_b32 v10, v48, v52, s55 bitop3:66
    v_lshlrev_b32 v32, 16, v48
    v_and_b32 v33, s38, v48
    v_lshlrev_b32 v34, 16, v49
    v_and_b32 v35, s38, v49
    v_lshlrev_b32 v36, 16, v50
    v_and_b32 v37, s38, v50
    v_lshlrev_b32 v38, 16, v51
    v_and_b32 v39, s38, v51
    v_lshlrev_b32 v40, 16, v52
    v_and_b32 v41, s38, v52
    v_lshlrev_b32 v42, 16, v53
    v_and_b32 v43, s38, v53
    v_lshlrev_b32 v44, 16, v54
    v_and_b32 v45, s38, v54
    v_lshlrev_b32 v46, 16, v55
    v_and_b32 v47, s38, v55
    v_pk_add_f32 v[16:17], v[16:17], v[32:33]
    v_pk_add_f32 v[18:19], v[18:19], v[34:35]
    v_pk_add_f32 v[20:21], v[20:21], v[36:37]
    v_pk_add_f32 v[22:23], v[22:23], v[38:39]
    v_pk_add_f32 v[24:25], v[24:25], v[40:41]
    v_pk_add_f32 v[26:27], v[26:27], v[42:43]
    v_pk_add_f32 v[28:29], v[28:29], v[44:45]
    v_pk_add_f32 v[30:31], v[30:31], v[46:47]
    s_waitcnt vmcnt(4)
    v_bitop3_b32 v10, v10, v56, s55 bitop3:96
    v_bitop3_b32 v10, v10, v60, s55 bitop3:96
    v_lshlrev_b32 v32, 16, v56
    v_and_b32 v33, s38, v56
    v_lshlrev_b32 v34, 16, v57
    v_and_b32 v35, s38, v57
    v_lshlrev_b32 v36, 16, v58
    v_and_b32 v37, s38, v58
    v_lshlrev_b32 v38, 16, v59
    v_and_b32 v39, s38, v59
    v_lshlrev_b32 v40, 16, v60
    v_and_b32 v41, s38, v60
    v_lshlrev_b32 v42, 16, v61
    v_and_b32 v43, s38, v61
    v_lshlrev_b32 v44, 16, v62
    v_and_b32 v45, s38, v62
    v_lshlrev_b32 v46, 16, v63
    v_and_b32 v47, s38, v63
    v_pk_add_f32 v[16:17], v[16:17], v[32:33]
    v_pk_add_f32 v[18:19], v[18:19], v[34:35]
    v_pk_add_f32 v[20:21], v[20:21], v[36:37]
    v_pk_add_f32 v[22:23], v[22:23], v[38:39]
    v_pk_add_f32 v[24:25], v[24:25], v[40:41]
    v_pk_add_f32 v[26:27], v[26:27], v[42:43]
    v_pk_add_f32 v[28:29], v[28:29], v[44:45]
    v_pk_add_f32 v[30:31], v[30:31], v[46:47]
    s_waitcnt vmcnt(2)
    v_bitop3_b32 v10, v10, v64, s55 bitop3:96
    v_bitop3_b32 v10, v10, v68, s55 bitop3:96
    v_lshlrev_b32 v32, 16, v64
    v_and_b32 v33, s38, v64
    v_lshlrev_b32 v34, 16, v65
    v_and_b32 v35, s38, v65
    v_lshlrev_b32 v36, 16, v66
    v_and_b32 v37, s38, v66
    v_lshlrev_b32 v38, 16, v67
    v_and_b32 v39, s38, v67
    v_lshlrev_b32 v40, 16, v68
    v_and_b32 v41, s38, v68
    v_lshlrev_b32 v42, 16, v69
    v_and_b32 v43, s38, v69
    v_lshlrev_b32 v44, 16, v70
    v_and_b32 v45, s38, v70
    v_lshlrev_b32 v46, 16, v71
    v_and_b32 v47, s38, v71
    v_pk_add_f32 v[16:17], v[16:17], v[32:33]
    v_pk_add_f32 v[18:19], v[18:19], v[34:35]
    v_pk_add_f32 v[20:21], v[20:21], v[36:37]
    v_pk_add_f32 v[22:23], v[22:23], v[38:39]
    v_pk_add_f32 v[24:25], v[24:25], v[40:41]
    v_pk_add_f32 v[26:27], v[26:27], v[42:43]
    v_pk_add_f32 v[28:29], v[28:29], v[44:45]
    v_pk_add_f32 v[30:31], v[30:31], v[46:47]
    s_waitcnt vmcnt(0)
    v_bitop3_b32 v10, v10, v72, s55 bitop3:96
    v_bitop3_b32 v10, v10, v76, s55 bitop3:96
    v_and_b32 v10, 1, v10
    v_cmp_eq_u32 vcc, 0, v10
    v_lshlrev_b32 v32, 16, v72
    v_and_b32 v33, s38, v72
    v_lshlrev_b32 v34, 16, v73
    v_and_b32 v35, s38, v73
    v_lshlrev_b32 v36, 16, v74
    v_and_b32 v37, s38, v74
    v_lshlrev_b32 v38, 16, v75
    v_and_b32 v39, s38, v75
    v_lshlrev_b32 v40, 16, v76
    v_and_b32 v41, s38, v76
    v_lshlrev_b32 v42, 16, v77
    v_and_b32 v43, s38, v77
    v_lshlrev_b32 v44, 16, v78
    v_and_b32 v45, s38, v78
    v_lshlrev_b32 v46, 16, v79
    v_and_b32 v47, s38, v79
    v_pk_add_f32 v[16:17], v[16:17], v[32:33]
    v_pk_add_f32 v[18:19], v[18:19], v[34:35]
    v_pk_add_f32 v[20:21], v[20:21], v[36:37]
    v_pk_add_f32 v[22:23], v[22:23], v[38:39]
    v_pk_add_f32 v[24:25], v[24:25], v[40:41]
    v_pk_add_f32 v[26:27], v[26:27], v[42:43]
    v_pk_add_f32 v[28:29], v[28:29], v[44:45]
    v_pk_add_f32 v[30:31], v[30:31], v[46:47]
L_join_21:
    s_cbranch_vccnz L_retry_22
L_retry_22_skip:
    buffer_load_dword v6, v5, s[8:11], s34 offen sc1
    v_cvt_pk_bf16_f32 v80, v16, v17
    v_cvt_pk_bf16_f32 v81, v18, v19
    v_cvt_pk_bf16_f32 v82, v20, v21
    v_cvt_pk_bf16_f32 v83, v22, v23
    v_cvt_pk_bf16_f32 v84, v24, v25
    v_cvt_pk_bf16_f32 v85, v26, v27
    v_cvt_pk_bf16_f32 v86, v28, v29
    v_cvt_pk_bf16_f32 v87, v30, v31
    buffer_store_dwordx4 v[80:83], v2, s[8:11], s32 offen offset:0
    buffer_store_dwordx4 v[84:87], v2, s[8:11], s32 offen offset:1024
    v_lshlrev_b32 v16, 16, v80
    v_and_b32 v17, s38, v80
    v_lshlrev_b32 v18, 16, v81
    v_and_b32 v19, s38, v81
    v_lshlrev_b32 v20, 16, v82
    v_and_b32 v21, s38, v82
    v_lshlrev_b32 v22, 16, v83
    v_and_b32 v23, s38, v83
    v_lshlrev_b32 v24, 16, v84
    v_and_b32 v25, s38, v84
    v_lshlrev_b32 v26, 16, v85
    v_and_b32 v27, s38, v85
    v_lshlrev_b32 v28, 16, v86
    v_and_b32 v29, s38, v86
    v_lshlrev_b32 v30, 16, v87
    v_and_b32 v31, s38, v87
    v_pk_add_f32 v[118:119], v[16:17], v[24:25]
    v_pk_add_f32 v[120:121], v[18:19], v[26:27]
    v_pk_add_f32 v[122:123], v[20:21], v[28:29]
    v_pk_add_f32 v[124:125], v[22:23], v[30:31]
    v_pk_add_f32 v[118:119], v[118:119], v[122:123]
    v_pk_add_f32 v[120:121], v[120:121], v[124:125]
    v_pk_add_f32 v[118:119], v[118:119], v[120:121]
    v_add_f32 v10, v118, v119
    s_nop 1
    v_add_f32_dpp v10, v10, v10 row_ror:8 row_mask:0xf bank_mask:0xf
    v_mov_b32 v11, v10
    s_nop 1
    v_permlane16_swap_b32 v10, v11
    v_add_f32 v12, v10, v11
    v_add_f32 v13, v10, v11
    s_nop 1
    v_permlane32_swap_b32 v12, v13
    v_add_f32 v10, v12, v13
    v_mul_f32 v14, s40, v10
    v_pk_add_f32 v[32:33], v[16:17], v[14:15] op_sel_hi:[1,0] neg_lo:[0,1] neg_hi:[0,1]
    v_pk_add_f32 v[34:35], v[18:19], v[14:15] op_sel_hi:[1,0] neg_lo:[0,1] neg_hi:[0,1]
    v_pk_add_f32 v[36:37], v[20:21], v[14:15] op_sel_hi:[1,0] neg_lo:[0,1] neg_hi:[0,1]
    v_pk_add_f32 v[38:39], v[22:23], v[14:15] op_sel_hi:[1,0] neg_lo:[0,1] neg_hi:[0,1]
    v_pk_add_f32 v[40:41], v[24:25], v[14:15] op_sel_hi:[1,0] neg_lo:[0,1] neg_hi:[0,1]
    v_pk_add_f32 v[42:43], v[26:27], v[14:15] op_sel_hi:[1,0] neg_lo:[0,1] neg_hi:[0,1]
    v_pk_add_f32 v[44:45], v[28:29], v[14:15] op_sel_hi:[1,0] neg_lo:[0,1] neg_hi:[0,1]
    v_pk_add_f32 v[46:47], v[30:31], v[14:15] op_sel_hi:[1,0] neg_lo:[0,1] neg_hi:[0,1]
    v_pk_mul_f32 v[32:33], v[32:33], v[32:33]
    v_pk_mul_f32 v[34:35], v[34:35], v[34:35]
    v_pk_mul_f32 v[36:37], v[36:37], v[36:37]
    v_pk_mul_f32 v[38:39], v[38:39], v[38:39]
    v_pk_mul_f32 v[40:41], v[40:41], v[40:41]
    v_pk_mul_f32 v[42:43], v[42:43], v[42:43]
    v_pk_mul_f32 v[44:45], v[44:45], v[44:45]
    v_pk_mul_f32 v[46:47], v[46:47], v[46:47]
    v_pk_add_f32 v[118:119], v[32:33], v[40:41]
    v_pk_add_f32 v[120:121], v[34:35], v[42:43]
    v_pk_add_f32 v[122:123], v[36:37], v[44:45]
    v_pk_add_f32 v[124:125], v[38:39], v[46:47]
    v_pk_add_f32 v[118:119], v[118:119], v[122:123]
    v_pk_add_f32 v[120:121], v[120:121], v[124:125]
    v_pk_add_f32 v[118:119], v[118:119], v[120:121]
    v_add_f32 v10, v118, v119
    s_nop 1
    v_add_f32_dpp v10, v10, v10 row_ror:8 row_mask:0xf bank_mask:0xf
    v_mov_b32 v11, v10
    s_nop 1
    v_permlane16_swap_b32 v10, v11
    v_add_f32 v12, v10, v11
    v_add_f32 v13, v10, v11
    s_nop 1
    v_permlane32_swap_b32 v12, v13
    v_add_f32 v10, v12, v13
    v_mov_b32 v15, v10
    s_mov_b64 exec, 0xff
    ds_write_b64 v8, v[14:15]
    s_mov_b64 exec, -1
    s_waitcnt lgkmcnt(0)
    s_barrier
    ds_read_b128 v[118:121], v9
    ds_read_b128 v[122:125], v9 offset:16
    v_xor_b32 v8, 256, v8
    v_xor_b32 v9, 256, v9
    s_waitcnt lgkmcnt(0)
    v_add_f32 v10, v118, v120
    v_add_f32 v11, v122, v124
    v_add_f32 v12, v119, v121
    v_add_f32 v13, v123, v125
    v_add_f32 v10, v10, v11
    v_add_f32 v12, v12, v13
    v_mul_f32 v10, 1048576000, v10
    v_sub_f32 v118, v118, v10
    v_sub_f32 v120, v120, v10
    v_sub_f32 v122, v122, v10
    v_sub_f32 v124, v124, v10
    v_mul_f32 v118, v118, v118
    v_fmac_f32 v118, v120, v120
    v_fmac_f32 v118, v122, v122
    v_fmac_f32 v118, v124, v124
    v_fmac_f32 v12, s39, v118
    v_mov_b32 v13, s41
    v_fmac_f32 v13, 989855744, v12
    v_rsq_f32 v12, v13
    s_nop 0
    v_mul_f32 v10, v10, v12
    v_pk_fma_f32 v[16:17], v[16:17], v[12:13], v[10:11] op_sel_hi:[1,0,0] neg_lo:[0,0,1] neg_hi:[0,0,1]
    v_pk_fma_f32 v[18:19], v[18:19], v[12:13], v[10:11] op_sel_hi:[1,0,0] neg_lo:[0,0,1] neg_hi:[0,0,1]
    v_pk_fma_f32 v[20:21], v[20:21], v[12:13], v[10:11] op_sel_hi:[1,0,0] neg_lo:[0,0,1] neg_hi:[0,0,1]
    v_pk_fma_f32 v[22:23], v[22:23], v[12:13], v[10:11] op_sel_hi:[1,0,0] neg_lo:[0,0,1] neg_hi:[0,0,1]
    v_pk_fma_f32 v[24:25], v[24:25], v[12:13], v[10:11] op_sel_hi:[1,0,0] neg_lo:[0,0,1] neg_hi:[0,0,1]
    v_pk_fma_f32 v[26:27], v[26:27], v[12:13], v[10:11] op_sel_hi:[1,0,0] neg_lo:[0,0,1] neg_hi:[0,0,1]
    v_pk_fma_f32 v[28:29], v[28:29], v[12:13], v[10:11] op_sel_hi:[1,0,0] neg_lo:[0,0,1] neg_hi:[0,0,1]
    v_pk_fma_f32 v[30:31], v[30:31], v[12:13], v[10:11] op_sel_hi:[1,0,0] neg_lo:[0,0,1] neg_hi:[0,0,1]
    v_cvt_pk_bf16_f32 v88, v16, v17
    v_cvt_pk_bf16_f32 v89, v18, v19
    v_cvt_pk_bf16_f32 v90, v20, v21
    v_cvt_pk_bf16_f32 v91, v22, v23
    v_cvt_pk_bf16_f32 v92, v24, v25
    v_cvt_pk_bf16_f32 v93, v26, v27
    v_cvt_pk_bf16_f32 v94, v28, v29
    v_cvt_pk_bf16_f32 v95, v30, v31
    s_bfe_u32 s55, s28, 65539
    s_xor_b32 s55, s55, 1
    s_xor_b32 s44, s55, 1
    s_lshl_b32 s44, s44, 16
    v_add_u32 v10, s44, v16
    v_lshrrev_b32 v10, 16, v10
    v_and_or_b32 v10, v10, -2, s55
    v_and_or_b32 v88, v88, s38, v10
    s_xor_b32 s44, s55, 1
    s_lshl_b32 s44, s44, 16
    v_add_u32 v10, s44, v24
    v_lshrrev_b32 v10, 16, v10
    v_and_or_b32 v10, v10, -2, s55
    v_and_or_b32 v92, v92, s38, v10
    s_add_u32 s28, s28, 1
    s_add_u32 s29, s29, 1
    s_and_b32 s42, s28, 7
    s_mul_i32 s30, s42, 131072
    s_add_u32 s30, s30, s48
    s_and_b32 s42, s28, 63
    s_mul_i32 s31, s42, 32768
    s_add_u32 s31, s31, s49
    s_waitcnt vmcnt(0)
    v_cmp_gt_u32 vcc, s29, v6
    s_cbranch_vccnz L_notready_23
    buffer_store_dwordx4 v[88:91], v2, s[8:11], s33 offen offset:0
    buffer_store_dwordx4 v[92:95], v2, s[8:11], s33 offen offset:1024
    v_mov_b32 v7, s28
    s_mov_b64 exec, 1
    buffer_store_dword v7, v4, s[8:11], s35 offen
    s_mov_b64 exec, -1
    buffer_load_dwordx4 v[104:107], v2, s[8:11], s31 offen offset:0 sc1
    buffer_load_dwordx4 v[108:111], v2, s[8:11], s31 offen offset:1024 sc1
    s_add_u32 s44, s30, 0
    buffer_load_dwordx4 v[48:51], v2, s[8:11], s44 offen offset:0 sc1
    buffer_load_dwordx4 v[52:55], v2, s[8:11], s44 offen offset:1024 sc1
    s_add_u32 s45, s30, 32768
    buffer_load_dwordx4 v[56:59], v2, s[8:11], s45 offen offset:0 sc1
    buffer_load_dwordx4 v[60:63], v2, s[8:11], s45 offen offset:1024 sc1
    s_add_u32 s46, s30, 65536
    buffer_load_dwordx4 v[64:67], v2, s[8:11], s46 offen offset:0 sc1
    buffer_load_dwordx4 v[68:71], v2, s[8:11], s46 offen offset:1024 sc1
    s_add_u32 s47, s30, 98304
    buffer_load_dwordx4 v[72:75], v2, s[8:11], s47 offen offset:0 sc1
    buffer_load_dwordx4 v[76:79], v2, s[8:11], s47 offen offset:1024 sc1
    s_sub_u32 s54, s29, 64
    s_max_i32 s54, s54, 0
    s_and_b32 s42, s28, 7
    s_mul_i32 s32, s42, 32768
    s_add_u32 s32, s32, s50
    s_mul_i32 s33, s42, 32768
    s_add_u32 s33, s33, s51
    s_bfe_u32 s55, s28, 65539
    s_waitcnt vmcnt(8)
    v_lshlrev_b32 v16, 16, v104
    v_and_b32 v17, s38, v104
    v_lshlrev_b32 v18, 16, v105
    v_and_b32 v19, s38, v105
    v_lshlrev_b32 v20, 16, v106
    v_and_b32 v21, s38, v106
    v_lshlrev_b32 v22, 16, v107
    v_and_b32 v23, s38, v107
    v_lshlrev_b32 v24, 16, v108
    v_and_b32 v25, s38, v108
    v_lshlrev_b32 v26, 16, v109
    v_and_b32 v27, s38, v109
    v_lshlrev_b32 v28, 16, v110
    v_and_b32 v29, s38, v110
    v_lshlrev_b32 v30, 16, v111
    v_and_b32 v31, s38, v111
    s_waitcnt vmcnt(6)
    v_bitop3_b32 v10, v48, v52, s55 bitop3:66
    v_lshlrev_b32 v32, 16, v48
    v_and_b32 v33, s38, v48
    v_lshlrev_b32 v34, 16, v49
    v_and_b32 v35, s38, v49
    v_lshlrev_b32 v36, 16, v50
    v_and_b32 v37, s38, v50
    v_lshlrev_b32 v38, 16, v51
    v_and_b32 v39, s38, v51
    v_lshlrev_b32 v40, 16, v52
    v_and_b32 v41, s38, v52
    v_lshlrev_b32 v42, 16, v53
    v_and_b32 v43, s38, v53
    v_lshlrev_b32 v44, 16, v54
    v_and_b32 v45, s38, v54
    v_lshlrev_b32 v46, 16, v55
    v_and_b32 v47, s38, v55
    v_pk_add_f32 v[16:17], v[16:17], v[32:33]
    v_pk_add_f32 v[18:19], v[18:19], v[34:35]
    v_pk_add_f32 v[20:21], v[20:21], v[36:37]
    v_pk_add_f32 v[22:23], v[22:23], v[38:39]
    v_pk_add_f32 v[24:25], v[24:25], v[40:41]
    v_pk_add_f32 v[26:27], v[26:27], v[42:43]
    v_pk_add_f32 v[28:29], v[28:29], v[44:45]
    v_pk_add_f32 v[30:31], v[30:31], v[46:47]
    s_waitcnt vmcnt(4)
    v_bitop3_b32 v10, v10, v56, s55 bitop3:96
    v_bitop3_b32 v10, v10, v60, s55 bitop3:96
    v_lshlrev_b32 v32, 16, v56
    v_and_b32 v33, s38, v56
    v_lshlrev_b32 v34, 16, v57
    v_and_b32 v35, s38, v57
    v_lshlrev_b32 v36, 16, v58
    v_and_b32 v37, s38, v58
    v_lshlrev_b32 v38, 16, v59
    v_and_b32 v39, s38, v59
    v_lshlrev_b32 v40, 16, v60
    v_and_b32 v41, s38, v60
    v_lshlrev_b32 v42, 16, v61
    v_and_b32 v43, s38, v61
    v_lshlrev_b32 v44, 16, v62
    v_and_b32 v45, s38, v62
    v_lshlrev_b32 v46, 16, v63
    v_and_b32 v47, s38, v63
    v_pk_add_f32 v[16:17], v[16:17], v[32:33]
    v_pk_add_f32 v[18:19], v[18:19], v[34:35]
    v_pk_add_f32 v[20:21], v[20:21], v[36:37]
    v_pk_add_f32 v[22:23], v[22:23], v[38:39]
    v_pk_add_f32 v[24:25], v[24:25], v[40:41]
    v_pk_add_f32 v[26:27], v[26:27], v[42:43]
    v_pk_add_f32 v[28:29], v[28:29], v[44:45]
    v_pk_add_f32 v[30:31], v[30:31], v[46:47]
    s_waitcnt vmcnt(2)
    v_bitop3_b32 v10, v10, v64, s55 bitop3:96
    v_bitop3_b32 v10, v10, v68, s55 bitop3:96
    v_lshlrev_b32 v32, 16, v64
    v_and_b32 v33, s38, v64
    v_lshlrev_b32 v34, 16, v65
    v_and_b32 v35, s38, v65
    v_lshlrev_b32 v36, 16, v66
    v_and_b32 v37, s38, v66
    v_lshlrev_b32 v38, 16, v67
    v_and_b32 v39, s38, v67
    v_lshlrev_b32 v40, 16, v68
    v_and_b32 v41, s38, v68
    v_lshlrev_b32 v42, 16, v69
    v_and_b32 v43, s38, v69
    v_lshlrev_b32 v44, 16, v70
    v_and_b32 v45, s38, v70
    v_lshlrev_b32 v46, 16, v71
    v_and_b32 v47, s38, v71
    v_pk_add_f32 v[16:17], v[16:17], v[32:33]
    v_pk_add_f32 v[18:19], v[18:19], v[34:35]
    v_pk_add_f32 v[20:21], v[20:21], v[36:37]
    v_pk_add_f32 v[22:23], v[22:23], v[38:39]
    v_pk_add_f32 v[24:25], v[24:25], v[40:41]
    v_pk_add_f32 v[26:27], v[26:27], v[42:43]
    v_pk_add_f32 v[28:29], v[28:29], v[44:45]
    v_pk_add_f32 v[30:31], v[30:31], v[46:47]
    s_waitcnt vmcnt(0)
    v_bitop3_b32 v10, v10, v72, s55 bitop3:96
    v_bitop3_b32 v10, v10, v76, s55 bitop3:96
    v_and_b32 v10, 1, v10
    v_cmp_eq_u32 vcc, 0, v10
    v_lshlrev_b32 v32, 16, v72
    v_and_b32 v33, s38, v72
    v_lshlrev_b32 v34, 16, v73
    v_and_b32 v35, s38, v73
    v_lshlrev_b32 v36, 16, v74
    v_and_b32 v37, s38, v74
    v_lshlrev_b32 v38, 16, v75
    v_and_b32 v39, s38, v75
    v_lshlrev_b32 v40, 16, v76
    v_and_b32 v41, s38, v76
    v_lshlrev_b32 v42, 16, v77
    v_and_b32 v43, s38, v77
    v_lshlrev_b32 v44, 16, v78
    v_and_b32 v45, s38, v78
    v_lshlrev_b32 v46, 16, v79
    v_and_b32 v47, s38, v79
    v_pk_add_f32 v[16:17], v[16:17], v[32:33]
    v_pk_add_f32 v[18:19], v[18:19], v[34:35]
    v_pk_add_f32 v[20:21], v[20:21], v[36:37]
    v_pk_add_f32 v[22:23], v[22:23], v[38:39]
    v_pk_add_f32 v[24:25], v[24:25], v[40:41]
    v_pk_add_f32 v[26:27], v[26:27], v[42:43]
    v_pk_add_f32 v[28:29], v[28:29], v[44:45]
    v_pk_add_f32 v[30:31], v[30:31], v[46:47]
    s_branch L_join_21
L_notready_23:
    buffer_store_dwordx4 v[88:91], v2, s[8:11], s33 offen offset:0
    buffer_store_dwordx4 v[92:95], v2, s[8:11], s33 offen offset:1024
    v_mov_b32 v7, s28
    s_mov_b64 exec, 1
    buffer_store_dword v7, v4, s[8:11], s35 offen
    s_mov_b64 exec, -1
    s_sub_u32 s54, s29, 64
    s_max_i32 s54, s54, 0
    s_and_b32 s42, s28, 7
    s_mul_i32 s32, s42, 32768
    s_add_u32 s32, s32, s50
    s_mul_i32 s33, s42, 32768
    s_add_u32 s33, s33, s51
    buffer_load_dword v6, v5, s[8:11], s34 offen sc1
    s_waitcnt vmcnt(0)
    s_cmp_eq_u32 s28, 64
    s_cbranch_scc1 L_fin_19
    v_cmp_gt_u32 vcc, s29, v6
    s_cbranch_vccz L_ld_18
    s_branch L_item_17
L_retry_22:
    s_cmp_eq_u32 s29, 0
    s_cbranch_scc1 L_retry_22_skip
    s_add_u32 s52, s52, 0x1001
    s_cmp_lt_u32 s52, 2147418112
    s_waitcnt vmcnt(0)
    s_cbranch_scc1 L_ld_18
    s_branch L_fail
L_fin_19:
    s_branch L_done
L_nonlocal_16:
L_item_25:
L_poll_32:
    buffer_load_dword v6, v5, s[8:11], s34 offen sc1
    s_waitcnt vmcnt(0)
    v_cmp_gt_u32 vcc, s29, v6
    s_add_u32 s52, s52, 0x1000
    s_cmp_lt_u32 s52, 2147418112
    s_cbranch_vccz L_poll_32_ok
    s_cbranch_scc1 L_poll_32
    s_branch L_fail
L_poll_32_ok:
L_ld_26:
    buffer_load_dwordx4 v[104:107], v2, s[8:11], s31 offen offset:0 sc1
    buffer_load_dwordx4 v[108:111], v2, s[8:11], s31 offen offset:1024 sc1
    s_add_u32 s44, s30, 0
    buffer_load_dwordx4 v[48:51], v2, s[8:11], s44 offen offset:0 sc1
    buffer_load_dwordx4 v[52:55], v2, s[8:11], s44 offen offset:1024 sc1
    s_add_u32 s45, s30, 32768
    buffer_load_dwordx4 v[56:59], v2, s[8:11], s45 offen offset:0 sc1
    buffer_load_dwordx4 v[60:63], v2, s[8:11], s45 offen offset:1024 sc1
    s_add_u32 s46, s30, 65536
    buffer_load_dwordx4 v[64:67], v2, s[8:11], s46 offen offset:0 sc1
    buffer_load_dwordx4 v[68:71], v2, s[8:11], s46 offen offset:1024 sc1
    s_add_u32 s47, s30, 98304
    buffer_load_dwordx4 v[72:75], v2, s[8:11], s47 offen offset:0 sc1
    buffer_load_dwordx4 v[76:79], v2, s[8:11], s47 offen offset:1024 sc1
    s_bfe_u32 s55, s28, 65539
    s_waitcnt vmcnt(8)
    v_lshlrev_b32 v16, 16, v104
    v_and_b32 v17, s38, v104
    v_lshlrev_b32 v18, 16, v105
    v_and_b32 v19, s38, v105
    v_lshlrev_b32 v20, 16, v106
    v_and_b32 v21, s38, v106
    v_lshlrev_b32 v22, 16, v107
    v_and_b32 v23, s38, v107
    v_lshlrev_b32 v24, 16, v108
    v_and_b32 v25, s38, v108
    v_lshlrev_b32 v26, 16, v109
    v_and_b32 v27, s38, v109
    v_lshlrev_b32 v28, 16, v110
    v_and_b32 v29, s38, v110
    v_lshlrev_b32 v30, 16, v111
    v_and_b32 v31, s38, v111
    s_waitcnt vmcnt(6)
    v_bitop3_b32 v10, v48, v52, s55 bitop3:66
    v_lshlrev_b32 v32, 16, v48
    v_and_b32 v33, s38, v48
    v_lshlrev_b32 v34, 16, v49
    v_and_b32 v35, s38, v49
    v_lshlrev_b32 v36, 16, v50
    v_and_b32 v37, s38, v50
    v_lshlrev_b32 v38, 16, v51
    v_and_b32 v39, s38, v51
    v_lshlrev_b32 v40, 16, v52
    v_and_b32 v41, s38, v52
    v_lshlrev_b32 v42, 16, v53
    v_and_b32 v43, s38, v53
    v_lshlrev_b32 v44, 16, v54
    v_and_b32 v45, s38, v54
    v_lshlrev_b32 v46, 16, v55
    v_and_b32 v47, s38, v55
    v_pk_add_f32 v[16:17], v[16:17], v[32:33]
    v_pk_add_f32 v[18:19], v[18:19], v[34:35]
    v_pk_add_f32 v[20:21], v[20:21], v[36:37]
    v_pk_add_f32 v[22:23], v[22:23], v[38:39]
    v_pk_add_f32 v[24:25], v[24:25], v[40:41]
    v_pk_add_f32 v[26:27], v[26:27], v[42:43]
    v_pk_add_f32 v[28:29], v[28:29], v[44:45]
    v_pk_add_f32 v[30:31], v[30:31], v[46:47]
    s_waitcnt vmcnt(4)
    v_bitop3_b32 v10, v10, v56, s55 bitop3:96
    v_bitop3_b32 v10, v10, v60, s55 bitop3:96
    v_lshlrev_b32 v32, 16, v56
    v_and_b32 v33, s38, v56
    v_lshlrev_b32 v34, 16, v57
    v_and_b32 v35, s38, v57
    v_lshlrev_b32 v36, 16, v58
    v_and_b32 v37, s38, v58
    v_lshlrev_b32 v38, 16, v59
    v_and_b32 v39, s38, v59
    v_lshlrev_b32 v40, 16, v60
    v_and_b32 v41, s38, v60
    v_lshlrev_b32 v42, 16, v61
    v_and_b32 v43, s38, v61
    v_lshlrev_b32 v44, 16, v62
    v_and_b32 v45, s38, v62
    v_lshlrev_b32 v46, 16, v63
    v_and_b32 v47, s38, v63
    v_pk_add_f32 v[16:17], v[16:17], v[32:33]
    v_pk_add_f32 v[18:19], v[18:19], v[34:35]
    v_pk_add_f32 v[20:21], v[20:21], v[36:37]
    v_pk_add_f32 v[22:23], v[22:23], v[38:39]
    v_pk_add_f32 v[24:25], v[24:25], v[40:41]
    v_pk_add_f32 v[26:27], v[26:27], v[42:43]
    v_pk_add_f32 v[28:29], v[28:29], v[44:45]
    v_pk_add_f32 v[30:31], v[30:31], v[46:47]
    s_waitcnt vmcnt(2)
    v_bitop3_b32 v10, v10, v64, s55 bitop3:96
    v_bitop3_b32 v10, v10, v68, s55 bitop3:96
    v_lshlrev_b32 v32, 16, v64
    v_and_b32 v33, s38, v64
    v_lshlrev_b32 v34, 16, v65
    v_and_b32 v35, s38, v65
    v_lshlrev_b32 v36, 16, v66
    v_and_b32 v37, s38, v66
    v_lshlrev_b32 v38, 16, v67
    v_and_b32 v39, s38, v67
    v_lshlrev_b32 v40, 16, v68
    v_and_b32 v41, s38, v68
    v_lshlrev_b32 v42, 16, v69
    v_and_b32 v43, s38, v69
    v_lshlrev_b32 v44, 16, v70
    v_and_b32 v45, s38, v70
    v_lshlrev_b32 v46, 16, v71
    v_and_b32 v47, s38, v71
    v_pk_add_f32 v[16:17], v[16:17], v[32:33]
    v_pk_add_f32 v[18:19], v[18:19], v[34:35]
    v_pk_add_f32 v[20:21], v[20:21], v[36:37]
    v_pk_add_f32 v[22:23], v[22:23], v[38:39]
    v_pk_add_f32 v[24:25], v[24:25], v[40:41]
    v_pk_add_f32 v[26:27], v[26:27], v[42:43]
    v_pk_add_f32 v[28:29], v[28:29], v[44:45]
    v_pk_add_f32 v[30:31], v[30:31], v[46:47]
    s_waitcnt vmcnt(0)
    v_bitop3_b32 v10, v10, v72, s55 bitop3:96
    v_bitop3_b32 v10, v10, v76, s55 bitop3:96
    v_and_b32 v10, 1, v10
    v_cmp_eq_u32 vcc, 0, v10
    v_lshlrev_b32 v32, 16, v72
    v_and_b32 v33, s38, v72
    v_lshlrev_b32 v34, 16, v73
    v_and_b32 v35, s38, v73
    v_lshlrev_b32 v36, 16, v74
    v_and_b32 v37, s38, v74
    v_lshlrev_b32 v38, 16, v75
    v_and_b32 v39, s38, v75
    v_lshlrev_b32 v40, 16, v76
    v_and_b32 v41, s38, v76
    v_lshlrev_b32 v42, 16, v77
    v_and_b32 v43, s38, v77
    v_lshlrev_b32 v44, 16, v78
    v_and_b32 v45, s38, v78
    v_lshlrev_b32 v46, 16, v79
    v_and_b32 v47, s38, v79
    v_pk_add_f32 v[16:17], v[16:17], v[32:33]
    v_pk_add_f32 v[18:19], v[18:19], v[34:35]
    v_pk_add_f32 v[20:21], v[20:21], v[36:37]
    v_pk_add_f32 v[22:23], v[22:23], v[38:39]
    v_pk_add_f32 v[24:25], v[24:25], v[40:41]
    v_pk_add_f32 v[26:27], v[26:27], v[42:43]
    v_pk_add_f32 v[28:29], v[28:29], v[44:45]
    v_pk_add_f32 v[30:31], v[30:31], v[46:47]
L_join_29:
    s_cbranch_vccnz L_retry_30
L_retry_30_skip:
    buffer_load_dword v6, v5, s[8:11], s34 offen sc1
    v_cvt_pk_bf16_f32 v80, v16, v17
    v_cvt_pk_bf16_f32 v81, v18, v19
    v_cvt_pk_bf16_f32 v82, v20, v21
    v_cvt_pk_bf16_f32 v83, v22, v23
    v_cvt_pk_bf16_f32 v84, v24, v25
    v_cvt_pk_bf16_f32 v85, v26, v27
    v_cvt_pk_bf16_f32 v86, v28, v29
    v_cvt_pk_bf16_f32 v87, v30, v31
    buffer_store_dwordx4 v[80:83], v2, s[8:11], s32 offen offset:0 sc1
    buffer_store_dwordx4 v[84:87], v2, s[8:11], s32 offen offset:1024 sc1
    v_lshlrev_b32 v16, 16, v80
    v_and_b32 v17, s38, v80
    v_lshlrev_b32 v18, 16, v81
    v_and_b32 v19, s38, v81
    v_lshlrev_b32 v20, 16, v82
    v_and_b32 v21, s38, v82
    v_lshlrev_b32 v22, 16, v83
    v_and_b32 v23, s38, v83
    v_lshlrev_b32 v24, 16, v84
    v_and_b32 v25, s38, v84
    v_lshlrev_b32 v26, 16, v85
    v_and_b32 v27, s38, v85
    v_lshlrev_b32 v28, 16, v86
    v_and_b32 v29, s38, v86
    v_lshlrev_b32 v30, 16, v87
    v_and_b32 v31, s38, v87
    v_pk_add_f32 v[118:119], v[16:17], v[24:25]
    v_pk_add_f32 v[120:121], v[18:19], v[26:27]
    v_pk_add_f32 v[122:123], v[20:21], v[28:29]
    v_pk_add_f32 v[124:125], v[22:23], v[30:31]
    v_pk_add_f32 v[118:119], v[118:119], v[122:123]
    v_pk_add_f32 v[120:121], v[120:121], v[124:125]
    v_pk_add_f32 v[118:119], v[118:119], v[120:121]
    v_add_f32 v10, v118, v119
    s_nop 1
    v_add_f32_dpp v10, v10, v10 row_ror:8 row_mask:0xf bank_mask:0xf
    v_mov_b32 v11, v10
    s_nop 1
    v_permlane16_swap_b32 v10, v11
    v_add_f32 v12, v10, v11
    v_add_f32 v13, v10, v11
    s_nop 1
    v_permlane32_swap_b32 v12, v13
    v_add_f32 v10, v12, v13
    v_mul_f32 v14, s40, v10
    v_pk_add_f32 v[32:33], v[16:17], v[14:15] op_sel_hi:[1,0] neg_lo:[0,1] neg_hi:[0,1]
    v_pk_add_f32 v[34:35], v[18:19], v[14:15] op_sel_hi:[1,0] neg_lo:[0,1] neg_hi:[0,1]
    v_pk_add_f32 v[36:37], v[20:21], v[14:15] op_sel_hi:[1,0] neg_lo:[0,1] neg_hi:[0,1]
    v_pk_add_f32 v[38:39], v[22:23], v[14:15] op_sel_hi:[1,0] neg_lo:[0,1] neg_hi:[0,1]
    v_pk_add_f32 v[40:41], v[24:25], v[14:15] op_sel_hi:[1,0] neg_lo:[0,1] neg_hi:[0,1]
    v_pk_add_f32 v[42:43], v[26:27], v[14:15] op_sel_hi:[1,0] neg_lo:[0,1] neg_hi:[0,1]
    v_pk_add_f32 v[44:45], v[28:29], v[14:15] op_sel_hi:[1,0] neg_lo:[0,1] neg_hi:[0,1]
    v_pk_add_f32 v[46:47], v[30:31], v[14:15] op_sel_hi:[1,0] neg_lo:[0,1] neg_hi:[0,1]
    v_pk_mul_f32 v[32:33], v[32:33], v[32:33]
    v_pk_mul_f32 v[34:35], v[34:35], v[34:35]
    v_pk_mul_f32 v[36:37], v[36:37], v[36:37]
    v_pk_mul_f32 v[38:39], v[38:39], v[38:39]
    v_pk_mul_f32 v[40:41], v[40:41], v[40:41]
    v_pk_mul_f32 v[42:43], v[42:43], v[42:43]
    v_pk_mul_f32 v[44:45], v[44:45], v[44:45]
    v_pk_mul_f32 v[46:47], v[46:47], v[46:47]
    v_pk_add_f32 v[118:119], v[32:33], v[40:41]
    v_pk_add_f32 v[120:121], v[34:35], v[42:43]
    v_pk_add_f32 v[122:123], v[36:37], v[44:45]
    v_pk_add_f32 v[124:125], v[38:39], v[46:47]
    v_pk_add_f32 v[118:119], v[118:119], v[122:123]
    v_pk_add_f32 v[120:121], v[120:121], v[124:125]
    v_pk_add_f32 v[118:119], v[118:119], v[120:121]
    v_add_f32 v10, v118, v119
    s_nop 1
    v_add_f32_dpp v10, v10, v10 row_ror:8 row_mask:0xf bank_mask:0xf
    v_mov_b32 v11, v10
    s_nop 1
    v_permlane16_swap_b32 v10, v11
    v_add_f32 v12, v10, v11
    v_add_f32 v13, v10, v11
    s_nop 1
    v_permlane32_swap_b32 v12, v13
    v_add_f32 v10, v12, v13
    v_mov_b32 v15, v10
    s_mov_b64 exec, 0xff
    ds_write_b64 v8, v[14:15]
    s_mov_b64 exec, -1
    s_waitcnt lgkmcnt(0)
    s_barrier
    ds_read_b128 v[118:121], v9
    ds_read_b128 v[122:125], v9 offset:16
    v_xor_b32 v8, 256, v8
    v_xor_b32 v9, 256, v9
    s_waitcnt lgkmcnt(0)
    v_add_f32 v10, v118, v120
    v_add_f32 v11, v122, v124
    v_add_f32 v12, v119, v121
    v_add_f32 v13, v123, v125
    v_add_f32 v10, v10, v11
    v_add_f32 v12, v12, v13
    v_mul_f32 v10, 1048576000, v10
    v_sub_f32 v118, v118, v10
    v_sub_f32 v120, v120, v10
    v_sub_f32 v122, v122, v10
    v_sub_f32 v124, v124, v10
    v_mul_f32 v118, v118, v118
    v_fmac_f32 v118, v120, v120
    v_fmac_f32 v118, v122, v122
    v_fmac_f32 v118, v124, v124
    v_fmac_f32 v12, s39, v118
    v_mov_b32 v13, s41
    v_fmac_f32 v13, 989855744, v12
    v_rsq_f32 v12, v13
    s_nop 0
    v_mul_f32 v10, v10, v12
    v_pk_fma_f32 v[16:17], v[16:17], v[12:13], v[10:11] op_sel_hi:[1,0,0] neg_lo:[0,0,1] neg_hi:[0,0,1]
    v_pk_fma_f32 v[18:19], v[18:19], v[12:13], v[10:11] op_sel_hi:[1,0,0] neg_lo:[0,0,1] neg_hi:[0,0,1]
    v_pk_fma_f32 v[20:21], v[20:21], v[12:13], v[10:11] op_sel_hi:[1,0,0] neg_lo:[0,0,1] neg_hi:[0,0,1]
    v_pk_fma_f32 v[22:23], v[22:23], v[12:13], v[10:11] op_sel_hi:[1,0,0] neg_lo:[0,0,1] neg_hi:[0,0,1]
    v_pk_fma_f32 v[24:25], v[24:25], v[12:13], v[10:11] op_sel_hi:[1,0,0] neg_lo:[0,0,1] neg_hi:[0,0,1]
    v_pk_fma_f32 v[26:27], v[26:27], v[12:13], v[10:11] op_sel_hi:[1,0,0] neg_lo:[0,0,1] neg_hi:[0,0,1]
    v_pk_fma_f32 v[28:29], v[28:29], v[12:13], v[10:11] op_sel_hi:[1,0,0] neg_lo:[0,0,1] neg_hi:[0,0,1]
    v_pk_fma_f32 v[30:31], v[30:31], v[12:13], v[10:11] op_sel_hi:[1,0,0] neg_lo:[0,0,1] neg_hi:[0,0,1]
    v_cvt_pk_bf16_f32 v88, v16, v17
    v_cvt_pk_bf16_f32 v89, v18, v19
    v_cvt_pk_bf16_f32 v90, v20, v21
    v_cvt_pk_bf16_f32 v91, v22, v23
    v_cvt_pk_bf16_f32 v92, v24, v25
    v_cvt_pk_bf16_f32 v93, v26, v27
    v_cvt_pk_bf16_f32 v94, v28, v29
    v_cvt_pk_bf16_f32 v95, v30, v31
    s_bfe_u32 s55, s28, 65539
    s_xor_b32 s55, s55, 1
    s_xor_b32 s44, s55, 1
    s_lshl_b32 s44, s44, 16
    v_add_u32 v10, s44, v16
    v_lshrrev_b32 v10, 16, v10
    v_and_or_b32 v10, v10, -2, s55
    v_and_or_b32 v88, v88, s38, v10
    s_xor_b32 s44, s55, 1
    s_lshl_b32 s44, s44, 16
    v_add_u32 v10, s44, v24
    v_lshrrev_b32 v10, 16, v10
    v_and_or_b32 v10, v10, -2, s55
    v_and_or_b32 v92, v92, s38, v10
    s_add_u32 s28, s28, 1
    s_add_u32 s29, s29, 1
    s_and_b32 s42, s28, 7
    s_mul_i32 s30, s42, 131072
    s_add_u32 s30, s30, s48
    s_and_b32 s42, s28, 63
    s_mul_i32 s31, s42, 32768
    s_add_u32 s31, s31, s49
    s_waitcnt vmcnt(0)
    v_cmp_gt_u32 vcc, s29, v6
    s_cbranch_vccnz L_notready_31
    buffer_store_dwordx4 v[88:91], v2, s[8:11], s33 offen offset:0 sc1
    buffer_store_dwordx4 v[92:95], v2, s[8:11], s33 offen offset:1024 sc1
    v_mov_b32 v7, s28
    s_mov_b64 exec, 1
    buffer_store_dword v7, v4, s[8:11], s35 offen sc1
    s_mov_b64 exec, -1
    buffer_load_dwordx4 v[104:107], v2, s[8:11], s31 offen offset:0 sc1
    buffer_load_dwordx4 v[108:111], v2, s[8:11], s31 offen offset:1024 sc1
    s_add_u32 s44, s30, 0
    buffer_load_dwordx4 v[48:51], v2, s[8:11], s44 offen offset:0 sc1
    buffer_load_dwordx4 v[52:55], v2, s[8:11], s44 offen offset:1024 sc1
    s_add_u32 s45, s30, 32768
    buffer_load_dwordx4 v[56:59], v2, s[8:11], s45 offen offset:0 sc1
    buffer_load_dwordx4 v[60:63], v2, s[8:11], s45 offen offset:1024 sc1
    s_add_u32 s46, s30, 65536
    buffer_load_dwordx4 v[64:67], v2, s[8:11], s46 offen offset:0 sc1
    buffer_load_dwordx4 v[68:71], v2, s[8:11], s46 offen offset:1024 sc1
    s_add_u32 s47, s30, 98304
    buffer_load_dwordx4 v[72:75], v2, s[8:11], s47 offen offset:0 sc1
    buffer_load_dwordx4 v[76:79], v2, s[8:11], s47 offen offset:1024 sc1
    s_sub_u32 s54, s29, 64
    s_max_i32 s54, s54, 0
    s_and_b32 s42, s28, 7
    s_mul_i32 s32, s42, 32768
    s_add_u32 s32, s32, s50
    s_mul_i32 s33, s42, 32768
    s_add_u32 s33, s33, s51
    s_bfe_u32 s55, s28, 65539
    s_waitcnt vmcnt(8)
    v_lshlrev_b32 v16, 16, v104
    v_and_b32 v17, s38, v104
    v_lshlrev_b32 v18, 16, v105
    v_and_b32 v19, s38, v105
    v_lshlrev_b32 v20, 16, v106
    v_and_b32 v21, s38, v106
    v_lshlrev_b32 v22, 16, v107
    v_and_b32 v23, s38, v107
    v_lshlrev_b32 v24, 16, v108
    v_and_b32 v25, s38, v108
    v_lshlrev_b32 v26, 16, v109
    v_and_b32 v27, s38, v109
    v_lshlrev_b32 v28, 16, v110
    v_and_b32 v29, s38, v110
    v_lshlrev_b32 v30, 16, v111
    v_and_b32 v31, s38, v111
    s_waitcnt vmcnt(6)
    v_bitop3_b32 v10, v48, v52, s55 bitop3:66
    v_lshlrev_b32 v32, 16, v48
    v_and_b32 v33, s38, v48
    v_lshlrev_b32 v34, 16, v49
    v_and_b32 v35, s38, v49
    v_lshlrev_b32 v36, 16, v50
    v_and_b32 v37, s38, v50
    v_lshlrev_b32 v38, 16, v51
    v_and_b32 v39, s38, v51
    v_lshlrev_b32 v40, 16, v52
    v_and_b32 v41, s38, v52
    v_lshlrev_b32 v42, 16, v53
    v_and_b32 v43, s38, v53
    v_lshlrev_b32 v44, 16, v54
    v_and_b32 v45, s38, v54
    v_lshlrev_b32 v46, 16, v55
    v_and_b32 v47, s38, v55
    v_pk_add_f32 v[16:17], v[16:17], v[32:33]
    v_pk_add_f32 v[18:19], v[18:19], v[34:35]
    v_pk_add_f32 v[20:21], v[20:21], v[36:37]
    v_pk_add_f32 v[22:23], v[22:23], v[38:39]
    v_pk_add_f32 v[24:25], v[24:25], v[40:41]
    v_pk_add_f32 v[26:27], v[26:27], v[42:43]
    v_pk_add_f32 v[28:29], v[28:29], v[44:45]
    v_pk_add_f32 v[30:31], v[30:31], v[46:47]
    s_waitcnt vmcnt(4)
    v_bitop3_b32 v10, v10, v56, s55 bitop3:96
    v_bitop3_b32 v10, v10, v60, s55 bitop3:96
    v_lshlrev_b32 v32, 16, v56
    v_and_b32 v33, s38, v56
    v_lshlrev_b32 v34, 16, v57
    v_and_b32 v35, s38, v57
    v_lshlrev_b32 v36, 16, v58
    v_and_b32 v37, s38, v58
    v_lshlrev_b32 v38, 16, v59
    v_and_b32 v39, s38, v59
    v_lshlrev_b32 v40, 16, v60
    v_and_b32 v41, s38, v60
    v_lshlrev_b32 v42, 16, v61
    v_and_b32 v43, s38, v61
    v_lshlrev_b32 v44, 16, v62
    v_and_b32 v45, s38, v62
    v_lshlrev_b32 v46, 16, v63
    v_and_b32 v47, s38, v63
    v_pk_add_f32 v[16:17], v[16:17], v[32:33]
    v_pk_add_f32 v[18:19], v[18:19], v[34:35]
    v_pk_add_f32 v[20:21], v[20:21], v[36:37]
    v_pk_add_f32 v[22:23], v[22:23], v[38:39]
    v_pk_add_f32 v[24:25], v[24:25], v[40:41]
    v_pk_add_f32 v[26:27], v[26:27], v[42:43]
    v_pk_add_f32 v[28:29], v[28:29], v[44:45]
    v_pk_add_f32 v[30:31], v[30:31], v[46:47]
    s_waitcnt vmcnt(2)
    v_bitop3_b32 v10, v10, v64, s55 bitop3:96
    v_bitop3_b32 v10, v10, v68, s55 bitop3:96
    v_lshlrev_b32 v32, 16, v64
    v_and_b32 v33, s38, v64
    v_lshlrev_b32 v34, 16, v65
    v_and_b32 v35, s38, v65
    v_lshlrev_b32 v36, 16, v66
    v_and_b32 v37, s38, v66
    v_lshlrev_b32 v38, 16, v67
    v_and_b32 v39, s38, v67
    v_lshlrev_b32 v40, 16, v68
    v_and_b32 v41, s38, v68
    v_lshlrev_b32 v42, 16, v69
    v_and_b32 v43, s38, v69
    v_lshlrev_b32 v44, 16, v70
    v_and_b32 v45, s38, v70
    v_lshlrev_b32 v46, 16, v71
    v_and_b32 v47, s38, v71
    v_pk_add_f32 v[16:17], v[16:17], v[32:33]
    v_pk_add_f32 v[18:19], v[18:19], v[34:35]
    v_pk_add_f32 v[20:21], v[20:21], v[36:37]
    v_pk_add_f32 v[22:23], v[22:23], v[38:39]
    v_pk_add_f32 v[24:25], v[24:25], v[40:41]
    v_pk_add_f32 v[26:27], v[26:27], v[42:43]
    v_pk_add_f32 v[28:29], v[28:29], v[44:45]
    v_pk_add_f32 v[30:31], v[30:31], v[46:47]
    s_waitcnt vmcnt(0)
    v_bitop3_b32 v10, v10, v72, s55 bitop3:96
    v_bitop3_b32 v10, v10, v76, s55 bitop3:96
    v_and_b32 v10, 1, v10
    v_cmp_eq_u32 vcc, 0, v10
    v_lshlrev_b32 v32, 16, v72
    v_and_b32 v33, s38, v72
    v_lshlrev_b32 v34, 16, v73
    v_and_b32 v35, s38, v73
    v_lshlrev_b32 v36, 16, v74
    v_and_b32 v37, s38, v74
    v_lshlrev_b32 v38, 16, v75
    v_and_b32 v39, s38, v75
    v_lshlrev_b32 v40, 16, v76
    v_and_b32 v41, s38, v76
    v_lshlrev_b32 v42, 16, v77
    v_and_b32 v43, s38, v77
    v_lshlrev_b32 v44, 16, v78
    v_and_b32 v45, s38, v78
    v_lshlrev_b32 v46, 16, v79
    v_and_b32 v47, s38, v79
    v_pk_add_f32 v[16:17], v[16:17], v[32:33]
    v_pk_add_f32 v[18:19], v[18:19], v[34:35]
    v_pk_add_f32 v[20:21], v[20:21], v[36:37]
    v_pk_add_f32 v[22:23], v[22:23], v[38:39]
    v_pk_add_f32 v[24:25], v[24:25], v[40:41]
    v_pk_add_f32 v[26:27], v[26:27], v[42:43]
    v_pk_add_f32 v[28:29], v[28:29], v[44:45]
    v_pk_add_f32 v[30:31], v[30:31], v[46:47]
    s_branch L_join_29
L_notready_31:
    buffer_store_dwordx4 v[88:91], v2, s[8:11], s33 offen offset:0 sc1
    buffer_store_dwordx4 v[92:95], v2, s[8:11], s33 offen offset:1024 sc1
    v_mov_b32 v7, s28
    s_mov_b64 exec, 1
    buffer_store_dword v7, v4, s[8:11], s35 offen sc1
    s_mov_b64 exec, -1
    s_sub_u32 s54, s29, 64
    s_max_i32 s54, s54, 0
    s_and_b32 s42, s28, 7
    s_mul_i32 s32, s42, 32768
    s_add_u32 s32, s32, s50
    s_mul_i32 s33, s42, 32768
    s_add_u32 s33, s33, s51
    buffer_load_dword v6, v5, s[8:11], s34 offen sc1
    s_waitcnt vmcnt(0)
    s_cmp_eq_u32 s28, 64
    s_cbranch_scc1 L_fin_27
    v_cmp_gt_u32 vcc, s29, v6
    s_cbranch_vccz L_ld_26
    s_branch L_item_25
L_retry_30:
    s_cmp_eq_u32 s29, 0
    s_cbranch_scc1 L_retry_30_skip
    s_add_u32 s52, s52, 0x1001
    s_cmp_lt_u32 s52, 2147418112
    s_waitcnt vmcnt(0)
    s_cbranch_scc1 L_ld_26
    s_branch L_fail
L_fin_27:
    s_branch L_done
    .p2align 6
L_r2:
    v_mov_b32 v100, v0
    v_mov_b32 v4, 0
    s_mov_b32 s52, 0
    v_mov_b32 v1, 0
    v_bfe_i32 v101, v100, 0, 1
    v_and_b32 v101, 16, v101
    v_xor_b32 v1, v1, v101
    v_bfe_i32 v101, v100, 1, 1
    v_and_b32 v101, 32, v101
    v_xor_b32 v1, v1, v101
    v_bfe_i32 v101, v100, 2, 1
    v_and_b32 v101, 64, v101
    v_xor_b32 v1, v1, v101
    v_bfe_i32 v101, v100, 3, 1
    v_and_b32 v101, 512, v101
    v_xor_b32 v1, v1, v101
    v_bfe_i32 v101, v100, 4, 1
    v_and_b32 v101, 4096, v101
    v_xor_b32 v1, v1, v101
    v_bfe_i32 v101, v100, 5, 1
    v_and_b32 v101, 8192, v101
    v_xor_b32 v1, v1, v101
    v_mov_b32 v2, 0
    v_bfe_i32 v101, v100, 0, 1
    v_and_b32 v101, 16, v101
    v_xor_b32 v2, v2, v101
    v_bfe_i32 v101, v100, 1, 1
    v_and_b32 v101, 32, v101
    v_xor_b32 v2, v2, v101
    v_bfe_i32 v101, v100, 2, 1
    v_and_b32 v101, 64, v101
    v_xor_b32 v2, v2, v101
    v_bfe_i32 v101, v100, 3, 1
    v_and_b32 v101, 512, v101
    v_xor_b32 v2, v2, v101
    v_bfe_i32 v101, v100, 4, 1
    v_and_b32 v101, 2048, v101
    v_xor_b32 v2, v2, v101
    v_bfe_i32 v101, v100, 5, 1
    v_and_b32 v101, 4096, v101
    v_xor_b32 v2, v2, v101
    v_mov_b32 v3, 0
    v_bfe_i32 v101, v100, 0, 1
    v_and_b32 v101, 1024, v101
    v_xor_b32 v3, v3, v101
    v_bfe_i32 v101, v100, 1, 1
    v_and_b32 v101, 2048, v101
    v_xor_b32 v3, v3, v101
    v_bfe_i32 v101, v100, 2, 1
    v_and_b32 v101, 4096, v101
    v_xor_b32 v3, v3, v101
    v_bfe_i32 v101, v100, 3, 1
    v_and_b32 v101, 8, v101
    v_xor_b32 v3, v3, v101
    v_bfe_i32 v101, v100, 4, 1
    v_and_b32 v101, 64, v101
    v_xor_b32 v3, v3, v101
    v_bfe_i32 v101, v100, 5, 1
    v_and_b32 v101, 128, v101
    v_xor_b32 v3, v3, v101
    v_and_b32 v9, 7, v100
    v_lshlrev_b32 v9, 5, v9
    s_lshl_b32 s42, s24, 3
    v_add_u32 v8, s42, v9
    s_lshl_b32 s42, s24, 13
    s_lshl_b32 s43, s26, 7
    s_add_u32 s31, s42, s43
    s_mov_b32 s30, s31
    s_lshl_b32 s36, s26, 13
    s_lshl_b32 s42, s24, 8
    s_add_u32 s36, s36, s42
    s_lshl_b32 s35, s26, 2
    s_add_u32 s35, s35, s24
    s_lshl_b32 s35, s35, 2
    v_and_b32 v115, 7, v100
    v_mul_u32_u24 v115, 272, v115
    v_lshrrev_b32 v116, 3, v100
    v_and_b32 v117, 1, v116
    v_lshl_add_u32 v115, v117, 3, v115
    v_lshrrev_b32 v117, 4, v100
    v_lshl_add_u32 v115, v117, 6, v115
    v_mul_u32_u24 v116, 272, v117
    v_and_b32 v101, 15, v100
    v_lshl_add_u32 v116, v101, 4, v116
    v_lshlrev_b32 v117, 10, v117
    v_lshl_add_u32 v117, v101, 4, v117
    s_mul_i32 s42, s24, 2304
    s_add_u32 s42, s42, 1024
    v_add_u32 v115, s42, v115
    v_add_u32 v116, s42, v116
    s_add_u32 s32, s31, 249561088
    s_add_u32 s33, s31, 245366784
    s_lshl_b32 s43, s27, 21
    s_add_u32 s31, s31, s43
    s_add_u32 s31, s31, 251658240
    s_lshl_b32 s43, s27, 22
    s_add_u32 s30, s30, s43
    s_add_u32 s30, s30, 209715200
    s_lshl_b32 s43, s27, 8
    s_lshl_b32 s34, s27, 15
    s_add_u32 s34, s34, 360448
    s_lshl_b32 s35, s27, 15
    s_add_u32 s35, s35, 98304
    s_mul_i32 s44, s26, 1024
    s_add_u32 s35, s35, s44
    s_lshl_b32 s44, s24, 2
    s_add_u32 s35, s35, s44
    v_lshrrev_b32 v5, 2, v100
    v_and_b32 v5, 7, v5
    v_mul_u32_u24 v5, 128, v5
    v_and_b32 v101, 3, v100
    v_lshl_add_u32 v5, v101, 2, v5
    s_mov_b32 s16, s86
    s_mov_b32 s17, s87
    s_mov_b32 s18, 2097152
    s_mov_b32 s19, 0x00020000
    v_mov_b32 v7, 0
    s_mov_b64 exec, 1
    buffer_store_dword v7, v4, s[8:11], s35 offen sc1
    s_mov_b64 exec, -1
    s_mov_b32 s48, s30
    s_mov_b32 s49, s31
    s_mov_b32 s50, s32
    s_mov_b32 s51, s33
    s_mov_b32 s53, 131072
    s_mov_b32 s54, 0
    v_mov_b32 v96, 0
    v_mov_b32 v112, 0
    v_lshrrev_b32 v97, 2, v100
    v_and_b32 v97, 3, v97
    v_mul_u32_u24 v97, 1024, v97
    v_and_b32 v101, 3, v100
    v_lshl_add_u32 v97, v101, 2, v97
    s_waitcnt vmcnt(0)
    s_barrier
    s_cmp_lg_u32 s24, 0
    s_cbranch_scc1 L_na_33
    v_mov_b32 v126, 1
    v_mov_b32 v127, 4
    s_mov_b64 exec, 1
    buffer_atomic_add v126, v127, s[12:15], 0 offen
    s_mov_b64 exec, -1
L_na_33:
    v_mov_b64 v[16:17], 0
    v_mov_b64 v[18:19], 0
    s_mov_b32 s44, s33
    s_mov_b32 s45, 64
    s_cmp_lg_u32 s27, 0
    s_cbranch_scc1 L_clr_34_e
L_clr_34:
    buffer_store_dwordx4 v[16:19], v2, s[8:11], s44 offen sc1
    buffer_store_dwordx4 v[16:19], v2, s[8:11], s44 offen offset:1024 sc1
    s_add_u32 s44, s44, 32768
    s_sub_u32 s45, s45, 1
    s_cmp_lg_u32 s45, 0
    s_cbranch_scc1 L_clr_34
    s_waitcnt vmcnt(0)
L_clr_34_e:
    v_mbcnt_lo_u32_b32 v126, -1, 0
    v_mbcnt_hi_u32_b32 v126, -1, v126
    v_lshlrev_b32 v126, 5, v126
    v_cmp_gt_u32 vcc, 256, v126
    s_nop 1
    v_cndmask_b32 v126, 4, v126, vcc
    buffer_load_dword v127, v126, s[12:15], 0 offen sc1
    s_waitcnt vmcnt(0)
    v_readlane_b32 s98, v127, 8
    v_cmp_ne_u32 vcc, 32, v127
    s_nop 3
    s_and_b32 s5, vcc_lo, 0xff
    s_cmp_lt_u32 s98, 256
    s_cselect_b32 s98, 1, s5
    s_cmp_eq_u32 s98, 0
    s_cbranch_scc1 L_gw_35_done
L_gw_35:
    buffer_load_dword v127, v126, s[12:15], 0 offen sc1
    s_add_u32 s52, s52, 0x1000
    s_cmp_ge_u32 s52, 2147418112
    s_cbranch_scc1 L_fail
    s_waitcnt vmcnt(0)
    v_readlane_b32 s98, v127, 8
    s_nop 3
    s_cmp_ge_u32 s98, 256
    s_cbranch_scc1 L_gw_35_ok
    s_sleep 4
    s_branch L_gw_35
L_gw_35_ok:
    buffer_load_dword v127, v126, s[12:15], 0 offen sc1
    s_waitcnt vmcnt(0)
    v_cmp_ne_u32 vcc, 32, v127
    s_nop 3
    s_and_b32 s5, vcc_lo, 0xff
L_gw_35_done:
    s_mov_b32 s40, 1006632960
    s_mov_b32 s41, 925353388
    s_mov_b32 s38, 0xffff0000
    s_mov_b32 s39, 1124073472
    s_mov_b32 s28, 0
    s_mov_b32 s29, 1
L_item_36:
L_poll_43:
    buffer_load_dword v6, v5, s[8:11], s34 offen sc1
    s_waitcnt vmcnt(0)
    v_cmp_gt_u32 vcc, s29, v6
    s_add_u32 s52, s52, 0x1000
    s_cmp_lt_u32 s52, 2147418112
    s_cbranch_vccz L_poll_43_ok
    s_cbranch_scc1 L_poll_43
    s_branch L_fail
L_poll_43_ok:
L_ld_37:
    buffer_load_dwordx4 v[104:107], v2, s[8:11], s31 offen offset:0 sc1
    buffer_load_dwordx4 v[108:111], v2, s[8:11], s31 offen offset:1024 sc1
    s_add_u32 s44, s30, 0
    buffer_load_dwordx4 v[48:51], v2, s[8:11], s44 offen offset:0 sc1
    buffer_load_dwordx4 v[52:55], v2, s[8:11], s44 offen offset:1024 sc1
    s_add_u32 s45, s30, 32768
    buffer_load_dwordx4 v[56:59], v2, s[8:11], s45 offen offset:0 sc1
    buffer_load_dwordx4 v[60:63], v2, s[8:11], s45 offen offset:1024 sc1
    s_bfe_u32 s55, s28, 65539
    s_waitcnt vmcnt(4)
    v_lshlrev_b32 v16, 16, v104
    v_and_b32 v17, s38, v104
    v_lshlrev_b32 v18, 16, v105
    v_and_b32 v19, s38, v105
    v_lshlrev_b32 v20, 16, v106
    v_and_b32 v21, s38, v106
    v_lshlrev_b32 v22, 16, v107
    v_and_b32 v23, s38, v107
    v_lshlrev_b32 v24, 16, v108
    v_and_b32 v25, s38, v108
    v_lshlrev_b32 v26, 16, v109
    v_and_b32 v27, s38, v109
    v_lshlrev_b32 v28, 16, v110
    v_and_b32 v29, s38, v110
    v_lshlrev_b32 v30, 16, v111
    v_and_b32 v31, s38, v111
    s_waitcnt vmcnt(2)
    v_bitop3_b32 v10, v48, v52, s55 bitop3:66
    v_lshlrev_b32 v32, 16, v48
    v_and_b32 v33, s38, v48
    v_lshlrev_b32 v34, 16, v49
    v_and_b32 v35, s38, v49
    v_lshlrev_b32 v36, 16, v50
    v_and_b32 v37, s38, v50
    v_lshlrev_b32 v38, 16, v51
    v_and_b32 v39, s38, v51
    v_lshlrev_b32 v40, 16, v52
    v_and_b32 v41, s38, v52
    v_lshlrev_b32 v42, 16, v53
    v_and_b32 v43, s38, v53
    v_lshlrev_b32 v44, 16, v54
    v_and_b32 v45, s38, v54
    v_lshlrev_b32 v46, 16, v55
    v_and_b32 v47, s38, v55
    v_pk_add_f32 v[16:17], v[16:17], v[32:33]
    v_pk_add_f32 v[18:19], v[18:19], v[34:35]
    v_pk_add_f32 v[20:21], v[20:21], v[36:37]
    v_pk_add_f32 v[22:23], v[22:23], v[38:39]
    v_pk_add_f32 v[24:25], v[24:25], v[40:41]
    v_pk_add_f32 v[26:27], v[26:27], v[42:43]
    v_pk_add_f32 v[28:29], v[28:29], v[44:45]
    v_pk_add_f32 v[30:31], v[30:31], v[46:47]
    s_waitcnt vmcnt(0)
    v_bitop3_b32 v10, v10, v56, s55 bitop3:96
    v_bitop3_b32 v10, v10, v60, s55 bitop3:96
    v_and_b32 v10, 1, v10
    v_cmp_eq_u32 vcc, 0, v10
    v_lshlrev_b32 v32, 16, v56
    v_and_b32 v33, s38, v56
    v_lshlrev_b32 v34, 16, v57
    v_and_b32 v35, s38, v57
    v_lshlrev_b32 v36, 16, v58
    v_and_b32 v37, s38, v58
    v_lshlrev_b32 v38, 16, v59
    v_and_b32 v39, s38, v59
    v_lshlrev_b32 v40, 16, v60
    v_and_b32 v41, s38, v60
    v_lshlrev_b32 v42, 16, v61
    v_and_b32 v43, s38, v61
    v_lshlrev_b32 v44, 16, v62
    v_and_b32 v45, s38, v62
    v_lshlrev_b32 v46, 16, v63
    v_and_b32 v47, s38, v63
    v_pk_add_f32 v[16:17], v[16:17], v[32:33]
    v_pk_add_f32 v[18:19], v[18:19], v[34:35]
    v_pk_add_f32 v[20:21], v[20:21], v[36:37]
    v_pk_add_f32 v[22:23], v[22:23], v[38:39]
    v_pk_add_f32 v[24:25], v[24:25], v[40:41]
    v_pk_add_f32 v[26:27], v[26:27], v[42:43]
    v_pk_add_f32 v[28:29], v[28:29], v[44:45]
    v_pk_add_f32 v[30:31], v[30:31], v[46:47]
L_join_40:
    s_cbranch_vccnz L_retry_41
L_retry_41_skip:
    buffer_load_dword v6, v5, s[8:11], s34 offen sc1
    v_cvt_pk_bf16_f32 v80, v16, v17
    v_cvt_pk_bf16_f32 v81, v18, v19
    v_cvt_pk_bf16_f32 v82, v20, v21
    v_cvt_pk_bf16_f32 v83, v22, v23
    v_cvt_pk_bf16_f32 v84, v24, v25
    v_cvt_pk_bf16_f32 v85, v26, v27
    v_cvt_pk_bf16_f32 v86, v28, v29
    v_cvt_pk_bf16_f32 v87, v30, v31
    s_cmp_lg_u32 s27, 0
    s_cbranch_scc1 L_out_39
    buffer_store_dwordx4 v[80:83], v2, s[8:11], s32 offen offset:0 sc1
    buffer_store_dwordx4 v[84:87], v2, s[8:11], s32 offen offset:1024 sc1
    v_lshlrev_b32 v16, 16, v80
    v_and_b32 v17, s38, v80
    v_lshlrev_b32 v18, 16, v81
    v_and_b32 v19, s38, v81
    v_lshlrev_b32 v20, 16, v82
    v_and_b32 v21, s38, v82
    v_lshlrev_b32 v22, 16, v83
    v_and_b32 v23, s38, v83
    v_lshlrev_b32 v24, 16, v84
    v_and_b32 v25, s38, v84
    v_lshlrev_b32 v26, 16, v85
    v_and_b32 v27, s38, v85
    v_lshlrev_b32 v28, 16, v86
    v_and_b32 v29, s38, v86
    v_lshlrev_b32 v30, 16, v87
    v_and_b32 v31, s38, v87
    v_pk_add_f32 v[118:119], v[16:17], v[24:25]
    v_pk_add_f32 v[120:121], v[18:19], v[26:27]
    v_pk_add_f32 v[122:123], v[20:21], v[28:29]
    v_pk_add_f32 v[124:125], v[22:23], v[30:31]
    v_pk_add_f32 v[118:119], v[118:119], v[122:123]
    v_pk_add_f32 v[120:121], v[120:121], v[124:125]
    v_pk_add_f32 v[118:119], v[118:119], v[120:121]
    v_add_f32 v10, v118, v119
    s_nop 1
    v_add_f32_dpp v10, v10, v10 row_ror:8 row_mask:0xf bank_mask:0xf
    v_mov_b32 v11, v10
    s_nop 1
    v_permlane16_swap_b32 v10, v11
    v_add_f32 v12, v10, v11
    v_add_f32 v13, v10, v11
    s_nop 1
    v_permlane32_swap_b32 v12, v13
    v_add_f32 v10, v12, v13
    v_mul_f32 v14, s40, v10
    v_pk_add_f32 v[32:33], v[16:17], v[14:15] op_sel_hi:[1,0] neg_lo:[0,1] neg_hi:[0,1]
    v_pk_add_f32 v[34:35], v[18:19], v[14:15] op_sel_hi:[1,0] neg_lo:[0,1] neg_hi:[0,1]
    v_pk_add_f32 v[36:37], v[20:21], v[14:15] op_sel_hi:[1,0] neg_lo:[0,1] neg_hi:[0,1]
    v_pk_add_f32 v[38:39], v[22:23], v[14:15] op_sel_hi:[1,0] neg_lo:[0,1] neg_hi:[0,1]
    v_pk_add_f32 v[40:41], v[24:25], v[14:15] op_sel_hi:[1,0] neg_lo:[0,1] neg_hi:[0,1]
    v_pk_add_f32 v[42:43], v[26:27], v[14:15] op_sel_hi:[1,0] neg_lo:[0,1] neg_hi:[0,1]
    v_pk_add_f32 v[44:45], v[28:29], v[14:15] op_sel_hi:[1,0] neg_lo:[0,1] neg_hi:[0,1]
    v_pk_add_f32 v[46:47], v[30:31], v[14:15] op_sel_hi:[1,0] neg_lo:[0,1] neg_hi:[0,1]
    v_pk_mul_f32 v[32:33], v[32:33], v[32:33]
    v_pk_mul_f32 v[34:35], v[34:35], v[34:35]
    v_pk_mul_f32 v[36:37], v[36:37], v[36:37]
    v_pk_mul_f32 v[38:39], v[38:39], v[38:39]
    v_pk_mul_f32 v[40:41], v[40:41], v[40:41]
    v_pk_mul_f32 v[42:43], v[42:43], v[42:43]
    v_pk_mul_f32 v[44:45], v[44:45], v[44:45]
    v_pk_mul_f32 v[46:47], v[46:47], v[46:47]
    v_pk_add_f32 v[118:119], v[32:33], v[40:41]
    v_pk_add_f32 v[120:121], v[34:35], v[42:43]
    v_pk_add_f32 v[122:123], v[36:37], v[44:45]
    v_pk_add_f32 v[124:125], v[38:39], v[46:47]
    v_pk_add_f32 v[118:119], v[118:119], v[122:123]
    v_pk_add_f32 v[120:121], v[120:121], v[124:125]
    v_pk_add_f32 v[118:119], v[118:119], v[120:121]
    v_add_f32 v10, v118, v119
    s_nop 1
    v_add_f32_dpp v10, v10, v10 row_ror:8 row_mask:0xf bank_mask:0xf
    v_mov_b32 v11, v10
    s_nop 1
    v_permlane16_swap_b32 v10, v11
    v_add_f32 v12, v10, v11
    v_add_f32 v13, v10, v11
    s_nop 1
    v_permlane32_swap_b32 v12, v13
    v_add_f32 v10, v12, v13
    v_mov_b32 v15, v10
    s_mov_b64 exec, 0xff
    ds_write_b64 v8, v[14:15]
    s_mov_b64 exec, -1
    s_waitcnt lgkmcnt(0)
    s_barrier
    ds_read_b128 v[118:121], v9
    ds_read_b128 v[122:125], v9 offset:16
    v_xor_b32 v8, 256, v8
    v_xor_b32 v9, 256, v9
    s_waitcnt lgkmcnt(0)
    v_add_f32 v10, v118, v120
    v_add_f32 v11, v122, v124
    v_add_f32 v12, v119, v121
    v_add_f32 v13, v123, v125
    v_add_f32 v10, v10, v11
    v_add_f32 v12, v12, v13
    v_mul_f32 v10, 1048576000, v10
    v_sub_f32 v118, v118, v10
    v_sub_f32 v120, v120, v10
    v_sub_f32 v122, v122, v10
    v_sub_f32 v124, v124, v10
    v_mul_f32 v118, v118, v118
    v_fmac_f32 v118, v120, v120
    v_fmac_f32 v118, v122, v122
    v_fmac_f32 v118, v124, v124
    v_fmac_f32 v12, s39, v118
    v_mov_b32 v13, s41
    v_fmac_f32 v13, 989855744, v12
    v_rsq_f32 v12, v13
    s_nop 0
    v_mul_f32 v10, v10, v12
    v_pk_fma_f32 v[16:17], v[16:17], v[12:13], v[10:11] op_sel_hi:[1,0,0] neg_lo:[0,0,1] neg_hi:[0,0,1]
    v_pk_fma_f32 v[18:19], v[18:19], v[12:13], v[10:11] op_sel_hi:[1,0,0] neg_lo:[0,0,1] neg_hi:[0,0,1]
    v_pk_fma_f32 v[20:21], v[20:21], v[12:13], v[10:11] op_sel_hi:[1,0,0] neg_lo:[0,0,1] neg_hi:[0,0,1]
    v_pk_fma_f32 v[22:23], v[22:23], v[12:13], v[10:11] op_sel_hi:[1,0,0] neg_lo:[0,0,1] neg_hi:[0,0,1]
    v_pk_fma_f32 v[24:25], v[24:25], v[12:13], v[10:11] op_sel_hi:[1,0,0] neg_lo:[0,0,1] neg_hi:[0,0,1]
    v_pk_fma_f32 v[26:27], v[26:27], v[12:13], v[10:11] op_sel_hi:[1,0,0] neg_lo:[0,0,1] neg_hi:[0,0,1]
    v_pk_fma_f32 v[28:29], v[28:29], v[12:13], v[10:11] op_sel_hi:[1,0,0] neg_lo:[0,0,1] neg_hi:[0,0,1]
    v_pk_fma_f32 v[30:31], v[30:31], v[12:13], v[10:11] op_sel_hi:[1,0,0] neg_lo:[0,0,1] neg_hi:[0,0,1]
    v_cvt_pk_bf16_f32 v88, v16, v17
    v_cvt_pk_bf16_f32 v89, v18, v19
    v_cvt_pk_bf16_f32 v90, v20, v21
    v_cvt_pk_bf16_f32 v91, v22, v23
    v_cvt_pk_bf16_f32 v92, v24, v25
    v_cvt_pk_bf16_f32 v93, v26, v27
    v_cvt_pk_bf16_f32 v94, v28, v29
    v_cvt_pk_bf16_f32 v95, v30, v31
    v_lshrrev_b32 v10, 16, v16
    v_or_b32 v10, 1, v10
    v_and_or_b32 v88, v88, s38, v10
    v_lshrrev_b32 v10, 16, v24
    v_or_b32 v10, 1, v10
    v_and_or_b32 v92, v92, s38, v10
    s_add_u32 s28, s28, 1
    s_add_u32 s29, s29, 1
    s_and_b32 s42, s28, 7
    s_mul_i32 s30, s42, 65536
    s_add_u32 s30, s30, s48
    s_and_b32 s42, s28, 7
    s_mul_i32 s31, s42, 32768
    s_add_u32 s31, s31, s49
    s_waitcnt vmcnt(0)
    v_cmp_gt_u32 vcc, s29, v6
    s_cbranch_vccnz L_notready_42
    buffer_store_dwordx4 v[88:91], v2, s[8:11], s33 offen offset:0 sc1
    buffer_store_dwordx4 v[92:95], v2, s[8:11], s33 offen offset:1024 sc1
    v_mov_b32 v7, s28
    s_mov_b64 exec, 1
    buffer_store_dword v7, v4, s[8:11], s35 offen sc1
    s_mov_b64 exec, -1
    buffer_load_dwordx4 v[104:107], v2, s[8:11], s31 offen offset:0 sc1
    buffer_load_dwordx4 v[108:111], v2, s[8:11], s31 offen offset:1024 sc1
    s_add_u32 s44, s30, 0
    buffer_load_dwordx4 v[48:51], v2, s[8:11], s44 offen offset:0 sc1
    buffer_load_dwordx4 v[52:55], v2, s[8:11], s44 offen offset:1024 sc1
    s_add_u32 s45, s30, 32768
    buffer_load_dwordx4 v[56:59], v2, s[8:11], s45 offen offset:0 sc1
    buffer_load_dwordx4 v[60:63], v2, s[8:11], s45 offen offset:1024 sc1
    s_sub_u32 s54, s29, 64
    s_max_i32 s54, s54, 0
    s_and_b32 s42, s28, 63
    s_mul_i32 s32, s42, 32768
    s_add_u32 s32, s32, s50
    s_mul_i32 s33, s42, 32768
    s_add_u32 s33, s33, s51
    s_bfe_u32 s55, s28, 65539
    s_waitcnt vmcnt(4)
    v_lshlrev_b32 v16, 16, v104
    v_and_b32 v17, s38, v104
    v_lshlrev_b32 v18, 16, v105
    v_and_b32 v19, s38, v105
    v_lshlrev_b32 v20, 16, v106
    v_and_b32 v21, s38, v106
    v_lshlrev_b32 v22, 16, v107
    v_and_b32 v23, s38, v107
    v_lshlrev_b32 v24, 16, v108
    v_and_b32 v25, s38, v108
    v_lshlrev_b32 v26, 16, v109
    v_and_b32 v27, s38, v109
    v_lshlrev_b32 v28, 16, v110
    v_and_b32 v29, s38, v110
    v_lshlrev_b32 v30, 16, v111
    v_and_b32 v31, s38, v111
    s_waitcnt vmcnt(2)
    v_bitop3_b32 v10, v48, v52, s55 bitop3:66
    v_lshlrev_b32 v32, 16, v48
    v_and_b32 v33, s38, v48
    v_lshlrev_b32 v34, 16, v49
    v_and_b32 v35, s38, v49
    v_lshlrev_b32 v36, 16, v50
    v_and_b32 v37, s38, v50
    v_lshlrev_b32 v38, 16, v51
    v_and_b32 v39, s38, v51
    v_lshlrev_b32 v40, 16, v52
    v_and_b32 v41, s38, v52
    v_lshlrev_b32 v42, 16, v53
    v_and_b32 v43, s38, v53
    v_lshlrev_b32 v44, 16, v54
    v_and_b32 v45, s38, v54
    v_lshlrev_b32 v46, 16, v55
    v_and_b32 v47, s38, v55
    v_pk_add_f32 v[16:17], v[16:17], v[32:33]
    v_pk_add_f32 v[18:19], v[18:19], v[34:35]
    v_pk_add_f32 v[20:21], v[20:21], v[36:37]
    v_pk_add_f32 v[22:23], v[22:23], v[38:39]
    v_pk_add_f32 v[24:25], v[24:25], v[40:41]
    v_pk_add_f32 v[26:27], v[26:27], v[42:43]
    v_pk_add_f32 v[28:29], v[28:29], v[44:45]
    v_pk_add_f32 v[30:31], v[30:31], v[46:47]
    s_waitcnt vmcnt(0)
    v_bitop3_b32 v10, v10, v56, s55 bitop3:96
    v_bitop3_b32 v10, v10, v60, s55 bitop3:96
    v_and_b32 v10, 1, v10
    v_cmp_eq_u32 vcc, 0, v10
    v_lshlrev_b32 v32, 16, v56
    v_and_b32 v33, s38, v56
    v_lshlrev_b32 v34, 16, v57
    v_and_b32 v35, s38, v57
    v_lshlrev_b32 v36, 16, v58
    v_and_b32 v37, s38, v58
    v_lshlrev_b32 v38, 16, v59
    v_and_b32 v39, s38, v59
    v_lshlrev_b32 v40, 16, v60
    v_and_b32 v41, s38, v60
    v_lshlrev_b32 v42, 16, v61
    v_and_b32 v43, s38, v61
    v_lshlrev_b32 v44, 16, v62
    v_and_b32 v45, s38, v62
    v_lshlrev_b32 v46, 16, v63
    v_and_b32 v47, s38, v63
    v_pk_add_f32 v[16:17], v[16:17], v[32:33]
    v_pk_add_f32 v[18:19], v[18:19], v[34:35]
    v_pk_add_f32 v[20:21], v[20:21], v[36:37]
    v_pk_add_f32 v[22:23], v[22:23], v[38:39]
    v_pk_add_f32 v[24:25], v[24:25], v[40:41]
    v_pk_add_f32 v[26:27], v[26:27], v[42:43]
    v_pk_add_f32 v[28:29], v[28:29], v[44:45]
    v_pk_add_f32 v[30:31], v[30:31], v[46:47]
    s_branch L_join_40
L_notready_42:
    buffer_store_dwordx4 v[88:91], v2, s[8:11], s33 offen offset:0 sc1
    buffer_store_dwordx4 v[92:95], v2, s[8:11], s33 offen offset:1024 sc1
    v_mov_b32 v7, s28
    s_mov_b64 exec, 1
    buffer_store_dword v7, v4, s[8:11], s35 offen sc1
    s_mov_b64 exec, -1
    s_sub_u32 s54, s29, 64
    s_max_i32 s54, s54, 0
    s_and_b32 s42, s28, 63
    s_mul_i32 s32, s42, 32768
    s_add_u32 s32, s32, s50
    s_mul_i32 s33, s42, 32768
    s_add_u32 s33, s33, s51
    buffer_load_dword v6, v5, s[8:11], s34 offen sc1
    s_waitcnt vmcnt(0)
    s_cmp_eq_u32 s28, 64
    s_cbranch_scc1 L_fin_38
    v_cmp_gt_u32 vcc, s29, v6
    s_cbranch_vccz L_ld_37
    s_branch L_item_36
L_out_39:
    s_add_u32 s44, s36, 4096
    ds_write_b64 v115, v[80:81] offset:0
    ds_write_b64 v115, v[82:83] offset:16
    ds_write_b64 v115, v[84:85] offset:32
    ds_write_b64 v115, v[86:87] offset:48
    s_waitcnt lgkmcnt(0)
    ds_read_b128 v[88:91], v116 offset:0
    ds_read_b128 v[92:95], v116 offset:1088
    s_waitcnt lgkmcnt(0)
    buffer_store_dwordx4 v[88:91], v117, s[16:19], s36 offen sc1
    buffer_store_dwordx4 v[92:95], v117, s[16:19], s44 offen sc1
    s_add_u32 s28, s28, 1
    s_add_u32 s29, s29, 1
    s_and_b32 s42, s28, 7
    s_mul_i32 s30, s42, 65536
    s_add_u32 s30, s30, s48
    s_and_b32 s42, s28, 7
    s_mul_i32 s31, s42, 32768
    s_add_u32 s31, s31, s49
    s_add_u32 s36, s36, 32768
    v_mov_b32 v7, s28
    s_mov_b64 exec, 1
    buffer_store_dword v7, v4, s[8:11], s35 offen sc1
    s_mov_b64 exec, -1
    s_cmp_eq_u32 s28, 64
    s_cbranch_scc1 L_fin_38
    s_waitcnt vmcnt(3)
    v_cmp_gt_u32 vcc, s29, v6
    s_cbranch_vccz L_ld_37
    s_branch L_item_36
L_retry_41:
    s_cmp_eq_u32 s29, 0
    s_cbranch_scc1 L_retry_41_skip
    s_add_u32 s52, s52, 0x1001
    s_cmp_lt_u32 s52, 2147418112
    s_waitcnt vmcnt(0)
    s_cbranch_scc1 L_ld_37
    s_branch L_fail
L_fin_38:
    s_branch L_done
    .p2align 6
L_att:
    v_mov_b32 v100, v0
    v_lshlrev_b32 v0, 4, v100
    v_and_b32 v7, 0, v100
    v_lshlrev_b32 v7, 10, v7
    v_add_u32 v7, 4104, v7
    v_mov_b32 v1, 0
    s_mov_b32 s52, 0
    s_and_b32 s37, s24, 1
    s_lshr_b32 s42, s24, 1
    s_lshl_b32 s43, s26, 1
    s_add_u32 s43, s43, s42
    s_lshl_b32 s42, s27, 11
    s_add_u32 s42, s42, s43
    s_lshl_b32 s30, s42, 14
    s_add_u32 s30, s30, 8388608
    s_lshl_b32 s32, s42, 13
    s_add_u32 s31, s32, 75497472
    s_add_u32 s32, s32, 109051904
    s_lshl_b32 s33, s42, 13
    s_add_u32 s33, s33, 142606336
    s_lshl_b32 s42, s37, 12
    s_add_u32 s31, s31, s42
    s_lshl_b32 s42, s37, 8
    s_add_u32 s33, s33, s42
    s_lshl_b32 s42, s27, 5
    s_add_u32 s42, s42, s43
    s_lshl_b32 s42, s42, 7
    s_add_u32 s35, s42, 32768
    s_lshl_b32 s34, s27, 16
    s_add_u32 s34, s34, 622592
    s_mul_i32 s42, s43, 128
    s_add_u32 s34, s34, s42
    s_lshl_b32 s36, s27, 15
    s_add_u32 s36, s36, 425984
    s_mul_i32 s42, s26, 128
    s_add_u32 s36, s36, s42
    s_lshl_b32 s42, s24, 2
    s_add_u32 s36, s36, s42
    s_lshl_b32 s38, s24, 12
    v_and_b32 v2, 3, v100
    v_lshlrev_b32 v2, 2, v2
    s_and_b32 s42, s26, 12
    s_lshl_b32 s53, s27, 15
    s_add_u32 s53, s53, 98304
    v_lshrrev_b32 v15, 2, v100
    v_and_b32 v15, 3, v15
    v_mul_u32_u24 v15, 1024, v15
    v_and_b32 v101, 3, v100
    v_lshl_add_u32 v15, v101, 2, v15
    s_mov_b32 s92, s30
    s_mov_b32 s93, s31
    s_mov_b32 s94, s32
    s_mov_b32 s95, s33
    s_mov_b32 s40, 1040356334
    s_mov_b32 s41, 1040356334
    v_mov_b32 v6, 0
    s_mov_b64 exec, 1
    buffer_store_dword v6, v1, s[8:11], s36 offen sc1
    s_mov_b64 exec, -1
    v_mov_b64 v[16:17], 0
    v_mov_b64 v[18:19], 0
    s_mul_i32 s43, s37, 1048576
    s_add_u32 s43, s43, s32
    s_add_u32 s42, s43, 4096
    buffer_store_dwordx4 v[16:19], v0, s[8:11], s42 offen offset:0 sc1
    buffer_store_dwordx4 v[16:19], v0, s[8:11], s42 offen offset:1024 sc1
    buffer_store_dwordx4 v[16:19], v0, s[8:11], s42 offen offset:2048 sc1
    buffer_store_dwordx4 v[16:19], v0, s[8:11], s42 offen offset:3072 sc1
    s_add_u32 s42, s43, 266240
    buffer_store_dwordx4 v[16:19], v0, s[8:11], s42 offen offset:0 sc1
    buffer_store_dwordx4 v[16:19], v0, s[8:11], s42 offen offset:1024 sc1
    buffer_store_dwordx4 v[16:19], v0, s[8:11], s42 offen offset:2048 sc1
    buffer_store_dwordx4 v[16:19], v0, s[8:11], s42 offen offset:3072 sc1
    s_add_u32 s42, s43, 528384
    buffer_store_dwordx4 v[16:19], v0, s[8:11], s42 offen offset:0 sc1
    buffer_store_dwordx4 v[16:19], v0, s[8:11], s42 offen offset:1024 sc1
    buffer_store_dwordx4 v[16:19], v0, s[8:11], s42 offen offset:2048 sc1
    buffer_store_dwordx4 v[16:19], v0, s[8:11], s42 offen offset:3072 sc1
    s_add_u32 s42, s43, 790528
    buffer_store_dwordx4 v[16:19], v0, s[8:11], s42 offen offset:0 sc1
    buffer_store_dwordx4 v[16:19], v0, s[8:11], s42 offen offset:1024 sc1
    buffer_store_dwordx4 v[16:19], v0, s[8:11], s42 offen offset:2048 sc1
    buffer_store_dwordx4 v[16:19], v0, s[8:11], s42 offen offset:3072 sc1
    s_waitcnt vmcnt(0)
    s_barrier
    s_cmp_lg_u32 s24, 0
    s_cbranch_scc1 L_na_44
    v_mov_b32 v126, 1
    v_mov_b32 v127, 4
    s_mov_b64 exec, 1
    buffer_atomic_add v126, v127, s[12:15], 0 offen
    s_mov_b64 exec, -1
L_na_44:
    v_mov_b32 v4, 0
    v_bfe_i32 v101, v100, 0, 1
    v_and_b32 v101, 8, v101
    v_xor_b32 v4, v4, v101
    v_bfe_i32 v101, v100, 1, 1
    v_and_b32 v101, 16, v101
    v_xor_b32 v4, v4, v101
    v_bfe_i32 v101, v100, 2, 1
    v_and_b32 v101, 32, v101
    v_xor_b32 v4, v4, v101
    v_bfe_i32 v101, v100, 3, 1
    v_and_b32 v101, 64, v101
    v_xor_b32 v4, v4, v101
    v_bfe_i32 v101, v100, 4, 1
    v_and_b32 v101, 136, v101
    v_xor_b32 v4, v4, v101
    v_bfe_i32 v101, v100, 5, 1
    v_and_b32 v101, 512, v101
    v_xor_b32 v4, v4, v101
    v_add_u32 v4, s38, v4
    v_xor_b32 v5, 16, v4
    v_mov_b32 v8, 0
    v_bfe_i32 v101, v100, 0, 1
    v_and_b32 v101, 16, v101
    v_xor_b32 v8, v8, v101
    v_bfe_i32 v101, v100, 1, 1
    v_and_b32 v101, 32, v101
    v_xor_b32 v8, v8, v101
    v_bfe_i32 v101, v100, 2, 1
    v_and_b32 v101, 64, v101
    v_xor_b32 v8, v8, v101
    v_bfe_i32 v101, v100, 3, 1
    v_and_b32 v101, 128, v101
    v_xor_b32 v8, v8, v101
    v_bfe_i32 v101, v100, 4, 1
    v_and_b32 v101, 512, v101
    v_xor_b32 v8, v8, v101
    v_bfe_i32 v101, v100, 5, 1
    v_and_b32 v101, 1024, v101
    v_xor_b32 v8, v8, v101
    v_and_b32 v102, 15, v100
    v_lshrrev_b32 v103, 4, v100
    v_lshlrev_b32 v103, 2, v103
    v_sub_u32 v102, v102, v103
    v_cmp_le_i32 vcc, 0, v102
    s_nop 3
    s_cmp_eq_u32 s37, 0
    s_cselect_b64 s[44:45], vcc, -1
    s_cselect_b64 s[54:55], 0, vcc
    v_cmp_le_i32 vcc, 1, v102
    s_nop 3
    s_cmp_eq_u32 s37, 0
    s_cselect_b64 s[46:47], vcc, -1
    s_cselect_b64 s[56:57], 0, vcc
    v_cmp_le_i32 vcc, 2, v102
    s_nop 3
    s_cmp_eq_u32 s37, 0
    s_cselect_b64 s[48:49], vcc, -1
    s_cselect_b64 s[58:59], 0, vcc
    v_cmp_le_i32 vcc, 3, v102
    s_nop 3
    s_cmp_eq_u32 s37, 0
    s_cselect_b64 s[50:51], vcc, -1
    s_cselect_b64 s[60:61], 0, vcc
    v_mov_b32 v9, 0xff800000
    v_mov_b32 v96, 0
    v_mov_b32 v89, 0
    v_mov_b32 v90, 0
    s_cmp_eq_u32 s27, 0
    s_cselect_b32 s99, 0, 64
    v_mov_b32 v126, 132
    s_cmp_eq_u32 s99, 0
    s_cbranch_scc1 L_gate_45_ok
L_gate_45:
    s_sleep 8
    buffer_load_dword v127, v126, s[12:15], 0 offen sc1
    s_add_u32 s52, s52, 0x1000
    s_cmp_ge_u32 s52, 2147418112
    s_cbranch_scc1 L_fail
    s_waitcnt vmcnt(0)
    v_cmp_gt_u32 vcc, s99, v127
    s_cbranch_vccnz L_gate_45
L_gate_45_ok:
    v_mov_b64 v[16:17], 0
    v_mov_b64 v[18:19], 0
    s_add_u32 s42, s33, 0
    buffer_store_dwordx4 v[16:19], v8, s[8:11], s42 offen offset:0 sc1
    buffer_store_dwordx4 v[16:19], v8, s[8:11], s42 offen offset:2048 sc1
    s_add_u32 s42, s33, 4096
    buffer_store_dwordx4 v[16:19], v8, s[8:11], s42 offen offset:0 sc1
    buffer_store_dwordx4 v[16:19], v8, s[8:11], s42 offen offset:2048 sc1
    s_add_u32 s42, s33, 262144
    buffer_store_dwordx4 v[16:19], v8, s[8:11], s42 offen offset:0 sc1
    buffer_store_dwordx4 v[16:19], v8, s[8:11], s42 offen offset:2048 sc1
    s_add_u32 s42, s33, 266240
    buffer_store_dwordx4 v[16:19], v8, s[8:11], s42 offen offset:0 sc1
    buffer_store_dwordx4 v[16:19], v8, s[8:11], s42 offen offset:2048 sc1
    s_add_u32 s42, s33, 524288
    buffer_store_dwordx4 v[16:19], v8, s[8:11], s42 offen offset:0 sc1
    buffer_store_dwordx4 v[16:19], v8, s[8:11], s42 offen offset:2048 sc1
    s_add_u32 s42, s33, 528384
    buffer_store_dwordx4 v[16:19], v8, s[8:11], s42 offen offset:0 sc1
    buffer_store_dwordx4 v[16:19], v8, s[8:11], s42 offen offset:2048 sc1
    s_add_u32 s42, s33, 786432
    buffer_store_dwordx4 v[16:19], v8, s[8:11], s42 offen offset:0 sc1
    buffer_store_dwordx4 v[16:19], v8, s[8:11], s42 offen offset:2048 sc1
    s_add_u32 s42, s33, 790528
    buffer_store_dwordx4 v[16:19], v8, s[8:11], s42 offen offset:0 sc1
    buffer_store_dwordx4 v[16:19], v8, s[8:11], s42 offen offset:2048 sc1
    s_add_u32 s42, s33, 1048576
    buffer_store_dwordx4 v[16:19], v8, s[8:11], s42 offen offset:0 sc1
    buffer_store_dwordx4 v[16:19], v8, s[8:11], s42 offen offset:2048 sc1
    s_add_u32 s42, s33, 1052672
    buffer_store_dwordx4 v[16:19], v8, s[8:11], s42 offen offset:0 sc1
    buffer_store_dwordx4 v[16:19], v8, s[8:11], s42 offen offset:2048 sc1
    s_add_u32 s42, s33, 1310720
    buffer_store_dwordx4 v[16:19], v8, s[8:11], s42 offen offset:0 sc1
    buffer_store_dwordx4 v[16:19], v8, s[8:11], s42 offen offset:2048 sc1
    s_add_u32 s42, s33, 1314816
    buffer_store_dwordx4 v[16:19], v8, s[8:11], s42 offen offset:0 sc1
    buffer_store_dwordx4 v[16:19], v8, s[8:11], s42 offen offset:2048 sc1
    s_add_u32 s42, s33, 1572864
    buffer_store_dwordx4 v[16:19], v8, s[8:11], s42 offen offset:0 sc1
    buffer_store_dwordx4 v[16:19], v8, s[8:11], s42 offen offset:2048 sc1
    s_add_u32 s42, s33, 1576960
    buffer_store_dwordx4 v[16:19], v8, s[8:11], s42 offen offset:0 sc1
    buffer_store_dwordx4 v[16:19], v8, s[8:11], s42 offen offset:2048 sc1
    s_add_u32 s42, s33, 1835008
    buffer_store_dwordx4 v[16:19], v8, s[8:11], s42 offen offset:0 sc1
    buffer_store_dwordx4 v[16:19], v8, s[8:11], s42 offen offset:2048 sc1
    s_add_u32 s42, s33, 1839104
    buffer_store_dwordx4 v[16:19], v8, s[8:11], s42 offen offset:0 sc1
    buffer_store_dwordx4 v[16:19], v8, s[8:11], s42 offen offset:2048 sc1
    s_waitcnt vmcnt(0)
    s_mov_b32 s42, s31
    s_mov_b32 s99, 8
L_warm_46:
    buffer_load_dwordx4 v[16:19], v0, s[8:11], s42 offen offset:0 sc1
    buffer_load_dwordx4 v[20:23], v0, s[8:11], s42 offen offset:1024 sc1
    buffer_load_dwordx4 v[24:27], v0, s[8:11], s42 offen offset:2048 sc1
    buffer_load_dwordx4 v[28:31], v0, s[8:11], s42 offen offset:3072 sc1
    s_add_u32 s42, s42, 262144
    s_sub_u32 s99, s99, 1
    s_cmp_lg_u32 s99, 0
    s_cbranch_scc1 L_warm_46
    s_waitcnt vmcnt(0)
    s_mov_b32 s42, s33
    s_mov_b32 s99, 8
L_warm_47:
    buffer_load_dwordx4 v[16:19], v8, s[8:11], s42 offen offset:0 sc1
    buffer_load_dwordx4 v[20:23], v8, s[8:11], s42 offen offset:2048 sc1
    s_add_u32 s98, s42, 4096
    buffer_load_dwordx4 v[24:27], v8, s[8:11], s98 offen offset:0 sc1
    s_add_u32 s98, s42, 4096
    buffer_load_dwordx4 v[28:31], v8, s[8:11], s98 offen offset:2048 sc1
    s_add_u32 s42, s42, 262144
    s_sub_u32 s99, s99, 1
    s_cmp_lg_u32 s99, 0
    s_cbranch_scc1 L_warm_47
    s_waitcnt vmcnt(0)
    v_mbcnt_lo_u32_b32 v126, -1, 0
    v_mbcnt_hi_u32_b32 v126, -1, v126
    v_lshlrev_b32 v126, 5, v126
    v_cmp_gt_u32 vcc, 256, v126
    s_nop 1
    v_cndmask_b32 v126, 4, v126, vcc
    buffer_load_dword v127, v126, s[12:15], 0 offen sc1
    s_waitcnt vmcnt(0)
    v_readlane_b32 s98, v127, 8
    v_cmp_ne_u32 vcc, 32, v127
    s_nop 3
    s_and_b32 s5, vcc_lo, 0xff
    s_cmp_lt_u32 s98, 256
    s_cselect_b32 s98, 1, s5
    s_cmp_eq_u32 s98, 0
    s_cbranch_scc1 L_gw_48_done
L_gw_48:
    buffer_load_dword v127, v126, s[12:15], 0 offen sc1
    s_add_u32 s52, s52, 0x1000
    s_cmp_ge_u32 s52, 2147418112
    s_cbranch_scc1 L_fail
    s_waitcnt vmcnt(0)
    v_readlane_b32 s98, v127, 8
    s_nop 3
    s_cmp_ge_u32 s98, 256
    s_cbranch_scc1 L_gw_48_ok
    s_sleep 4
    s_branch L_gw_48
L_gw_48_ok:
    buffer_load_dword v127, v126, s[12:15], 0 offen sc1
    s_waitcnt vmcnt(0)
    v_cmp_ne_u32 vcc, 32, v127
    s_nop 3
    s_and_b32 s5, vcc_lo, 0xff
L_gw_48_done:
    s_cmp_lg_u32 s5, 0
    s_cbranch_scc1 L_nonlocal_49
    s_mov_b32 s28, 0
    s_mov_b32 s29, 1
    s_add_u32 s63, s30, 4096
    s_add_u32 s16, s30, 8192
    s_add_u32 s17, s30, 12288
L_pq_52:
    buffer_load_dword v14, v2, s[8:11], s34 offen sc1
    s_waitcnt vmcnt(0)
    v_cmp_gt_u32 vcc, s29, v14
    s_add_u32 s52, s52, 0x1000
    s_cmp_lt_u32 s52, 2147418112
    s_cbranch_vccz L_pq_52_ok
    s_sleep 1
    s_cbranch_scc1 L_pq_52
    s_branch L_fail
L_pq_52_ok:
    buffer_load_dwordx4 a[0:3], v0, s[8:11], s31 offen offset:0 sc1
    buffer_load_dwordx4 a[4:7], v0, s[8:11], s31 offen offset:1024 sc1
    buffer_load_dwordx4 a[8:11], v0, s[8:11], s31 offen offset:2048 sc1
    buffer_load_dwordx4 a[12:15], v0, s[8:11], s31 offen offset:3072 sc1
    buffer_load_dwordx4 a[16:19], v0, s[8:11], s30 offen offset:0 sc1
    buffer_load_dwordx4 a[20:23], v0, s[8:11], s30 offen offset:1024 sc1
    buffer_load_dwordx4 a[24:27], v0, s[8:11], s30 offen offset:2048 sc1
    buffer_load_dwordx4 a[28:31], v0, s[8:11], s30 offen offset:3072 sc1
    buffer_load_dwordx4 a[32:35], v0, s[8:11], s63 offen offset:0 sc1
    buffer_load_dwordx4 a[36:39], v0, s[8:11], s63 offen offset:1024 sc1
    buffer_load_dwordx4 a[40:43], v0, s[8:11], s63 offen offset:2048 sc1
    buffer_load_dwordx4 a[44:47], v0, s[8:11], s63 offen offset:3072 sc1
    buffer_load_dwordx4 a[48:51], v0, s[8:11], s16 offen offset:0 sc1
    buffer_load_dwordx4 a[52:55], v0, s[8:11], s16 offen offset:1024 sc1
    buffer_load_dwordx4 a[56:59], v0, s[8:11], s16 offen offset:2048 sc1
    buffer_load_dwordx4 a[60:63], v0, s[8:11], s16 offen offset:3072 sc1
    buffer_load_dwordx4 a[64:67], v0, s[8:11], s17 offen offset:0 sc1
    buffer_load_dwordx4 a[68:71], v0, s[8:11], s17 offen offset:1024 sc1
    buffer_load_dwordx4 a[72:75], v0, s[8:11], s17 offen offset:2048 sc1
    buffer_load_dwordx4 a[76:79], v0, s[8:11], s17 offen offset:3072 sc1
    s_waitcnt vmcnt(0)
L_top_53:
    s_and_b32 s42, s28, 7
    s_mul_i32 s32, s42, 262144
    s_add_u32 s32, s32, s94
    s_sub_u32 s62, s29, 8
    s_max_i32 s62, s62, 0
    v_cmp_gt_u32 vcc, s62, v96
    s_cbranch_vccz L_lazy_55
    buffer_load_dword v96, v15, s[8:11], s53 offen sc1
L_lazy_55:
    buffer_load_dword v14, v2, s[8:11], s34 offen sc1
    buffer_load_dword v3, v7, s[8:11], s32 offen sc1
    v_mfma_f32_16x16x32_bf16 v[104:107], a[16:19], a[0:3], 0
    v_mfma_f32_16x16x32_bf16 v[108:111], a[32:35], a[0:3], 0
    v_mfma_f32_16x16x32_bf16 v[104:107], a[20:23], a[4:7], v[104:107]
    v_mfma_f32_16x16x32_bf16 v[108:111], a[36:39], a[4:7], v[108:111]
    v_mfma_f32_16x16x32_bf16 v[104:107], a[24:27], a[8:11], v[104:107]
    v_mfma_f32_16x16x32_bf16 v[108:111], a[40:43], a[8:11], v[108:111]
    v_mfma_f32_16x16x32_bf16 v[104:107], a[28:31], a[12:15], v[104:107]
    v_mfma_f32_16x16x32_bf16 v[108:111], a[44:47], a[12:15], v[108:111]
    s_add_u32 s39, s29, 1
    s_min_u32 s39, s39, 64
    s_sub_u32 s62, s29, 8
    s_max_i32 s62, s62, 0
    s_sub_u32 s42, s39, 1
    s_and_b32 s42, s42, 7
    s_mul_i32 s30, s42, 524288
    s_add_u32 s30, s30, s92
    s_mul_i32 s31, s42, 262144
    s_add_u32 s31, s31, s93
    s_and_b32 s42, s28, 7
    s_mul_i32 s33, s42, 262144
    s_add_u32 s33, s33, s95
    s_add_u32 s63, s30, 4096
    s_add_u32 s16, s30, 8192
    s_add_u32 s17, s30, 12288
    s_mov_b32 m0, s38
    s_add_u32 s35, s32, 4096
    s_branch L_pm_54_c
L_pm_54:
    buffer_load_dword v14, v2, s[8:11], s34 offen sc1
    buffer_load_dword v96, v15, s[8:11], s53 offen sc1
    buffer_load_dword v3, v7, s[8:11], s32 offen sc1
L_pm_54_c:
    s_waitcnt vmcnt(0)
    v_cmp_ne_u32 vcc, s29, v3
    v_cmp_gt_u32 s[18:19], s39, v14
    v_cmp_gt_u32 s[6:7], s62, v96
    s_add_u32 s52, s52, 0x1000
    s_nop 1
    s_or_b64 s[6:7], s[6:7], s[18:19]
    s_cbranch_scc1 L_pm_54_a
    s_cbranch_vccnz L_pm_54_b
L_pm_54_ok:
    buffer_load_dwordx4 v0, s[8:11], s32 offen offset:0 sc1  lds
    buffer_load_dwordx4 v0, s[8:11], s32 offen offset:1024 sc1  lds
    buffer_load_dwordx4 v0, s[8:11], s32 offen offset:2048 sc1  lds
    buffer_load_dwordx4 v0, s[8:11], s32 offen offset:3072 sc1  lds
    buffer_load_dwordx4 v[128:131], v0, s[8:11], s35 offen offset:0 sc1
    buffer_load_dwordx4 v[132:135], v0, s[8:11], s35 offen offset:1024 sc1
    buffer_load_dwordx4 v[136:139], v0, s[8:11], s35 offen offset:2048 sc1
    buffer_load_dwordx4 v[140:143], v0, s[8:11], s35 offen offset:3072 sc1
    buffer_load_dwordx4 a[80:83], v0, s[8:11], s31 offen offset:0 sc1
    buffer_load_dwordx4 a[84:87], v0, s[8:11], s31 offen offset:1024 sc1
    buffer_load_dwordx4 a[88:91], v0, s[8:11], s31 offen offset:2048 sc1
    buffer_load_dwordx4 a[92:95], v0, s[8:11], s31 offen offset:3072 sc1
    buffer_load_dwordx4 a[96:99], v0, s[8:11], s30 offen offset:0 sc1
    buffer_load_dwordx4 a[100:103], v0, s[8:11], s30 offen offset:1024 sc1
    v_cndmask_b32 v104, v9, v104, s[44:45]
    v_cndmask_b32 v105, v9, v105, s[46:47]
    v_cndmask_b32 v106, v9, v106, s[48:49]
    v_cndmask_b32 v107, v9, v107, s[50:51]
    v_cndmask_b32 v108, v9, v108, s[54:55]
    v_cndmask_b32 v109, v9, v109, s[56:57]
    v_cndmask_b32 v110, v9, v110, s[58:59]
    v_cndmask_b32 v111, v9, v111, s[60:61]
    v_max3_f32 v10, v104, v105, v106
    v_max3_f32 v11, v107, v108, v109
    v_max3_f32 v10, v10, v110, v111
    v_max_f32 v10, v10, v11
    s_nop 0
    s_waitcnt vmcnt(13)
    ds_read_b64_tr_b16 v[64:65], v4 offset:0
    ds_read_b64_tr_b16 v[66:67], v5 offset:256
    s_waitcnt vmcnt(12)
    ds_read_b64_tr_b16 v[68:69], v4 offset:1024
    ds_read_b64_tr_b16 v[70:71], v5 offset:1280
    s_waitcnt vmcnt(11)
    ds_read_b64_tr_b16 v[72:73], v4 offset:2048
    ds_read_b64_tr_b16 v[74:75], v5 offset:2304
    s_waitcnt vmcnt(10)
    ds_read_b64_tr_b16 v[76:77], v4 offset:3072
    ds_read_b64_tr_b16 v[78:79], v5 offset:3328
    buffer_load_dwordx4 a[104:107], v0, s[8:11], s30 offen offset:2048 sc1
    s_waitcnt lgkmcnt(6)
    v_mfma_f32_16x16x32_bf16 v[112:115], v[64:67], a[0:3], 0
    s_waitcnt lgkmcnt(4)
    v_mfma_f32_16x16x32_bf16 v[112:115], v[68:71], a[4:7], v[112:115]
    s_waitcnt lgkmcnt(2)
    v_mfma_f32_16x16x32_bf16 v[112:115], v[72:75], a[8:11], v[112:115]
    s_waitcnt lgkmcnt(0)
    v_mfma_f32_16x16x32_bf16 v[112:115], v[76:79], a[12:15], v[112:115]
    buffer_load_dwordx4 a[108:111], v0, s[8:11], s30 offen offset:3072 sc1
    s_nop 6
    v_max3_f32 v11, v10, v112, v113
    v_max3_f32 v10, v10, v112, v113
    s_nop 0
    buffer_load_dwordx4 a[112:115], v0, s[8:11], s63 offen offset:0 sc1
    v_permlane32_swap_b32 v10, v11
    v_max_f32 v12, v10, v11
    v_max_f32 v13, v10, v11
    s_nop 1
    v_permlane16_swap_b32 v12, v13
    v_max_f32 v10, v12, v13
    v_mul_f32 v10, s40, v10
    buffer_load_dwordx4 a[116:119], v0, s[8:11], s63 offen offset:1024 sc1
    v_pk_fma_f32 v[104:105], v[104:105], s[40:41], v[10:11] op_sel_hi:[1,1,0] neg_lo:[0,0,1] neg_hi:[0,0,1]
    v_pk_fma_f32 v[106:107], v[106:107], s[40:41], v[10:11] op_sel_hi:[1,1,0] neg_lo:[0,0,1] neg_hi:[0,0,1]
    v_pk_fma_f32 v[108:109], v[108:109], s[40:41], v[10:11] op_sel_hi:[1,1,0] neg_lo:[0,0,1] neg_hi:[0,0,1]
    v_pk_fma_f32 v[110:111], v[110:111], s[40:41], v[10:11] op_sel_hi:[1,1,0] neg_lo:[0,0,1] neg_hi:[0,0,1]
    v_pk_fma_f32 v[112:113], v[112:113], s[40:41], v[10:11] op_sel_hi:[1,1,0] neg_lo:[0,0,1] neg_hi:[0,0,1]
    v_exp_f32 v104, v104
    v_exp_f32 v105, v105
    v_exp_f32 v106, v106
    v_cvt_pk_bf16_f32 v92, v104, v105
    v_exp_f32 v107, v107
    buffer_load_dwordx4 a[120:123], v0, s[8:11], s63 offen offset:2048 sc1
    v_exp_f32 v108, v108
    v_cvt_pk_bf16_f32 v93, v106, v107
    v_exp_f32 v109, v109
    v_pk_add_f32 v[12:13], v[104:105], v[106:107]
    v_exp_f32 v110, v110
    v_cvt_pk_bf16_f32 v94, v108, v109
    v_exp_f32 v111, v111
    buffer_load_dwordx4 a[124:127], v0, s[8:11], s63 offen offset:3072 sc1
    v_pk_add_f32 v[12:13], v[12:13], v[108:109]
    v_exp_f32 v112, v112
    v_cvt_pk_bf16_f32 v95, v110, v111
    v_exp_f32 v113, v113
    v_pk_add_f32 v[12:13], v[12:13], v[110:111]
    v_cvt_pk_bf16_f32 v88, v112, v113
    v_cvt_pk_bf16_f32 v91, v112, v113
    v_pk_add_f32 v[12:13], v[12:13], v[112:113]
    s_waitcnt vmcnt(12)
L_vtag_56_c:
    v_bitop3_b32 v10, v130, v134, s29 bitop3:126
    v_bitop3_b32 v11, v138, v142, s29 bitop3:126
    v_or_b32 v10, v10, v11
    v_cmp_ne_u32 vcc, 0, v10
    s_cbranch_vccnz L_vtag_56
    s_add_u32 s29, s29, 1
    s_add_u32 s42, s33, 4096
    s_bfe_u32 s76, s28, 65539
    s_xor_b32 s76, s76, 1
    v_mfma_f32_16x16x32_bf16 v[160:163], a[48:51], v[92:95], 0
    v_add_f32 v10, v12, v13
    v_add_f32 v11, v12, v13
    v_mfma_f32_16x16x32_bf16 v[164:167], a[52:55], v[92:95], 0
    s_nop 1
    v_permlane32_swap_b32 v10, v11
    v_mfma_f32_16x16x16_bf16 v[160:163], v[128:129], v[88:89], v[160:163]
    v_add_f32 v12, v10, v11
    v_add_f32 v13, v10, v11
    v_mfma_f32_16x16x16_bf16 v[164:167], v[128:129], v[90:91], v[164:167]
    s_nop 1
    v_permlane16_swap_b32 v12, v13
    v_mfma_f32_16x16x32_bf16 v[168:171], a[56:59], v[92:95], 0
    v_add_f32 v10, v12, v13
    v_rcp_f32 v10, v10
    v_mfma_f32_16x16x32_bf16 v[172:175], a[60:63], v[92:95], 0
    s_nop 0
    v_mfma_f32_16x16x16_bf16 v[168:171], v[132:133], v[88:89], v[168:171]
    v_mul_f32 v160, v160, v10
    v_mul_f32 v161, v161, v10
    v_mfma_f32_16x16x16_bf16 v[172:175], v[132:133], v[90:91], v[172:175]
    v_mul_f32 v162, v162, v10
    v_mul_f32 v163, v163, v10
    v_mfma_f32_16x16x32_bf16 v[176:179], a[64:67], v[92:95], 0
    v_mul_f32 v164, v164, v10
    v_mul_f32 v165, v165, v10
    v_mfma_f32_16x16x32_bf16 v[180:183], a[68:71], v[92:95], 0
    v_mul_f32 v166, v166, v10
    v_mul_f32 v167, v167, v10
    v_mfma_f32_16x16x16_bf16 v[176:179], v[136:137], v[88:89], v[176:179]
    v_cvt_pk_bf16_f32 v116, v160, v161
    v_cvt_pk_bf16_f32 v117, v162, v163
    v_mfma_f32_16x16x16_bf16 v[180:183], v[136:137], v[90:91], v[180:183]
    v_cvt_pk_bf16_f32 v118, v164, v165
    v_cvt_pk_bf16_f32 v119, v166, v167
    v_mfma_f32_16x16x32_bf16 v[184:187], a[72:75], v[92:95], 0
    v_and_or_b32 v116, v116, -2, s76
    buffer_store_dwordx4 v[116:119], v8, s[8:11], s33 offen offset:0
    v_mfma_f32_16x16x32_bf16 v[188:191], a[76:79], v[92:95], 0
    v_mul_f32 v168, v168, v10
    v_mul_f32 v169, v169, v10
    v_mfma_f32_16x16x16_bf16 v[184:187], v[140:141], v[88:89], v[184:187]
    v_mul_f32 v170, v170, v10
    v_mul_f32 v171, v171, v10
    v_mfma_f32_16x16x16_bf16 v[188:191], v[140:141], v[90:91], v[188:191]
    v_mul_f32 v172, v172, v10
    v_mul_f32 v173, v173, v10
    v_mul_f32 v174, v174, v10
    v_mul_f32 v175, v175, v10
    v_cvt_pk_bf16_f32 v120, v168, v169
    v_cvt_pk_bf16_f32 v121, v170, v171
    v_cvt_pk_bf16_f32 v122, v172, v173
    v_cvt_pk_bf16_f32 v123, v174, v175
    v_and_or_b32 v120, v120, -2, s76
    buffer_store_dwordx4 v[120:123], v8, s[8:11], s33 offen offset:2048
    v_mul_f32 v176, v176, v10
    v_mul_f32 v177, v177, v10
    v_mul_f32 v178, v178, v10
    v_mul_f32 v179, v179, v10
    v_mul_f32 v180, v180, v10
    v_mul_f32 v181, v181, v10
    v_mul_f32 v182, v182, v10
    v_mul_f32 v183, v183, v10
    v_cvt_pk_bf16_f32 v116, v176, v177
    v_cvt_pk_bf16_f32 v117, v178, v179
    v_cvt_pk_bf16_f32 v118, v180, v181
    v_cvt_pk_bf16_f32 v119, v182, v183
    v_and_or_b32 v116, v116, -2, s76
    buffer_store_dwordx4 v[116:119], v8, s[8:11], s42 offen offset:0
    v_mul_f32 v184, v184, v10
    v_mul_f32 v185, v185, v10
    v_mul_f32 v186, v186, v10
    v_mul_f32 v187, v187, v10
    v_mul_f32 v188, v188, v10
    v_mul_f32 v189, v189, v10
    v_mul_f32 v190, v190, v10
    v_mul_f32 v191, v191, v10
    v_cvt_pk_bf16_f32 v120, v184, v185
    v_cvt_pk_bf16_f32 v121, v186, v187
    v_cvt_pk_bf16_f32 v122, v188, v189
    v_cvt_pk_bf16_f32 v123, v190, v191
    v_and_or_b32 v120, v120, -2, s76
    buffer_store_dwordx4 v[120:123], v8, s[8:11], s42 offen offset:2048
    s_add_u32 s28, s28, 1
    v_mov_b32 v6, s28
    s_mov_b64 exec, 1
    buffer_store_dword v6, v1, s[8:11], s36 offen
    s_mov_b64 exec, -1
    buffer_load_dwordx4 a[128:131], v0, s[8:11], s16 offen offset:0 sc1
    buffer_load_dwordx4 a[132:135], v0, s[8:11], s16 offen offset:1024 sc1
    buffer_load_dwordx4 a[136:139], v0, s[8:11], s16 offen offset:2048 sc1
    buffer_load_dwordx4 a[140:143], v0, s[8:11], s16 offen offset:3072 sc1
    buffer_load_dwordx4 a[144:147], v0, s[8:11], s17 offen offset:0 sc1
    buffer_load_dwordx4 a[148:151], v0, s[8:11], s17 offen offset:1024 sc1
    buffer_load_dwordx4 a[152:155], v0, s[8:11], s17 offen offset:2048 sc1
    buffer_load_dwordx4 a[156:159], v0, s[8:11], s17 offen offset:3072 sc1
    s_waitcnt vmcnt(13)
L_half1_51:
    s_and_b32 s42, s28, 7
    s_mul_i32 s32, s42, 262144
    s_add_u32 s32, s32, s94
    s_sub_u32 s62, s29, 8
    s_max_i32 s62, s62, 0
    v_cmp_gt_u32 vcc, s62, v96
    s_cbranch_vccz L_lazy_58
    buffer_load_dword v96, v15, s[8:11], s53 offen sc1
L_lazy_58:
    buffer_load_dword v14, v2, s[8:11], s34 offen sc1
    buffer_load_dword v3, v7, s[8:11], s32 offen sc1
    v_mfma_f32_16x16x32_bf16 v[104:107], a[96:99], a[80:83], 0
    v_mfma_f32_16x16x32_bf16 v[108:111], a[112:115], a[80:83], 0
    v_mfma_f32_16x16x32_bf16 v[104:107], a[100:103], a[84:87], v[104:107]
    v_mfma_f32_16x16x32_bf16 v[108:111], a[116:119], a[84:87], v[108:111]
    v_mfma_f32_16x16x32_bf16 v[104:107], a[104:107], a[88:91], v[104:107]
    v_mfma_f32_16x16x32_bf16 v[108:111], a[120:123], a[88:91], v[108:111]
    v_mfma_f32_16x16x32_bf16 v[104:107], a[108:111], a[92:95], v[104:107]
    v_mfma_f32_16x16x32_bf16 v[108:111], a[124:127], a[92:95], v[108:111]
    s_add_u32 s39, s29, 1
    s_min_u32 s39, s39, 64
    s_sub_u32 s62, s29, 8
    s_max_i32 s62, s62, 0
    s_sub_u32 s42, s39, 1
    s_and_b32 s42, s42, 7
    s_mul_i32 s30, s42, 524288
    s_add_u32 s30, s30, s92
    s_mul_i32 s31, s42, 262144
    s_add_u32 s31, s31, s93
    s_and_b32 s42, s28, 7
    s_mul_i32 s33, s42, 262144
    s_add_u32 s33, s33, s95
    s_add_u32 s63, s30, 4096
    s_add_u32 s16, s30, 8192
    s_add_u32 s17, s30, 12288
    s_mov_b32 m0, s38
    s_add_u32 s35, s32, 4096
    s_branch L_pm_57_c
L_pm_57:
    buffer_load_dword v14, v2, s[8:11], s34 offen sc1
    buffer_load_dword v96, v15, s[8:11], s53 offen sc1
    buffer_load_dword v3, v7, s[8:11], s32 offen sc1
L_pm_57_c:
    s_waitcnt vmcnt(0)
    v_cmp_ne_u32 vcc, s29, v3
    v_cmp_gt_u32 s[18:19], s39, v14
    v_cmp_gt_u32 s[6:7], s62, v96
    s_add_u32 s52, s52, 0x1000
    s_nop 1
    s_or_b64 s[6:7], s[6:7], s[18:19]
    s_cbranch_scc1 L_pm_57_a
    s_cbranch_vccnz L_pm_57_b
L_pm_57_ok:
    buffer_load_dwordx4 v0, s[8:11], s32 offen offset:0 sc1  lds
    buffer_load_dwordx4 v0, s[8:11], s32 offen offset:1024 sc1  lds
    buffer_load_dwordx4 v0, s[8:11], s32 offen offset:2048 sc1  lds
    buffer_load_dwordx4 v0, s[8:11], s32 offen offset:3072 sc1  lds
    buffer_load_dwordx4 v[128:131], v0, s[8:11], s35 offen offset:0 sc1
    buffer_load_dwordx4 v[132:135], v0, s[8:11], s35 offen offset:1024 sc1
    buffer_load_dwordx4 v[136:139], v0, s[8:11], s35 offen offset:2048 sc1
    buffer_load_dwordx4 v[140:143], v0, s[8:11], s35 offen offset:3072 sc1
    buffer_load_dwordx4 a[0:3], v0, s[8:11], s31 offen offset:0 sc1
    buffer_load_dwordx4 a[4:7], v0, s[8:11], s31 offen offset:1024 sc1
    buffer_load_dwordx4 a[8:11], v0, s[8:11], s31 offen offset:2048 sc1
    buffer_load_dwordx4 a[12:15], v0, s[8:11], s31 offen offset:3072 sc1
    buffer_load_dwordx4 a[16:19], v0, s[8:11], s30 offen offset:0 sc1
    buffer_load_dwordx4 a[20:23], v0, s[8:11], s30 offen offset:1024 sc1
    v_cndmask_b32 v104, v9, v104, s[44:45]
    v_cndmask_b32 v105, v9, v105, s[46:47]
    v_cndmask_b32 v106, v9, v106, s[48:49]
    v_cndmask_b32 v107, v9, v107, s[50:51]
    v_cndmask_b32 v108, v9, v108, s[54:55]
    v_cndmask_b32 v109, v9, v109, s[56:57]
    v_cndmask_b32 v110, v9, v110, s[58:59]
    v_cndmask_b32 v111, v9, v111, s[60:61]
    v_max3_f32 v10, v104, v105, v106
    v_max3_f32 v11, v107, v108, v109
    v_max3_f32 v10, v10, v110, v111
    v_max_f32 v10, v10, v11
    s_nop 0
    s_waitcnt vmcnt(13)
    ds_read_b64_tr_b16 v[64:65], v4 offset:0
    ds_read_b64_tr_b16 v[66:67], v5 offset:256
    s_waitcnt vmcnt(12)
    ds_read_b64_tr_b16 v[68:69], v4 offset:1024
    ds_read_b64_tr_b16 v[70:71], v5 offset:1280
    s_waitcnt vmcnt(11)
    ds_read_b64_tr_b16 v[72:73], v4 offset:2048
    ds_read_b64_tr_b16 v[74:75], v5 offset:2304
    s_waitcnt vmcnt(10)
    ds_read_b64_tr_b16 v[76:77], v4 offset:3072
    ds_read_b64_tr_b16 v[78:79], v5 offset:3328
    buffer_load_dwordx4 a[24:27], v0, s[8:11], s30 offen offset:2048 sc1
    s_waitcnt lgkmcnt(6)
    v_mfma_f32_16x16x32_bf16 v[112:115], v[64:67], a[80:83], 0
    s_waitcnt lgkmcnt(4)
    v_mfma_f32_16x16x32_bf16 v[112:115], v[68:71], a[84:87], v[112:115]
    s_waitcnt lgkmcnt(2)
    v_mfma_f32_16x16x32_bf16 v[112:115], v[72:75], a[88:91], v[112:115]
    s_waitcnt lgkmcnt(0)
    v_mfma_f32_16x16x32_bf16 v[112:115], v[76:79], a[92:95], v[112:115]
    buffer_load_dwordx4 a[28:31], v0, s[8:11], s30 offen offset:3072 sc1
    s_nop 6
    v_max3_f32 v11, v10, v112, v113
    v_max3_f32 v10, v10, v112, v113
    s_nop 0
    buffer_load_dwordx4 a[32:35], v0, s[8:11], s63 offen offset:0 sc1
    v_permlane32_swap_b32 v10, v11
    v_max_f32 v12, v10, v11
    v_max_f32 v13, v10, v11
    s_nop 1
    v_permlane16_swap_b32 v12, v13
    v_max_f32 v10, v12, v13
    v_mul_f32 v10, s40, v10
    buffer_load_dwordx4 a[36:39], v0, s[8:11], s63 offen offset:1024 sc1
    v_pk_fma_f32 v[104:105], v[104:105], s[40:41], v[10:11] op_sel_hi:[1,1,0] neg_lo:[0,0,1] neg_hi:[0,0,1]
    v_pk_fma_f32 v[106:107], v[106:107], s[40:41], v[10:11] op_sel_hi:[1,1,0] neg_lo:[0,0,1] neg_hi:[0,0,1]
    v_pk_fma_f32 v[108:109], v[108:109], s[40:41], v[10:11] op_sel_hi:[1,1,0] neg_lo:[0,0,1] neg_hi:[0,0,1]
    v_pk_fma_f32 v[110:111], v[110:111], s[40:41], v[10:11] op_sel_hi:[1,1,0] neg_lo:[0,0,1] neg_hi:[0,0,1]
    v_pk_fma_f32 v[112:113], v[112:113], s[40:41], v[10:11] op_sel_hi:[1,1,0] neg_lo:[0,0,1] neg_hi:[0,0,1]
    v_exp_f32 v104, v104
    v_exp_f32 v105, v105
    v_exp_f32 v106, v106
    v_cvt_pk_bf16_f32 v92, v104, v105
    v_exp_f32 v107, v107
    buffer_load_dwordx4 a[40:43], v0, s[8:11], s63 offen offset:2048 sc1
    v_exp_f32 v108, v108
    v_cvt_pk_bf16_f32 v93, v106, v107
    v_exp_f32 v109, v109
    v_pk_add_f32 v[12:13], v[104:105], v[106:107]
    v_exp_f32 v110, v110
    v_cvt_pk_bf16_f32 v94, v108, v109
    v_exp_f32 v111, v111
    buffer_load_dwordx4 a[44:47], v0, s[8:11], s63 offen offset:3072 sc1
    v_pk_add_f32 v[12:13], v[12:13], v[108:109]
    v_exp_f32 v112, v112
    v_cvt_pk_bf16_f32 v95, v110, v111
    v_exp_f32 v113, v113
    v_pk_add_f32 v[12:13], v[12:13], v[110:111]
    v_cvt_pk_bf16_f32 v88, v112, v113
    v_cvt_pk_bf16_f32 v91, v112, v113
    v_pk_add_f32 v[12:13], v[12:13], v[112:113]
    s_waitcnt vmcnt(12)
L_vtag_59_c:
    v_bitop3_b32 v10, v130, v134, s29 bitop3:126
    v_bitop3_b32 v11, v138, v142, s29 bitop3:126
    v_or_b32 v10, v10, v11
    v_cmp_ne_u32 vcc, 0, v10
    s_cbranch_vccnz L_vtag_59
    s_add_u32 s29, s29, 1
    s_add_u32 s42, s33, 4096
    s_bfe_u32 s76, s28, 65539
    s_xor_b32 s76, s76, 1
    v_mfma_f32_16x16x32_bf16 v[160:163], a[128:131], v[92:95], 0
    v_add_f32 v10, v12, v13
    v_add_f32 v11, v12, v13
    v_mfma_f32_16x16x32_bf16 v[164:167], a[132:135], v[92:95], 0
    s_nop 1
    v_permlane32_swap_b32 v10, v11
    v_mfma_f32_16x16x16_bf16 v[160:163], v[128:129], v[88:89], v[160:163]
    v_add_f32 v12, v10, v11
    v_add_f32 v13, v10, v11
    v_mfma_f32_16x16x16_bf16 v[164:167], v[128:129], v[90:91], v[164:167]
    s_nop 1
    v_permlane16_swap_b32 v12, v13
    v_mfma_f32_16x16x32_bf16 v[168:171], a[136:139], v[92:95], 0
    v_add_f32 v10, v12, v13
    v_rcp_f32 v10, v10
    v_mfma_f32_16x16x32_bf16 v[172:175], a[140:143], v[92:95], 0
    s_nop 0
    v_mfma_f32_16x16x16_bf16 v[168:171], v[132:133], v[88:89], v[168:171]
    v_mul_f32 v160, v160, v10
    v_mul_f32 v161, v161, v10
    v_mfma_f32_16x16x16_bf16 v[172:175], v[132:133], v[90:91], v[172:175]
    v_mul_f32 v162, v162, v10
    v_mul_f32 v163, v163, v10
    v_mfma_f32_16x16x32_bf16 v[176:179], a[144:147], v[92:95], 0
    v_mul_f32 v164, v164, v10
    v_mul_f32 v165, v165, v10
    v_mfma_f32_16x16x32_bf16 v[180:183], a[148:151], v[92:95], 0
    v_mul_f32 v166, v166, v10
    v_mul_f32 v167, v167, v10
    v_mfma_f32_16x16x16_bf16 v[176:179], v[136:137], v[88:89], v[176:179]
    v_cvt_pk_bf16_f32 v116, v160, v161
    v_cvt_pk_bf16_f32 v117, v162, v163
    v_mfma_f32_16x16x16_bf16 v[180:183], v[136:137], v[90:91], v[180:183]
    v_cvt_pk_bf16_f32 v118, v164, v165
    v_cvt_pk_bf16_f32 v119, v166, v167
    v_mfma_f32_16x16x32_bf16 v[184:187], a[152:155], v[92:95], 0
    v_and_or_b32 v116, v116, -2, s76
    buffer_store_dwordx4 v[116:119], v8, s[8:11], s33 offen offset:0
    v_mfma_f32_16x16x32_bf16 v[188:191], a[156:159], v[92:95], 0
    v_mul_f32 v168, v168, v10
    v_mul_f32 v169, v169, v10
    v_mfma_f32_16x16x16_bf16 v[184:187], v[140:141], v[88:89], v[184:187]
    v_mul_f32 v170, v170, v10
    v_mul_f32 v171, v171, v10
    v_mfma_f32_16x16x16_bf16 v[188:191], v[140:141], v[90:91], v[188:191]
    v_mul_f32 v172, v172, v10
    v_mul_f32 v173, v173, v10
    v_mul_f32 v174, v174, v10
    v_mul_f32 v175, v175, v10
    v_cvt_pk_bf16_f32 v120, v168, v169
    v_cvt_pk_bf16_f32 v121, v170, v171
    v_cvt_pk_bf16_f32 v122, v172, v173
    v_cvt_pk_bf16_f32 v123, v174, v175
    v_and_or_b32 v120, v120, -2, s76
    buffer_store_dwordx4 v[120:123], v8, s[8:11], s33 offen offset:2048
    v_mul_f32 v176, v176, v10
    v_mul_f32 v177, v177, v10
    v_mul_f32 v178, v178, v10
    v_mul_f32 v179, v179, v10
    v_mul_f32 v180, v180, v10
    v_mul_f32 v181, v181, v10
    v_mul_f32 v182, v182, v10
    v_mul_f32 v183, v183, v10
    v_cvt_pk_bf16_f32 v116, v176, v177
    v_cvt_pk_bf16_f32 v117, v178, v179
    v_cvt_pk_bf16_f32 v118, v180, v181
    v_cvt_pk_bf16_f32 v119, v182, v183
    v_and_or_b32 v116, v116, -2, s76
    buffer_store_dwordx4 v[116:119], v8, s[8:11], s42 offen offset:0
    v_mul_f32 v184, v184, v10
    v_mul_f32 v185, v185, v10
    v_mul_f32 v186, v186, v10
    v_mul_f32 v187, v187, v10
    v_mul_f32 v188, v188, v10
    v_mul_f32 v189, v189, v10
    v_mul_f32 v190, v190, v10
    v_mul_f32 v191, v191, v10
    v_cvt_pk_bf16_f32 v120, v184, v185
    v_cvt_pk_bf16_f32 v121, v186, v187
    v_cvt_pk_bf16_f32 v122, v188, v189
    v_cvt_pk_bf16_f32 v123, v190, v191
    v_and_or_b32 v120, v120, -2, s76
    buffer_store_dwordx4 v[120:123], v8, s[8:11], s42 offen offset:2048
    s_add_u32 s28, s28, 1
    v_mov_b32 v6, s28
    s_mov_b64 exec, 1
    buffer_store_dword v6, v1, s[8:11], s36 offen
    s_mov_b64 exec, -1
    buffer_load_dwordx4 a[48:51], v0, s[8:11], s16 offen offset:0 sc1
    buffer_load_dwordx4 a[52:55], v0, s[8:11], s16 offen offset:1024 sc1
    buffer_load_dwordx4 a[56:59], v0, s[8:11], s16 offen offset:2048 sc1
    buffer_load_dwordx4 a[60:63], v0, s[8:11], s16 offen offset:3072 sc1
    buffer_load_dwordx4 a[64:67], v0, s[8:11], s17 offen offset:0 sc1
    buffer_load_dwordx4 a[68:71], v0, s[8:11], s17 offen offset:1024 sc1
    buffer_load_dwordx4 a[72:75], v0, s[8:11], s17 offen offset:2048 sc1
    buffer_load_dwordx4 a[76:79], v0, s[8:11], s17 offen offset:3072 sc1
    s_waitcnt vmcnt(13)
    s_cmp_eq_u32 s28, 64
    s_cbranch_scc0 L_top_53
    s_branch L_fin_50
L_pm_54_a:
    s_cmp_lt_u32 s52, 2147418112
    s_cbranch_scc1 L_pm_54
    s_branch L_fail
L_pm_54_b:
    buffer_load_dword v3, v7, s[8:11], s32 offen sc1
    s_add_u32 s52, s52, 0x1000
    s_cmp_lt_u32 s52, 2147418112
    s_cbranch_scc0 L_fail
    s_waitcnt vmcnt(0)
    v_cmp_ne_u32 vcc, s29, v3
    s_cbranch_vccnz L_pm_54_b
    s_branch L_pm_54_ok
L_vtag_56:
    buffer_load_dwordx4 v[128:131], v0, s[8:11], s35 offen offset:0 sc1
    buffer_load_dwordx4 v[132:135], v0, s[8:11], s35 offen offset:1024 sc1
    buffer_load_dwordx4 v[136:139], v0, s[8:11], s35 offen offset:2048 sc1
    buffer_load_dwordx4 v[140:143], v0, s[8:11], s35 offen offset:3072 sc1
    s_add_u32 s52, s52, 0x1000
    s_cmp_lt_u32 s52, 2147418112
    s_waitcnt vmcnt(0)
    s_cbranch_scc1 L_vtag_56_c
    s_branch L_fail
L_pm_57_a:
    s_cmp_lt_u32 s52, 2147418112
    s_cbranch_scc1 L_pm_57
    s_branch L_fail
L_pm_57_b:
    buffer_load_dword v3, v7, s[8:11], s32 offen sc1
    s_add_u32 s52, s52, 0x1000
    s_cmp_lt_u32 s52, 2147418112
    s_cbranch_scc0 L_fail
    s_waitcnt vmcnt(0)
    v_cmp_ne_u32 vcc, s29, v3
    s_cbranch_vccnz L_pm_57_b
    s_branch L_pm_57_ok
L_vtag_59:
    buffer_load_dwordx4 v[128:131], v0, s[8:11], s35 offen offset:0 sc1
    buffer_load_dwordx4 v[132:135], v0, s[8:11], s35 offen offset:1024 sc1
    buffer_load_dwordx4 v[136:139], v0, s[8:11], s35 offen offset:2048 sc1
    buffer_load_dwordx4 v[140:143], v0, s[8:11], s35 offen offset:3072 sc1
    s_add_u32 s52, s52, 0x1000
    s_cmp_lt_u32 s52, 2147418112
    s_waitcnt vmcnt(0)
    s_cbranch_scc1 L_vtag_59_c
    s_branch L_fail
L_fin_50:
    s_branch L_done
L_nonlocal_49:
    s_mov_b32 s28, 0
    s_mov_b32 s29, 1
    s_add_u32 s63, s30, 4096
    s_add_u32 s16, s30, 8192
    s_add_u32 s17, s30, 12288
L_pq_62:
    buffer_load_dword v14, v2, s[8:11], s34 offen sc1
    s_waitcnt vmcnt(0)
    v_cmp_gt_u32 vcc, s29, v14
    s_add_u32 s52, s52, 0x1000
    s_cmp_lt_u32 s52, 2147418112
    s_cbranch_vccz L_pq_62_ok
    s_sleep 1
    s_cbranch_scc1 L_pq_62
    s_branch L_fail
L_pq_62_ok:
    buffer_load_dwordx4 a[0:3], v0, s[8:11], s31 offen offset:0 sc1
    buffer_load_dwordx4 a[4:7], v0, s[8:11], s31 offen offset:1024 sc1
    buffer_load_dwordx4 a[8:11], v0, s[8:11], s31 offen offset:2048 sc1
    buffer_load_dwordx4 a[12:15], v0, s[8:11], s31 offen offset:3072 sc1
    buffer_load_dwordx4 a[16:19], v0, s[8:11], s30 offen offset:0 sc1
    buffer_load_dwordx4 a[20:23], v0, s[8:11], s30 offen offset:1024 sc1
    buffer_load_dwordx4 a[24:27], v0, s[8:11], s30 offen offset:2048 sc1
    buffer_load_dwordx4 a[28:31], v0, s[8:11], s30 offen offset:3072 sc1
    buffer_load_dwordx4 a[32:35], v0, s[8:11], s63 offen offset:0 sc1
    buffer_load_dwordx4 a[36:39], v0, s[8:11], s63 offen offset:1024 sc1
    buffer_load_dwordx4 a[40:43], v0, s[8:11], s63 offen offset:2048 sc1
    buffer_load_dwordx4 a[44:47], v0, s[8:11], s63 offen offset:3072 sc1
    buffer_load_dwordx4 a[48:51], v0, s[8:11], s16 offen offset:0 sc1
    buffer_load_dwordx4 a[52:55], v0, s[8:11], s16 offen offset:1024 sc1
    buffer_load_dwordx4 a[56:59], v0, s[8:11], s16 offen offset:2048 sc1
    buffer_load_dwordx4 a[60:63], v0, s[8:11], s16 offen offset:3072 sc1
    buffer_load_dwordx4 a[64:67], v0, s[8:11], s17 offen offset:0 sc1
    buffer_load_dwordx4 a[68:71], v0, s[8:11], s17 offen offset:1024 sc1
    buffer_load_dwordx4 a[72:75], v0, s[8:11], s17 offen offset:2048 sc1
    buffer_load_dwordx4 a[76:79], v0, s[8:11], s17 offen offset:3072 sc1
    s_waitcnt vmcnt(0)
L_top_63:
    s_and_b32 s42, s28, 7
    s_mul_i32 s32, s42, 262144
    s_add_u32 s32, s32, s94
    s_sub_u32 s62, s29, 8
    s_max_i32 s62, s62, 0
    v_cmp_gt_u32 vcc, s62, v96
    s_cbranch_vccz L_lazy_65
    buffer_load_dword v96, v15, s[8:11], s53 offen sc1
L_lazy_65:
    buffer_load_dword v14, v2, s[8:11], s34 offen sc1
    buffer_load_dword v3, v7, s[8:11], s32 offen sc1
    v_mfma_f32_16x16x32_bf16 v[104:107], a[16:19], a[0:3], 0
    v_mfma_f32_16x16x32_bf16 v[108:111], a[32:35], a[0:3], 0
    v_mfma_f32_16x16x32_bf16 v[104:107], a[20:23], a[4:7], v[104:107]
    v_mfma_f32_16x16x32_bf16 v[108:111], a[36:39], a[4:7], v[108:111]
    v_mfma_f32_16x16x32_bf16 v[104:107], a[24:27], a[8:11], v[104:107]
    v_mfma_f32_16x16x32_bf16 v[108:111], a[40:43], a[8:11], v[108:111]
    v_mfma_f32_16x16x32_bf16 v[104:107], a[28:31], a[12:15], v[104:107]
    v_mfma_f32_16x16x32_bf16 v[108:111], a[44:47], a[12:15], v[108:111]
    s_add_u32 s39, s29, 1
    s_min_u32 s39, s39, 64
    s_sub_u32 s62, s29, 8
    s_max_i32 s62, s62, 0
    s_sub_u32 s42, s39, 1
    s_and_b32 s42, s42, 7
    s_mul_i32 s30, s42, 524288
    s_add_u32 s30, s30, s92
    s_mul_i32 s31, s42, 262144
    s_add_u32 s31, s31, s93
    s_and_b32 s42, s28, 7
    s_mul_i32 s33, s42, 262144
    s_add_u32 s33, s33, s95
    s_add_u32 s63, s30, 4096
    s_add_u32 s16, s30, 8192
    s_add_u32 s17, s30, 12288
    s_mov_b32 m0, s38
    s_add_u32 s35, s32, 4096
    s_branch L_pm_64_c
L_pm_64:
    buffer_load_dword v14, v2, s[8:11], s34 offen sc1
    buffer_load_dword v96, v15, s[8:11], s53 offen sc1
    buffer_load_dword v3, v7, s[8:11], s32 offen sc1
L_pm_64_c:
    s_waitcnt vmcnt(0)
    v_cmp_ne_u32 vcc, s29, v3
    v_cmp_gt_u32 s[18:19], s39, v14
    v_cmp_gt_u32 s[6:7], s62, v96
    s_add_u32 s52, s52, 0x1000
    s_nop 1
    s_or_b64 s[6:7], s[6:7], s[18:19]
    s_cbranch_scc1 L_pm_64_a
    s_cbranch_vccnz L_pm_64_b
L_pm_64_ok:
    buffer_load_dwordx4 v0, s[8:11], s32 offen offset:0 sc1  lds
    buffer_load_dwordx4 v0, s[8:11], s32 offen offset:1024 sc1  lds
    buffer_load_dwordx4 v0, s[8:11], s32 offen offset:2048 sc1  lds
    buffer_load_dwordx4 v0, s[8:11], s32 offen offset:3072 sc1  lds
    buffer_load_dwordx4 v[128:131], v0, s[8:11], s35 offen offset:0 sc1
    buffer_load_dwordx4 v[132:135], v0, s[8:11], s35 offen offset:1024 sc1
    buffer_load_dwordx4 v[136:139], v0, s[8:11], s35 offen offset:2048 sc1
    buffer_load_dwordx4 v[140:143], v0, s[8:11], s35 offen offset:3072 sc1
    buffer_load_dwordx4 a[80:83], v0, s[8:11], s31 offen offset:0 sc1
    buffer_load_dwordx4 a[84:87], v0, s[8:11], s31 offen offset:1024 sc1
    buffer_load_dwordx4 a[88:91], v0, s[8:11], s31 offen offset:2048 sc1
    buffer_load_dwordx4 a[92:95], v0, s[8:11], s31 offen offset:3072 sc1
    buffer_load_dwordx4 a[96:99], v0, s[8:11], s30 offen offset:0 sc1
    buffer_load_dwordx4 a[100:103], v0, s[8:11], s30 offen offset:1024 sc1
    v_cndmask_b32 v104, v9, v104, s[44:45]
    v_cndmask_b32 v105, v9, v105, s[46:47]
    v_cndmask_b32 v106, v9, v106, s[48:49]
    v_cndmask_b32 v107, v9, v107, s[50:51]
    v_cndmask_b32 v108, v9, v108, s[54:55]
    v_cndmask_b32 v109, v9, v109, s[56:57]
    v_cndmask_b32 v110, v9, v110, s[58:59]
    v_cndmask_b32 v111, v9, v111, s[60:61]
    v_max3_f32 v10, v104, v105, v106
    v_max3_f32 v11, v107, v108, v109
    v_max3_f32 v10, v10, v110, v111
    v_max_f32 v10, v10, v11
    s_nop 0
    s_waitcnt vmcnt(13)
    ds_read_b64_tr_b16 v[64:65], v4 offset:0
    ds_read_b64_tr_b16 v[66:67], v5 offset:256
    s_waitcnt vmcnt(12)
    ds_read_b64_tr_b16 v[68:69], v4 offset:1024
    ds_read_b64_tr_b16 v[70:71], v5 offset:1280
    s_waitcnt vmcnt(11)
    ds_read_b64_tr_b16 v[72:73], v4 offset:2048
    ds_read_b64_tr_b16 v[74:75], v5 offset:2304
    s_waitcnt vmcnt(10)
    ds_read_b64_tr_b16 v[76:77], v4 offset:3072
    ds_read_b64_tr_b16 v[78:79], v5 offset:3328
    buffer_load_dwordx4 a[104:107], v0, s[8:11], s30 offen offset:2048 sc1
    s_waitcnt lgkmcnt(6)
    v_mfma_f32_16x16x32_bf16 v[112:115], v[64:67], a[0:3], 0
    s_waitcnt lgkmcnt(4)
    v_mfma_f32_16x16x32_bf16 v[112:115], v[68:71], a[4:7], v[112:115]
    s_waitcnt lgkmcnt(2)
    v_mfma_f32_16x16x32_bf16 v[112:115], v[72:75], a[8:11], v[112:115]
    s_waitcnt lgkmcnt(0)
    v_mfma_f32_16x16x32_bf16 v[112:115], v[76:79], a[12:15], v[112:115]
    buffer_load_dwordx4 a[108:111], v0, s[8:11], s30 offen offset:3072 sc1
    s_nop 6
    v_max3_f32 v11, v10, v112, v113
    v_max3_f32 v10, v10, v112, v113
    s_nop 0
    buffer_load_dwordx4 a[112:115], v0, s[8:11], s63 offen offset:0 sc1
    v_permlane32_swap_b32 v10, v11
    v_max_f32 v12, v10, v11
    v_max_f32 v13, v10, v11
    s_nop 1
    v_permlane16_swap_b32 v12, v13
    v_max_f32 v10, v12, v13
    v_mul_f32 v10, s40, v10
    buffer_load_dwordx4 a[116:119], v0, s[8:11], s63 offen offset:1024 sc1
    v_pk_fma_f32 v[104:105], v[104:105], s[40:41], v[10:11] op_sel_hi:[1,1,0] neg_lo:[0,0,1] neg_hi:[0,0,1]
    v_pk_fma_f32 v[106:107], v[106:107], s[40:41], v[10:11] op_sel_hi:[1,1,0] neg_lo:[0,0,1] neg_hi:[0,0,1]
    v_pk_fma_f32 v[108:109], v[108:109], s[40:41], v[10:11] op_sel_hi:[1,1,0] neg_lo:[0,0,1] neg_hi:[0,0,1]
    v_pk_fma_f32 v[110:111], v[110:111], s[40:41], v[10:11] op_sel_hi:[1,1,0] neg_lo:[0,0,1] neg_hi:[0,0,1]
    v_pk_fma_f32 v[112:113], v[112:113], s[40:41], v[10:11] op_sel_hi:[1,1,0] neg_lo:[0,0,1] neg_hi:[0,0,1]
    v_exp_f32 v104, v104
    v_exp_f32 v105, v105
    v_exp_f32 v106, v106
    v_cvt_pk_bf16_f32 v92, v104, v105
    v_exp_f32 v107, v107
    buffer_load_dwordx4 a[120:123], v0, s[8:11], s63 offen offset:2048 sc1
    v_exp_f32 v108, v108
    v_cvt_pk_bf16_f32 v93, v106, v107
    v_exp_f32 v109, v109
    v_pk_add_f32 v[12:13], v[104:105], v[106:107]
    v_exp_f32 v110, v110
    v_cvt_pk_bf16_f32 v94, v108, v109
    v_exp_f32 v111, v111
    buffer_load_dwordx4 a[124:127], v0, s[8:11], s63 offen offset:3072 sc1
    v_pk_add_f32 v[12:13], v[12:13], v[108:109]
    v_exp_f32 v112, v112
    v_cvt_pk_bf16_f32 v95, v110, v111
    v_exp_f32 v113, v113
    v_pk_add_f32 v[12:13], v[12:13], v[110:111]
    v_cvt_pk_bf16_f32 v88, v112, v113
    v_cvt_pk_bf16_f32 v91, v112, v113
    v_pk_add_f32 v[12:13], v[12:13], v[112:113]
    s_waitcnt vmcnt(12)
L_vtag_66_c:
    v_bitop3_b32 v10, v130, v134, s29 bitop3:126
    v_bitop3_b32 v11, v138, v142, s29 bitop3:126
    v_or_b32 v10, v10, v11
    v_cmp_ne_u32 vcc, 0, v10
    s_cbranch_vccnz L_vtag_66
    s_add_u32 s29, s29, 1
    s_add_u32 s42, s33, 4096
    s_bfe_u32 s76, s28, 65539
    s_xor_b32 s76, s76, 1
    v_mfma_f32_16x16x32_bf16 v[160:163], a[48:51], v[92:95], 0
    v_add_f32 v10, v12, v13
    v_add_f32 v11, v12, v13
    v_mfma_f32_16x16x32_bf16 v[164:167], a[52:55], v[92:95], 0
    s_nop 1
    v_permlane32_swap_b32 v10, v11
    v_mfma_f32_16x16x16_bf16 v[160:163], v[128:129], v[88:89], v[160:163]
    v_add_f32 v12, v10, v11
    v_add_f32 v13, v10, v11
    v_mfma_f32_16x16x16_bf16 v[164:167], v[128:129], v[90:91], v[164:167]
    s_nop 1
    v_permlane16_swap_b32 v12, v13
    v_mfma_f32_16x16x32_bf16 v[168:171], a[56:59], v[92:95], 0
    v_add_f32 v10, v12, v13
    v_rcp_f32 v10, v10
    v_mfma_f32_16x16x32_bf16 v[172:175], a[60:63], v[92:95], 0
    s_nop 0
    v_mfma_f32_16x16x16_bf16 v[168:171], v[132:133], v[88:89], v[168:171]
    v_mul_f32 v160, v160, v10
    v_mul_f32 v161, v161, v10
    v_mfma_f32_16x16x16_bf16 v[172:175], v[132:133], v[90:91], v[172:175]
    v_mul_f32 v162, v162, v10
    v_mul_f32 v163, v163, v10
    v_mfma_f32_16x16x32_bf16 v[176:179], a[64:67], v[92:95], 0
    v_mul_f32 v164, v164, v10
    v_mul_f32 v165, v165, v10
    v_mfma_f32_16x16x32_bf16 v[180:183], a[68:71], v[92:95], 0
    v_mul_f32 v166, v166, v10
    v_mul_f32 v167, v167, v10
    v_mfma_f32_16x16x16_bf16 v[176:179], v[136:137], v[88:89], v[176:179]
    v_cvt_pk_bf16_f32 v116, v160, v161
    v_cvt_pk_bf16_f32 v117, v162, v163
    v_mfma_f32_16x16x16_bf16 v[180:183], v[136:137], v[90:91], v[180:183]
    v_cvt_pk_bf16_f32 v118, v164, v165
    v_cvt_pk_bf16_f32 v119, v166, v167
    v_mfma_f32_16x16x32_bf16 v[184:187], a[72:75], v[92:95], 0
    v_and_or_b32 v116, v116, -2, s76
    buffer_store_dwordx4 v[116:119], v8, s[8:11], s33 offen offset:0 sc1
    v_mfma_f32_16x16x32_bf16 v[188:191], a[76:79], v[92:95], 0
    v_mul_f32 v168, v168, v10
    v_mul_f32 v169, v169, v10
    v_mfma_f32_16x16x16_bf16 v[184:187], v[140:141], v[88:89], v[184:187]
    v_mul_f32 v170, v170, v10
    v_mul_f32 v171, v171, v10
    v_mfma_f32_16x16x16_bf16 v[188:191], v[140:141], v[90:91], v[188:191]
    v_mul_f32 v172, v172, v10
    v_mul_f32 v173, v173, v10
    v_mul_f32 v174, v174, v10
    v_mul_f32 v175, v175, v10
    v_cvt_pk_bf16_f32 v120, v168, v169
    v_cvt_pk_bf16_f32 v121, v170, v171
    v_cvt_pk_bf16_f32 v122, v172, v173
    v_cvt_pk_bf16_f32 v123, v174, v175
    v_and_or_b32 v120, v120, -2, s76
    buffer_store_dwordx4 v[120:123], v8, s[8:11], s33 offen offset:2048 sc1
    v_mul_f32 v176, v176, v10
    v_mul_f32 v177, v177, v10
    v_mul_f32 v178, v178, v10
    v_mul_f32 v179, v179, v10
    v_mul_f32 v180, v180, v10
    v_mul_f32 v181, v181, v10
    v_mul_f32 v182, v182, v10
    v_mul_f32 v183, v183, v10
    v_cvt_pk_bf16_f32 v116, v176, v177
    v_cvt_pk_bf16_f32 v117, v178, v179
    v_cvt_pk_bf16_f32 v118, v180, v181
    v_cvt_pk_bf16_f32 v119, v182, v183
    v_and_or_b32 v116, v116, -2, s76
    buffer_store_dwordx4 v[116:119], v8, s[8:11], s42 offen offset:0 sc1
    v_mul_f32 v184, v184, v10
    v_mul_f32 v185, v185, v10
    v_mul_f32 v186, v186, v10
    v_mul_f32 v187, v187, v10
    v_mul_f32 v188, v188, v10
    v_mul_f32 v189, v189, v10
    v_mul_f32 v190, v190, v10
    v_mul_f32 v191, v191, v10
    v_cvt_pk_bf16_f32 v120, v184, v185
    v_cvt_pk_bf16_f32 v121, v186, v187
    v_cvt_pk_bf16_f32 v122, v188, v189
    v_cvt_pk_bf16_f32 v123, v190, v191
    v_and_or_b32 v120, v120, -2, s76
    buffer_store_dwordx4 v[120:123], v8, s[8:11], s42 offen offset:2048 sc1
    s_add_u32 s28, s28, 1
    v_mov_b32 v6, s28
    s_mov_b64 exec, 1
    buffer_store_dword v6, v1, s[8:11], s36 offen sc1
    s_mov_b64 exec, -1
    buffer_load_dwordx4 a[128:131], v0, s[8:11], s16 offen offset:0 sc1
    buffer_load_dwordx4 a[132:135], v0, s[8:11], s16 offen offset:1024 sc1
    buffer_load_dwordx4 a[136:139], v0, s[8:11], s16 offen offset:2048 sc1
    buffer_load_dwordx4 a[140:143], v0, s[8:11], s16 offen offset:3072 sc1
    buffer_load_dwordx4 a[144:147], v0, s[8:11], s17 offen offset:0 sc1
    buffer_load_dwordx4 a[148:151], v0, s[8:11], s17 offen offset:1024 sc1
    buffer_load_dwordx4 a[152:155], v0, s[8:11], s17 offen offset:2048 sc1
    buffer_load_dwordx4 a[156:159], v0, s[8:11], s17 offen offset:3072 sc1
    s_waitcnt vmcnt(13)
L_half1_61:
    s_and_b32 s42, s28, 7
    s_mul_i32 s32, s42, 262144
    s_add_u32 s32, s32, s94
    s_sub_u32 s62, s29, 8
    s_max_i32 s62, s62, 0
    v_cmp_gt_u32 vcc, s62, v96
    s_cbranch_vccz L_lazy_68
    buffer_load_dword v96, v15, s[8:11], s53 offen sc1
L_lazy_68:
    buffer_load_dword v14, v2, s[8:11], s34 offen sc1
    buffer_load_dword v3, v7, s[8:11], s32 offen sc1
    v_mfma_f32_16x16x32_bf16 v[104:107], a[96:99], a[80:83], 0
    v_mfma_f32_16x16x32_bf16 v[108:111], a[112:115], a[80:83], 0
    v_mfma_f32_16x16x32_bf16 v[104:107], a[100:103], a[84:87], v[104:107]
    v_mfma_f32_16x16x32_bf16 v[108:111], a[116:119], a[84:87], v[108:111]
    v_mfma_f32_16x16x32_bf16 v[104:107], a[104:107], a[88:91], v[104:107]
    v_mfma_f32_16x16x32_bf16 v[108:111], a[120:123], a[88:91], v[108:111]
    v_mfma_f32_16x16x32_bf16 v[104:107], a[108:111], a[92:95], v[104:107]
    v_mfma_f32_16x16x32_bf16 v[108:111], a[124:127], a[92:95], v[108:111]
    s_add_u32 s39, s29, 1
    s_min_u32 s39, s39, 64
    s_sub_u32 s62, s29, 8
    s_max_i32 s62, s62, 0
    s_sub_u32 s42, s39, 1
    s_and_b32 s42, s42, 7
    s_mul_i32 s30, s42, 524288
    s_add_u32 s30, s30, s92
    s_mul_i32 s31, s42, 262144
    s_add_u32 s31, s31, s93
    s_and_b32 s42, s28, 7
    s_mul_i32 s33, s42, 262144
    s_add_u32 s33, s33, s95
    s_add_u32 s63, s30, 4096
    s_add_u32 s16, s30, 8192
    s_add_u32 s17, s30, 12288
    s_mov_b32 m0, s38
    s_add_u32 s35, s32, 4096
    s_branch L_pm_67_c
L_pm_67:
    buffer_load_dword v14, v2, s[8:11], s34 offen sc1
    buffer_load_dword v96, v15, s[8:11], s53 offen sc1
    buffer_load_dword v3, v7, s[8:11], s32 offen sc1
L_pm_67_c:
    s_waitcnt vmcnt(0)
    v_cmp_ne_u32 vcc, s29, v3
    v_cmp_gt_u32 s[18:19], s39, v14
    v_cmp_gt_u32 s[6:7], s62, v96
    s_add_u32 s52, s52, 0x1000
    s_nop 1
    s_or_b64 s[6:7], s[6:7], s[18:19]
    s_cbranch_scc1 L_pm_67_a
    s_cbranch_vccnz L_pm_67_b
L_pm_67_ok:
    buffer_load_dwordx4 v0, s[8:11], s32 offen offset:0 sc1  lds
    buffer_load_dwordx4 v0, s[8:11], s32 offen offset:1024 sc1  lds
    buffer_load_dwordx4 v0, s[8:11], s32 offen offset:2048 sc1  lds
    buffer_load_dwordx4 v0, s[8:11], s32 offen offset:3072 sc1  lds
    buffer_load_dwordx4 v[128:131], v0, s[8:11], s35 offen offset:0 sc1
    buffer_load_dwordx4 v[132:135], v0, s[8:11], s35 offen offset:1024 sc1
    buffer_load_dwordx4 v[136:139], v0, s[8:11], s35 offen offset:2048 sc1
    buffer_load_dwordx4 v[140:143], v0, s[8:11], s35 offen offset:3072 sc1
    buffer_load_dwordx4 a[0:3], v0, s[8:11], s31 offen offset:0 sc1
    buffer_load_dwordx4 a[4:7], v0, s[8:11], s31 offen offset:1024 sc1
    buffer_load_dwordx4 a[8:11], v0, s[8:11], s31 offen offset:2048 sc1
    buffer_load_dwordx4 a[12:15], v0, s[8:11], s31 offen offset:3072 sc1
    buffer_load_dwordx4 a[16:19], v0, s[8:11], s30 offen offset:0 sc1
    buffer_load_dwordx4 a[20:23], v0, s[8:11], s30 offen offset:1024 sc1
    v_cndmask_b32 v104, v9, v104, s[44:45]
    v_cndmask_b32 v105, v9, v105, s[46:47]
    v_cndmask_b32 v106, v9, v106, s[48:49]
    v_cndmask_b32 v107, v9, v107, s[50:51]
    v_cndmask_b32 v108, v9, v108, s[54:55]
    v_cndmask_b32 v109, v9, v109, s[56:57]
    v_cndmask_b32 v110, v9, v110, s[58:59]
    v_cndmask_b32 v111, v9, v111, s[60:61]
    v_max3_f32 v10, v104, v105, v106
    v_max3_f32 v11, v107, v108, v109
    v_max3_f32 v10, v10, v110, v111
    v_max_f32 v10, v10, v11
    s_nop 0
    s_waitcnt vmcnt(13)
    ds_read_b64_tr_b16 v[64:65], v4 offset:0
    ds_read_b64_tr_b16 v[66:67], v5 offset:256
    s_waitcnt vmcnt(12)
    ds_read_b64_tr_b16 v[68:69], v4 offset:1024
    ds_read_b64_tr_b16 v[70:71], v5 offset:1280
    s_waitcnt vmcnt(11)
    ds_read_b64_tr_b16 v[72:73], v4 offset:2048
    ds_read_b64_tr_b16 v[74:75], v5 offset:2304
    s_waitcnt vmcnt(10)
    ds_read_b64_tr_b16 v[76:77], v4 offset:3072
    ds_read_b64_tr_b16 v[78:79], v5 offset:3328
    buffer_load_dwordx4 a[24:27], v0, s[8:11], s30 offen offset:2048 sc1
    s_waitcnt lgkmcnt(6)
    v_mfma_f32_16x16x32_bf16 v[112:115], v[64:67], a[80:83], 0
    s_waitcnt lgkmcnt(4)
    v_mfma_f32_16x16x32_bf16 v[112:115], v[68:71], a[84:87], v[112:115]
    s_waitcnt lgkmcnt(2)
    v_mfma_f32_16x16x32_bf16 v[112:115], v[72:75], a[88:91], v[112:115]
    s_waitcnt lgkmcnt(0)
    v_mfma_f32_16x16x32_bf16 v[112:115], v[76:79], a[92:95], v[112:115]
    buffer_load_dwordx4 a[28:31], v0, s[8:11], s30 offen offset:3072 sc1
    s_nop 6
    v_max3_f32 v11, v10, v112, v113
    v_max3_f32 v10, v10, v112, v113
    s_nop 0
    buffer_load_dwordx4 a[32:35], v0, s[8:11], s63 offen offset:0 sc1
    v_permlane32_swap_b32 v10, v11
    v_max_f32 v12, v10, v11
    v_max_f32 v13, v10, v11
    s_nop 1
    v_permlane16_swap_b32 v12, v13
    v_max_f32 v10, v12, v13
    v_mul_f32 v10, s40, v10
    buffer_load_dwordx4 a[36:39], v0, s[8:11], s63 offen offset:1024 sc1
    v_pk_fma_f32 v[104:105], v[104:105], s[40:41], v[10:11] op_sel_hi:[1,1,0] neg_lo:[0,0,1] neg_hi:[0,0,1]
    v_pk_fma_f32 v[106:107], v[106:107], s[40:41], v[10:11] op_sel_hi:[1,1,0] neg_lo:[0,0,1] neg_hi:[0,0,1]
    v_pk_fma_f32 v[108:109], v[108:109], s[40:41], v[10:11] op_sel_hi:[1,1,0] neg_lo:[0,0,1] neg_hi:[0,0,1]
    v_pk_fma_f32 v[110:111], v[110:111], s[40:41], v[10:11] op_sel_hi:[1,1,0] neg_lo:[0,0,1] neg_hi:[0,0,1]
    v_pk_fma_f32 v[112:113], v[112:113], s[40:41], v[10:11] op_sel_hi:[1,1,0] neg_lo:[0,0,1] neg_hi:[0,0,1]
    v_exp_f32 v104, v104
    v_exp_f32 v105, v105
    v_exp_f32 v106, v106
    v_cvt_pk_bf16_f32 v92, v104, v105
    v_exp_f32 v107, v107
    buffer_load_dwordx4 a[40:43], v0, s[8:11], s63 offen offset:2048 sc1
    v_exp_f32 v108, v108
    v_cvt_pk_bf16_f32 v93, v106, v107
    v_exp_f32 v109, v109
    v_pk_add_f32 v[12:13], v[104:105], v[106:107]
    v_exp_f32 v110, v110
    v_cvt_pk_bf16_f32 v94, v108, v109
    v_exp_f32 v111, v111
    buffer_load_dwordx4 a[44:47], v0, s[8:11], s63 offen offset:3072 sc1
    v_pk_add_f32 v[12:13], v[12:13], v[108:109]
    v_exp_f32 v112, v112
    v_cvt_pk_bf16_f32 v95, v110, v111
    v_exp_f32 v113, v113
    v_pk_add_f32 v[12:13], v[12:13], v[110:111]
    v_cvt_pk_bf16_f32 v88, v112, v113
    v_cvt_pk_bf16_f32 v91, v112, v113
    v_pk_add_f32 v[12:13], v[12:13], v[112:113]
    s_waitcnt vmcnt(12)
L_vtag_69_c:
    v_bitop3_b32 v10, v130, v134, s29 bitop3:126
    v_bitop3_b32 v11, v138, v142, s29 bitop3:126
    v_or_b32 v10, v10, v11
    v_cmp_ne_u32 vcc, 0, v10
    s_cbranch_vccnz L_vtag_69
    s_add_u32 s29, s29, 1
    s_add_u32 s42, s33, 4096
    s_bfe_u32 s76, s28, 65539
    s_xor_b32 s76, s76, 1
    v_mfma_f32_16x16x32_bf16 v[160:163], a[128:131], v[92:95], 0
    v_add_f32 v10, v12, v13
    v_add_f32 v11, v12, v13
    v_mfma_f32_16x16x32_bf16 v[164:167], a[132:135], v[92:95], 0
    s_nop 1
    v_permlane32_swap_b32 v10, v11
    v_mfma_f32_16x16x16_bf16 v[160:163], v[128:129], v[88:89], v[160:163]
    v_add_f32 v12, v10, v11
    v_add_f32 v13, v10, v11
    v_mfma_f32_16x16x16_bf16 v[164:167], v[128:129], v[90:91], v[164:167]
    s_nop 1
    v_permlane16_swap_b32 v12, v13
    v_mfma_f32_16x16x32_bf16 v[168:171], a[136:139], v[92:95], 0
    v_add_f32 v10, v12, v13
    v_rcp_f32 v10, v10
    v_mfma_f32_16x16x32_bf16 v[172:175], a[140:143], v[92:95], 0
    s_nop 0
    v_mfma_f32_16x16x16_bf16 v[168:171], v[132:133], v[88:89], v[168:171]
    v_mul_f32 v160, v160, v10
    v_mul_f32 v161, v161, v10
    v_mfma_f32_16x16x16_bf16 v[172:175], v[132:133], v[90:91], v[172:175]
    v_mul_f32 v162, v162, v10
    v_mul_f32 v163, v163, v10
    v_mfma_f32_16x16x32_bf16 v[176:179], a[144:147], v[92:95], 0
    v_mul_f32 v164, v164, v10
    v_mul_f32 v165, v165, v10
    v_mfma_f32_16x16x32_bf16 v[180:183], a[148:151], v[92:95], 0
    v_mul_f32 v166, v166, v10
    v_mul_f32 v167, v167, v10
    v_mfma_f32_16x16x16_bf16 v[176:179], v[136:137], v[88:89], v[176:179]
    v_cvt_pk_bf16_f32 v116, v160, v161
    v_cvt_pk_bf16_f32 v117, v162, v163
    v_mfma_f32_16x16x16_bf16 v[180:183], v[136:137], v[90:91], v[180:183]
    v_cvt_pk_bf16_f32 v118, v164, v165
    v_cvt_pk_bf16_f32 v119, v166, v167
    v_mfma_f32_16x16x32_bf16 v[184:187], a[152:155], v[92:95], 0
    v_and_or_b32 v116, v116, -2, s76
    buffer_store_dwordx4 v[116:119], v8, s[8:11], s33 offen offset:0 sc1
    v_mfma_f32_16x16x32_bf16 v[188:191], a[156:159], v[92:95], 0
    v_mul_f32 v168, v168, v10
    v_mul_f32 v169, v169, v10
    v_mfma_f32_16x16x16_bf16 v[184:187], v[140:141], v[88:89], v[184:187]
    v_mul_f32 v170, v170, v10
    v_mul_f32 v171, v171, v10
    v_mfma_f32_16x16x16_bf16 v[188:191], v[140:141], v[90:91], v[188:191]
    v_mul_f32 v172, v172, v10
    v_mul_f32 v173, v173, v10
    v_mul_f32 v174, v174, v10
    v_mul_f32 v175, v175, v10
    v_cvt_pk_bf16_f32 v120, v168, v169
    v_cvt_pk_bf16_f32 v121, v170, v171
    v_cvt_pk_bf16_f32 v122, v172, v173
    v_cvt_pk_bf16_f32 v123, v174, v175
    v_and_or_b32 v120, v120, -2, s76
    buffer_store_dwordx4 v[120:123], v8, s[8:11], s33 offen offset:2048 sc1
    v_mul_f32 v176, v176, v10
    v_mul_f32 v177, v177, v10
    v_mul_f32 v178, v178, v10
    v_mul_f32 v179, v179, v10
    v_mul_f32 v180, v180, v10
    v_mul_f32 v181, v181, v10
    v_mul_f32 v182, v182, v10
    v_mul_f32 v183, v183, v10
    v_cvt_pk_bf16_f32 v116, v176, v177
    v_cvt_pk_bf16_f32 v117, v178, v179
    v_cvt_pk_bf16_f32 v118, v180, v181
    v_cvt_pk_bf16_f32 v119, v182, v183
    v_and_or_b32 v116, v116, -2, s76
    buffer_store_dwordx4 v[116:119], v8, s[8:11], s42 offen offset:0 sc1
    v_mul_f32 v184, v184, v10
    v_mul_f32 v185, v185, v10
    v_mul_f32 v186, v186, v10
    v_mul_f32 v187, v187, v10
    v_mul_f32 v188, v188, v10
    v_mul_f32 v189, v189, v10
    v_mul_f32 v190, v190, v10
    v_mul_f32 v191, v191, v10
    v_cvt_pk_bf16_f32 v120, v184, v185
    v_cvt_pk_bf16_f32 v121, v186, v187
    v_cvt_pk_bf16_f32 v122, v188, v189
    v_cvt_pk_bf16_f32 v123, v190, v191
    v_and_or_b32 v120, v120, -2, s76
    buffer_store_dwordx4 v[120:123], v8, s[8:11], s42 offen offset:2048 sc1
    s_add_u32 s28, s28, 1
    v_mov_b32 v6, s28
    s_mov_b64 exec, 1
    buffer_store_dword v6, v1, s[8:11], s36 offen sc1
    s_mov_b64 exec, -1
    buffer_load_dwordx4 a[48:51], v0, s[8:11], s16 offen offset:0 sc1
    buffer_load_dwordx4 a[52:55], v0, s[8:11], s16 offen offset:1024 sc1
    buffer_load_dwordx4 a[56:59], v0, s[8:11], s16 offen offset:2048 sc1
    buffer_load_dwordx4 a[60:63], v0, s[8:11], s16 offen offset:3072 sc1
    buffer_load_dwordx4 a[64:67], v0, s[8:11], s17 offen offset:0 sc1
    buffer_load_dwordx4 a[68:71], v0, s[8:11], s17 offen offset:1024 sc1
    buffer_load_dwordx4 a[72:75], v0, s[8:11], s17 offen offset:2048 sc1
    buffer_load_dwordx4 a[76:79], v0, s[8:11], s17 offen offset:3072 sc1
    s_waitcnt vmcnt(13)
    s_cmp_eq_u32 s28, 64
    s_cbranch_scc0 L_top_63
    s_branch L_fin_60
L_pm_64_a:
    s_cmp_lt_u32 s52, 2147418112
    s_cbranch_scc1 L_pm_64
    s_branch L_fail
L_pm_64_b:
    buffer_load_dword v3, v7, s[8:11], s32 offen sc1
    s_add_u32 s52, s52, 0x1000
    s_cmp_lt_u32 s52, 2147418112
    s_cbranch_scc0 L_fail
    s_waitcnt vmcnt(0)
    v_cmp_ne_u32 vcc, s29, v3
    s_cbranch_vccnz L_pm_64_b
    s_branch L_pm_64_ok
L_vtag_66:
    buffer_load_dwordx4 v[128:131], v0, s[8:11], s35 offen offset:0 sc1
    buffer_load_dwordx4 v[132:135], v0, s[8:11], s35 offen offset:1024 sc1
    buffer_load_dwordx4 v[136:139], v0, s[8:11], s35 offen offset:2048 sc1
    buffer_load_dwordx4 v[140:143], v0, s[8:11], s35 offen offset:3072 sc1
    s_add_u32 s52, s52, 0x1000
    s_cmp_lt_u32 s52, 2147418112
    s_waitcnt vmcnt(0)
    s_cbranch_scc1 L_vtag_66_c
    s_branch L_fail
L_pm_67_a:
    s_cmp_lt_u32 s52, 2147418112
    s_cbranch_scc1 L_pm_67
    s_branch L_fail
L_pm_67_b:
    buffer_load_dword v3, v7, s[8:11], s32 offen sc1
    s_add_u32 s52, s52, 0x1000
    s_cmp_lt_u32 s52, 2147418112
    s_cbranch_scc0 L_fail
    s_waitcnt vmcnt(0)
    v_cmp_ne_u32 vcc, s29, v3
    s_cbranch_vccnz L_pm_67_b
    s_branch L_pm_67_ok
L_vtag_69:
    buffer_load_dwordx4 v[128:131], v0, s[8:11], s35 offen offset:0 sc1
    buffer_load_dwordx4 v[132:135], v0, s[8:11], s35 offen offset:1024 sc1
    buffer_load_dwordx4 v[136:139], v0, s[8:11], s35 offen offset:2048 sc1
    buffer_load_dwordx4 v[140:143], v0, s[8:11], s35 offen offset:3072 sc1
    s_add_u32 s52, s52, 0x1000
    s_cmp_lt_u32 s52, 2147418112
    s_waitcnt vmcnt(0)
    s_cbranch_scc1 L_vtag_69_c
    s_branch L_fail
L_fin_60:
    s_branch L_done
    .p2align 6
L_chain:
    v_mov_b32 v40, v0
    v_lshlrev_b32 v0, 4, v40
    s_mul_i32 s42, s27, 0x80000
    s_add_u32 s42, s42, 1048576
    s_lshl_b32 s43, s24, 16
    s_add_u32 s31, s42, s43
    s_add_u32 s32, s31, 32768
    s_lshl_b32 s43, s26, 13
    s_add_u32 s33, s42, s43
    s_add_u32 s34, s33, 4096
    s_add_u32 s35, s42, 0x40000
    s_add_u32 s36, s42, 0x42000
    s_add_u32 s37, s42, 0x44000
    s_lshl_b32 s42, s27, 11
    s_add_u32 s42, s42, s26
    s_lshl_b32 s38, s42, 14
    s_add_u32 s38, s38, 8388608
    s_lshl_b32 s39, s42, 13
    s_add_u32 s39, s39, 108896256
    s_lshl_b32 s42, s27, 5
    s_add_u32 s42, s42, s26
    s_lshl_b32 s40, s27, 16
    s_add_u32 s40, s40, 491520
    s_mul_i32 s43, s26, 1024
    s_add_u32 s40, s40, s43
    s_mov_b32 s44, 0xcccccccc
    s_mov_b32 s45, 0xcccccccc
    s_mov_b32 s46, -1
    s_mov_b32 s47, 0
    s_mov_b32 s50, 1040356334
    s_mov_b32 s51, 1040356334
    s_mov_b32 s52, 0
    s_lshl_b32 s53, s24, 11
    s_add_u32 s38, s38, s53
    v_mov_b32 v9, 0
    v_bfe_i32 v41, v40, 0, 1
    v_and_b32 v41, 32, v41
    v_xor_b32 v9, v9, v41
    v_bfe_i32 v41, v40, 1, 1
    v_and_b32 v41, 256, v41
    v_xor_b32 v9, v9, v41
    v_bfe_i32 v41, v40, 2, 1
    v_and_b32 v41, 512, v41
    v_xor_b32 v9, v9, v41
    v_bfe_i32 v41, v40, 3, 1
    v_and_b32 v41, 1024, v41
    v_xor_b32 v9, v9, v41
    v_bfe_i32 v41, v40, 4, 1
    v_and_b32 v41, 16, v41
    v_xor_b32 v9, v9, v41
    s_lshr_b32 s42, s26, 3
    s_lshl_b32 s42, s42, 11
    s_and_b32 s43, s26, 3
    s_lshl_b32 s43, s43, 6
    s_add_u32 s42, s42, s43
    s_and_b32 s43, s26, 4
    s_lshl_b32 s43, s43, 1
    s_add_u32 s42, s42, s43
    v_add_u32 v9, s42, v9
    s_mov_b32 s16, s66
    s_mov_b32 s17, s67
    s_mov_b32 s18, 8192
    s_mov_b32 s19, 0x00020000
    v_mov_b32 v48, 0
    v_bfe_i32 v41, v40, 0, 1
    v_and_b32 v41, 1024, v41
    v_xor_b32 v48, v48, v41
    v_bfe_i32 v41, v40, 1, 1
    v_and_b32 v41, 2, v41
    v_xor_b32 v48, v48, v41
    v_bfe_i32 v41, v40, 2, 1
    v_and_b32 v41, 2048, v41
    v_xor_b32 v48, v48, v41
    v_bfe_i32 v41, v40, 3, 1
    v_and_b32 v41, 4096, v41
    v_xor_b32 v48, v48, v41
    v_bfe_i32 v41, v40, 4, 1
    v_and_b32 v41, 4, v41
    v_xor_b32 v48, v48, v41
    v_bfe_i32 v41, v40, 5, 1
    v_and_b32 v41, 64, v41
    v_xor_b32 v48, v48, v41
    s_lshl_b32 s42, s24, 8
    buffer_load_ushort v24, v48, s[16:19], s42 offen offset:0
    buffer_load_ushort v25, v48, s[16:19], s42 offen offset:8
    buffer_load_ushort v26, v48, s[16:19], s42 offen offset:16
    buffer_load_ushort v27, v48, s[16:19], s42 offen offset:24
    buffer_load_ushort v28, v48, s[16:19], s42 offen offset:32
    buffer_load_ushort v29, v48, s[16:19], s42 offen offset:40
    buffer_load_ushort v30, v48, s[16:19], s42 offen offset:48
    buffer_load_ushort v31, v48, s[16:19], s42 offen offset:56
    buffer_load_ushort v32, v48, s[16:19], s42 offen offset:128
    buffer_load_ushort v33, v48, s[16:19], s42 offen offset:136
    buffer_load_ushort v34, v48, s[16:19], s42 offen offset:144
    buffer_load_ushort v35, v48, s[16:19], s42 offen offset:152
    buffer_load_ushort v36, v48, s[16:19], s42 offen offset:160
    buffer_load_ushort v37, v48, s[16:19], s42 offen offset:168
    buffer_load_ushort v38, v48, s[16:19], s42 offen offset:176
    buffer_load_ushort v39, v48, s[16:19], s42 offen offset:184
    s_cmp_lg_u32 s24, 0
    s_cbranch_scc1 L_noarm_70
    v_mov_b32 v16, -1
    v_mov_b32 v17, -1
    v_mov_b64 v[20:21], 0
    v_mov_b64 v[22:23], 0
    s_mov_b64 exec, s[46:47]
    buffer_store_dwordx2 v[16:17], v9, s[8:11], s35 offen sc1
    buffer_store_dwordx2 v[16:17], v9, s[8:11], s36 offen sc1
    buffer_store_dwordx2 v[16:17], v9, s[8:11], s37 offen sc1
    s_mov_b64 exec, -1
    buffer_store_dwordx4 v[20:23], v0, s[8:11], s33 offen offset:0 sc1
    buffer_store_dwordx4 v[20:23], v0, s[8:11], s33 offen offset:1024 sc1
    buffer_store_dwordx4 v[20:23], v0, s[8:11], s33 offen offset:2048 sc1
    buffer_store_dwordx4 v[20:23], v0, s[8:11], s33 offen offset:3072 sc1
    buffer_store_dwordx4 v[20:23], v0, s[8:11], s34 offen offset:0 sc1
    buffer_store_dwordx4 v[20:23], v0, s[8:11], s34 offen offset:1024 sc1
    buffer_store_dwordx4 v[20:23], v0, s[8:11], s34 offen offset:2048 sc1
    buffer_store_dwordx4 v[20:23], v0, s[8:11], s34 offen offset:3072 sc1
L_noarm_70:
    v_mov_b32 v42, 0
    v_bfe_i32 v41, v40, 0, 1
    v_and_b32 v41, 16, v41
    v_xor_b32 v42, v42, v41
    v_bfe_i32 v41, v40, 1, 1
    v_and_b32 v41, 32, v41
    v_xor_b32 v42, v42, v41
    v_bfe_i32 v41, v40, 2, 1
    v_and_b32 v41, 64, v41
    v_xor_b32 v42, v42, v41
    v_bfe_i32 v41, v40, 3, 1
    v_and_b32 v41, 128, v41
    v_xor_b32 v42, v42, v41
    v_bfe_i32 v41, v40, 4, 1
    v_and_b32 v41, 8224, v41
    v_xor_b32 v42, v42, v41
    v_bfe_i32 v41, v40, 5, 1
    v_and_b32 v41, 16384, v41
    v_xor_b32 v42, v42, v41
    s_and_b32 s42, s24, 1
    s_lshl_b32 s42, s42, 7
    v_xor_b32 v42, s42, v42
    v_xor_b32 v43, 64, v42
    v_mov_b32 v44, 0
    v_bfe_i32 v41, v40, 0, 1
    v_and_b32 v41, 8, v41
    v_xor_b32 v44, v44, v41
    v_bfe_i32 v41, v40, 1, 1
    v_and_b32 v41, 16, v41
    v_xor_b32 v44, v44, v41
    v_bfe_i32 v41, v40, 2, 1
    v_and_b32 v41, 1088, v41
    v_xor_b32 v44, v44, v41
    v_bfe_i32 v41, v40, 3, 1
    v_and_b32 v41, 288, v41
    v_xor_b32 v44, v44, v41
    v_bfe_i32 v41, v40, 4, 1
    v_and_b32 v41, 4224, v41
    v_xor_b32 v44, v44, v41
    v_bfe_i32 v41, v40, 5, 1
    v_and_b32 v41, 512, v41
    v_xor_b32 v44, v44, v41
    s_lshl_b32 s42, s24, 6
    v_xor_b32 v44, s42, v44
    v_xor_b32 v45, 32, v44
    s_and_b32 s42, s24, 1
    s_lshl_b32 s42, s42, 5
    v_xor_b32 v50, s42, v0
    v_xor_b32 v51, 16, v50
    v_mov_b32 v46, 0
    v_bfe_i32 v41, v40, 0, 1
    v_and_b32 v41, 64, v41
    v_xor_b32 v46, v46, v41
    v_bfe_i32 v41, v40, 1, 1
    v_and_b32 v41, 128, v41
    v_xor_b32 v46, v46, v41
    v_bfe_i32 v41, v40, 2, 1
    v_and_b32 v41, 1040, v41
    v_xor_b32 v46, v46, v41
    v_bfe_i32 v41, v40, 3, 1
    v_and_b32 v41, 4128, v41
    v_xor_b32 v46, v46, v41
    v_bfe_i32 v41, v40, 4, 1
    v_and_b32 v41, 16384, v41
    v_xor_b32 v46, v46, v41
    v_bfe_i32 v41, v40, 5, 1
    v_and_b32 v41, 8192, v41
    v_xor_b32 v46, v46, v41
    s_lshl_b32 s42, s24, 8
    v_add_u32 v46, s42, v46
    s_mov_b32 s16, s68
    s_mov_b32 s17, s69
    s_mov_b32 s18, 4194304
    s_mov_b32 s19, 0x00020000
    s_mov_b32 s20, s70
    s_mov_b32 s21, s71
    s_mov_b32 s22, 4194304
    s_mov_b32 s23, 0x00020000
    s_mov_b32 s56, s72
    s_mov_b32 s57, s73
    s_mov_b32 s58, 4194304
    s_mov_b32 s59, 0x00020000
    s_mov_b32 s60, s74
    s_mov_b32 s61, s75
    s_mov_b32 s62, 4194304
    s_mov_b32 s63, 0x00020000
    s_lshl_b32 s54, s24, 17
    s_lshl_b32 s42, s26, 8
    s_add_u32 s54, s54, s42
    s_lshl_b32 s55, s26, 17
    s_lshl_b32 s42, s24, 12
    s_add_u32 s55, s55, s42
    s_lshl_b32 s3, s24, 12
    s_cmp_eq_u32 s27, 0
    s_cbranch_scc1 L_l1arr_71
    s_waitcnt vmcnt(0)
    s_cmp_lg_u32 s24, 0
    s_cbranch_scc1 L_na_72
    v_mov_b32 v126, 1
    v_mov_b32 v127, 4
    s_mov_b64 exec, 1
    buffer_atomic_add v126, v127, s[12:15], 0 offen
    s_mov_b64 exec, -1
L_na_72:
    s_cmp_eq_u32 s27, 0
    s_cselect_b32 s99, 0, 0
    v_mov_b32 v126, 132
    s_cmp_eq_u32 s99, 0
    s_cbranch_scc1 L_gate_73_ok
L_gate_73:
    s_sleep 8
    buffer_load_dword v127, v126, s[12:15], 0 offen sc1
    s_add_u32 s52, s52, 0x1000
    s_cmp_ge_u32 s52, 2147418112
    s_cbranch_scc1 L_fail
    s_waitcnt vmcnt(0)
    v_cmp_gt_u32 vcc, s99, v127
    s_cbranch_vccnz L_gate_73
L_gate_73_ok:
L_l1arr_71:
    s_add_u32 m0, s3, 0
    s_add_u32 s42, s55, 0
    buffer_load_dwordx4 v50, s[60:63], s42 offen  lds
    s_add_u32 m0, s3, 1024
    s_add_u32 s42, s55, 1024
    buffer_load_dwordx4 v51, s[60:63], s42 offen  lds
    s_add_u32 m0, s3, 2048
    s_add_u32 s42, s55, 2048
    buffer_load_dwordx4 v50, s[60:63], s42 offen  lds
    s_add_u32 m0, s3, 3072
    s_add_u32 s42, s55, 3072
    buffer_load_dwordx4 v51, s[60:63], s42 offen  lds
    s_add_u32 m0, s3, 16384
    s_add_u32 s42, s55, 16384
    buffer_load_dwordx4 v50, s[60:63], s42 offen  lds
    s_add_u32 m0, s3, 17408
    s_add_u32 s42, s55, 17408
    buffer_load_dwordx4 v51, s[60:63], s42 offen  lds
    s_add_u32 m0, s3, 18432
    s_add_u32 s42, s55, 18432
    buffer_load_dwordx4 v50, s[60:63], s42 offen  lds
    s_add_u32 m0, s3, 19456
    s_add_u32 s42, s55, 19456
    buffer_load_dwordx4 v51, s[60:63], s42 offen  lds
    s_add_u32 m0, s3, 32768
    s_add_u32 s42, s55, 32768
    buffer_load_dwordx4 v50, s[60:63], s42 offen  lds
    s_add_u32 m0, s3, 33792
    s_add_u32 s42, s55, 33792
    buffer_load_dwordx4 v51, s[60:63], s42 offen  lds
    s_add_u32 m0, s3, 34816
    s_add_u32 s42, s55, 34816
    buffer_load_dwordx4 v50, s[60:63], s42 offen  lds
    s_add_u32 m0, s3, 35840
    s_add_u32 s42, s55, 35840
    buffer_load_dwordx4 v51, s[60:63], s42 offen  lds
    s_add_u32 m0, s3, 49152
    s_add_u32 s42, s55, 49152
    buffer_load_dwordx4 v50, s[60:63], s42 offen  lds
    s_add_u32 m0, s3, 50176
    s_add_u32 s42, s55, 50176
    buffer_load_dwordx4 v51, s[60:63], s42 offen  lds
    s_add_u32 m0, s3, 51200
    s_add_u32 s42, s55, 51200
    buffer_load_dwordx4 v50, s[60:63], s42 offen  lds
    s_add_u32 m0, s3, 52224
    s_add_u32 s42, s55, 52224
    buffer_load_dwordx4 v51, s[60:63], s42 offen  lds
    s_add_u32 m0, s3, 65536
    s_add_u32 s42, s54, 0
    buffer_load_dwordx4 v42, s[56:59], s42 offen  lds
    s_add_u32 m0, s3, 66560
    s_add_u32 s42, s54, 32768
    buffer_load_dwordx4 v43, s[56:59], s42 offen  lds
    s_add_u32 m0, s3, 67584
    s_add_u32 s42, s54, 65536
    buffer_load_dwordx4 v42, s[56:59], s42 offen  lds
    s_add_u32 m0, s3, 68608
    s_add_u32 s42, s54, 98304
    buffer_load_dwordx4 v43, s[56:59], s42 offen  lds
    s_add_u32 m0, s3, 81920
    s_add_u32 s42, s54, 1048576
    buffer_load_dwordx4 v42, s[56:59], s42 offen  lds
    s_add_u32 m0, s3, 82944
    s_add_u32 s42, s54, 1081344
    buffer_load_dwordx4 v43, s[56:59], s42 offen  lds
    s_add_u32 m0, s3, 83968
    s_add_u32 s42, s54, 1114112
    buffer_load_dwordx4 v42, s[56:59], s42 offen  lds
    s_add_u32 m0, s3, 84992
    s_add_u32 s42, s54, 1146880
    buffer_load_dwordx4 v43, s[56:59], s42 offen  lds
    s_add_u32 m0, s3, 98304
    s_add_u32 s42, s54, 2097152
    buffer_load_dwordx4 v42, s[56:59], s42 offen  lds
    s_add_u32 m0, s3, 99328
    s_add_u32 s42, s54, 2129920
    buffer_load_dwordx4 v43, s[56:59], s42 offen  lds
    s_add_u32 m0, s3, 100352
    s_add_u32 s42, s54, 2162688
    buffer_load_dwordx4 v42, s[56:59], s42 offen  lds
    s_add_u32 m0, s3, 101376
    s_add_u32 s42, s54, 2195456
    buffer_load_dwordx4 v43, s[56:59], s42 offen  lds
    s_add_u32 m0, s3, 114688
    s_add_u32 s42, s54, 3145728
    buffer_load_dwordx4 v42, s[56:59], s42 offen  lds
    s_add_u32 m0, s3, 115712
    s_add_u32 s42, s54, 3178496
    buffer_load_dwordx4 v43, s[56:59], s42 offen  lds
    s_add_u32 m0, s3, 116736
    s_add_u32 s42, s54, 3211264
    buffer_load_dwordx4 v42, s[56:59], s42 offen  lds
    s_add_u32 m0, s3, 117760
    s_add_u32 s42, s54, 3244032
    buffer_load_dwordx4 v43, s[56:59], s42 offen  lds
    s_cmp_lg_u32 s27, 0
    s_cbranch_scc1 L_l1arr_71_b
    s_waitcnt vmcnt(32)
    s_cmp_lg_u32 s24, 0
    s_cbranch_scc1 L_na_74
    v_mov_b32 v126, 1
    v_mov_b32 v127, 4
    s_mov_b64 exec, 1
    buffer_atomic_add v126, v127, s[12:15], 0 offen
    s_mov_b64 exec, -1
L_na_74:
L_l1arr_71_b:
    s_lshl_b32 s42, s24, 14
    v_add_u32 v2, s42, v0
    v_add_u32 v3, 65536, v2
    v_add_u32 v1, 131072, v0
    s_waitcnt vmcnt(16)
    s_barrier
    v_xor_b32 v47, 0, v46
    ds_read_b64_tr_b16 v[160:161], v47 offset:0
    ds_read_b64_tr_b16 v[162:163], v47 offset:2048
    ds_read_b64_tr_b16 v[164:165], v47 offset:32768
    ds_read_b64_tr_b16 v[166:167], v47 offset:34816
    ds_read_b64_tr_b16 v[168:169], v47 offset:8
    ds_read_b64_tr_b16 v[170:171], v47 offset:2056
    ds_read_b64_tr_b16 v[172:173], v47 offset:32776
    ds_read_b64_tr_b16 v[174:175], v47 offset:34824
    v_xor_b32 v47, 16, v46
    ds_read_b64_tr_b16 v[176:177], v47 offset:0
    ds_read_b64_tr_b16 v[178:179], v47 offset:2048
    ds_read_b64_tr_b16 v[180:181], v47 offset:32768
    ds_read_b64_tr_b16 v[182:183], v47 offset:34816
    ds_read_b64_tr_b16 v[184:185], v47 offset:8
    ds_read_b64_tr_b16 v[186:187], v47 offset:2056
    ds_read_b64_tr_b16 v[188:189], v47 offset:32776
    ds_read_b64_tr_b16 v[190:191], v47 offset:34824
    v_xor_b32 v47, 32, v46
    ds_read_b64_tr_b16 v[192:193], v47 offset:0
    ds_read_b64_tr_b16 v[194:195], v47 offset:2048
    ds_read_b64_tr_b16 v[196:197], v47 offset:32768
    ds_read_b64_tr_b16 v[198:199], v47 offset:34816
    ds_read_b64_tr_b16 v[200:201], v47 offset:8
    ds_read_b64_tr_b16 v[202:203], v47 offset:2056
    ds_read_b64_tr_b16 v[204:205], v47 offset:32776
    ds_read_b64_tr_b16 v[206:207], v47 offset:34824
    v_xor_b32 v47, 48, v46
    ds_read_b64_tr_b16 v[208:209], v47 offset:0
    ds_read_b64_tr_b16 v[210:211], v47 offset:2048
    ds_read_b64_tr_b16 v[212:213], v47 offset:32768
    ds_read_b64_tr_b16 v[214:215], v47 offset:34816
    ds_read_b64_tr_b16 v[216:217], v47 offset:8
    ds_read_b64_tr_b16 v[218:219], v47 offset:2056
    ds_read_b64_tr_b16 v[220:221], v47 offset:32776
    ds_read_b64_tr_b16 v[222:223], v47 offset:34824
    v_lshl_or_b32 v24, v25, 16, v24
    v_lshl_or_b32 v25, v27, 16, v26
    v_lshl_or_b32 v26, v29, 16, v28
    v_lshl_or_b32 v27, v31, 16, v30
    v_lshl_or_b32 v28, v33, 16, v32
    v_lshl_or_b32 v29, v35, 16, v34
    v_lshl_or_b32 v30, v37, 16, v36
    v_lshl_or_b32 v31, v39, 16, v38
    v_min_u32 v24, -2, v24
    v_min_u32 v26, -2, v26
    v_min_u32 v28, -2, v28
    v_min_u32 v30, -2, v30
    s_waitcnt lgkmcnt(0)
    s_barrier
    s_add_u32 m0, s3, 0
    s_add_u32 s42, s54, 524288
    buffer_load_dwordx4 v42, s[56:59], s42 offen  lds
    s_add_u32 m0, s3, 1024
    s_add_u32 s42, s54, 557056
    buffer_load_dwordx4 v43, s[56:59], s42 offen  lds
    s_add_u32 m0, s3, 2048
    s_add_u32 s42, s54, 589824
    buffer_load_dwordx4 v42, s[56:59], s42 offen  lds
    s_add_u32 m0, s3, 3072
    s_add_u32 s42, s54, 622592
    buffer_load_dwordx4 v43, s[56:59], s42 offen  lds
    s_add_u32 m0, s3, 16384
    s_add_u32 s42, s54, 1572864
    buffer_load_dwordx4 v42, s[56:59], s42 offen  lds
    s_add_u32 m0, s3, 17408
    s_add_u32 s42, s54, 1605632
    buffer_load_dwordx4 v43, s[56:59], s42 offen  lds
    s_add_u32 m0, s3, 18432
    s_add_u32 s42, s54, 1638400
    buffer_load_dwordx4 v42, s[56:59], s42 offen  lds
    s_add_u32 m0, s3, 19456
    s_add_u32 s42, s54, 1671168
    buffer_load_dwordx4 v43, s[56:59], s42 offen  lds
    s_add_u32 m0, s3, 32768
    s_add_u32 s42, s54, 2621440
    buffer_load_dwordx4 v42, s[56:59], s42 offen  lds
    s_add_u32 m0, s3, 33792
    s_add_u32 s42, s54, 2654208
    buffer_load_dwordx4 v43, s[56:59], s42 offen  lds
    s_add_u32 m0, s3, 34816
    s_add_u32 s42, s54, 2686976
    buffer_load_dwordx4 v42, s[56:59], s42 offen  lds
    s_add_u32 m0, s3, 35840
    s_add_u32 s42, s54, 2719744
    buffer_load_dwordx4 v43, s[56:59], s42 offen  lds
    s_add_u32 m0, s3, 49152
    s_add_u32 s42, s54, 3670016
    buffer_load_dwordx4 v42, s[56:59], s42 offen  lds
    s_add_u32 m0, s3, 50176
    s_add_u32 s42, s54, 3702784
    buffer_load_dwordx4 v43, s[56:59], s42 offen  lds
    s_add_u32 m0, s3, 51200
    s_add_u32 s42, s54, 3735552
    buffer_load_dwordx4 v42, s[56:59], s42 offen  lds
    s_add_u32 m0, s3, 52224
    s_add_u32 s42, s54, 3768320
    buffer_load_dwordx4 v43, s[56:59], s42 offen  lds
    v_mov_b32 v5, 0
    v_bfe_i32 v41, v40, 0, 1
    v_and_b32 v41, 32, v41
    v_xor_b32 v5, v5, v41
    v_bfe_i32 v41, v40, 1, 1
    v_and_b32 v41, 64, v41
    v_xor_b32 v5, v5, v41
    v_bfe_i32 v41, v40, 2, 1
    v_and_b32 v41, 136, v41
    v_xor_b32 v5, v5, v41
    v_bfe_i32 v41, v40, 3, 1
    v_and_b32 v41, 272, v41
    v_xor_b32 v5, v5, v41
    v_bfe_i32 v41, v40, 4, 1
    v_and_b32 v41, 8, v41
    v_xor_b32 v5, v5, v41
    v_bfe_i32 v41, v40, 5, 1
    v_and_b32 v41, 16, v41
    v_xor_b32 v5, v5, v41
    s_lshl_b32 s42, s24, 10
    s_add_u32 s42, s42, 155648
    v_add_u32 v5, s42, v5
    v_mov_b32 v6, 0
    v_bfe_i32 v41, v40, 0, 1
    v_and_b32 v41, 8, v41
    v_xor_b32 v6, v6, v41
    v_bfe_i32 v41, v40, 1, 1
    v_and_b32 v41, 16, v41
    v_xor_b32 v6, v6, v41
    v_bfe_i32 v41, v40, 2, 1
    v_and_b32 v41, 32, v41
    v_xor_b32 v6, v6, v41
    v_bfe_i32 v41, v40, 3, 1
    v_and_b32 v41, 64, v41
    v_xor_b32 v6, v6, v41
    v_bfe_i32 v41, v40, 4, 1
    v_and_b32 v41, 136, v41
    v_xor_b32 v6, v6, v41
    v_bfe_i32 v41, v40, 5, 1
    v_and_b32 v41, 512, v41
    v_xor_b32 v6, v6, v41
    v_add_u32 v6, 155648, v6
    v_mov_b32 v7, 0
    v_bfe_i32 v41, v40, 0, 1
    v_and_b32 v41, 16, v41
    v_xor_b32 v7, v7, v41
    v_bfe_i32 v41, v40, 2, 1
    v_and_b32 v41, 64, v41
    v_xor_b32 v7, v7, v41
    v_bfe_i32 v41, v40, 3, 1
    v_and_b32 v41, 128, v41
    v_xor_b32 v7, v7, v41
    v_bfe_i32 v41, v40, 4, 1
    v_and_b32 v41, 32, v41
    v_xor_b32 v7, v7, v41
    v_bfe_i32 v41, v40, 5, 1
    v_and_b32 v41, 256, v41
    v_xor_b32 v7, v7, v41
    s_lshl_b32 s42, s24, 9
    s_add_u32 s42, s42, 159744
    v_add_u32 v7, s42, v7
    v_mov_b32 v8, 0
    v_bfe_i32 v41, v40, 0, 1
    v_and_b32 v41, 16, v41
    v_xor_b32 v8, v8, v41
    v_bfe_i32 v41, v40, 1, 1
    v_and_b32 v41, 32, v41
    v_xor_b32 v8, v8, v41
    v_bfe_i32 v41, v40, 2, 1
    v_and_b32 v41, 64, v41
    v_xor_b32 v8, v8, v41
    v_bfe_i32 v41, v40, 3, 1
    v_and_b32 v41, 128, v41
    v_xor_b32 v8, v8, v41
    v_bfe_i32 v41, v40, 4, 1
    v_and_b32 v41, 9216, v41
    v_xor_b32 v8, v8, v41
    v_bfe_i32 v41, v40, 5, 1
    v_and_b32 v41, 18432, v41
    v_xor_b32 v8, v8, v41
    s_and_b32 s42, s26, 15
    s_lshl_b32 s42, s42, 8
    v_xor_b32 v8, s42, v8
    s_and_b32 s42, s26, 16
    s_lshl_b32 s42, s42, 8
    s_add_u32 s31, s31, s42
    s_xor_b32 s42, s42, 4096
    s_add_u32 s32, s32, s42
    v_bfe_u32 v4, v0, 2, 5
    v_mov_b32 v10, 17476
    v_bfe_i32 v41, v40, 1, 1
    v_and_b32 v41, 43690, v41
    v_xor_b32 v10, v10, v41
    v_add_u32 v11, 131072, v0
    s_lshl_b32 s42, s24, 10
    s_add_u32 s42, s42, 159744
    v_add_u32 v13, s42, v0
    v_and_b32 v14, 15, v40
    v_and_b32 v15, 1, v14
    v_lshlrev_b32 v15, 4, v15
    v_mov_b32 v18, 0x3f80
    v_lshlrev_b32 v15, v15, v18
    v_lshrrev_b32 v14, 1, v14
    v_cmp_eq_u32 vcc, 0, v14
    s_nop 1
    v_cndmask_b32 v20, 0, v15, vcc
    v_cmp_eq_u32 vcc, 1, v14
    s_nop 1
    v_cndmask_b32 v21, 0, v15, vcc
    v_cmp_eq_u32 vcc, 2, v14
    s_nop 1
    v_cndmask_b32 v22, 0, v15, vcc
    v_cmp_eq_u32 vcc, 3, v14
    s_nop 1
    v_cndmask_b32 v23, 0, v15, vcc
    ds_write_b128 v1, v[20:23] offset:30720
    s_waitcnt vmcnt(16)
    s_barrier
    s_xor_b32 s42, s24, 0
    s_lshl_b32 s42, s42, 14
    s_add_u32 s42, s42, 65536
    v_add_u32 v47, s42, v44
    v_add_u32 v48, s42, v45
    ds_read_b64_tr_b16 a[160:161], v47 offset:0
    ds_read_b64_tr_b16 a[162:163], v47 offset:2048
    ds_read_b64_tr_b16 a[164:165], v47 offset:8192
    ds_read_b64_tr_b16 a[166:167], v47 offset:10240
    ds_read_b64_tr_b16 a[168:169], v48 offset:0
    ds_read_b64_tr_b16 a[170:171], v48 offset:2048
    ds_read_b64_tr_b16 a[172:173], v48 offset:8192
    ds_read_b64_tr_b16 a[174:175], v48 offset:10240
    s_xor_b32 s42, s24, 1
    s_lshl_b32 s42, s42, 14
    s_add_u32 s42, s42, 65536
    v_add_u32 v47, s42, v44
    v_add_u32 v48, s42, v45
    ds_read_b64_tr_b16 a[192:193], v47 offset:0
    ds_read_b64_tr_b16 a[194:195], v47 offset:2048
    ds_read_b64_tr_b16 a[196:197], v47 offset:8192
    ds_read_b64_tr_b16 a[198:199], v47 offset:10240
    ds_read_b64_tr_b16 a[200:201], v48 offset:0
    ds_read_b64_tr_b16 a[202:203], v48 offset:2048
    ds_read_b64_tr_b16 a[204:205], v48 offset:8192
    ds_read_b64_tr_b16 a[206:207], v48 offset:10240
    s_xor_b32 s42, s24, 2
    s_lshl_b32 s42, s42, 14
    s_add_u32 s42, s42, 65536
    v_add_u32 v47, s42, v44
    v_add_u32 v48, s42, v45
    ds_read_b64_tr_b16 a[224:225], v47 offset:0
    ds_read_b64_tr_b16 a[226:227], v47 offset:2048
    ds_read_b64_tr_b16 a[228:229], v47 offset:8192
    ds_read_b64_tr_b16 a[230:231], v47 offset:10240
    ds_read_b64_tr_b16 a[232:233], v48 offset:0
    ds_read_b64_tr_b16 a[234:235], v48 offset:2048
    ds_read_b64_tr_b16 a[236:237], v48 offset:8192
    ds_read_b64_tr_b16 a[238:239], v48 offset:10240
    s_xor_b32 s42, s24, 3
    s_lshl_b32 s42, s42, 14
    s_add_u32 s42, s42, 65536
    v_add_u32 v47, s42, v44
    v_add_u32 v48, s42, v45
    ds_read_b64_tr_b16 v[128:129], v47 offset:0
    ds_read_b64_tr_b16 v[130:131], v47 offset:2048
    ds_read_b64_tr_b16 v[132:133], v47 offset:8192
    ds_read_b64_tr_b16 v[134:135], v47 offset:10240
    ds_read_b64_tr_b16 v[136:137], v48 offset:0
    ds_read_b64_tr_b16 v[138:139], v48 offset:2048
    ds_read_b64_tr_b16 v[140:141], v48 offset:8192
    ds_read_b64_tr_b16 v[142:143], v48 offset:10240
    s_waitcnt lgkmcnt(0)
    s_barrier
    s_add_u32 m0, s3, 65536
    s_add_u32 s42, s54, 524288
    buffer_load_dwordx4 v42, s[16:19], s42 offen  lds
    s_add_u32 m0, s3, 66560
    s_add_u32 s42, s54, 557056
    buffer_load_dwordx4 v43, s[16:19], s42 offen  lds
    s_add_u32 m0, s3, 67584
    s_add_u32 s42, s54, 589824
    buffer_load_dwordx4 v42, s[16:19], s42 offen  lds
    s_add_u32 m0, s3, 68608
    s_add_u32 s42, s54, 622592
    buffer_load_dwordx4 v43, s[16:19], s42 offen  lds
    s_add_u32 m0, s3, 81920
    s_add_u32 s42, s54, 1572864
    buffer_load_dwordx4 v42, s[16:19], s42 offen  lds
    s_add_u32 m0, s3, 82944
    s_add_u32 s42, s54, 1605632
    buffer_load_dwordx4 v43, s[16:19], s42 offen  lds
    s_add_u32 m0, s3, 83968
    s_add_u32 s42, s54, 1638400
    buffer_load_dwordx4 v42, s[16:19], s42 offen  lds
    s_add_u32 m0, s3, 84992
    s_add_u32 s42, s54, 1671168
    buffer_load_dwordx4 v43, s[16:19], s42 offen  lds
    s_add_u32 m0, s3, 98304
    s_add_u32 s42, s54, 2621440
    buffer_load_dwordx4 v42, s[16:19], s42 offen  lds
    s_add_u32 m0, s3, 99328
    s_add_u32 s42, s54, 2654208
    buffer_load_dwordx4 v43, s[16:19], s42 offen  lds
    s_add_u32 m0, s3, 100352
    s_add_u32 s42, s54, 2686976
    buffer_load_dwordx4 v42, s[16:19], s42 offen  lds
    s_add_u32 m0, s3, 101376
    s_add_u32 s42, s54, 2719744
    buffer_load_dwordx4 v43, s[16:19], s42 offen  lds
    s_add_u32 m0, s3, 114688
    s_add_u32 s42, s54, 3670016
    buffer_load_dwordx4 v42, s[16:19], s42 offen  lds
    s_add_u32 m0, s3, 115712
    s_add_u32 s42, s54, 3702784
    buffer_load_dwordx4 v43, s[16:19], s42 offen  lds
    s_add_u32 m0, s3, 116736
    s_add_u32 s42, s54, 3735552
    buffer_load_dwordx4 v42, s[16:19], s42 offen  lds
    s_add_u32 m0, s3, 117760
    s_add_u32 s42, s54, 3768320
    buffer_load_dwordx4 v43, s[16:19], s42 offen  lds
    v_mbcnt_lo_u32_b32 v16, -1, 0
    v_mbcnt_hi_u32_b32 v16, -1, v16
    v_lshlrev_b32 v16, 5, v16
    v_cmp_gt_u32 vcc, 256, v16
    s_nop 1
    v_cndmask_b32 v16, 4, v16, vcc
    buffer_load_dword v17, v16, s[12:15], 0 offen sc1
    s_waitcnt vmcnt(16)
    s_barrier
    s_xor_b32 s42, s24, 0
    s_lshl_b32 s42, s42, 14
    s_add_u32 s42, s42, 0
    v_add_u32 v47, s42, v44
    v_add_u32 v48, s42, v45
    ds_read_b64_tr_b16 a[176:177], v47 offset:0
    ds_read_b64_tr_b16 a[178:179], v47 offset:2048
    ds_read_b64_tr_b16 a[180:181], v47 offset:8192
    ds_read_b64_tr_b16 a[182:183], v47 offset:10240
    ds_read_b64_tr_b16 a[184:185], v48 offset:0
    ds_read_b64_tr_b16 a[186:187], v48 offset:2048
    ds_read_b64_tr_b16 a[188:189], v48 offset:8192
    ds_read_b64_tr_b16 a[190:191], v48 offset:10240
    s_xor_b32 s42, s24, 1
    s_lshl_b32 s42, s42, 14
    s_add_u32 s42, s42, 0
    v_add_u32 v47, s42, v44
    v_add_u32 v48, s42, v45
    ds_read_b64_tr_b16 a[208:209], v47 offset:0
    ds_read_b64_tr_b16 a[210:211], v47 offset:2048
    ds_read_b64_tr_b16 a[212:213], v47 offset:8192
    ds_read_b64_tr_b16 a[214:215], v47 offset:10240
    ds_read_b64_tr_b16 a[216:217], v48 offset:0
    ds_read_b64_tr_b16 a[218:219], v48 offset:2048
    ds_read_b64_tr_b16 a[220:221], v48 offset:8192
    ds_read_b64_tr_b16 a[222:223], v48 offset:10240
    s_xor_b32 s42, s24, 2
    s_lshl_b32 s42, s42, 14
    s_add_u32 s42, s42, 0
    v_add_u32 v47, s42, v44
    v_add_u32 v48, s42, v45
    ds_read_b64_tr_b16 a[240:241], v47 offset:0
    ds_read_b64_tr_b16 a[242:243], v47 offset:2048
    ds_read_b64_tr_b16 a[244:245], v47 offset:8192
    ds_read_b64_tr_b16 a[246:247], v47 offset:10240
    ds_read_b64_tr_b16 a[248:249], v48 offset:0
    ds_read_b64_tr_b16 a[250:251], v48 offset:2048
    ds_read_b64_tr_b16 a[252:253], v48 offset:8192
    ds_read_b64_tr_b16 a[254:255], v48 offset:10240
    s_xor_b32 s42, s24, 3
    s_lshl_b32 s42, s42, 14
    s_add_u32 s42, s42, 0
    v_add_u32 v47, s42, v44
    v_add_u32 v48, s42, v45
    ds_read_b64_tr_b16 v[144:145], v47 offset:0
    ds_read_b64_tr_b16 v[146:147], v47 offset:2048
    ds_read_b64_tr_b16 v[148:149], v47 offset:8192
    ds_read_b64_tr_b16 v[150:151], v47 offset:10240
    ds_read_b64_tr_b16 v[152:153], v48 offset:0
    ds_read_b64_tr_b16 v[154:155], v48 offset:2048
    ds_read_b64_tr_b16 v[156:157], v48 offset:8192
    ds_read_b64_tr_b16 v[158:159], v48 offset:10240
    s_waitcnt lgkmcnt(0)
    s_barrier
    s_add_u32 m0, s3, 0
    s_add_u32 s42, s54, 524288
    buffer_load_dwordx4 v42, s[20:23], s42 offen  lds
    s_add_u32 m0, s3, 1024
    s_add_u32 s42, s54, 557056
    buffer_load_dwordx4 v43, s[20:23], s42 offen  lds
    s_add_u32 m0, s3, 2048
    s_add_u32 s42, s54, 589824
    buffer_load_dwordx4 v42, s[20:23], s42 offen  lds
    s_add_u32 m0, s3, 3072
    s_add_u32 s42, s54, 622592
    buffer_load_dwordx4 v43, s[20:23], s42 offen  lds
    s_add_u32 m0, s3, 16384
    s_add_u32 s42, s54, 1572864
    buffer_load_dwordx4 v42, s[20:23], s42 offen  lds
    s_add_u32 m0, s3, 17408
    s_add_u32 s42, s54, 1605632
    buffer_load_dwordx4 v43, s[20:23], s42 offen  lds
    s_add_u32 m0, s3, 18432
    s_add_u32 s42, s54, 1638400
    buffer_load_dwordx4 v42, s[20:23], s42 offen  lds
    s_add_u32 m0, s3, 19456
    s_add_u32 s42, s54, 1671168
    buffer_load_dwordx4 v43, s[20:23], s42 offen  lds
    s_add_u32 m0, s3, 32768
    s_add_u32 s42, s54, 2621440
    buffer_load_dwordx4 v42, s[20:23], s42 offen  lds
    s_add_u32 m0, s3, 33792
    s_add_u32 s42, s54, 2654208
    buffer_load_dwordx4 v43, s[20:23], s42 offen  lds
    s_add_u32 m0, s3, 34816
    s_add_u32 s42, s54, 2686976
    buffer_load_dwordx4 v42, s[20:23], s42 offen  lds
    s_add_u32 m0, s3, 35840
    s_add_u32 s42, s54, 2719744
    buffer_load_dwordx4 v43, s[20:23], s42 offen  lds
    s_add_u32 m0, s3, 49152
    s_add_u32 s42, s54, 3670016
    buffer_load_dwordx4 v42, s[20:23], s42 offen  lds
    s_add_u32 m0, s3, 50176
    s_add_u32 s42, s54, 3702784
    buffer_load_dwordx4 v43, s[20:23], s42 offen  lds
    s_add_u32 m0, s3, 51200
    s_add_u32 s42, s54, 3735552
    buffer_load_dwordx4 v42, s[20:23], s42 offen  lds
    s_add_u32 m0, s3, 52224
    s_add_u32 s42, s54, 3768320
    buffer_load_dwordx4 v43, s[20:23], s42 offen  lds
    s_waitcnt vmcnt(16)
    s_barrier
    s_xor_b32 s42, s24, 0
    s_lshl_b32 s42, s42, 14
    s_add_u32 s42, s42, 65536
    v_add_u32 v47, s42, v44
    v_add_u32 v48, s42, v45
    ds_read_b64_tr_b16 a[0:1], v47 offset:0
    ds_read_b64_tr_b16 a[2:3], v47 offset:2048
    ds_read_b64_tr_b16 a[4:5], v47 offset:8192
    ds_read_b64_tr_b16 a[6:7], v47 offset:10240
    ds_read_b64_tr_b16 a[8:9], v48 offset:0
    ds_read_b64_tr_b16 a[10:11], v48 offset:2048
    ds_read_b64_tr_b16 a[12:13], v48 offset:8192
    ds_read_b64_tr_b16 a[14:15], v48 offset:10240
    s_xor_b32 s42, s24, 1
    s_lshl_b32 s42, s42, 14
    s_add_u32 s42, s42, 65536
    v_add_u32 v47, s42, v44
    v_add_u32 v48, s42, v45
    ds_read_b64_tr_b16 a[16:17], v47 offset:0
    ds_read_b64_tr_b16 a[18:19], v47 offset:2048
    ds_read_b64_tr_b16 a[20:21], v47 offset:8192
    ds_read_b64_tr_b16 a[22:23], v47 offset:10240
    ds_read_b64_tr_b16 a[24:25], v48 offset:0
    ds_read_b64_tr_b16 a[26:27], v48 offset:2048
    ds_read_b64_tr_b16 a[28:29], v48 offset:8192
    ds_read_b64_tr_b16 a[30:31], v48 offset:10240
    s_xor_b32 s42, s24, 2
    s_lshl_b32 s42, s42, 14
    s_add_u32 s42, s42, 65536
    v_add_u32 v47, s42, v44
    v_add_u32 v48, s42, v45
    ds_read_b64_tr_b16 a[48:49], v47 offset:0
    ds_read_b64_tr_b16 a[50:51], v47 offset:2048
    ds_read_b64_tr_b16 a[52:53], v47 offset:8192
    ds_read_b64_tr_b16 a[54:55], v47 offset:10240
    ds_read_b64_tr_b16 a[56:57], v48 offset:0
    ds_read_b64_tr_b16 a[58:59], v48 offset:2048
    ds_read_b64_tr_b16 a[60:61], v48 offset:8192
    ds_read_b64_tr_b16 a[62:63], v48 offset:10240
    s_xor_b32 s42, s24, 3
    s_lshl_b32 s42, s42, 14
    s_add_u32 s42, s42, 65536
    v_add_u32 v47, s42, v44
    v_add_u32 v48, s42, v45
    ds_read_b64_tr_b16 a[80:81], v47 offset:0
    ds_read_b64_tr_b16 a[82:83], v47 offset:2048
    ds_read_b64_tr_b16 a[84:85], v47 offset:8192
    ds_read_b64_tr_b16 a[86:87], v47 offset:10240
    ds_read_b64_tr_b16 a[88:89], v48 offset:0
    ds_read_b64_tr_b16 a[90:91], v48 offset:2048
    ds_read_b64_tr_b16 a[92:93], v48 offset:8192
    ds_read_b64_tr_b16 a[94:95], v48 offset:10240
    s_waitcnt lgkmcnt(0)
    s_barrier
    s_add_u32 m0, s3, 65536
    s_add_u32 s42, s55, 65536
    buffer_load_dwordx4 v50, s[60:63], s42 offen  lds
    s_add_u32 m0, s3, 66560
    s_add_u32 s42, s55, 66560
    buffer_load_dwordx4 v51, s[60:63], s42 offen  lds
    s_add_u32 m0, s3, 67584
    s_add_u32 s42, s55, 67584
    buffer_load_dwordx4 v50, s[60:63], s42 offen  lds
    s_add_u32 m0, s3, 68608
    s_add_u32 s42, s55, 68608
    buffer_load_dwordx4 v51, s[60:63], s42 offen  lds
    s_add_u32 m0, s3, 81920
    s_add_u32 s42, s55, 81920
    buffer_load_dwordx4 v50, s[60:63], s42 offen  lds
    s_add_u32 m0, s3, 82944
    s_add_u32 s42, s55, 82944
    buffer_load_dwordx4 v51, s[60:63], s42 offen  lds
    s_add_u32 m0, s3, 83968
    s_add_u32 s42, s55, 83968
    buffer_load_dwordx4 v50, s[60:63], s42 offen  lds
    s_add_u32 m0, s3, 84992
    s_add_u32 s42, s55, 84992
    buffer_load_dwordx4 v51, s[60:63], s42 offen  lds
    s_add_u32 m0, s3, 98304
    s_add_u32 s42, s55, 98304
    buffer_load_dwordx4 v50, s[60:63], s42 offen  lds
    s_add_u32 m0, s3, 99328
    s_add_u32 s42, s55, 99328
    buffer_load_dwordx4 v51, s[60:63], s42 offen  lds
    s_add_u32 m0, s3, 100352
    s_add_u32 s42, s55, 100352
    buffer_load_dwordx4 v50, s[60:63], s42 offen  lds
    s_add_u32 m0, s3, 101376
    s_add_u32 s42, s55, 101376
    buffer_load_dwordx4 v51, s[60:63], s42 offen  lds
    s_add_u32 m0, s3, 114688
    s_add_u32 s42, s55, 114688
    buffer_load_dwordx4 v50, s[60:63], s42 offen  lds
    s_add_u32 m0, s3, 115712
    s_add_u32 s42, s55, 115712
    buffer_load_dwordx4 v51, s[60:63], s42 offen  lds
    s_add_u32 m0, s3, 116736
    s_add_u32 s42, s55, 116736
    buffer_load_dwordx4 v50, s[60:63], s42 offen  lds
    s_add_u32 m0, s3, 117760
    s_add_u32 s42, s55, 117760
    buffer_load_dwordx4 v51, s[60:63], s42 offen  lds
    s_waitcnt vmcnt(16)
    s_barrier
    s_xor_b32 s42, s24, 0
    s_lshl_b32 s42, s42, 14
    s_add_u32 s42, s42, 0
    v_add_u32 v47, s42, v44
    v_add_u32 v48, s42, v45
    ds_read_b64_tr_b16 a[96:97], v47 offset:0
    ds_read_b64_tr_b16 a[98:99], v47 offset:2048
    ds_read_b64_tr_b16 a[100:101], v47 offset:8192
    ds_read_b64_tr_b16 a[102:103], v47 offset:10240
    ds_read_b64_tr_b16 a[104:105], v48 offset:0
    ds_read_b64_tr_b16 a[106:107], v48 offset:2048
    ds_read_b64_tr_b16 a[108:109], v48 offset:8192
    ds_read_b64_tr_b16 a[110:111], v48 offset:10240
    s_xor_b32 s42, s24, 1
    s_lshl_b32 s42, s42, 14
    s_add_u32 s42, s42, 0
    v_add_u32 v47, s42, v44
    v_add_u32 v48, s42, v45
    ds_read_b64_tr_b16 a[112:113], v47 offset:0
    ds_read_b64_tr_b16 a[114:115], v47 offset:2048
    ds_read_b64_tr_b16 a[116:117], v47 offset:8192
    ds_read_b64_tr_b16 a[118:119], v47 offset:10240
    ds_read_b64_tr_b16 a[120:121], v48 offset:0
    ds_read_b64_tr_b16 a[122:123], v48 offset:2048
    ds_read_b64_tr_b16 a[124:125], v48 offset:8192
    ds_read_b64_tr_b16 a[126:127], v48 offset:10240
    s_xor_b32 s42, s24, 2
    s_lshl_b32 s42, s42, 14
    s_add_u32 s42, s42, 0
    v_add_u32 v47, s42, v44
    v_add_u32 v48, s42, v45
    ds_read_b64_tr_b16 a[128:129], v47 offset:0
    ds_read_b64_tr_b16 a[130:131], v47 offset:2048
    ds_read_b64_tr_b16 a[132:133], v47 offset:8192
    ds_read_b64_tr_b16 a[134:135], v47 offset:10240
    ds_read_b64_tr_b16 a[136:137], v48 offset:0
    ds_read_b64_tr_b16 a[138:139], v48 offset:2048
    ds_read_b64_tr_b16 a[140:141], v48 offset:8192
    ds_read_b64_tr_b16 a[142:143], v48 offset:10240
    s_xor_b32 s42, s24, 3
    s_lshl_b32 s42, s42, 14
    s_add_u32 s42, s42, 0
    v_add_u32 v47, s42, v44
    v_add_u32 v48, s42, v45
    ds_read_b64_tr_b16 a[144:145], v47 offset:0
    ds_read_b64_tr_b16 a[146:147], v47 offset:2048
    ds_read_b64_tr_b16 a[148:149], v47 offset:8192
    ds_read_b64_tr_b16 a[150:151], v47 offset:10240
    ds_read_b64_tr_b16 a[152:153], v48 offset:0
    ds_read_b64_tr_b16 a[154:155], v48 offset:2048
    ds_read_b64_tr_b16 a[156:157], v48 offset:8192
    ds_read_b64_tr_b16 a[158:159], v48 offset:10240
    s_waitcnt lgkmcnt(0)
    s_barrier
    s_add_u32 m0, s3, 0
    s_add_u32 s42, s54, 0
    buffer_load_dwordx4 v42, s[16:19], s42 offen  lds
    s_add_u32 m0, s3, 1024
    s_add_u32 s42, s54, 32768
    buffer_load_dwordx4 v43, s[16:19], s42 offen  lds
    s_add_u32 m0, s3, 2048
    s_add_u32 s42, s54, 65536
    buffer_load_dwordx4 v42, s[16:19], s42 offen  lds
    s_add_u32 m0, s3, 3072
    s_add_u32 s42, s54, 98304
    buffer_load_dwordx4 v43, s[16:19], s42 offen  lds
    s_add_u32 m0, s3, 16384
    s_add_u32 s42, s54, 1048576
    buffer_load_dwordx4 v42, s[16:19], s42 offen  lds
    s_add_u32 m0, s3, 17408
    s_add_u32 s42, s54, 1081344
    buffer_load_dwordx4 v43, s[16:19], s42 offen  lds
    s_add_u32 m0, s3, 18432
    s_add_u32 s42, s54, 1114112
    buffer_load_dwordx4 v42, s[16:19], s42 offen  lds
    s_add_u32 m0, s3, 19456
    s_add_u32 s42, s54, 1146880
    buffer_load_dwordx4 v43, s[16:19], s42 offen  lds
    s_add_u32 m0, s3, 32768
    s_add_u32 s42, s54, 2097152
    buffer_load_dwordx4 v42, s[16:19], s42 offen  lds
    s_add_u32 m0, s3, 33792
    s_add_u32 s42, s54, 2129920
    buffer_load_dwordx4 v43, s[16:19], s42 offen  lds
    s_add_u32 m0, s3, 34816
    s_add_u32 s42, s54, 2162688
    buffer_load_dwordx4 v42, s[16:19], s42 offen  lds
    s_add_u32 m0, s3, 35840
    s_add_u32 s42, s54, 2195456
    buffer_load_dwordx4 v43, s[16:19], s42 offen  lds
    s_add_u32 m0, s3, 49152
    s_add_u32 s42, s54, 3145728
    buffer_load_dwordx4 v42, s[16:19], s42 offen  lds
    s_add_u32 m0, s3, 50176
    s_add_u32 s42, s54, 3178496
    buffer_load_dwordx4 v43, s[16:19], s42 offen  lds
    s_add_u32 m0, s3, 51200
    s_add_u32 s42, s54, 3211264
    buffer_load_dwordx4 v42, s[16:19], s42 offen  lds
    s_add_u32 m0, s3, 52224
    s_add_u32 s42, s54, 3244032
    buffer_load_dwordx4 v43, s[16:19], s42 offen  lds
    v_readlane_b32 s98, v17, 8
    v_cmp_ne_u32 vcc, 32, v17
    s_nop 3
    s_and_b32 s5, vcc_lo, 0xff
    s_cmp_lt_u32 s98, 256
    s_cselect_b32 s98, 1, s5
    s_cmp_eq_u32 s98, 0
    s_cbranch_scc1 L_gw_75_done
L_gw_75:
    buffer_load_dword v17, v16, s[12:15], 0 offen sc1
    s_add_u32 s52, s52, 0x1000
    s_cmp_ge_u32 s52, 2147418112
    s_cbranch_scc1 L_fail
    s_waitcnt vmcnt(0)
    v_readlane_b32 s98, v17, 8
    s_nop 3
    s_cmp_ge_u32 s98, 256
    s_cbranch_scc1 L_gw_75_ok
    s_sleep 4
    s_branch L_gw_75
L_gw_75_ok:
    buffer_load_dword v17, v16, s[12:15], 0 offen sc1
    s_waitcnt vmcnt(0)
    v_cmp_ne_u32 vcc, 32, v17
    s_nop 3
    s_and_b32 s5, vcc_lo, 0xff
L_gw_75_done:
    s_waitcnt vmcnt(16)
    s_barrier
    v_xor_b32 v47, 0, v46
    v_add_u32 v47, 65536, v47
    ds_read_b64_tr_b16 v[224:225], v47 offset:0
    ds_read_b64_tr_b16 v[226:227], v47 offset:2048
    ds_read_b64_tr_b16 v[228:229], v47 offset:32768
    ds_read_b64_tr_b16 v[230:231], v47 offset:34816
    ds_read_b64_tr_b16 v[232:233], v47 offset:8
    ds_read_b64_tr_b16 v[234:235], v47 offset:2056
    ds_read_b64_tr_b16 v[236:237], v47 offset:32776
    ds_read_b64_tr_b16 v[238:239], v47 offset:34824
    v_xor_b32 v47, 16, v46
    v_add_u32 v47, 65536, v47
    ds_read_b64_tr_b16 v[240:241], v47 offset:0
    ds_read_b64_tr_b16 v[242:243], v47 offset:2048
    ds_read_b64_tr_b16 v[244:245], v47 offset:32768
    ds_read_b64_tr_b16 v[246:247], v47 offset:34816
    ds_read_b64_tr_b16 v[248:249], v47 offset:8
    ds_read_b64_tr_b16 v[250:251], v47 offset:2056
    ds_read_b64_tr_b16 v[252:253], v47 offset:32776
    ds_read_b64_tr_b16 v[254:255], v47 offset:34824
    v_xor_b32 v47, 32, v46
    v_add_u32 v47, 65536, v47
    ds_read_b64_tr_b16 v[56:57], v47 offset:0
    ds_read_b64_tr_b16 v[58:59], v47 offset:2048
    ds_read_b64_tr_b16 v[60:61], v47 offset:32768
    ds_read_b64_tr_b16 v[62:63], v47 offset:34816
    ds_read_b64_tr_b16 v[64:65], v47 offset:8
    ds_read_b64_tr_b16 v[66:67], v47 offset:2056
    ds_read_b64_tr_b16 v[68:69], v47 offset:32776
    ds_read_b64_tr_b16 v[70:71], v47 offset:34824
    v_xor_b32 v47, 48, v46
    v_add_u32 v47, 65536, v47
    ds_read_b64_tr_b16 v[72:73], v47 offset:0
    ds_read_b64_tr_b16 v[74:75], v47 offset:2048
    ds_read_b64_tr_b16 v[76:77], v47 offset:32768
    ds_read_b64_tr_b16 v[78:79], v47 offset:34816
    ds_read_b64_tr_b16 v[80:81], v47 offset:8
    ds_read_b64_tr_b16 v[82:83], v47 offset:2056
    ds_read_b64_tr_b16 v[84:85], v47 offset:32776
    ds_read_b64_tr_b16 v[86:87], v47 offset:34824
    s_waitcnt lgkmcnt(0)
    s_barrier
    s_add_u32 m0, s3, 65536
    s_add_u32 s42, s54, 0
    buffer_load_dwordx4 v42, s[20:23], s42 offen  lds
    s_add_u32 m0, s3, 66560
    s_add_u32 s42, s54, 32768
    buffer_load_dwordx4 v43, s[20:23], s42 offen  lds
    s_add_u32 m0, s3, 67584
    s_add_u32 s42, s54, 65536
    buffer_load_dwordx4 v42, s[20:23], s42 offen  lds
    s_add_u32 m0, s3, 68608
    s_add_u32 s42, s54, 98304
    buffer_load_dwordx4 v43, s[20:23], s42 offen  lds
    s_add_u32 m0, s3, 81920
    s_add_u32 s42, s54, 1048576
    buffer_load_dwordx4 v42, s[20:23], s42 offen  lds
    s_add_u32 m0, s3, 82944
    s_add_u32 s42, s54, 1081344
    buffer_load_dwordx4 v43, s[20:23], s42 offen  lds
    s_add_u32 m0, s3, 83968
    s_add_u32 s42, s54, 1114112
    buffer_load_dwordx4 v42, s[20:23], s42 offen  lds
    s_add_u32 m0, s3, 84992
    s_add_u32 s42, s54, 1146880
    buffer_load_dwordx4 v43, s[20:23], s42 offen  lds
    s_add_u32 m0, s3, 98304
    s_add_u32 s42, s54, 2097152
    buffer_load_dwordx4 v42, s[20:23], s42 offen  lds
    s_add_u32 m0, s3, 99328
    s_add_u32 s42, s54, 2129920
    buffer_load_dwordx4 v43, s[20:23], s42 offen  lds
    s_add_u32 m0, s3, 100352
    s_add_u32 s42, s54, 2162688
    buffer_load_dwordx4 v42, s[20:23], s42 offen  lds
    s_add_u32 m0, s3, 101376
    s_add_u32 s42, s54, 2195456
    buffer_load_dwordx4 v43, s[20:23], s42 offen  lds
    s_add_u32 m0, s3, 114688
    s_add_u32 s42, s54, 3145728
    buffer_load_dwordx4 v42, s[20:23], s42 offen  lds
    s_add_u32 m0, s3, 115712
    s_add_u32 s42, s54, 3178496
    buffer_load_dwordx4 v43, s[20:23], s42 offen  lds
    s_add_u32 m0, s3, 116736
    s_add_u32 s42, s54, 3211264
    buffer_load_dwordx4 v42, s[20:23], s42 offen  lds
    s_add_u32 m0, s3, 117760
    s_add_u32 s42, s54, 3244032
    buffer_load_dwordx4 v43, s[20:23], s42 offen  lds
    s_or_b32 s99, s24, s27
    s_cbranch_scc1 L_na_76
    v_mov_b32 v126, 1
    v_mov_b32 v127, 132
    s_mov_b64 exec, 1
    buffer_atomic_add v126, v127, s[12:15], 0 offen
    s_mov_b64 exec, -1
L_na_76:
    buffer_load_dwordx4 v[32:35], v0, s[8:11], s33 offen offset:0 sc1
    buffer_load_dwordx4 v[32:35], v0, s[8:11], s33 offen offset:1024 sc1
    buffer_load_dwordx4 v[32:35], v0, s[8:11], s33 offen offset:2048 sc1
    buffer_load_dwordx4 v[32:35], v0, s[8:11], s33 offen offset:3072 sc1
    buffer_load_dwordx4 v[32:35], v0, s[8:11], s34 offen offset:0 sc1
    buffer_load_dwordx4 v[32:35], v0, s[8:11], s34 offen offset:1024 sc1
    buffer_load_dwordx4 v[32:35], v0, s[8:11], s34 offen offset:2048 sc1
    buffer_load_dwordx4 v[32:35], v0, s[8:11], s34 offen offset:3072 sc1
    s_add_u32 s42, s35, s53
    buffer_load_dwordx4 v[36:39], v0, s[8:11], s42 offen offset:0 sc1
    buffer_load_dwordx4 v[36:39], v0, s[8:11], s42 offen offset:1024 sc1
    s_add_u32 s42, s36, s53
    buffer_load_dwordx4 v[36:39], v0, s[8:11], s42 offen offset:0 sc1
    buffer_load_dwordx4 v[36:39], v0, s[8:11], s42 offen offset:1024 sc1
    s_add_u32 s42, s37, s53
    buffer_load_dwordx4 v[36:39], v0, s[8:11], s42 offen offset:0 sc1
    buffer_load_dwordx4 v[36:39], v0, s[8:11], s42 offen offset:1024 sc1
    s_waitcnt vmcnt(30)
    s_barrier
    s_xor_b32 s42, s24, 0
    s_lshl_b32 s42, s42, 14
    s_add_u32 s42, s42, 0
    v_add_u32 v47, s42, v44
    v_add_u32 v48, s42, v45
    ds_read_b64_tr_b16 v[88:89], v47 offset:0
    ds_read_b64_tr_b16 v[90:91], v47 offset:2048
    ds_read_b64_tr_b16 v[92:93], v47 offset:8192
    ds_read_b64_tr_b16 v[94:95], v47 offset:10240
    ds_read_b64_tr_b16 v[96:97], v48 offset:0
    ds_read_b64_tr_b16 v[98:99], v48 offset:2048
    ds_read_b64_tr_b16 v[100:101], v48 offset:8192
    ds_read_b64_tr_b16 v[102:103], v48 offset:10240
    s_xor_b32 s42, s24, 1
    s_lshl_b32 s42, s42, 14
    s_add_u32 s42, s42, 0
    v_add_u32 v47, s42, v44
    v_add_u32 v48, s42, v45
    ds_read_b64_tr_b16 v[104:105], v47 offset:0
    ds_read_b64_tr_b16 v[106:107], v47 offset:2048
    ds_read_b64_tr_b16 v[108:109], v47 offset:8192
    ds_read_b64_tr_b16 v[110:111], v47 offset:10240
    ds_read_b64_tr_b16 v[112:113], v48 offset:0
    ds_read_b64_tr_b16 v[114:115], v48 offset:2048
    ds_read_b64_tr_b16 v[116:117], v48 offset:8192
    ds_read_b64_tr_b16 v[118:119], v48 offset:10240
    s_xor_b32 s42, s24, 2
    s_lshl_b32 s42, s42, 14
    s_add_u32 s42, s42, 0
    v_add_u32 v47, s42, v44
    v_add_u32 v48, s42, v45
    ds_read_b64_tr_b16 a[32:33], v47 offset:0
    ds_read_b64_tr_b16 a[34:35], v47 offset:2048
    ds_read_b64_tr_b16 a[36:37], v47 offset:8192
    ds_read_b64_tr_b16 a[38:39], v47 offset:10240
    ds_read_b64_tr_b16 a[40:41], v48 offset:0
    ds_read_b64_tr_b16 a[42:43], v48 offset:2048
    ds_read_b64_tr_b16 a[44:45], v48 offset:8192
    ds_read_b64_tr_b16 a[46:47], v48 offset:10240
    s_xor_b32 s42, s24, 3
    s_lshl_b32 s42, s42, 14
    s_add_u32 s42, s42, 0
    v_add_u32 v47, s42, v44
    v_add_u32 v48, s42, v45
    ds_read_b64_tr_b16 a[64:65], v47 offset:0
    ds_read_b64_tr_b16 a[66:67], v47 offset:2048
    ds_read_b64_tr_b16 a[68:69], v47 offset:8192
    ds_read_b64_tr_b16 a[70:71], v47 offset:10240
    ds_read_b64_tr_b16 a[72:73], v48 offset:0
    ds_read_b64_tr_b16 a[74:75], v48 offset:2048
    ds_read_b64_tr_b16 a[76:77], v48 offset:8192
    ds_read_b64_tr_b16 a[78:79], v48 offset:10240
    s_waitcnt lgkmcnt(0)
    s_barrier
    ds_write_b128 v2, v[56:59] offset:0
    ds_write_b128 v2, v[60:63] offset:1024
    ds_write_b128 v2, v[64:67] offset:2048
    ds_write_b128 v2, v[68:71] offset:3072
    ds_write_b128 v2, v[72:75] offset:4096
    ds_write_b128 v2, v[76:79] offset:5120
    ds_write_b128 v2, v[80:83] offset:6144
    ds_write_b128 v2, v[84:87] offset:7168
    ds_write_b128 v2, v[88:91] offset:8192
    ds_write_b128 v2, v[92:95] offset:9216
    ds_write_b128 v2, v[96:99] offset:10240
    ds_write_b128 v2, v[100:103] offset:11264
    ds_write_b128 v2, v[104:107] offset:12288
    ds_write_b128 v2, v[108:111] offset:13312
    ds_write_b128 v2, v[112:115] offset:14336
    ds_write_b128 v2, v[116:119] offset:15360
    s_or_b32 s99, s24, s27
    s_cbranch_scc1 L_na_77
    v_mov_b32 v126, 1
    v_mov_b32 v127, 132
    s_mov_b64 exec, 1
    buffer_atomic_add v126, v127, s[12:15], 0 offen
    s_mov_b64 exec, -1
L_na_77:
    buffer_load_dword v12, v4, s[8:11], s40 offen sc1
    s_waitcnt lgkmcnt(0)
    s_waitcnt vmcnt(15)
    s_barrier
    s_xor_b32 s42, s24, 0
    s_lshl_b32 s42, s42, 14
    s_add_u32 s42, s42, 65536
    v_add_u32 v47, s42, v44
    v_add_u32 v48, s42, v45
    ds_read_b64_tr_b16 v[56:57], v47 offset:0
    ds_read_b64_tr_b16 v[58:59], v47 offset:2048
    ds_read_b64_tr_b16 v[60:61], v47 offset:8192
    ds_read_b64_tr_b16 v[62:63], v47 offset:10240
    ds_read_b64_tr_b16 v[64:65], v48 offset:0
    ds_read_b64_tr_b16 v[66:67], v48 offset:2048
    ds_read_b64_tr_b16 v[68:69], v48 offset:8192
    ds_read_b64_tr_b16 v[70:71], v48 offset:10240
    s_xor_b32 s42, s24, 1
    s_lshl_b32 s42, s42, 14
    s_add_u32 s42, s42, 65536
    v_add_u32 v47, s42, v44
    v_add_u32 v48, s42, v45
    ds_read_b64_tr_b16 v[72:73], v47 offset:0
    ds_read_b64_tr_b16 v[74:75], v47 offset:2048
    ds_read_b64_tr_b16 v[76:77], v47 offset:8192
    ds_read_b64_tr_b16 v[78:79], v47 offset:10240
    ds_read_b64_tr_b16 v[80:81], v48 offset:0
    ds_read_b64_tr_b16 v[82:83], v48 offset:2048
    ds_read_b64_tr_b16 v[84:85], v48 offset:8192
    ds_read_b64_tr_b16 v[86:87], v48 offset:10240
    s_xor_b32 s42, s24, 2
    s_lshl_b32 s42, s42, 14
    s_add_u32 s42, s42, 65536
    v_add_u32 v47, s42, v44
    v_add_u32 v48, s42, v45
    ds_read_b64_tr_b16 v[88:89], v47 offset:0
    ds_read_b64_tr_b16 v[90:91], v47 offset:2048
    ds_read_b64_tr_b16 v[92:93], v47 offset:8192
    ds_read_b64_tr_b16 v[94:95], v47 offset:10240
    ds_read_b64_tr_b16 v[96:97], v48 offset:0
    ds_read_b64_tr_b16 v[98:99], v48 offset:2048
    ds_read_b64_tr_b16 v[100:101], v48 offset:8192
    ds_read_b64_tr_b16 v[102:103], v48 offset:10240
    s_xor_b32 s42, s24, 3
    s_lshl_b32 s42, s42, 14
    s_add_u32 s42, s42, 65536
    v_add_u32 v47, s42, v44
    v_add_u32 v48, s42, v45
    ds_read_b64_tr_b16 v[104:105], v47 offset:0
    ds_read_b64_tr_b16 v[106:107], v47 offset:2048
    ds_read_b64_tr_b16 v[108:109], v47 offset:8192
    ds_read_b64_tr_b16 v[110:111], v47 offset:10240
    ds_read_b64_tr_b16 v[112:113], v48 offset:0
    ds_read_b64_tr_b16 v[114:115], v48 offset:2048
    ds_read_b64_tr_b16 v[116:117], v48 offset:8192
    ds_read_b64_tr_b16 v[118:119], v48 offset:10240
    s_waitcnt lgkmcnt(0)
    s_barrier
    ds_write_b128 v3, v[56:59] offset:0
    ds_write_b128 v3, v[60:63] offset:1024
    ds_write_b128 v3, v[64:67] offset:2048
    ds_write_b128 v3, v[68:71] offset:3072
    ds_write_b128 v3, v[72:75] offset:4096
    ds_write_b128 v3, v[76:79] offset:5120
    ds_write_b128 v3, v[80:83] offset:6144
    ds_write_b128 v3, v[84:87] offset:7168
    ds_write_b128 v3, v[88:91] offset:8192
    ds_write_b128 v3, v[92:95] offset:9216
    ds_write_b128 v3, v[96:99] offset:10240
    ds_write_b128 v3, v[100:103] offset:11264
    ds_write_b128 v3, v[104:107] offset:12288
    ds_write_b128 v3, v[108:111] offset:13312
    ds_write_b128 v3, v[112:115] offset:14336
    ds_write_b128 v3, v[116:119] offset:15360
    s_mov_b32 s52, 0
    s_mov_b32 s28, -1
    s_mov_b32 s6, s39
    s_add_u32 s39, s39, 1835008
    s_mov_b32 s62, s38
    s_mov_b32 s60, s38
    s_add_u32 s63, s53, 131072
    s_mov_b32 m0, s63
    s_mov_b32 s43, 2
    s_waitcnt vmcnt(0)
    v_cmp_gt_u32 vcc, s43, v12
    s_cbranch_vccz L_f0_78_ok
L_f0_78:
    buffer_load_dword v12, v4, s[8:11], s40 offen sc1
    s_waitcnt vmcnt(0)
    v_cmp_gt_u32 vcc, s43, v12
    s_add_u32 s52, s52, 0x1000
    s_cmp_lt_u32 s52, 2147418112
    s_cbranch_vccz L_f0_78_ok
    s_cbranch_scc1 L_f0_78
    s_branch L_fail
L_f0_78_ok:
    buffer_load_dwordx4 v0, s[8:11], s60 offen sc1 lds
    buffer_load_dwordx4 v0, s[8:11], s60 offen offset:1024 sc1 lds
    s_cmp_lg_u32 s5, 0
    s_cbranch_scc1 L_nonlocal_79
    s_add_u32 s28, s28, 1
    s_mov_b32 s41, s39
    s_and_b32 s42, s28, 7
    s_mul_i32 s42, s42, 262144
    s_add_u32 s39, s42, s6
    s_add_u32 s61, s60, 8192
    s_add_u32 s42, s28, 1
    s_min_u32 s42, s42, 63
    s_and_b32 s42, s42, 7
    s_mul_i32 s42, s42, 524288
    s_add_u32 s60, s42, s62
    s_xor_b32 s63, s63, 8192
    s_mov_b32 m0, s63
    s_add_u32 s54, s36, s53
    s_add_u32 s38, s28, 2
    s_min_u32 s38, s38, 65
    v_mov_b64 v[48:49], 0
    v_mov_b64 v[50:51], 0
    v_mov_b64 v[52:53], 0
    v_mov_b64 v[54:55], 0
    v_mov_b64 v[56:57], 0
    v_mov_b64 v[58:59], 0
    v_mov_b64 v[60:61], 0
    v_mov_b64 v[62:63], 0
    v_mov_b64 v[68:69], 0
    v_mov_b64 v[70:71], 0
    v_mov_b32 v66, s28
    v_mov_b32 v67, 0
    v_add_u32 v14, s53, v1
    s_xor_b32 s43, s53, 2048
    v_add_u32 v120, s43, v1
    s_xor_b32 s43, s53, 4096
    v_add_u32 v121, s43, v1
    s_xor_b32 s43, s53, 6144
    v_add_u32 v122, s43, v1
    ds_read_b128 v[72:75], v2 offset:8192
    ds_read_b128 v[76:79], v2 offset:9216
    ds_read_b128 v[80:83], v3 offset:0
    ds_read_b128 v[84:87], v3 offset:1024
    ds_read_b128 v[88:91], v2 offset:10240
    ds_read_b128 v[92:95], v2 offset:11264
    ds_read_b128 v[96:99], v3 offset:2048
    ds_read_b128 v[100:103], v3 offset:3072
    ds_read_b128 v[104:107], v2 offset:12288
    ds_read_b128 v[108:111], v2 offset:13312
    ds_read_b128 v[112:115], v3 offset:4096
    ds_read_b128 v[116:119], v3 offset:5120
    v_mov_b64 v[16:17], v[24:25]
    v_mov_b64 v[18:19], v[26:27]
    v_mov_b64 v[20:21], v[28:29]
    v_mov_b64 v[22:23], v[30:31]
    s_mov_b32 s30, 0
    s_mov_b32 s29, 1
    s_mov_b32 s7, 0
    s_mov_b32 s3, s60
    s_waitcnt vmcnt(0)
    s_branch L_enter_88
    .p2align 6
L_hop1_80:
    ds_read_b128 v[124:127], v1 offset:30720
    s_add_u32 s28, s28, 1
    s_mov_b32 s41, s39
    s_and_b32 s42, s28, 7
    s_mul_i32 s42, s42, 262144
    s_add_u32 s39, s42, s6
    s_add_u32 s61, s60, 8192
    s_add_u32 s42, s28, 1
    s_min_u32 s42, s42, 63
    s_and_b32 s42, s42, 7
    s_mul_i32 s42, s42, 524288
    s_add_u32 s60, s42, s62
    s_xor_b32 s63, s63, 8192
    s_mov_b32 m0, s63
    s_add_u32 s54, s36, s53
    s_add_u32 s38, s28, 2
    s_min_u32 s38, s38, 65
    s_cmp_lg_u32 s24, 0
    s_cbranch_scc1 L_nored_87
    s_waitcnt vmcnt(0)
L_poll1_85:
    buffer_load_dwordx4 v[16:19], v0, s[8:11], s33 offen offset:0 sc1
    buffer_load_dwordx4 v[20:23], v0, s[8:11], s33 offen offset:1024 sc1
    buffer_load_dwordx4 v[24:27], v0, s[8:11], s33 offen offset:2048 sc1
    buffer_load_dwordx4 v[28:31], v0, s[8:11], s33 offen offset:3072 sc1
    buffer_load_dwordx4 v[32:35], v0, s[8:11], s34 offen offset:0 sc1
    buffer_load_dwordx4 v[36:39], v0, s[8:11], s34 offen offset:1024 sc1
    buffer_load_dwordx4 v[40:43], v0, s[8:11], s34 offen offset:2048 sc1
    buffer_load_dwordx4 v[44:47], v0, s[8:11], s34 offen offset:3072 sc1
    s_waitcnt lgkmcnt(0)
    s_waitcnt vmcnt(7)
    v_mfma_f32_16x16x32_bf16 v[120:123], v[124:127], v[16:19], 0
    s_waitcnt vmcnt(6)
    v_mfma_f32_16x16x32_bf16 v[120:123], v[124:127], v[20:23], v[120:123]
    v_bitop3_b32 v14, v16, v20, s30 bitop3:66
    s_waitcnt vmcnt(5)
    v_mfma_f32_16x16x32_bf16 v[120:123], v[124:127], v[24:27], v[120:123]
    v_bitop3_b32 v14, v14, v24, s30 bitop3:96
    s_waitcnt vmcnt(4)
    v_mfma_f32_16x16x32_bf16 v[120:123], v[124:127], v[28:31], v[120:123]
    v_bitop3_b32 v14, v14, v28, s30 bitop3:96
    s_waitcnt vmcnt(3)
    v_mfma_f32_16x16x32_bf16 v[120:123], v[124:127], v[32:35], v[120:123]
    v_bitop3_b32 v14, v14, v32, s30 bitop3:96
    s_waitcnt vmcnt(2)
    v_mfma_f32_16x16x32_bf16 v[120:123], v[124:127], v[36:39], v[120:123]
    v_bitop3_b32 v14, v14, v36, s30 bitop3:96
    s_waitcnt vmcnt(1)
    v_mfma_f32_16x16x32_bf16 v[120:123], v[124:127], v[40:43], v[120:123]
    v_bitop3_b32 v14, v14, v40, s30 bitop3:96
    s_waitcnt vmcnt(0)
    v_mfma_f32_16x16x32_bf16 v[120:123], v[124:127], v[44:47], v[120:123]
    v_bitop3_b32 v14, v14, v44, s30 bitop3:96
    v_and_b32 v14, 1, v14
    v_cmp_eq_u32 vcc, 0, v14
    v_mov_b32 v124, -1
    v_mov_b32 v125, -1
    s_mov_b64 exec, s[46:47]
    s_nop 1
    v_cvt_pk_bf16_f32 v14, v120, v121
    v_cvt_pk_bf16_f32 v15, v122, v123
    v_min_u32 v14, -2, v14
    s_cbranch_vccnz L_poll1_85_r
    buffer_store_dwordx2 v[14:15], v9, s[8:11], s36 offen
    buffer_store_dwordx2 v[124:125], v9, s[8:11], s37 offen
    s_mov_b64 exec, -1
L_hop2_81:
    s_barrier
    v_cmp_gt_u32 vcc, s38, v12
    s_mov_b32 s42, s35
    s_mov_b32 s35, s36
    s_mov_b32 s36, s37
    s_mov_b32 s37, s42
    s_and_b32 s30, s28, 1
    s_xor_b32 s29, s30, 1
    s_and_b32 s42, vcc_lo, 0xf0
    s_cbranch_scc1 L_flag_86
L_flag_86_ok:
    s_and_b32 s7, vcc_lo, 0x0f
    s_cselect_b32 s3, 0x40000000, s60
    v_mov_b64 v[48:49], 0
    v_mov_b64 v[50:51], 0
    v_mov_b64 v[52:53], 0
    v_mov_b64 v[54:55], 0
    v_mov_b64 v[56:57], 0
    v_mov_b64 v[58:59], 0
    v_mov_b64 v[60:61], 0
    v_mov_b64 v[62:63], 0
    v_mov_b64 v[68:69], 0
    v_mov_b64 v[70:71], 0
    v_mov_b32 v66, s28
    v_mov_b32 v67, 0
    v_add_u32 v14, s53, v1
    s_xor_b32 s43, s53, 2048
    v_add_u32 v120, s43, v1
    s_xor_b32 s43, s53, 4096
    v_add_u32 v121, s43, v1
    s_xor_b32 s43, s53, 6144
    v_add_u32 v122, s43, v1
L_gath_83:
    buffer_load_dwordx4 v[16:19], v0, s[8:11], s54 offen sc1
    buffer_load_dwordx4 v[20:23], v0, s[8:11], s54 offen offset:1024 sc1
    ds_read_b128 v[72:75], v2 offset:8192
    ds_read_b128 v[76:79], v2 offset:9216
    ds_read_b128 v[80:83], v3 offset:0
    ds_read_b128 v[84:87], v3 offset:1024
    ds_read_b128 v[88:91], v2 offset:10240
    ds_read_b128 v[92:95], v2 offset:11264
    ds_read_b128 v[96:99], v3 offset:2048
    ds_read_b128 v[100:103], v3 offset:3072
    ds_read_b128 v[104:107], v2 offset:12288
    ds_read_b128 v[108:111], v2 offset:13312
    ds_read_b128 v[112:115], v3 offset:4096
    ds_read_b128 v[116:119], v3 offset:5120
L_enter_88:
    s_waitcnt vmcnt(1) lgkmcnt(0)
    ds_write_b128 v14, v[16:19] offset:16384
    v_smfmac_f32_16x16x64_bf16 v[48:51], v[16:19], v[72:79], v10
    s_waitcnt vmcnt(0)
    ds_write_b128 v14, v[20:23] offset:17408
    v_max3_u32 v15, v16, v18, v20
    v_max_u32 v15, v15, v22
    v_cmp_eq_u32 vcc, -1, v15
    v_smfmac_f32_16x16x64_bf16 v[52:55], v[16:19], v[80:87], v10
    v_smfmac_f32_16x16x64_bf16 v[56:59], v[16:19], v[88:95], v10
    s_cbranch_vccnz L_gath_83_r
    v_smfmac_f32_16x16x64_bf16 v[60:63], v[16:19], v[96:103], v10
    s_waitcnt lgkmcnt(0)
    s_barrier
    ds_read_b128 v[24:27], v120 offset:16384
    ds_read_b128 v[28:31], v120 offset:17408
    ds_read_b128 v[36:39], v121 offset:17408
    ds_read_b128 v[44:47], v122 offset:17408
    ds_read_b128 v[32:35], v121 offset:16384
    ds_read_b128 v[40:43], v122 offset:16384
    buffer_load_dwordx4 v[120:123], v0, s[8:11], s61 offen sc1
    v_smfmac_f32_16x16x64_bf16 v[48:51], v[20:23], a[0:7], v10
    ds_read_b128 v[72:75], v3 offset:8192
    v_smfmac_f32_16x16x64_bf16 v[52:55], v[20:23], a[96:103], v10
    ds_read_b128 v[76:79], v3 offset:9216
    v_smfmac_f32_16x16x64_bf16 v[56:59], v[20:23], a[8:15], v10
    ds_read_b128 v[80:83], v3 offset:12288
    v_smfmac_f32_16x16x64_bf16 v[60:63], v[20:23], a[104:111], v10
    ds_read_b128 v[84:87], v3 offset:13312
    s_waitcnt lgkmcnt(9)
    v_smfmac_f32_16x16x64_bf16 v[48:51], v[24:27], v[104:111], v10
    ds_read_b128 v[104:107], v3 offset:10240
    ds_read_b128 v[108:111], v3 offset:11264
    v_smfmac_f32_16x16x64_bf16 v[52:55], v[24:27], v[112:119], v10
    buffer_load_dwordx4 v[124:127], v0, s[8:11], s61 offen offset:1024 sc1
    s_waitcnt lgkmcnt(9)
    v_smfmac_f32_16x16x64_bf16 v[48:51], v[28:31], a[16:23], v10
    ds_read_b128 v[112:115], v3 offset:14336
    ds_read_b128 v[116:119], v3 offset:15360
    v_smfmac_f32_16x16x64_bf16 v[52:55], v[28:31], a[112:119], v10
    buffer_load_dword v12, v4, s[8:11], s40 offen sc1
    ds_read_b128 v[88:91], v2 offset:14336
    v_smfmac_f32_16x16x64_bf16 v[48:51], v[36:39], a[48:55], v10
    buffer_store_dwordx4 v[64:67], v13, s[8:11], s41 offen sc1
    ds_read_b128 v[92:95], v2 offset:15360
    v_smfmac_f32_16x16x64_bf16 v[52:55], v[36:39], a[128:135], v10
    ds_read_b128 v[96:99], v3 offset:6144
    s_waitcnt lgkmcnt(7)
    v_smfmac_f32_16x16x64_bf16 v[48:51], v[44:47], a[80:87], v10
    ds_read_b128 v[100:103], v3 offset:7168
    v_smfmac_f32_16x16x64_bf16 v[52:55], v[44:47], a[144:151], v10
    v_mov_b32 v64, 0
    v_smfmac_f32_16x16x64_bf16 v[48:51], v[32:35], a[32:39], v10
    buffer_load_dwordx4 v0, s[8:11], s3 offen sc1 lds
    v_smfmac_f32_16x16x64_bf16 v[52:55], v[32:35], v[72:79], v10
    v_mov_b32 v65, 0
    v_smfmac_f32_16x16x64_bf16 v[48:51], v[40:43], a[64:71], v10
    v_mov_b32 v66, 0
    v_smfmac_f32_16x16x64_bf16 v[52:55], v[40:43], v[80:87], v10
    s_waitcnt lgkmcnt(0)
    v_smfmac_f32_16x16x64_bf16 v[56:59], v[24:27], v[88:95], v10
    buffer_load_dwordx4 v0, s[8:11], s3 offen offset:1024 sc1 lds
    ds_read_b128 v[88:91], v11 offset:0
    v_smfmac_f32_16x16x64_bf16 v[60:63], v[24:27], v[96:103], v10
    v_add_f32 v52, v52, v54
    v_smfmac_f32_16x16x64_bf16 v[56:59], v[32:35], a[40:47], v10
    v_add_f32 v53, v53, v55
    v_smfmac_f32_16x16x64_bf16 v[60:63], v[32:35], v[104:111], v10
    v_add_f32 v48, v48, v50
    v_smfmac_f32_16x16x64_bf16 v[56:59], v[40:43], a[72:79], v10
    v_add_f32 v49, v49, v51
    v_smfmac_f32_16x16x64_bf16 v[60:63], v[40:43], v[112:119], v10
    v_cvt_pk_bf16_f32 v50, v52, v53
    v_smfmac_f32_16x16x64_bf16 v[56:59], v[28:31], a[24:31], v10
    v_cvt_pk_bf16_f32 v51, v48, v49
    v_smfmac_f32_16x16x64_bf16 v[60:63], v[28:31], a[120:127], v10
    ds_write_b64 v5, v[50:51]
    ds_read_b128 v[92:95], v11 offset:4096
    v_smfmac_f32_16x16x64_bf16 v[56:59], v[36:39], a[56:63], v10
    ds_read_b128 v[96:99], v11 offset:1024
    ds_read_b128 v[100:103], v11 offset:5120
    v_smfmac_f32_16x16x64_bf16 v[60:63], v[36:39], a[136:143], v10
    buffer_store_dwordx2 v[50:51], v5, s[8:11], s39 offen sc1
    ds_read_b128 v[104:107], v11 offset:2048
    v_smfmac_f32_16x16x64_bf16 v[56:59], v[44:47], a[88:95], v10
    ds_read_b128 v[108:111], v11 offset:6144
    ds_read_b128 v[112:115], v11 offset:3072
    v_smfmac_f32_16x16x64_bf16 v[60:63], v[44:47], a[152:159], v10
    ds_read_b128 v[116:119], v11 offset:7168
    v_smfmac_f32_16x16x64_bf16 v[64:67], v[16:19], a[160:167], v10
    v_smfmac_f32_16x16x64_bf16 v[68:71], v[16:19], a[168:175], v10
    v_add_f32 v56, v56, v58
    v_add_f32 v57, v57, v59
    v_add_f32 v60, v60, v62
    v_add_f32 v61, v61, v63
    v_cvt_pk_bf16_f32 v59, v56, v57
    v_cvt_pk_bf16_f32 v58, v60, v61
    ds_write_b64 v5, v[58:59] offset:512
    v_smfmac_f32_16x16x64_bf16 v[64:67], v[20:23], a[176:183], v10
    buffer_store_dwordx2 v[58:59], v5, s[8:11], s39 offen offset:512 sc1
    v_smfmac_f32_16x16x64_bf16 v[68:71], v[20:23], a[184:191], v10
    v_xor_b32 v14, 16, v6
    s_cmp_eq_u32 s28, 63
    v_smfmac_f32_16x16x64_bf16 v[64:67], v[24:27], a[192:199], v10
    v_smfmac_f32_16x16x64_bf16 v[68:71], v[24:27], a[200:207], v10
    v_smfmac_f32_16x16x64_bf16 v[64:67], v[28:31], a[208:215], v10
    v_smfmac_f32_16x16x64_bf16 v[68:71], v[28:31], a[216:223], v10
    v_smfmac_f32_16x16x64_bf16 v[64:67], v[32:35], a[224:231], v10
    v_smfmac_f32_16x16x64_bf16 v[68:71], v[32:35], a[232:239], v10
    s_waitcnt lgkmcnt(0)
    s_barrier
    s_cbranch_scc1 L_fin_84
    ds_read_b64_tr_b16 v[72:73], v6 offset:0
    ds_read_b64_tr_b16 v[74:75], v14 offset:256
    v_smfmac_f32_16x16x64_bf16 v[64:67], v[36:39], a[240:247], v10
    ds_read_b64_tr_b16 v[76:77], v6 offset:1024
    ds_read_b64_tr_b16 v[78:79], v14 offset:1280
    v_smfmac_f32_16x16x64_bf16 v[68:71], v[36:39], a[248:255], v10
    ds_read_b64_tr_b16 v[80:81], v6 offset:2048
    ds_read_b64_tr_b16 v[82:83], v14 offset:2304
    v_smfmac_f32_16x16x64_bf16 v[64:67], v[40:43], v[128:135], v10
    ds_read_b64_tr_b16 v[84:85], v6 offset:3072
    ds_read_b64_tr_b16 v[86:87], v14 offset:3328
    v_smfmac_f32_16x16x64_bf16 v[68:71], v[40:43], v[136:143], v10
    s_waitcnt lgkmcnt(6)
    v_mfma_f32_16x16x32_bf16 v[48:51], v[88:91], v[72:75], 0
    v_mfma_f32_16x16x32_bf16 v[52:55], v[92:95], v[72:75], 0
    v_xor_b32 v11, 8192, v11
    v_mfma_f32_16x16x32_bf16 v[56:59], v[72:75], v[72:75], 0
    s_waitcnt lgkmcnt(4)
    v_mfma_f32_16x16x32_bf16 v[48:51], v[96:99], v[76:79], v[48:51]
    v_mfma_f32_16x16x32_bf16 v[52:55], v[100:103], v[76:79], v[52:55]
    s_cmp_lg_u32 s7, 0
    s_cbranch_scc1 L_klate_89
L_klate_89_ok:
    buffer_load_dword v12, v4, s[8:11], s40 offen sc1
    v_mfma_f32_16x16x32_bf16 v[56:59], v[76:79], v[76:79], v[56:59]
    s_waitcnt lgkmcnt(2)
    v_mfma_f32_16x16x32_bf16 v[48:51], v[104:107], v[80:83], v[48:51]
    v_mfma_f32_16x16x32_bf16 v[52:55], v[108:111], v[80:83], v[52:55]
    v_mfma_f32_16x16x32_bf16 v[56:59], v[80:83], v[80:83], v[56:59]
    s_waitcnt lgkmcnt(0)
    v_mfma_f32_16x16x32_bf16 v[48:51], v[112:115], v[84:87], v[48:51]
    v_mfma_f32_16x16x32_bf16 v[52:55], v[116:119], v[84:87], v[52:55]
    v_mfma_f32_16x16x32_bf16 v[56:59], v[84:87], v[84:87], v[56:59]
    v_smfmac_f32_16x16x64_bf16 v[64:67], v[44:47], v[144:151], v10
    v_smfmac_f32_16x16x64_bf16 v[68:71], v[44:47], v[152:159], v10
    v_max3_f32 v14, v48, v49, v50
    v_max3_f32 v15, v51, v52, v53
    v_max3_f32 v14, v14, v54, v55
    v_max3_f32 v15, v15, v56, v57
    v_max_f32 v58, v14, v15
    v_max_f32 v59, v14, v15
    v_add_f32 v64, v64, v66
    v_add_f32 v65, v65, v67
    v_permlane32_swap_b32 v58, v59
    v_max_f32 v14, v58, v59
    v_max_f32 v15, v58, v59
    v_add_f32 v68, v68, v70
    v_add_f32 v69, v69, v71
    v_permlane16_swap_b32 v14, v15
    v_max_f32 v14, v14, v15
    v_mul_f32 v14, s50, v14
    v_pk_fma_f32 v[48:49], v[48:49], s[50:51], v[14:15] op_sel_hi:[1,1,0] neg_lo:[0,0,1] neg_hi:[0,0,1]
    v_pk_fma_f32 v[50:51], v[50:51], s[50:51], v[14:15] op_sel_hi:[1,1,0] neg_lo:[0,0,1] neg_hi:[0,0,1]
    v_pk_fma_f32 v[52:53], v[52:53], s[50:51], v[14:15] op_sel_hi:[1,1,0] neg_lo:[0,0,1] neg_hi:[0,0,1]
    v_pk_fma_f32 v[54:55], v[54:55], s[50:51], v[14:15] op_sel_hi:[1,1,0] neg_lo:[0,0,1] neg_hi:[0,0,1]
    v_pk_fma_f32 v[56:57], v[56:57], s[50:51], v[14:15] op_sel_hi:[1,1,0] neg_lo:[0,0,1] neg_hi:[0,0,1]
    v_exp_f32 v56, v56
    v_exp_f32 v57, v57
    v_exp_f32 v48, v48
    v_exp_f32 v49, v49
    v_exp_f32 v50, v50
    v_cvt_pk_bf16_f32 v60, v48, v49
    v_exp_f32 v51, v51
    v_pk_add_f32 v[58:59], v[56:57], v[48:49]
    v_exp_f32 v52, v52
    v_cvt_pk_bf16_f32 v61, v50, v51
    v_exp_f32 v53, v53
    v_pk_add_f32 v[58:59], v[58:59], v[50:51]
    v_exp_f32 v54, v54
    v_cvt_pk_bf16_f32 v62, v52, v53
    v_exp_f32 v55, v55
    v_pk_add_f32 v[58:59], v[58:59], v[52:53]
    v_cvt_pk_bf16_f32 v63, v54, v55
    v_cvt_pk_bf16_f32 v64, v64, v65
    s_waitcnt vmcnt(7)
    v_mfma_f32_16x16x32_bf16 v[104:107], v[120:123], v[60:63], 0
    v_cvt_pk_bf16_f32 v65, v68, v69
    v_cvt_pk_bf16_f32 v112, v56, v57
    v_mfma_f32_16x16x32_bf16 v[108:111], v[124:127], v[60:63], 0
    v_mov_b32 v113, 0
    v_mov_b32 v114, 0
    v_cvt_pk_bf16_f32 v115, v56, v57
    v_mfma_f32_16x16x16_bf16 v[104:107], v[64:65], v[112:113], v[104:107]
    v_add_f32 v58, v58, v54
    v_add_f32 v59, v59, v55
    v_mfma_f32_16x16x16_bf16 v[108:111], v[64:65], v[114:115], v[108:111]
    v_add_f32 v14, v58, v59
    v_add_f32 v15, v58, v59
    s_nop 0
    ds_read_b128 v[16:19], v2
    v_permlane32_swap_b32 v14, v15
    v_add_f32 v48, v14, v15
    v_add_f32 v49, v14, v15
    ds_read_b128 v[20:23], v2 offset:1024
    ds_read_b128 v[24:27], v2 offset:2048
    v_permlane16_swap_b32 v48, v49
    v_add_f32 v14, v48, v49
    v_rcp_f32 v14, v14
    ds_read_b128 v[28:31], v2 offset:3072
    v_pk_mul_f32 v[104:105], v[104:105], v[14:15] op_sel_hi:[1,0]
    v_pk_mul_f32 v[106:107], v[106:107], v[14:15] op_sel_hi:[1,0]
    v_pk_mul_f32 v[108:109], v[108:109], v[14:15] op_sel_hi:[1,0]
    v_pk_mul_f32 v[110:111], v[110:111], v[14:15] op_sel_hi:[1,0]
    s_mov_b64 exec, s[44:45]
    v_cvt_pk_bf16_f32 v112, v104, v105
    v_cvt_pk_bf16_f32 v113, v106, v107
    v_cvt_pk_bf16_f32 v114, v108, v109
    v_cvt_pk_bf16_f32 v115, v110, v111
    ds_write_b128 v7, v[112:115]
    s_mov_b64 exec, -1
    v_mov_b64 v[72:73], 0
    v_mov_b64 v[74:75], 0
    v_mov_b64 v[76:77], 0
    v_mov_b64 v[78:79], 0
    v_mov_b64 v[80:81], 0
    v_mov_b64 v[82:83], 0
    v_mov_b64 v[84:85], 0
    v_mov_b64 v[86:87], 0
    v_mov_b64 v[88:89], 0
    v_mov_b64 v[90:91], 0
    v_mov_b64 v[92:93], 0
    v_mov_b64 v[94:95], 0
    s_waitcnt lgkmcnt(0)
    s_barrier
    ds_read_b128 v[120:123], v1 offset:28672
    ds_read_b128 v[124:127], v1 offset:29696
    v_mov_b64 v[96:97], 0
    v_mov_b64 v[98:99], 0
    v_mov_b64 v[100:101], 0
    v_mov_b64 v[102:103], 0
    s_waitcnt lgkmcnt(1)
    v_smfmac_f32_16x16x64_bf16 v[72:75], v[120:123], v[160:167], v10
    ds_read_b128 v[32:35], v2 offset:4096
    v_smfmac_f32_16x16x64_bf16 v[76:79], v[120:123], v[168:175], v10
    ds_read_b128 v[36:39], v2 offset:5120
    s_waitcnt lgkmcnt(2)
    v_smfmac_f32_16x16x64_bf16 v[72:75], v[124:127], v[224:231], v10
    ds_read_b128 v[40:43], v2 offset:6144
    v_smfmac_f32_16x16x64_bf16 v[76:79], v[124:127], v[232:239], v10
    ds_read_b128 v[44:47], v2 offset:7168
    v_smfmac_f32_16x16x64_bf16 v[80:83], v[120:123], v[176:183], v10
    v_add_f32 v72, v72, v74
    v_smfmac_f32_16x16x64_bf16 v[84:87], v[120:123], v[184:191], v10
    v_add_f32 v73, v73, v75
    v_smfmac_f32_16x16x64_bf16 v[80:83], v[124:127], v[240:247], v10
    v_add_f32 v76, v76, v78
    v_smfmac_f32_16x16x64_bf16 v[84:87], v[124:127], v[248:255], v10
    v_add_f32 v77, v77, v79
    v_smfmac_f32_16x16x64_bf16 v[88:91], v[120:123], v[192:199], v10
    v_cvt_pk_bf16_f32 v104, v72, v76
    v_add_f32 v80, v80, v82
    v_smfmac_f32_16x16x64_bf16 v[92:95], v[120:123], v[200:207], v10
    v_cvt_pk_bf16_f32 v106, v73, v77
    s_waitcnt lgkmcnt(0)
    v_smfmac_f32_16x16x64_bf16 v[88:91], v[124:127], v[16:23], v10
    v_add_f32 v84, v84, v86
    v_add_f32 v81, v81, v83
    v_smfmac_f32_16x16x64_bf16 v[92:95], v[124:127], v[24:31], v10
    v_add_f32 v85, v85, v87
    v_cvt_pk_bf16_f32 v105, v80, v84
    v_smfmac_f32_16x16x64_bf16 v[96:99], v[120:123], v[208:215], v10
    v_cvt_pk_bf16_f32 v107, v81, v85
    v_and_or_b32 v104, v104, -2, s29
    v_smfmac_f32_16x16x64_bf16 v[100:103], v[120:123], v[216:223], v10
    buffer_store_dwordx4 v[104:107], v8, s[8:11], s31 offen
    v_add_f32 v88, v88, v90
    v_smfmac_f32_16x16x64_bf16 v[96:99], v[124:127], v[32:39], v10
    v_add_f32 v92, v92, v94
    v_smfmac_f32_16x16x64_bf16 v[100:103], v[124:127], v[40:47], v10
    v_add_f32 v89, v89, v91
    v_add_f32 v93, v93, v95
    v_cvt_pk_bf16_f32 v108, v88, v92
    v_cvt_pk_bf16_f32 v110, v89, v93
    v_and_or_b32 v108, v108, -2, s29
    v_add_f32 v96, v96, v98
    v_add_f32 v97, v97, v99
    s_nop 0
    v_add_f32 v100, v100, v102
    v_add_f32 v101, v101, v103
    v_cvt_pk_bf16_f32 v109, v96, v100
    v_cvt_pk_bf16_f32 v111, v97, v101
    buffer_store_dwordx4 v[108:111], v8, s[8:11], s32 offen
    s_branch L_hop1_80
L_nored_87:
    s_waitcnt vmcnt(0)
    s_branch L_hop2_81
L_poll1_85_r:
    s_mov_b64 exec, -1
    ds_read_b128 v[124:127], v1 offset:30720
    s_add_u32 s52, s52, 0x1001
    s_cmp_lt_u32 s52, 2147418112
    s_waitcnt lgkmcnt(0)
    s_cbranch_scc1 L_poll1_85
    s_branch L_fail
L_flag_86:
    buffer_load_dword v12, v4, s[8:11], s40 offen sc1
    s_add_u32 s52, s52, 0x1001
    s_cmp_lt_u32 s52, 2147418112
    s_waitcnt vmcnt(0)
    s_cbranch_scc0 L_fail
    v_cmp_gt_u32 vcc, s38, v12
    s_nop 3
    s_and_b32 s42, vcc_lo, 0xf0
    s_cbranch_scc1 L_flag_86
    s_branch L_flag_86_ok
L_gath_83_r:
    s_add_u32 s52, s52, 0x1000
    s_cmp_lt_u32 s52, 2147418112
    s_cbranch_scc0 L_fail
    buffer_load_dwordx4 v[16:19], v0, s[8:11], s54 offen sc1
    buffer_load_dwordx4 v[20:23], v0, s[8:11], s54 offen offset:1024 sc1
    s_nop 3
    v_mov_b64 v[62:63], 0
    v_mov_b64 v[60:61], 0
    v_mov_b64 v[58:59], 0
    v_mov_b64 v[56:57], 0
    v_mov_b64 v[54:55], 0
    v_mov_b64 v[52:53], 0
    v_mov_b64 v[50:51], 0
    v_mov_b64 v[48:49], 0
    s_branch L_enter_88
L_klate_89:
    s_waitcnt vmcnt(5)
L_klate_89_c:
    v_cmp_gt_u32 vcc, s38, v12
    s_nop 3
    s_and_b32 s42, vcc_lo, 0x0f
    s_cbranch_scc0 L_klate_89_go
    buffer_load_dword v12, v4, s[8:11], s40 offen sc1
    s_add_u32 s52, s52, 0x1001
    s_cmp_lt_u32 s52, 2147418112
    s_waitcnt vmcnt(0)
    s_cbranch_scc1 L_klate_89_c
    s_branch L_fail
L_klate_89_go:
    buffer_load_dwordx4 v0, s[8:11], s60 offen sc1 lds
    buffer_load_dwordx4 v0, s[8:11], s60 offen offset:1024 sc1 lds
    s_branch L_klate_89_ok
L_fin_84:
    v_smfmac_f32_16x16x64_bf16 v[64:67], v[36:39], a[240:247], v10
    v_smfmac_f32_16x16x64_bf16 v[68:71], v[36:39], a[248:255], v10
    v_smfmac_f32_16x16x64_bf16 v[64:67], v[40:43], v[128:135], v10
    v_smfmac_f32_16x16x64_bf16 v[68:71], v[40:43], v[136:143], v10
    v_smfmac_f32_16x16x64_bf16 v[64:67], v[44:47], v[144:151], v10
    v_smfmac_f32_16x16x64_bf16 v[68:71], v[44:47], v[152:159], v10
    s_nop 7
    v_add_f32 v64, v64, v66
    v_add_f32 v65, v65, v67
    v_add_f32 v68, v68, v70
    v_add_f32 v69, v69, v71
    v_cvt_pk_bf16_f32 v64, v64, v65
    v_cvt_pk_bf16_f32 v65, v68, v69
    v_mov_b32 v66, 64
    v_mov_b32 v67, 0
    s_waitcnt vmcnt(0)
    s_barrier
    buffer_store_dwordx4 v[64:67], v13, s[8:11], s39 offen sc1
    s_branch L_done
L_nonlocal_79:
    s_add_u32 s28, s28, 1
    s_mov_b32 s41, s39
    s_and_b32 s42, s28, 7
    s_mul_i32 s42, s42, 262144
    s_add_u32 s39, s42, s6
    s_add_u32 s61, s60, 8192
    s_add_u32 s42, s28, 1
    s_min_u32 s42, s42, 63
    s_and_b32 s42, s42, 7
    s_mul_i32 s42, s42, 524288
    s_add_u32 s60, s42, s62
    s_xor_b32 s63, s63, 8192
    s_mov_b32 m0, s63
    s_add_u32 s54, s36, s53
    s_add_u32 s38, s28, 2
    s_min_u32 s38, s38, 65
    v_mov_b64 v[48:49], 0
    v_mov_b64 v[50:51], 0
    v_mov_b64 v[52:53], 0
    v_mov_b64 v[54:55], 0
    v_mov_b64 v[56:57], 0
    v_mov_b64 v[58:59], 0
    v_mov_b64 v[60:61], 0
    v_mov_b64 v[62:63], 0
    v_mov_b64 v[68:69], 0
    v_mov_b64 v[70:71], 0
    v_mov_b32 v66, s28
    v_mov_b32 v67, 0
    v_add_u32 v14, s53, v1
    s_xor_b32 s43, s53, 2048
    v_add_u32 v120, s43, v1
    s_xor_b32 s43, s53, 4096
    v_add_u32 v121, s43, v1
    s_xor_b32 s43, s53, 6144
    v_add_u32 v122, s43, v1
    ds_read_b128 v[72:75], v2 offset:8192
    ds_read_b128 v[76:79], v2 offset:9216
    ds_read_b128 v[80:83], v3 offset:0
    ds_read_b128 v[84:87], v3 offset:1024
    ds_read_b128 v[88:91], v2 offset:10240
    ds_read_b128 v[92:95], v2 offset:11264
    ds_read_b128 v[96:99], v3 offset:2048
    ds_read_b128 v[100:103], v3 offset:3072
    ds_read_b128 v[104:107], v2 offset:12288
    ds_read_b128 v[108:111], v2 offset:13312
    ds_read_b128 v[112:115], v3 offset:4096
    ds_read_b128 v[116:119], v3 offset:5120
    v_mov_b64 v[16:17], v[24:25]
    v_mov_b64 v[18:19], v[26:27]
    v_mov_b64 v[20:21], v[28:29]
    v_mov_b64 v[22:23], v[30:31]
    s_mov_b32 s30, 0
    s_mov_b32 s29, 1
    s_mov_b32 s7, 0
    s_mov_b32 s3, s60
    s_waitcnt vmcnt(0)
    s_branch L_enter_98
    .p2align 6
L_hop1_90:
    ds_read_b128 v[124:127], v1 offset:30720
    s_add_u32 s28, s28, 1
    s_mov_b32 s41, s39
    s_and_b32 s42, s28, 7
    s_mul_i32 s42, s42, 262144
    s_add_u32 s39, s42, s6
    s_add_u32 s61, s60, 8192
    s_add_u32 s42, s28, 1
    s_min_u32 s42, s42, 63
    s_and_b32 s42, s42, 7
    s_mul_i32 s42, s42, 524288
    s_add_u32 s60, s42, s62
    s_xor_b32 s63, s63, 8192
    s_mov_b32 m0, s63
    s_add_u32 s54, s36, s53
    s_add_u32 s38, s28, 2
    s_min_u32 s38, s38, 65
    s_cmp_lg_u32 s24, 0
    s_cbranch_scc1 L_nored_97
    s_waitcnt vmcnt(0)
L_poll1_95:
    buffer_load_dwordx4 v[16:19], v0, s[8:11], s33 offen offset:0 sc1
    buffer_load_dwordx4 v[20:23], v0, s[8:11], s33 offen offset:1024 sc1
    buffer_load_dwordx4 v[24:27], v0, s[8:11], s33 offen offset:2048 sc1
    buffer_load_dwordx4 v[28:31], v0, s[8:11], s33 offen offset:3072 sc1
    buffer_load_dwordx4 v[32:35], v0, s[8:11], s34 offen offset:0 sc1
    buffer_load_dwordx4 v[36:39], v0, s[8:11], s34 offen offset:1024 sc1
    buffer_load_dwordx4 v[40:43], v0, s[8:11], s34 offen offset:2048 sc1
    buffer_load_dwordx4 v[44:47], v0, s[8:11], s34 offen offset:3072 sc1
    s_waitcnt lgkmcnt(0)
    s_waitcnt vmcnt(7)
    v_mfma_f32_16x16x32_bf16 v[120:123], v[124:127], v[16:19], 0
    s_waitcnt vmcnt(6)
    v_mfma_f32_16x16x32_bf16 v[120:123], v[124:127], v[20:23], v[120:123]
    v_bitop3_b32 v14, v16, v20, s30 bitop3:66
    s_waitcnt vmcnt(5)
    v_mfma_f32_16x16x32_bf16 v[120:123], v[124:127], v[24:27], v[120:123]
    v_bitop3_b32 v14, v14, v24, s30 bitop3:96
    s_waitcnt vmcnt(4)
    v_mfma_f32_16x16x32_bf16 v[120:123], v[124:127], v[28:31], v[120:123]
    v_bitop3_b32 v14, v14, v28, s30 bitop3:96
    s_waitcnt vmcnt(3)
    v_mfma_f32_16x16x32_bf16 v[120:123], v[124:127], v[32:35], v[120:123]
    v_bitop3_b32 v14, v14, v32, s30 bitop3:96
    s_waitcnt vmcnt(2)
    v_mfma_f32_16x16x32_bf16 v[120:123], v[124:127], v[36:39], v[120:123]
    v_bitop3_b32 v14, v14, v36, s30 bitop3:96
    s_waitcnt vmcnt(1)
    v_mfma_f32_16x16x32_bf16 v[120:123], v[124:127], v[40:43], v[120:123]
    v_bitop3_b32 v14, v14, v40, s30 bitop3:96
    s_waitcnt vmcnt(0)
    v_mfma_f32_16x16x32_bf16 v[120:123], v[124:127], v[44:47], v[120:123]
    v_bitop3_b32 v14, v14, v44, s30 bitop3:96
    v_and_b32 v14, 1, v14
    v_cmp_eq_u32 vcc, 0, v14
    v_mov_b32 v124, -1
    v_mov_b32 v125, -1
    s_mov_b64 exec, s[46:47]
    s_nop 1
    v_cvt_pk_bf16_f32 v14, v120, v121
    v_cvt_pk_bf16_f32 v15, v122, v123
    v_min_u32 v14, -2, v14
    s_cbranch_vccnz L_poll1_95_r
    buffer_store_dwordx2 v[14:15], v9, s[8:11], s36 offen sc1
    buffer_store_dwordx2 v[124:125], v9, s[8:11], s37 offen sc1
    s_mov_b64 exec, -1
L_hop2_91:
    s_barrier
    v_cmp_gt_u32 vcc, s38, v12
    s_mov_b32 s42, s35
    s_mov_b32 s35, s36
    s_mov_b32 s36, s37
    s_mov_b32 s37, s42
    s_and_b32 s30, s28, 1
    s_xor_b32 s29, s30, 1
    s_and_b32 s42, vcc_lo, 0xf0
    s_cbranch_scc1 L_flag_96
L_flag_96_ok:
    s_and_b32 s7, vcc_lo, 0x0f
    s_cselect_b32 s3, 0x40000000, s60
    v_mov_b64 v[48:49], 0
    v_mov_b64 v[50:51], 0
    v_mov_b64 v[52:53], 0
    v_mov_b64 v[54:55], 0
    v_mov_b64 v[56:57], 0
    v_mov_b64 v[58:59], 0
    v_mov_b64 v[60:61], 0
    v_mov_b64 v[62:63], 0
    v_mov_b64 v[68:69], 0
    v_mov_b64 v[70:71], 0
    v_mov_b32 v66, s28
    v_mov_b32 v67, 0
    v_add_u32 v14, s53, v1
    s_xor_b32 s43, s53, 2048
    v_add_u32 v120, s43, v1
    s_xor_b32 s43, s53, 4096
    v_add_u32 v121, s43, v1
    s_xor_b32 s43, s53, 6144
    v_add_u32 v122, s43, v1
L_gath_93:
    buffer_load_dwordx4 v[16:19], v0, s[8:11], s54 offen sc1
    buffer_load_dwordx4 v[20:23], v0, s[8:11], s54 offen offset:1024 sc1
    ds_read_b128 v[72:75], v2 offset:8192
    ds_read_b128 v[76:79], v2 offset:9216
    ds_read_b128 v[80:83], v3 offset:0
    ds_read_b128 v[84:87], v3 offset:1024
    ds_read_b128 v[88:91], v2 offset:10240
    ds_read_b128 v[92:95], v2 offset:11264
    ds_read_b128 v[96:99], v3 offset:2048
    ds_read_b128 v[100:103], v3 offset:3072
    ds_read_b128 v[104:107], v2 offset:12288
    ds_read_b128 v[108:111], v2 offset:13312
    ds_read_b128 v[112:115], v3 offset:4096
    ds_read_b128 v[116:119], v3 offset:5120
L_enter_98:
    s_waitcnt vmcnt(1) lgkmcnt(0)
    ds_write_b128 v14, v[16:19] offset:16384
    v_smfmac_f32_16x16x64_bf16 v[48:51], v[16:19], v[72:79], v10
    s_waitcnt vmcnt(0)
    ds_write_b128 v14, v[20:23] offset:17408
    v_max3_u32 v15, v16, v18, v20
    v_max_u32 v15, v15, v22
    v_cmp_eq_u32 vcc, -1, v15
    v_smfmac_f32_16x16x64_bf16 v[52:55], v[16:19], v[80:87], v10
    v_smfmac_f32_16x16x64_bf16 v[56:59], v[16:19], v[88:95], v10
    s_cbranch_vccnz L_gath_93_r
    v_smfmac_f32_16x16x64_bf16 v[60:63], v[16:19], v[96:103], v10
    s_waitcnt lgkmcnt(0)
    s_barrier
    ds_read_b128 v[24:27], v120 offset:16384
    ds_read_b128 v[28:31], v120 offset:17408
    ds_read_b128 v[36:39], v121 offset:17408
    ds_read_b128 v[44:47], v122 offset:17408
    ds_read_b128 v[32:35], v121 offset:16384
    ds_read_b128 v[40:43], v122 offset:16384
    buffer_load_dwordx4 v[120:123], v0, s[8:11], s61 offen sc1
    v_smfmac_f32_16x16x64_bf16 v[48:51], v[20:23], a[0:7], v10
    ds_read_b128 v[72:75], v3 offset:8192
    v_smfmac_f32_16x16x64_bf16 v[52:55], v[20:23], a[96:103], v10
    ds_read_b128 v[76:79], v3 offset:9216
    v_smfmac_f32_16x16x64_bf16 v[56:59], v[20:23], a[8:15], v10
    ds_read_b128 v[80:83], v3 offset:12288
    v_smfmac_f32_16x16x64_bf16 v[60:63], v[20:23], a[104:111], v10
    ds_read_b128 v[84:87], v3 offset:13312
    s_waitcnt lgkmcnt(9)
    v_smfmac_f32_16x16x64_bf16 v[48:51], v[24:27], v[104:111], v10
    ds_read_b128 v[104:107], v3 offset:10240
    ds_read_b128 v[108:111], v3 offset:11264
    v_smfmac_f32_16x16x64_bf16 v[52:55], v[24:27], v[112:119], v10
    buffer_load_dwordx4 v[124:127], v0, s[8:11], s61 offen offset:1024 sc1
    s_waitcnt lgkmcnt(9)
    v_smfmac_f32_16x16x64_bf16 v[48:51], v[28:31], a[16:23], v10
    ds_read_b128 v[112:115], v3 offset:14336
    ds_read_b128 v[116:119], v3 offset:15360
    v_smfmac_f32_16x16x64_bf16 v[52:55], v[28:31], a[112:119], v10
    buffer_load_dword v12, v4, s[8:11], s40 offen sc1
    ds_read_b128 v[88:91], v2 offset:14336
    v_smfmac_f32_16x16x64_bf16 v[48:51], v[36:39], a[48:55], v10
    buffer_store_dwordx4 v[64:67], v13, s[8:11], s41 offen sc1
    ds_read_b128 v[92:95], v2 offset:15360
    v_smfmac_f32_16x16x64_bf16 v[52:55], v[36:39], a[128:135], v10
    ds_read_b128 v[96:99], v3 offset:6144
    s_waitcnt lgkmcnt(7)
    v_smfmac_f32_16x16x64_bf16 v[48:51], v[44:47], a[80:87], v10
    ds_read_b128 v[100:103], v3 offset:7168
    v_smfmac_f32_16x16x64_bf16 v[52:55], v[44:47], a[144:151], v10
    v_mov_b32 v64, 0
    v_smfmac_f32_16x16x64_bf16 v[48:51], v[32:35], a[32:39], v10
    buffer_load_dwordx4 v0, s[8:11], s3 offen sc1 lds
    v_smfmac_f32_16x16x64_bf16 v[52:55], v[32:35], v[72:79], v10
    v_mov_b32 v65, 0
    v_smfmac_f32_16x16x64_bf16 v[48:51], v[40:43], a[64:71], v10
    v_mov_b32 v66, 0
    v_smfmac_f32_16x16x64_bf16 v[52:55], v[40:43], v[80:87], v10
    s_waitcnt lgkmcnt(0)
    v_smfmac_f32_16x16x64_bf16 v[56:59], v[24:27], v[88:95], v10
    buffer_load_dwordx4 v0, s[8:11], s3 offen offset:1024 sc1 lds
    ds_read_b128 v[88:91], v11 offset:0
    v_smfmac_f32_16x16x64_bf16 v[60:63], v[24:27], v[96:103], v10
    v_add_f32 v52, v52, v54
    v_smfmac_f32_16x16x64_bf16 v[56:59], v[32:35], a[40:47], v10
    v_add_f32 v53, v53, v55
    v_smfmac_f32_16x16x64_bf16 v[60:63], v[32:35], v[104:111], v10
    v_add_f32 v48, v48, v50
    v_smfmac_f32_16x16x64_bf16 v[56:59], v[40:43], a[72:79], v10
    v_add_f32 v49, v49, v51
    v_smfmac_f32_16x16x64_bf16 v[60:63], v[40:43], v[112:119], v10
    v_cvt_pk_bf16_f32 v50, v52, v53
    v_smfmac_f32_16x16x64_bf16 v[56:59], v[28:31], a[24:31], v10
    v_cvt_pk_bf16_f32 v51, v48, v49
    v_smfmac_f32_16x16x64_bf16 v[60:63], v[28:31], a[120:127], v10
    ds_write_b64 v5, v[50:51]
    ds_read_b128 v[92:95], v11 offset:4096
    v_smfmac_f32_16x16x64_bf16 v[56:59], v[36:39], a[56:63], v10
    ds_read_b128 v[96:99], v11 offset:1024
    ds_read_b128 v[100:103], v11 offset:5120
    v_smfmac_f32_16x16x64_bf16 v[60:63], v[36:39], a[136:143], v10
    buffer_store_dwordx2 v[50:51], v5, s[8:11], s39 offen sc1
    ds_read_b128 v[104:107], v11 offset:2048
    v_smfmac_f32_16x16x64_bf16 v[56:59], v[44:47], a[88:95], v10
    ds_read_b128 v[108:111], v11 offset:6144
    ds_read_b128 v[112:115], v11 offset:3072
    v_smfmac_f32_16x16x64_bf16 v[60:63], v[44:47], a[152:159], v10
    ds_read_b128 v[116:119], v11 offset:7168
    v_smfmac_f32_16x16x64_bf16 v[64:67], v[16:19], a[160:167], v10
    v_smfmac_f32_16x16x64_bf16 v[68:71], v[16:19], a[168:175], v10
    v_add_f32 v56, v56, v58
    v_add_f32 v57, v57, v59
    v_add_f32 v60, v60, v62
    v_add_f32 v61, v61, v63
    v_cvt_pk_bf16_f32 v59, v56, v57
    v_cvt_pk_bf16_f32 v58, v60, v61
    ds_write_b64 v5, v[58:59] offset:512
    v_smfmac_f32_16x16x64_bf16 v[64:67], v[20:23], a[176:183], v10
    buffer_store_dwordx2 v[58:59], v5, s[8:11], s39 offen offset:512 sc1
    v_smfmac_f32_16x16x64_bf16 v[68:71], v[20:23], a[184:191], v10
    v_xor_b32 v14, 16, v6
    s_cmp_eq_u32 s28, 63
    v_smfmac_f32_16x16x64_bf16 v[64:67], v[24:27], a[192:199], v10
    v_smfmac_f32_16x16x64_bf16 v[68:71], v[24:27], a[200:207], v10
    v_smfmac_f32_16x16x64_bf16 v[64:67], v[28:31], a[208:215], v10
    v_smfmac_f32_16x16x64_bf16 v[68:71], v[28:31], a[216:223], v10
    v_smfmac_f32_16x16x64_bf16 v[64:67], v[32:35], a[224:231], v10
    v_smfmac_f32_16x16x64_bf16 v[68:71], v[32:35], a[232:239], v10
    s_waitcnt lgkmcnt(0)
    s_barrier
    s_cbranch_scc1 L_fin_94
    ds_read_b64_tr_b16 v[72:73], v6 offset:0
    ds_read_b64_tr_b16 v[74:75], v14 offset:256
    v_smfmac_f32_16x16x64_bf16 v[64:67], v[36:39], a[240:247], v10
    ds_read_b64_tr_b16 v[76:77], v6 offset:1024
    ds_read_b64_tr_b16 v[78:79], v14 offset:1280
    v_smfmac_f32_16x16x64_bf16 v[68:71], v[36:39], a[248:255], v10
    ds_read_b64_tr_b16 v[80:81], v6 offset:2048
    ds_read_b64_tr_b16 v[82:83], v14 offset:2304
    v_smfmac_f32_16x16x64_bf16 v[64:67], v[40:43], v[128:135], v10
    ds_read_b64_tr_b16 v[84:85], v6 offset:3072
    ds_read_b64_tr_b16 v[86:87], v14 offset:3328
    v_smfmac_f32_16x16x64_bf16 v[68:71], v[40:43], v[136:143], v10
    s_waitcnt lgkmcnt(6)
    v_mfma_f32_16x16x32_bf16 v[48:51], v[88:91], v[72:75], 0
    v_mfma_f32_16x16x32_bf16 v[52:55], v[92:95], v[72:75], 0
    v_xor_b32 v11, 8192, v11
    v_mfma_f32_16x16x32_bf16 v[56:59], v[72:75], v[72:75], 0
    s_waitcnt lgkmcnt(4)
    v_mfma_f32_16x16x32_bf16 v[48:51], v[96:99], v[76:79], v[48:51]
    v_mfma_f32_16x16x32_bf16 v[52:55], v[100:103], v[76:79], v[52:55]
    s_cmp_lg_u32 s7, 0
    s_cbranch_scc1 L_klate_99
L_klate_99_ok:
    buffer_load_dword v12, v4, s[8:11], s40 offen sc1
    v_mfma_f32_16x16x32_bf16 v[56:59], v[76:79], v[76:79], v[56:59]
    s_waitcnt lgkmcnt(2)
    v_mfma_f32_16x16x32_bf16 v[48:51], v[104:107], v[80:83], v[48:51]
    v_mfma_f32_16x16x32_bf16 v[52:55], v[108:111], v[80:83], v[52:55]
    v_mfma_f32_16x16x32_bf16 v[56:59], v[80:83], v[80:83], v[56:59]
    s_waitcnt lgkmcnt(0)
    v_mfma_f32_16x16x32_bf16 v[48:51], v[112:115], v[84:87], v[48:51]
    v_mfma_f32_16x16x32_bf16 v[52:55], v[116:119], v[84:87], v[52:55]
    v_mfma_f32_16x16x32_bf16 v[56:59], v[84:87], v[84:87], v[56:59]
    v_smfmac_f32_16x16x64_bf16 v[64:67], v[44:47], v[144:151], v10
    v_smfmac_f32_16x16x64_bf16 v[68:71], v[44:47], v[152:159], v10
    v_max3_f32 v14, v48, v49, v50
    v_max3_f32 v15, v51, v52, v53
    v_max3_f32 v14, v14, v54, v55
    v_max3_f32 v15, v15, v56, v57
    v_max_f32 v58, v14, v15
    v_max_f32 v59, v14, v15
    v_add_f32 v64, v64, v66
    v_add_f32 v65, v65, v67
    v_permlane32_swap_b32 v58, v59
    v_max_f32 v14, v58, v59
    v_max_f32 v15, v58, v59
    v_add_f32 v68, v68, v70
    v_add_f32 v69, v69, v71
    v_permlane16_swap_b32 v14, v15
    v_max_f32 v14, v14, v15
    v_mul_f32 v14, s50, v14
    v_pk_fma_f32 v[48:49], v[48:49], s[50:51], v[14:15] op_sel_hi:[1,1,0] neg_lo:[0,0,1] neg_hi:[0,0,1]
    v_pk_fma_f32 v[50:51], v[50:51], s[50:51], v[14:15] op_sel_hi:[1,1,0] neg_lo:[0,0,1] neg_hi:[0,0,1]
    v_pk_fma_f32 v[52:53], v[52:53], s[50:51], v[14:15] op_sel_hi:[1,1,0] neg_lo:[0,0,1] neg_hi:[0,0,1]
    v_pk_fma_f32 v[54:55], v[54:55], s[50:51], v[14:15] op_sel_hi:[1,1,0] neg_lo:[0,0,1] neg_hi:[0,0,1]
    v_pk_fma_f32 v[56:57], v[56:57], s[50:51], v[14:15] op_sel_hi:[1,1,0] neg_lo:[0,0,1] neg_hi:[0,0,1]
    v_exp_f32 v56, v56
    v_exp_f32 v57, v57
    v_exp_f32 v48, v48
    v_exp_f32 v49, v49
    v_exp_f32 v50, v50
    v_cvt_pk_bf16_f32 v60, v48, v49
    v_exp_f32 v51, v51
    v_pk_add_f32 v[58:59], v[56:57], v[48:49]
    v_exp_f32 v52, v52
    v_cvt_pk_bf16_f32 v61, v50, v51
    v_exp_f32 v53, v53
    v_pk_add_f32 v[58:59], v[58:59], v[50:51]
    v_exp_f32 v54, v54
    v_cvt_pk_bf16_f32 v62, v52, v53
    v_exp_f32 v55, v55
    v_pk_add_f32 v[58:59], v[58:59], v[52:53]
    v_cvt_pk_bf16_f32 v63, v54, v55
    v_cvt_pk_bf16_f32 v64, v64, v65
    s_waitcnt vmcnt(7)
    v_mfma_f32_16x16x32_bf16 v[104:107], v[120:123], v[60:63], 0
    v_cvt_pk_bf16_f32 v65, v68, v69
    v_cvt_pk_bf16_f32 v112, v56, v57
    v_mfma_f32_16x16x32_bf16 v[108:111], v[124:127], v[60:63], 0
    v_mov_b32 v113, 0
    v_mov_b32 v114, 0
    v_cvt_pk_bf16_f32 v115, v56, v57
    v_mfma_f32_16x16x16_bf16 v[104:107], v[64:65], v[112:113], v[104:107]
    v_add_f32 v58, v58, v54
    v_add_f32 v59, v59, v55
    v_mfma_f32_16x16x16_bf16 v[108:111], v[64:65], v[114:115], v[108:111]
    v_add_f32 v14, v58, v59
    v_add_f32 v15, v58, v59
    s_nop 0
    ds_read_b128 v[16:19], v2
    v_permlane32_swap_b32 v14, v15
    v_add_f32 v48, v14, v15
    v_add_f32 v49, v14, v15
    ds_read_b128 v[20:23], v2 offset:1024
    ds_read_b128 v[24:27], v2 offset:2048
    v_permlane16_swap_b32 v48, v49
    v_add_f32 v14, v48, v49
    v_rcp_f32 v14, v14
    ds_read_b128 v[28:31], v2 offset:3072
    v_pk_mul_f32 v[104:105], v[104:105], v[14:15] op_sel_hi:[1,0]
    v_pk_mul_f32 v[106:107], v[106:107], v[14:15] op_sel_hi:[1,0]
    v_pk_mul_f32 v[108:109], v[108:109], v[14:15] op_sel_hi:[1,0]
    v_pk_mul_f32 v[110:111], v[110:111], v[14:15] op_sel_hi:[1,0]
    s_mov_b64 exec, s[44:45]
    v_cvt_pk_bf16_f32 v112, v104, v105
    v_cvt_pk_bf16_f32 v113, v106, v107
    v_cvt_pk_bf16_f32 v114, v108, v109
    v_cvt_pk_bf16_f32 v115, v110, v111
    ds_write_b128 v7, v[112:115]
    s_mov_b64 exec, -1
    v_mov_b64 v[72:73], 0
    v_mov_b64 v[74:75], 0
    v_mov_b64 v[76:77], 0
    v_mov_b64 v[78:79], 0
    v_mov_b64 v[80:81], 0
    v_mov_b64 v[82:83], 0
    v_mov_b64 v[84:85], 0
    v_mov_b64 v[86:87], 0
    v_mov_b64 v[88:89], 0
    v_mov_b64 v[90:91], 0
    v_mov_b64 v[92:93], 0
    v_mov_b64 v[94:95], 0
    s_waitcnt lgkmcnt(0)
    s_barrier
    ds_read_b128 v[120:123], v1 offset:28672
    ds_read_b128 v[124:127], v1 offset:29696
    v_mov_b64 v[96:97], 0
    v_mov_b64 v[98:99], 0
    v_mov_b64 v[100:101], 0
    v_mov_b64 v[102:103], 0
    s_waitcnt lgkmcnt(1)
    v_smfmac_f32_16x16x64_bf16 v[72:75], v[120:123], v[160:167], v10
    ds_read_b128 v[32:35], v2 offset:4096
    v_smfmac_f32_16x16x64_bf16 v[76:79], v[120:123], v[168:175], v10
    ds_read_b128 v[36:39], v2 offset:5120
    s_waitcnt lgkmcnt(2)
    v_smfmac_f32_16x16x64_bf16 v[72:75], v[124:127], v[224:231], v10
    ds_read_b128 v[40:43], v2 offset:6144
    v_smfmac_f32_16x16x64_bf16 v[76:79], v[124:127], v[232:239], v10
    ds_read_b128 v[44:47], v2 offset:7168
    v_smfmac_f32_16x16x64_bf16 v[80:83], v[120:123], v[176:183], v10
    v_add_f32 v72, v72, v74
    v_smfmac_f32_16x16x64_bf16 v[84:87], v[120:123], v[184:191], v10
    v_add_f32 v73, v73, v75
    v_smfmac_f32_16x16x64_bf16 v[80:83], v[124:127], v[240:247], v10
    v_add_f32 v76, v76, v78
    v_smfmac_f32_16x16x64_bf16 v[84:87], v[124:127], v[248:255], v10
    v_add_f32 v77, v77, v79
    v_smfmac_f32_16x16x64_bf16 v[88:91], v[120:123], v[192:199], v10
    v_cvt_pk_bf16_f32 v104, v72, v76
    v_add_f32 v80, v80, v82
    v_smfmac_f32_16x16x64_bf16 v[92:95], v[120:123], v[200:207], v10
    v_cvt_pk_bf16_f32 v106, v73, v77
    s_waitcnt lgkmcnt(0)
    v_smfmac_f32_16x16x64_bf16 v[88:91], v[124:127], v[16:23], v10
    v_add_f32 v84, v84, v86
    v_add_f32 v81, v81, v83
    v_smfmac_f32_16x16x64_bf16 v[92:95], v[124:127], v[24:31], v10
    v_add_f32 v85, v85, v87
    v_cvt_pk_bf16_f32 v105, v80, v84
    v_smfmac_f32_16x16x64_bf16 v[96:99], v[120:123], v[208:215], v10
    v_cvt_pk_bf16_f32 v107, v81, v85
    v_and_or_b32 v104, v104, -2, s29
    v_smfmac_f32_16x16x64_bf16 v[100:103], v[120:123], v[216:223], v10
    buffer_store_dwordx4 v[104:107], v8, s[8:11], s31 offen sc1
    v_add_f32 v88, v88, v90
    v_smfmac_f32_16x16x64_bf16 v[96:99], v[124:127], v[32:39], v10
    v_add_f32 v92, v92, v94
    v_smfmac_f32_16x16x64_bf16 v[100:103], v[124:127], v[40:47], v10
    v_add_f32 v89, v89, v91
    v_add_f32 v93, v93, v95
    v_cvt_pk_bf16_f32 v108, v88, v92
    v_cvt_pk_bf16_f32 v110, v89, v93
    v_and_or_b32 v108, v108, -2, s29
    v_add_f32 v96, v96, v98
    v_add_f32 v97, v97, v99
    s_nop 0
    v_add_f32 v100, v100, v102
    v_add_f32 v101, v101, v103
    v_cvt_pk_bf16_f32 v109, v96, v100
    v_cvt_pk_bf16_f32 v111, v97, v101
    buffer_store_dwordx4 v[108:111], v8, s[8:11], s32 offen sc1
    s_branch L_hop1_90
L_nored_97:
    s_waitcnt vmcnt(0)
    s_branch L_hop2_91
L_poll1_95_r:
    s_mov_b64 exec, -1
    ds_read_b128 v[124:127], v1 offset:30720
    s_add_u32 s52, s52, 0x1001
    s_cmp_lt_u32 s52, 2147418112
    s_waitcnt lgkmcnt(0)
    s_cbranch_scc1 L_poll1_95
    s_branch L_fail
L_flag_96:
    buffer_load_dword v12, v4, s[8:11], s40 offen sc1
    s_add_u32 s52, s52, 0x1001
    s_cmp_lt_u32 s52, 2147418112
    s_waitcnt vmcnt(0)
    s_cbranch_scc0 L_fail
    v_cmp_gt_u32 vcc, s38, v12
    s_nop 3
    s_and_b32 s42, vcc_lo, 0xf0
    s_cbranch_scc1 L_flag_96
    s_branch L_flag_96_ok
L_gath_93_r:
    s_add_u32 s52, s52, 0x1000
    s_cmp_lt_u32 s52, 2147418112
    s_cbranch_scc0 L_fail
    buffer_load_dwordx4 v[16:19], v0, s[8:11], s54 offen sc1
    buffer_load_dwordx4 v[20:23], v0, s[8:11], s54 offen offset:1024 sc1
    s_nop 3
    v_mov_b64 v[62:63], 0
    v_mov_b64 v[60:61], 0
    v_mov_b64 v[58:59], 0
    v_mov_b64 v[56:57], 0
    v_mov_b64 v[54:55], 0
    v_mov_b64 v[52:53], 0
    v_mov_b64 v[50:51], 0
    v_mov_b64 v[48:49], 0
    s_branch L_enter_98
L_klate_99:
    s_waitcnt vmcnt(5)
L_klate_99_c:
    v_cmp_gt_u32 vcc, s38, v12
    s_nop 3
    s_and_b32 s42, vcc_lo, 0x0f
    s_cbranch_scc0 L_klate_99_go
    buffer_load_dword v12, v4, s[8:11], s40 offen sc1
    s_add_u32 s52, s52, 0x1001
    s_cmp_lt_u32 s52, 2147418112
    s_waitcnt vmcnt(0)
    s_cbranch_scc1 L_klate_99_c
    s_branch L_fail
L_klate_99_go:
    buffer_load_dwordx4 v0, s[8:11], s60 offen sc1 lds
    buffer_load_dwordx4 v0, s[8:11], s60 offen offset:1024 sc1 lds
    s_branch L_klate_99_ok
L_fin_94:
    v_smfmac_f32_16x16x64_bf16 v[64:67], v[36:39], a[240:247], v10
    v_smfmac_f32_16x16x64_bf16 v[68:71], v[36:39], a[248:255], v10
    v_smfmac_f32_16x16x64_bf16 v[64:67], v[40:43], v[128:135], v10
    v_smfmac_f32_16x16x64_bf16 v[68:71], v[40:43], v[136:143], v10
    v_smfmac_f32_16x16x64_bf16 v[64:67], v[44:47], v[144:151], v10
    v_smfmac_f32_16x16x64_bf16 v[68:71], v[44:47], v[152:159], v10
    s_nop 7
    v_add_f32 v64, v64, v66
    v_add_f32 v65, v65, v67
    v_add_f32 v68, v68, v70
    v_add_f32 v69, v69, v71
    v_cvt_pk_bf16_f32 v64, v64, v65
    v_cvt_pk_bf16_f32 v65, v68, v69
    v_mov_b32 v66, 64
    v_mov_b32 v67, 0
    s_waitcnt vmcnt(0)
    s_barrier
    buffer_store_dwordx4 v[64:67], v13, s[8:11], s39 offen sc1
    s_branch L_done
    .p2align 6
L_qkv:
    v_mov_b32 v112, v0
    v_lshlrev_b32 v0, 4, v112
    v_mov_b32 v2, 0
    s_mov_b32 s52, 0
    s_cmp_eq_u32 s24, 0
    s_cselect_b32 s42, 0, 0x40000000
    v_mov_b32 v10, s42
    s_lshl_b32 s38, s26, 8
    s_lshl_b32 s42, s27, 21
    s_add_u32 s29, s42, 243269632
    s_lshl_b32 s42, s27, 11
    s_add_u32 s42, s42, s26
    s_lshl_b32 s30, s42, 14
    s_add_u32 s30, s30, 8388608
    s_lshl_b32 s32, s42, 13
    s_add_u32 s32, s32, 75497472
    s_lshl_b32 s42, s24, 11
    s_add_u32 s31, s30, s42
    s_add_u32 s31, s31, 8192
    s_lshl_b32 s42, s24, 10
    s_add_u32 s30, s30, s42
    s_add_u32 s32, s32, s42
    s_lshl_b32 s33, s27, 15
    s_add_u32 s33, s33, 65536
    s_lshl_b32 s34, s27, 16
    s_add_u32 s34, s34, 491520
    s_mul_i32 s42, s26, 1024
    s_add_u32 s34, s34, s42
    s_lshl_b32 s42, s24, 2
    s_add_u32 s34, s34, s42
    s_lshl_b32 s37, s27, 16
    s_add_u32 s37, s37, 622592
    s_mul_i32 s42, s26, 128
    s_add_u32 s37, s37, s42
    s_lshl_b32 s42, s24, 2
    s_add_u32 s37, s37, s42
    v_lshrrev_b32 v1, 2, v112
    v_and_b32 v1, 3, v1
    v_mul_u32_u24 v1, 1024, v1
    v_and_b32 v113, 3, v112
    v_lshl_add_u32 v1, v113, 2, v1
    v_mov_b32 v5, 0
    v_bfe_i32 v113, v112, 0, 1
    v_and_b32 v113, 16, v113
    v_xor_b32 v5, v5, v113
    v_bfe_i32 v113, v112, 1, 1
    v_and_b32 v113, 32, v113
    v_xor_b32 v5, v5, v113
    v_bfe_i32 v113, v112, 2, 1
    v_and_b32 v113, 64, v113
    v_xor_b32 v5, v5, v113
    v_bfe_i32 v113, v112, 3, 1
    v_and_b32 v113, 128, v113
    v_xor_b32 v5, v5, v113
    v_bfe_i32 v113, v112, 4, 1
    v_and_b32 v113, 4096, v113
    v_xor_b32 v5, v5, v113
    v_bfe_i32 v113, v112, 5, 1
    v_and_b32 v113, 256, v113
    v_xor_b32 v5, v5, v113
    v_mov_b32 v6, 0
    v_bfe_i32 v113, v112, 0, 1
    v_and_b32 v113, 16, v113
    v_xor_b32 v6, v6, v113
    v_bfe_i32 v113, v112, 1, 1
    v_and_b32 v113, 32, v113
    v_xor_b32 v6, v6, v113
    v_bfe_i32 v113, v112, 2, 1
    v_and_b32 v113, 64, v113
    v_xor_b32 v6, v6, v113
    v_bfe_i32 v113, v112, 3, 1
    v_and_b32 v113, 128, v113
    v_xor_b32 v6, v6, v113
    v_bfe_i32 v113, v112, 4, 1
    v_and_b32 v113, 1024, v113
    v_xor_b32 v6, v6, v113
    v_bfe_i32 v113, v112, 5, 1
    v_and_b32 v113, 256, v113
    v_xor_b32 v6, v6, v113
    s_lshr_b32 s42, s26, 1
    s_lshl_b32 s63, s27, 15
    s_add_u32 s63, s63, 425984
    s_mul_i32 s43, s42, 128
    s_add_u32 s63, s63, s43
    s_and_b32 s42, s26, 1
    s_lshl_b32 s42, s42, 3
    s_add_u32 s63, s63, s42
    v_and_b32 v8, 1, v112
    v_lshlrev_b32 v8, 2, v8
    s_cmp_lg_u32 s24, 0
    s_cbranch_scc1 L_na_100
    v_lshlrev_b32 v7, 2, v112
    s_mov_b64 exec, 255
    buffer_store_dword v2, v7, s[8:11], s34 offen sc1
    buffer_store_dword v2, v7, s[8:11], s37 offen sc1
    s_mov_b64 exec, -1
    s_waitcnt vmcnt(0)
    v_mov_b32 v126, 1
    v_mov_b32 v127, 4
    s_mov_b64 exec, 1
    buffer_atomic_add v126, v127, s[12:15], 0 offen
    s_mov_b64 exec, -1
L_na_101:
L_na_100:
    s_mov_b32 s16, s70
    s_mov_b32 s17, s71
    s_mov_b32 s18, 4194304
    s_mov_b32 s19, 0x00020000
    s_mov_b32 s20, s72
    s_mov_b32 s21, s73
    s_mov_b32 s22, 4194304
    s_mov_b32 s23, 0x00020000
    s_mov_b32 s56, s68
    s_mov_b32 s57, s69
    s_mov_b32 s58, 4194304
    s_mov_b32 s59, 0x00020000
    v_mov_b32 v114, 0
    v_bfe_i32 v113, v112, 0, 1
    v_and_b32 v113, 16, v113
    v_xor_b32 v114, v114, v113
    v_bfe_i32 v113, v112, 1, 1
    v_and_b32 v113, 32, v113
    v_xor_b32 v114, v114, v113
    v_bfe_i32 v113, v112, 2, 1
    v_and_b32 v113, 64, v113
    v_xor_b32 v114, v114, v113
    v_bfe_i32 v113, v112, 3, 1
    v_and_b32 v113, 128, v113
    v_xor_b32 v114, v114, v113
    v_bfe_i32 v113, v112, 4, 1
    v_and_b32 v113, 64, v113
    v_xor_b32 v114, v114, v113
    v_bfe_i32 v113, v112, 5, 1
    v_and_b32 v113, 128, v113
    v_xor_b32 v114, v114, v113
    v_lshrrev_b32 v113, 4, v112
    v_mul_u32_u24 v113, 8192, v113
    v_xor_b32 v115, 32, v114
    v_add_u32 v114, v113, v114
    v_add_u32 v115, v113, v115
    s_mul_i32 s42, s24, 131072
    s_add_u32 s38, s38, s42
    s_lshl_b32 s39, s24, 12
    v_mov_b32 v116, 0
    v_bfe_i32 v113, v112, 0, 1
    v_and_b32 v113, 8, v113
    v_xor_b32 v116, v116, v113
    v_bfe_i32 v113, v112, 1, 1
    v_and_b32 v113, 16, v113
    v_xor_b32 v116, v116, v113
    v_bfe_i32 v113, v112, 2, 1
    v_and_b32 v113, 320, v113
    v_xor_b32 v116, v116, v113
    v_bfe_i32 v113, v112, 3, 1
    v_and_b32 v113, 640, v113
    v_xor_b32 v116, v116, v113
    v_bfe_i32 v113, v112, 4, 1
    v_and_b32 v113, 32, v113
    v_xor_b32 v116, v116, v113
    v_bfe_i32 v113, v112, 5, 1
    v_and_b32 v113, 1024, v113
    v_xor_b32 v116, v116, v113
    s_lshl_b32 s42, s24, 6
    v_xor_b32 v116, s42, v116
    s_cmp_eq_u32 s27, 0
    s_cselect_b32 s99, 0, 64
    v_mov_b32 v126, 132
    s_cmp_eq_u32 s99, 0
    s_cbranch_scc1 L_gate_102_ok
L_gate_102:
    s_sleep 8
    buffer_load_dword v127, v126, s[12:15], 0 offen sc1
    s_add_u32 s52, s52, 0x1000
    s_cmp_ge_u32 s52, 2147418112
    s_cbranch_scc1 L_fail
    s_waitcnt vmcnt(0)
    v_cmp_gt_u32 vcc, s99, v127
    s_cbranch_vccnz L_gate_102
L_gate_102_ok:
    s_add_u32 m0, s39, 0
    s_add_u32 s42, s38, 0
    buffer_load_dwordx4 v114, s[16:19], s42 offen  lds
    s_add_u32 m0, s39, 1024
    s_add_u32 s42, s38, 32768
    buffer_load_dwordx4 v114, s[16:19], s42 offen  lds
    s_add_u32 m0, s39, 2048
    s_add_u32 s42, s38, 65536
    buffer_load_dwordx4 v114, s[16:19], s42 offen  lds
    s_add_u32 m0, s39, 3072
    s_add_u32 s42, s38, 98304
    buffer_load_dwordx4 v114, s[16:19], s42 offen  lds
    s_add_u32 m0, s39, 16384
    s_add_u32 s42, s38, 524288
    buffer_load_dwordx4 v114, s[16:19], s42 offen  lds
    s_add_u32 m0, s39, 17408
    s_add_u32 s42, s38, 557056
    buffer_load_dwordx4 v114, s[16:19], s42 offen  lds
    s_add_u32 m0, s39, 18432
    s_add_u32 s42, s38, 589824
    buffer_load_dwordx4 v114, s[16:19], s42 offen  lds
    s_add_u32 m0, s39, 19456
    s_add_u32 s42, s38, 622592
    buffer_load_dwordx4 v114, s[16:19], s42 offen  lds
    s_add_u32 m0, s39, 32768
    s_add_u32 s42, s38, 1048576
    buffer_load_dwordx4 v114, s[16:19], s42 offen  lds
    s_add_u32 m0, s39, 33792
    s_add_u32 s42, s38, 1081344
    buffer_load_dwordx4 v114, s[16:19], s42 offen  lds
    s_add_u32 m0, s39, 34816
    s_add_u32 s42, s38, 1114112
    buffer_load_dwordx4 v114, s[16:19], s42 offen  lds
    s_add_u32 m0, s39, 35840
    s_add_u32 s42, s38, 1146880
    buffer_load_dwordx4 v114, s[16:19], s42 offen  lds
    s_add_u32 m0, s39, 49152
    s_add_u32 s42, s38, 1572864
    buffer_load_dwordx4 v114, s[16:19], s42 offen  lds
    s_add_u32 m0, s39, 50176
    s_add_u32 s42, s38, 1605632
    buffer_load_dwordx4 v114, s[16:19], s42 offen  lds
    s_add_u32 m0, s39, 51200
    s_add_u32 s42, s38, 1638400
    buffer_load_dwordx4 v114, s[16:19], s42 offen  lds
    s_add_u32 m0, s39, 52224
    s_add_u32 s42, s38, 1671168
    buffer_load_dwordx4 v114, s[16:19], s42 offen  lds
    s_add_u32 m0, s39, 65536
    s_add_u32 s42, s38, 2097152
    buffer_load_dwordx4 v114, s[16:19], s42 offen  lds
    s_add_u32 m0, s39, 66560
    s_add_u32 s42, s38, 2129920
    buffer_load_dwordx4 v114, s[16:19], s42 offen  lds
    s_add_u32 m0, s39, 67584
    s_add_u32 s42, s38, 2162688
    buffer_load_dwordx4 v114, s[16:19], s42 offen  lds
    s_add_u32 m0, s39, 68608
    s_add_u32 s42, s38, 2195456
    buffer_load_dwordx4 v114, s[16:19], s42 offen  lds
    s_add_u32 m0, s39, 81920
    s_add_u32 s42, s38, 2621440
    buffer_load_dwordx4 v114, s[16:19], s42 offen  lds
    s_add_u32 m0, s39, 82944
    s_add_u32 s42, s38, 2654208
    buffer_load_dwordx4 v114, s[16:19], s42 offen  lds
    s_add_u32 m0, s39, 83968
    s_add_u32 s42, s38, 2686976
    buffer_load_dwordx4 v114, s[16:19], s42 offen  lds
    s_add_u32 m0, s39, 84992
    s_add_u32 s42, s38, 2719744
    buffer_load_dwordx4 v114, s[16:19], s42 offen  lds
    s_add_u32 m0, s39, 98304
    s_add_u32 s42, s38, 3145728
    buffer_load_dwordx4 v114, s[16:19], s42 offen  lds
    s_add_u32 m0, s39, 99328
    s_add_u32 s42, s38, 3178496
    buffer_load_dwordx4 v114, s[16:19], s42 offen  lds
    s_add_u32 m0, s39, 100352
    s_add_u32 s42, s38, 3211264
    buffer_load_dwordx4 v114, s[16:19], s42 offen  lds
    s_add_u32 m0, s39, 101376
    s_add_u32 s42, s38, 3244032
    buffer_load_dwordx4 v114, s[16:19], s42 offen  lds
    s_add_u32 m0, s39, 114688
    s_add_u32 s42, s38, 3670016
    buffer_load_dwordx4 v114, s[16:19], s42 offen  lds
    s_add_u32 m0, s39, 115712
    s_add_u32 s42, s38, 3702784
    buffer_load_dwordx4 v114, s[16:19], s42 offen  lds
    s_add_u32 m0, s39, 116736
    s_add_u32 s42, s38, 3735552
    buffer_load_dwordx4 v114, s[16:19], s42 offen  lds
    s_add_u32 m0, s39, 117760
    s_add_u32 s42, s38, 3768320
    buffer_load_dwordx4 v114, s[16:19], s42 offen  lds
    s_add_u32 m0, s39, 131072
    s_add_u32 s42, s38, 0
    buffer_load_dwordx4 v114, s[20:23], s42 offen  lds
    s_add_u32 m0, s39, 132096
    s_add_u32 s42, s38, 32768
    buffer_load_dwordx4 v114, s[20:23], s42 offen  lds
    s_add_u32 m0, s39, 133120
    s_add_u32 s42, s38, 65536
    buffer_load_dwordx4 v114, s[20:23], s42 offen  lds
    s_add_u32 m0, s39, 134144
    s_add_u32 s42, s38, 98304
    buffer_load_dwordx4 v114, s[20:23], s42 offen  lds
    s_add_u32 m0, s39, 147456
    s_add_u32 s42, s38, 524288
    buffer_load_dwordx4 v114, s[20:23], s42 offen  lds
    s_add_u32 m0, s39, 148480
    s_add_u32 s42, s38, 557056
    buffer_load_dwordx4 v114, s[20:23], s42 offen  lds
    s_add_u32 m0, s39, 149504
    s_add_u32 s42, s38, 589824
    buffer_load_dwordx4 v114, s[20:23], s42 offen  lds
    s_add_u32 m0, s39, 150528
    s_add_u32 s42, s38, 622592
    buffer_load_dwordx4 v114, s[20:23], s42 offen  lds
    s_waitcnt vmcnt(36) lgkmcnt(0)
    s_barrier
    v_add_u32 v117, 0, v116
    ds_read_b64_tr_b16 a[0:1], v117 offset:0
    ds_read_b64_tr_b16 a[2:3], v117 offset:2048
    ds_read_b64_tr_b16 a[4:5], v117 offset:4096
    ds_read_b64_tr_b16 a[6:7], v117 offset:6144
    ds_read_b64_tr_b16 a[8:9], v117 offset:8192
    ds_read_b64_tr_b16 a[10:11], v117 offset:10240
    ds_read_b64_tr_b16 a[12:13], v117 offset:12288
    ds_read_b64_tr_b16 a[14:15], v117 offset:14336
    s_waitcnt vmcnt(32) lgkmcnt(0)
    s_barrier
    s_add_u32 m0, s39, 0
    s_add_u32 s42, s38, 1048576
    buffer_load_dwordx4 v114, s[20:23], s42 offen  lds
    s_add_u32 m0, s39, 1024
    s_add_u32 s42, s38, 1081344
    buffer_load_dwordx4 v114, s[20:23], s42 offen  lds
    s_add_u32 m0, s39, 2048
    s_add_u32 s42, s38, 1114112
    buffer_load_dwordx4 v114, s[20:23], s42 offen  lds
    s_add_u32 m0, s39, 3072
    s_add_u32 s42, s38, 1146880
    buffer_load_dwordx4 v114, s[20:23], s42 offen  lds
    v_add_u32 v117, 16384, v116
    ds_read_b64_tr_b16 a[16:17], v117 offset:0
    ds_read_b64_tr_b16 a[18:19], v117 offset:2048
    ds_read_b64_tr_b16 a[20:21], v117 offset:4096
    ds_read_b64_tr_b16 a[22:23], v117 offset:6144
    ds_read_b64_tr_b16 a[24:25], v117 offset:8192
    ds_read_b64_tr_b16 a[26:27], v117 offset:10240
    ds_read_b64_tr_b16 a[28:29], v117 offset:12288
    ds_read_b64_tr_b16 a[30:31], v117 offset:14336
    s_waitcnt vmcnt(32) lgkmcnt(0)
    s_barrier
    s_add_u32 m0, s39, 16384
    s_add_u32 s42, s38, 1572864
    buffer_load_dwordx4 v114, s[20:23], s42 offen  lds
    s_add_u32 m0, s39, 17408
    s_add_u32 s42, s38, 1605632
    buffer_load_dwordx4 v114, s[20:23], s42 offen  lds
    s_add_u32 m0, s39, 18432
    s_add_u32 s42, s38, 1638400
    buffer_load_dwordx4 v114, s[20:23], s42 offen  lds
    s_add_u32 m0, s39, 19456
    s_add_u32 s42, s38, 1671168
    buffer_load_dwordx4 v114, s[20:23], s42 offen  lds
    v_add_u32 v117, 32768, v116
    ds_read_b64_tr_b16 a[32:33], v117 offset:0
    ds_read_b64_tr_b16 a[34:35], v117 offset:2048
    ds_read_b64_tr_b16 a[36:37], v117 offset:4096
    ds_read_b64_tr_b16 a[38:39], v117 offset:6144
    ds_read_b64_tr_b16 a[40:41], v117 offset:8192
    ds_read_b64_tr_b16 a[42:43], v117 offset:10240
    ds_read_b64_tr_b16 a[44:45], v117 offset:12288
    ds_read_b64_tr_b16 a[46:47], v117 offset:14336
    s_waitcnt vmcnt(32) lgkmcnt(0)
    s_barrier
    s_add_u32 m0, s39, 32768
    s_add_u32 s42, s38, 2097152
    buffer_load_dwordx4 v114, s[20:23], s42 offen  lds
    s_add_u32 m0, s39, 33792
    s_add_u32 s42, s38, 2129920
    buffer_load_dwordx4 v114, s[20:23], s42 offen  lds
    s_add_u32 m0, s39, 34816
    s_add_u32 s42, s38, 2162688
    buffer_load_dwordx4 v114, s[20:23], s42 offen  lds
    s_add_u32 m0, s39, 35840
    s_add_u32 s42, s38, 2195456
    buffer_load_dwordx4 v114, s[20:23], s42 offen  lds
    v_add_u32 v117, 49152, v116
    ds_read_b64_tr_b16 a[48:49], v117 offset:0
    ds_read_b64_tr_b16 a[50:51], v117 offset:2048
    ds_read_b64_tr_b16 a[52:53], v117 offset:4096
    ds_read_b64_tr_b16 a[54:55], v117 offset:6144
    ds_read_b64_tr_b16 a[56:57], v117 offset:8192
    ds_read_b64_tr_b16 a[58:59], v117 offset:10240
    ds_read_b64_tr_b16 a[60:61], v117 offset:12288
    ds_read_b64_tr_b16 a[62:63], v117 offset:14336
    s_waitcnt vmcnt(32) lgkmcnt(0)
    s_barrier
    s_add_u32 m0, s39, 49152
    s_add_u32 s42, s38, 2621440
    buffer_load_dwordx4 v114, s[20:23], s42 offen  lds
    s_add_u32 m0, s39, 50176
    s_add_u32 s42, s38, 2654208
    buffer_load_dwordx4 v114, s[20:23], s42 offen  lds
    s_add_u32 m0, s39, 51200
    s_add_u32 s42, s38, 2686976
    buffer_load_dwordx4 v114, s[20:23], s42 offen  lds
    s_add_u32 m0, s39, 52224
    s_add_u32 s42, s38, 2719744
    buffer_load_dwordx4 v114, s[20:23], s42 offen  lds
    v_add_u32 v117, 65536, v116
    ds_read_b64_tr_b16 a[64:65], v117 offset:0
    ds_read_b64_tr_b16 a[66:67], v117 offset:2048
    ds_read_b64_tr_b16 a[68:69], v117 offset:4096
    ds_read_b64_tr_b16 a[70:71], v117 offset:6144
    ds_read_b64_tr_b16 a[72:73], v117 offset:8192
    ds_read_b64_tr_b16 a[74:75], v117 offset:10240
    ds_read_b64_tr_b16 a[76:77], v117 offset:12288
    ds_read_b64_tr_b16 a[78:79], v117 offset:14336
    s_waitcnt vmcnt(32) lgkmcnt(0)
    s_barrier
    s_add_u32 m0, s39, 65536
    s_add_u32 s42, s38, 3145728
    buffer_load_dwordx4 v114, s[20:23], s42 offen  lds
    s_add_u32 m0, s39, 66560
    s_add_u32 s42, s38, 3178496
    buffer_load_dwordx4 v114, s[20:23], s42 offen  lds
    s_add_u32 m0, s39, 67584
    s_add_u32 s42, s38, 3211264
    buffer_load_dwordx4 v114, s[20:23], s42 offen  lds
    s_add_u32 m0, s39, 68608
    s_add_u32 s42, s38, 3244032
    buffer_load_dwordx4 v114, s[20:23], s42 offen  lds
    v_add_u32 v117, 81920, v116
    ds_read_b64_tr_b16 a[80:81], v117 offset:0
    ds_read_b64_tr_b16 a[82:83], v117 offset:2048
    ds_read_b64_tr_b16 a[84:85], v117 offset:4096
    ds_read_b64_tr_b16 a[86:87], v117 offset:6144
    ds_read_b64_tr_b16 a[88:89], v117 offset:8192
    ds_read_b64_tr_b16 a[90:91], v117 offset:10240
    ds_read_b64_tr_b16 a[92:93], v117 offset:12288
    ds_read_b64_tr_b16 a[94:95], v117 offset:14336
    s_waitcnt vmcnt(32) lgkmcnt(0)
    s_barrier
    s_add_u32 m0, s39, 81920
    s_add_u32 s42, s38, 3670016
    buffer_load_dwordx4 v114, s[20:23], s42 offen  lds
    s_add_u32 m0, s39, 82944
    s_add_u32 s42, s38, 3702784
    buffer_load_dwordx4 v114, s[20:23], s42 offen  lds
    s_add_u32 m0, s39, 83968
    s_add_u32 s42, s38, 3735552
    buffer_load_dwordx4 v114, s[20:23], s42 offen  lds
    s_add_u32 m0, s39, 84992
    s_add_u32 s42, s38, 3768320
    buffer_load_dwordx4 v114, s[20:23], s42 offen  lds
    v_add_u32 v117, 98304, v116
    ds_read_b64_tr_b16 a[96:97], v117 offset:0
    ds_read_b64_tr_b16 a[98:99], v117 offset:2048
    ds_read_b64_tr_b16 a[100:101], v117 offset:4096
    ds_read_b64_tr_b16 a[102:103], v117 offset:6144
    ds_read_b64_tr_b16 a[104:105], v117 offset:8192
    ds_read_b64_tr_b16 a[106:107], v117 offset:10240
    ds_read_b64_tr_b16 a[108:109], v117 offset:12288
    ds_read_b64_tr_b16 a[110:111], v117 offset:14336
    s_waitcnt vmcnt(32) lgkmcnt(0)
    s_barrier
    s_add_u32 m0, s39, 98304
    s_add_u32 s42, s38, 0
    buffer_load_dwordx4 v114, s[56:59], s42 offen  lds
    s_add_u32 m0, s39, 99328
    s_add_u32 s42, s38, 32768
    buffer_load_dwordx4 v114, s[56:59], s42 offen  lds
    s_add_u32 m0, s39, 100352
    s_add_u32 s42, s38, 65536
    buffer_load_dwordx4 v114, s[56:59], s42 offen  lds
    s_add_u32 m0, s39, 101376
    s_add_u32 s42, s38, 98304
    buffer_load_dwordx4 v114, s[56:59], s42 offen  lds
    v_add_u32 v117, 114688, v116
    ds_read_b64_tr_b16 a[112:113], v117 offset:0
    ds_read_b64_tr_b16 a[114:115], v117 offset:2048
    ds_read_b64_tr_b16 a[116:117], v117 offset:4096
    ds_read_b64_tr_b16 a[118:119], v117 offset:6144
    ds_read_b64_tr_b16 a[120:121], v117 offset:8192
    ds_read_b64_tr_b16 a[122:123], v117 offset:10240
    ds_read_b64_tr_b16 a[124:125], v117 offset:12288
    ds_read_b64_tr_b16 a[126:127], v117 offset:14336
    s_waitcnt vmcnt(32) lgkmcnt(0)
    s_barrier
    s_add_u32 m0, s39, 114688
    s_add_u32 s42, s38, 524288
    buffer_load_dwordx4 v114, s[56:59], s42 offen  lds
    s_add_u32 m0, s39, 115712
    s_add_u32 s42, s38, 557056
    buffer_load_dwordx4 v114, s[56:59], s42 offen  lds
    s_add_u32 m0, s39, 116736
    s_add_u32 s42, s38, 589824
    buffer_load_dwordx4 v114, s[56:59], s42 offen  lds
    s_add_u32 m0, s39, 117760
    s_add_u32 s42, s38, 622592
    buffer_load_dwordx4 v114, s[56:59], s42 offen  lds
    v_add_u32 v117, 131072, v116
    ds_read_b64_tr_b16 a[128:129], v117 offset:0
    ds_read_b64_tr_b16 a[130:131], v117 offset:2048
    ds_read_b64_tr_b16 a[132:133], v117 offset:4096
    ds_read_b64_tr_b16 a[134:135], v117 offset:6144
    ds_read_b64_tr_b16 a[136:137], v117 offset:8192
    ds_read_b64_tr_b16 a[138:139], v117 offset:10240
    ds_read_b64_tr_b16 a[140:141], v117 offset:12288
    ds_read_b64_tr_b16 a[142:143], v117 offset:14336
    s_waitcnt vmcnt(32) lgkmcnt(0)
    s_barrier
    s_add_u32 m0, s39, 131072
    s_add_u32 s42, s38, 1048576
    buffer_load_dwordx4 v114, s[56:59], s42 offen  lds
    s_add_u32 m0, s39, 132096
    s_add_u32 s42, s38, 1081344
    buffer_load_dwordx4 v114, s[56:59], s42 offen  lds
    s_add_u32 m0, s39, 133120
    s_add_u32 s42, s38, 1114112
    buffer_load_dwordx4 v114, s[56:59], s42 offen  lds
    s_add_u32 m0, s39, 134144
    s_add_u32 s42, s38, 1146880
    buffer_load_dwordx4 v114, s[56:59], s42 offen  lds
    v_add_u32 v117, 147456, v116
    ds_read_b64_tr_b16 a[144:145], v117 offset:0
    ds_read_b64_tr_b16 a[146:147], v117 offset:2048
    ds_read_b64_tr_b16 a[148:149], v117 offset:4096
    ds_read_b64_tr_b16 a[150:151], v117 offset:6144
    ds_read_b64_tr_b16 a[152:153], v117 offset:8192
    ds_read_b64_tr_b16 a[154:155], v117 offset:10240
    ds_read_b64_tr_b16 a[156:157], v117 offset:12288
    ds_read_b64_tr_b16 a[158:159], v117 offset:14336
    s_waitcnt vmcnt(32) lgkmcnt(0)
    s_barrier
    s_add_u32 m0, s39, 147456
    s_add_u32 s42, s38, 1572864
    buffer_load_dwordx4 v114, s[56:59], s42 offen  lds
    s_add_u32 m0, s39, 148480
    s_add_u32 s42, s38, 1605632
    buffer_load_dwordx4 v114, s[56:59], s42 offen  lds
    s_add_u32 m0, s39, 149504
    s_add_u32 s42, s38, 1638400
    buffer_load_dwordx4 v114, s[56:59], s42 offen  lds
    s_add_u32 m0, s39, 150528
    s_add_u32 s42, s38, 1671168
    buffer_load_dwordx4 v114, s[56:59], s42 offen  lds
    v_add_u32 v117, 0, v116
    ds_read_b64_tr_b16 a[160:161], v117 offset:0
    ds_read_b64_tr_b16 a[162:163], v117 offset:2048
    ds_read_b64_tr_b16 a[164:165], v117 offset:4096
    ds_read_b64_tr_b16 a[166:167], v117 offset:6144
    ds_read_b64_tr_b16 a[168:169], v117 offset:8192
    ds_read_b64_tr_b16 a[170:171], v117 offset:10240
    ds_read_b64_tr_b16 a[172:173], v117 offset:12288
    ds_read_b64_tr_b16 a[174:175], v117 offset:14336
    s_waitcnt vmcnt(32) lgkmcnt(0)
    s_barrier
    s_add_u32 m0, s39, 0
    s_add_u32 s42, s38, 2097152
    buffer_load_dwordx4 v114, s[56:59], s42 offen  lds
    s_add_u32 m0, s39, 1024
    s_add_u32 s42, s38, 2129920
    buffer_load_dwordx4 v114, s[56:59], s42 offen  lds
    s_add_u32 m0, s39, 2048
    s_add_u32 s42, s38, 2162688
    buffer_load_dwordx4 v114, s[56:59], s42 offen  lds
    s_add_u32 m0, s39, 3072
    s_add_u32 s42, s38, 2195456
    buffer_load_dwordx4 v114, s[56:59], s42 offen  lds
    v_add_u32 v117, 16384, v116
    ds_read_b64_tr_b16 a[176:177], v117 offset:0
    ds_read_b64_tr_b16 a[178:179], v117 offset:2048
    ds_read_b64_tr_b16 a[180:181], v117 offset:4096
    ds_read_b64_tr_b16 a[182:183], v117 offset:6144
    ds_read_b64_tr_b16 a[184:185], v117 offset:8192
    ds_read_b64_tr_b16 a[186:187], v117 offset:10240
    ds_read_b64_tr_b16 a[188:189], v117 offset:12288
    ds_read_b64_tr_b16 a[190:191], v117 offset:14336
    s_waitcnt vmcnt(32) lgkmcnt(0)
    s_barrier
    s_add_u32 m0, s39, 16384
    s_add_u32 s42, s38, 2621440
    buffer_load_dwordx4 v114, s[56:59], s42 offen  lds
    s_add_u32 m0, s39, 17408
    s_add_u32 s42, s38, 2654208
    buffer_load_dwordx4 v114, s[56:59], s42 offen  lds
    s_add_u32 m0, s39, 18432
    s_add_u32 s42, s38, 2686976
    buffer_load_dwordx4 v114, s[56:59], s42 offen  lds
    s_add_u32 m0, s39, 19456
    s_add_u32 s42, s38, 2719744
    buffer_load_dwordx4 v114, s[56:59], s42 offen  lds
    v_add_u32 v117, 32768, v116
    ds_read_b64_tr_b16 a[192:193], v117 offset:0
    ds_read_b64_tr_b16 a[194:195], v117 offset:2048
    ds_read_b64_tr_b16 a[196:197], v117 offset:4096
    ds_read_b64_tr_b16 a[198:199], v117 offset:6144
    ds_read_b64_tr_b16 a[200:201], v117 offset:8192
    ds_read_b64_tr_b16 a[202:203], v117 offset:10240
    ds_read_b64_tr_b16 a[204:205], v117 offset:12288
    ds_read_b64_tr_b16 a[206:207], v117 offset:14336
    s_waitcnt vmcnt(32) lgkmcnt(0)
    s_barrier
    s_add_u32 m0, s39, 32768
    s_add_u32 s42, s38, 3145728
    buffer_load_dwordx4 v114, s[56:59], s42 offen  lds
    s_add_u32 m0, s39, 33792
    s_add_u32 s42, s38, 3178496
    buffer_load_dwordx4 v114, s[56:59], s42 offen  lds
    s_add_u32 m0, s39, 34816
    s_add_u32 s42, s38, 3211264
    buffer_load_dwordx4 v114, s[56:59], s42 offen  lds
    s_add_u32 m0, s39, 35840
    s_add_u32 s42, s38, 3244032
    buffer_load_dwordx4 v114, s[56:59], s42 offen  lds
    v_add_u32 v117, 49152, v116
    ds_read_b64_tr_b16 a[208:209], v117 offset:0
    ds_read_b64_tr_b16 a[210:211], v117 offset:2048
    ds_read_b64_tr_b16 a[212:213], v117 offset:4096
    ds_read_b64_tr_b16 a[214:215], v117 offset:6144
    ds_read_b64_tr_b16 a[216:217], v117 offset:8192
    ds_read_b64_tr_b16 a[218:219], v117 offset:10240
    ds_read_b64_tr_b16 a[220:221], v117 offset:12288
    ds_read_b64_tr_b16 a[222:223], v117 offset:14336
    s_waitcnt vmcnt(32) lgkmcnt(0)
    s_barrier
    s_add_u32 m0, s39, 49152
    s_add_u32 s42, s38, 3670016
    buffer_load_dwordx4 v114, s[56:59], s42 offen  lds
    s_add_u32 m0, s39, 50176
    s_add_u32 s42, s38, 3702784
    buffer_load_dwordx4 v114, s[56:59], s42 offen  lds
    s_add_u32 m0, s39, 51200
    s_add_u32 s42, s38, 3735552
    buffer_load_dwordx4 v114, s[56:59], s42 offen  lds
    s_add_u32 m0, s39, 52224
    s_add_u32 s42, s38, 3768320
    buffer_load_dwordx4 v114, s[56:59], s42 offen  lds
    v_add_u32 v117, 65536, v116
    ds_read_b64_tr_b16 a[224:225], v117 offset:0
    ds_read_b64_tr_b16 a[226:227], v117 offset:2048
    ds_read_b64_tr_b16 a[228:229], v117 offset:4096
    ds_read_b64_tr_b16 a[230:231], v117 offset:6144
    ds_read_b64_tr_b16 a[232:233], v117 offset:8192
    ds_read_b64_tr_b16 a[234:235], v117 offset:10240
    ds_read_b64_tr_b16 a[236:237], v117 offset:12288
    ds_read_b64_tr_b16 a[238:239], v117 offset:14336
    s_waitcnt vmcnt(32) lgkmcnt(0)
    s_barrier
    v_add_u32 v117, 81920, v116
    ds_read_b64_tr_b16 a[240:241], v117 offset:0
    ds_read_b64_tr_b16 a[242:243], v117 offset:2048
    ds_read_b64_tr_b16 a[244:245], v117 offset:4096
    ds_read_b64_tr_b16 a[246:247], v117 offset:6144
    ds_read_b64_tr_b16 a[248:249], v117 offset:8192
    ds_read_b64_tr_b16 a[250:251], v117 offset:10240
    ds_read_b64_tr_b16 a[252:253], v117 offset:12288
    ds_read_b64_tr_b16 a[254:255], v117 offset:14336
    s_waitcnt vmcnt(28) lgkmcnt(0)
    s_barrier
    v_add_u32 v117, 98304, v116
    ds_read_b64_tr_b16 v[128:129], v117 offset:0
    ds_read_b64_tr_b16 v[130:131], v117 offset:2048
    ds_read_b64_tr_b16 v[132:133], v117 offset:4096
    ds_read_b64_tr_b16 v[134:135], v117 offset:6144
    ds_read_b64_tr_b16 v[136:137], v117 offset:8192
    ds_read_b64_tr_b16 v[138:139], v117 offset:10240
    ds_read_b64_tr_b16 v[140:141], v117 offset:12288
    ds_read_b64_tr_b16 v[142:143], v117 offset:14336
    s_waitcnt vmcnt(24) lgkmcnt(0)
    s_barrier
    v_add_u32 v117, 114688, v116
    ds_read_b64_tr_b16 v[144:145], v117 offset:0
    ds_read_b64_tr_b16 v[146:147], v117 offset:2048
    ds_read_b64_tr_b16 v[148:149], v117 offset:4096
    ds_read_b64_tr_b16 v[150:151], v117 offset:6144
    ds_read_b64_tr_b16 v[152:153], v117 offset:8192
    ds_read_b64_tr_b16 v[154:155], v117 offset:10240
    ds_read_b64_tr_b16 v[156:157], v117 offset:12288
    ds_read_b64_tr_b16 v[158:159], v117 offset:14336
    s_waitcnt vmcnt(20) lgkmcnt(0)
    s_barrier
    v_add_u32 v117, 131072, v116
    ds_read_b64_tr_b16 v[160:161], v117 offset:0
    ds_read_b64_tr_b16 v[162:163], v117 offset:2048
    ds_read_b64_tr_b16 v[164:165], v117 offset:4096
    ds_read_b64_tr_b16 v[166:167], v117 offset:6144
    ds_read_b64_tr_b16 v[168:169], v117 offset:8192
    ds_read_b64_tr_b16 v[170:171], v117 offset:10240
    ds_read_b64_tr_b16 v[172:173], v117 offset:12288
    ds_read_b64_tr_b16 v[174:175], v117 offset:14336
    s_waitcnt vmcnt(16) lgkmcnt(0)
    s_barrier
    v_add_u32 v117, 147456, v116
    ds_read_b64_tr_b16 v[176:177], v117 offset:0
    ds_read_b64_tr_b16 v[178:179], v117 offset:2048
    ds_read_b64_tr_b16 v[180:181], v117 offset:4096
    ds_read_b64_tr_b16 v[182:183], v117 offset:6144
    ds_read_b64_tr_b16 v[184:185], v117 offset:8192
    ds_read_b64_tr_b16 v[186:187], v117 offset:10240
    ds_read_b64_tr_b16 v[188:189], v117 offset:12288
    ds_read_b64_tr_b16 v[190:191], v117 offset:14336
    s_waitcnt vmcnt(12) lgkmcnt(0)
    s_barrier
    v_add_u32 v117, 0, v116
    ds_read_b64_tr_b16 v[192:193], v117 offset:0
    ds_read_b64_tr_b16 v[194:195], v117 offset:2048
    ds_read_b64_tr_b16 v[196:197], v117 offset:4096
    ds_read_b64_tr_b16 v[198:199], v117 offset:6144
    ds_read_b64_tr_b16 v[200:201], v117 offset:8192
    ds_read_b64_tr_b16 v[202:203], v117 offset:10240
    ds_read_b64_tr_b16 v[204:205], v117 offset:12288
    ds_read_b64_tr_b16 v[206:207], v117 offset:14336
    s_waitcnt vmcnt(8) lgkmcnt(0)
    s_barrier
    v_add_u32 v117, 16384, v116
    ds_read_b64_tr_b16 v[208:209], v117 offset:0
    ds_read_b64_tr_b16 v[210:211], v117 offset:2048
    ds_read_b64_tr_b16 v[212:213], v117 offset:4096
    ds_read_b64_tr_b16 v[214:215], v117 offset:6144
    ds_read_b64_tr_b16 v[216:217], v117 offset:8192
    ds_read_b64_tr_b16 v[218:219], v117 offset:10240
    ds_read_b64_tr_b16 v[220:221], v117 offset:12288
    ds_read_b64_tr_b16 v[222:223], v117 offset:14336
    s_waitcnt vmcnt(4) lgkmcnt(0)
    s_barrier
    v_add_u32 v117, 32768, v116
    ds_read_b64_tr_b16 v[224:225], v117 offset:0
    ds_read_b64_tr_b16 v[226:227], v117 offset:2048
    ds_read_b64_tr_b16 v[228:229], v117 offset:4096
    ds_read_b64_tr_b16 v[230:231], v117 offset:6144
    ds_read_b64_tr_b16 v[232:233], v117 offset:8192
    ds_read_b64_tr_b16 v[234:235], v117 offset:10240
    ds_read_b64_tr_b16 v[236:237], v117 offset:12288
    ds_read_b64_tr_b16 v[238:239], v117 offset:14336
    s_waitcnt vmcnt(0) lgkmcnt(0)
    s_barrier
    v_add_u32 v117, 49152, v116
    ds_read_b64_tr_b16 v[240:241], v117 offset:0
    ds_read_b64_tr_b16 v[242:243], v117 offset:2048
    ds_read_b64_tr_b16 v[244:245], v117 offset:4096
    ds_read_b64_tr_b16 v[246:247], v117 offset:6144
    ds_read_b64_tr_b16 v[248:249], v117 offset:8192
    ds_read_b64_tr_b16 v[250:251], v117 offset:10240
    ds_read_b64_tr_b16 v[252:253], v117 offset:12288
    ds_read_b64_tr_b16 v[254:255], v117 offset:14336
    s_waitcnt lgkmcnt(0)
    s_barrier
    v_mbcnt_lo_u32_b32 v126, -1, 0
    v_mbcnt_hi_u32_b32 v126, -1, v126
    v_lshlrev_b32 v126, 5, v126
    v_cmp_gt_u32 vcc, 256, v126
    s_nop 1
    v_cndmask_b32 v126, 4, v126, vcc
    buffer_load_dword v127, v126, s[12:15], 0 offen sc1
    s_waitcnt vmcnt(0)
    v_readlane_b32 s98, v127, 8
    v_cmp_ne_u32 vcc, 32, v127
    s_nop 3
    s_and_b32 s5, vcc_lo, 0xff
    s_cmp_lt_u32 s98, 256
    s_cselect_b32 s98, 1, s5
    s_cmp_eq_u32 s98, 0
    s_cbranch_scc1 L_gw_103_done
L_gw_103:
    buffer_load_dword v127, v126, s[12:15], 0 offen sc1
    s_add_u32 s52, s52, 0x1000
    s_cmp_ge_u32 s52, 2147418112
    s_cbranch_scc1 L_fail
    s_waitcnt vmcnt(0)
    v_readlane_b32 s98, v127, 8
    s_nop 3
    s_cmp_ge_u32 s98, 256
    s_cbranch_scc1 L_gw_103_ok
    s_sleep 4
    s_branch L_gw_103
L_gw_103_ok:
    buffer_load_dword v127, v126, s[12:15], 0 offen sc1
    s_waitcnt vmcnt(0)
    v_cmp_ne_u32 vcc, 32, v127
    s_nop 3
    s_and_b32 s5, vcc_lo, 0xff
L_gw_103_done:
    s_cmp_lg_u32 s5, 0
    s_cbranch_scc1 L_nonlocal_104
    s_mov_b32 s28, 0
    s_mov_b32 s36, 1
    s_mov_b32 s35, 0
    s_lshl_b32 s44, s24, 11
    s_lshl_b32 s45, s24, 12
    s_add_u32 s46, s29, s44
    s_add_u32 s47, s29, s45
    s_mov_b32 s48, s46
    s_mov_b32 s49, s47
    s_mov_b32 s60, s30
    s_mov_b32 s61, s31
    s_mov_b32 s62, s32
    v_mov_b32 v4, v0
L_item_105:
L_poll_111:
    buffer_load_dword v3, v1, s[8:11], s33 offen sc1
    s_waitcnt vmcnt(0)
    v_cmp_gt_u32 vcc, s36, v3
    s_add_u32 s52, s52, 0x1000
    s_cmp_lt_u32 s52, 2147418112
    s_cbranch_vccz L_poll_111_ok
    s_cbranch_scc1 L_poll_111
    s_branch L_fail
L_poll_111_ok:
L_dma_106:
    s_add_u32 m0, s44, 0
    s_add_u32 s42, s46, 0
    buffer_load_dwordx4 v0, s[8:11], s42 offen offset:0 sc1  lds
    buffer_load_dwordx4 v0, s[8:11], s42 offen offset:1024 sc1  lds
    s_add_u32 m0, s44, 8192
    s_add_u32 s42, s46, 8192
    buffer_load_dwordx4 v0, s[8:11], s42 offen offset:0 sc1  lds
    buffer_load_dwordx4 v0, s[8:11], s42 offen offset:1024 sc1  lds
    s_add_u32 m0, s44, 16384
    s_add_u32 s42, s46, 16384
    buffer_load_dwordx4 v0, s[8:11], s42 offen offset:0 sc1  lds
    buffer_load_dwordx4 v0, s[8:11], s42 offen offset:1024 sc1  lds
L_rd_112:
    s_mov_b32 s6, 0
    s_waitcnt vmcnt(4)
    s_barrier
    ds_read_b128 v[64:67], v4 offset:0
    ds_read_b128 v[68:71], v4 offset:1024
    ds_read_b128 v[72:75], v4 offset:2048
    ds_read_b128 v[76:79], v4 offset:3072
    s_waitcnt lgkmcnt(3)
    v_mfma_f32_32x32x16_bf16 v[16:31], a[0:3], v[64:67], 0
    v_xor_b32 v12, s6, v64
    s_add_u32 m0, s44, 24576
    s_add_u32 s42, s46, 24576
    buffer_load_dwordx4 v0, s[8:11], s42 offen offset:0 sc1  lds
    ds_read_b128 v[64:67], v4 offset:4096
    s_waitcnt lgkmcnt(3)
    v_mfma_f32_32x32x16_bf16 v[16:31], a[4:7], v[68:71], v[16:31]
    v_bitop3_b32 v12, v12, v68, s6 bitop3:96
    ds_read_b128 v[68:71], v4 offset:5120
    s_waitcnt lgkmcnt(3)
    v_mfma_f32_32x32x16_bf16 v[16:31], a[8:11], v[72:75], v[16:31]
    v_bitop3_b32 v12, v12, v72, s6 bitop3:96
    buffer_load_dwordx4 v0, s[8:11], s42 offen offset:1024 sc1  lds
    ds_read_b128 v[72:75], v4 offset:6144
    s_waitcnt lgkmcnt(3)
    v_mfma_f32_32x32x16_bf16 v[16:31], a[12:15], v[76:79], v[16:31]
    v_bitop3_b32 v12, v12, v76, s6 bitop3:96
    ds_read_b128 v[76:79], v4 offset:7168
    s_waitcnt lgkmcnt(3)
    v_mfma_f32_32x32x16_bf16 v[16:31], a[16:19], v[64:67], v[16:31]
    v_bitop3_b32 v12, v12, v64, s6 bitop3:96
    s_waitcnt vmcnt(4)
    s_barrier
    ds_read_b128 v[64:67], v4 offset:8192
    s_waitcnt lgkmcnt(3)
    v_mfma_f32_32x32x16_bf16 v[16:31], a[20:23], v[68:71], v[16:31]
    v_bitop3_b32 v12, v12, v68, s6 bitop3:96
    ds_read_b128 v[68:71], v4 offset:9216
    s_waitcnt lgkmcnt(3)
    v_mfma_f32_32x32x16_bf16 v[16:31], a[24:27], v[72:75], v[16:31]
    v_bitop3_b32 v12, v12, v72, s6 bitop3:96
    ds_read_b128 v[72:75], v4 offset:10240
    s_waitcnt lgkmcnt(3)
    v_mfma_f32_32x32x16_bf16 v[16:31], a[28:31], v[76:79], v[16:31]
    v_bitop3_b32 v12, v12, v76, s6 bitop3:96
    ds_read_b128 v[76:79], v4 offset:11264
    s_waitcnt lgkmcnt(3)
    v_mfma_f32_32x32x16_bf16 v[16:31], a[32:35], v[64:67], v[16:31]
    v_bitop3_b32 v12, v12, v64, s6 bitop3:96
    ds_read_b128 v[64:67], v4 offset:12288
    s_waitcnt lgkmcnt(3)
    v_mfma_f32_32x32x16_bf16 v[16:31], a[36:39], v[68:71], v[16:31]
    v_bitop3_b32 v12, v12, v68, s6 bitop3:96
    ds_read_b128 v[68:71], v4 offset:13312
    s_waitcnt lgkmcnt(3)
    v_mfma_f32_32x32x16_bf16 v[16:31], a[40:43], v[72:75], v[16:31]
    v_bitop3_b32 v12, v12, v72, s6 bitop3:96
    ds_read_b128 v[72:75], v4 offset:14336
    s_waitcnt lgkmcnt(3)
    v_mfma_f32_32x32x16_bf16 v[16:31], a[44:47], v[76:79], v[16:31]
    v_bitop3_b32 v12, v12, v76, s6 bitop3:96
    ds_read_b128 v[76:79], v4 offset:15360
    s_waitcnt lgkmcnt(3)
    v_mfma_f32_32x32x16_bf16 v[16:31], a[48:51], v[64:67], v[16:31]
    v_bitop3_b32 v12, v12, v64, s6 bitop3:96
    s_waitcnt vmcnt(2)
    s_barrier
    ds_read_b128 v[64:67], v4 offset:16384
    s_waitcnt lgkmcnt(3)
    v_mfma_f32_32x32x16_bf16 v[16:31], a[52:55], v[68:71], v[16:31]
    v_bitop3_b32 v12, v12, v68, s6 bitop3:96
    ds_read_b128 v[68:71], v4 offset:17408
    s_waitcnt lgkmcnt(3)
    v_mfma_f32_32x32x16_bf16 v[16:31], a[56:59], v[72:75], v[16:31]
    v_bitop3_b32 v12, v12, v72, s6 bitop3:96
    ds_read_b128 v[72:75], v4 offset:18432
    s_waitcnt lgkmcnt(3)
    v_mfma_f32_32x32x16_bf16 v[16:31], a[60:63], v[76:79], v[16:31]
    v_bitop3_b32 v12, v12, v76, s6 bitop3:96
    ds_read_b128 v[76:79], v4 offset:19456
    s_waitcnt lgkmcnt(3)
    v_mfma_f32_32x32x16_bf16 v[16:31], a[64:67], v[64:67], v[16:31]
    v_bitop3_b32 v12, v12, v64, s6 bitop3:96
    ds_read_b128 v[64:67], v4 offset:20480
    s_waitcnt lgkmcnt(3)
    v_mfma_f32_32x32x16_bf16 v[16:31], a[68:71], v[68:71], v[16:31]
    v_bitop3_b32 v12, v12, v68, s6 bitop3:96
    ds_read_b128 v[68:71], v4 offset:21504
    s_waitcnt lgkmcnt(3)
    v_mfma_f32_32x32x16_bf16 v[16:31], a[72:75], v[72:75], v[16:31]
    v_bitop3_b32 v12, v12, v72, s6 bitop3:96
    ds_read_b128 v[72:75], v4 offset:22528
    s_waitcnt lgkmcnt(3)
    v_mfma_f32_32x32x16_bf16 v[16:31], a[76:79], v[76:79], v[16:31]
    v_bitop3_b32 v12, v12, v76, s6 bitop3:96
    ds_read_b128 v[76:79], v4 offset:23552
    s_waitcnt lgkmcnt(3)
    v_mfma_f32_32x32x16_bf16 v[16:31], a[80:83], v[64:67], v[16:31]
    v_bitop3_b32 v12, v12, v64, s6 bitop3:96
    s_waitcnt vmcnt(0)
    s_barrier
    ds_read_b128 v[64:67], v4 offset:24576
    s_waitcnt lgkmcnt(3)
    v_mfma_f32_32x32x16_bf16 v[16:31], a[84:87], v[68:71], v[16:31]
    v_bitop3_b32 v12, v12, v68, s6 bitop3:96
    ds_read_b128 v[68:71], v4 offset:25600
    s_waitcnt lgkmcnt(3)
    v_mfma_f32_32x32x16_bf16 v[16:31], a[88:91], v[72:75], v[16:31]
    v_bitop3_b32 v12, v12, v72, s6 bitop3:96
    ds_read_b128 v[72:75], v4 offset:26624
    s_waitcnt lgkmcnt(3)
    v_mfma_f32_32x32x16_bf16 v[16:31], a[92:95], v[76:79], v[16:31]
    v_bitop3_b32 v12, v12, v76, s6 bitop3:96
    ds_read_b128 v[76:79], v4 offset:27648
    s_waitcnt lgkmcnt(3)
    v_mfma_f32_32x32x16_bf16 v[16:31], a[96:99], v[64:67], v[16:31]
    v_bitop3_b32 v12, v12, v64, s6 bitop3:96
    ds_read_b128 v[64:67], v4 offset:28672
    s_waitcnt lgkmcnt(3)
    v_mfma_f32_32x32x16_bf16 v[16:31], a[100:103], v[68:71], v[16:31]
    v_bitop3_b32 v12, v12, v68, s6 bitop3:96
    ds_read_b128 v[68:71], v4 offset:29696
    s_waitcnt lgkmcnt(3)
    v_mfma_f32_32x32x16_bf16 v[16:31], a[104:107], v[72:75], v[16:31]
    v_bitop3_b32 v12, v12, v72, s6 bitop3:96
    ds_read_b128 v[72:75], v4 offset:30720
    s_waitcnt lgkmcnt(3)
    v_mfma_f32_32x32x16_bf16 v[16:31], a[108:111], v[76:79], v[16:31]
    v_bitop3_b32 v12, v12, v76, s6 bitop3:96
    ds_read_b128 v[76:79], v4 offset:31744
    s_waitcnt lgkmcnt(3)
    v_mfma_f32_32x32x16_bf16 v[16:31], a[112:115], v[64:67], v[16:31]
    v_bitop3_b32 v12, v12, v64, s6 bitop3:96
    v_mov_b32 v7, s28
    s_sub_u32 s53, s28, 6
    v_mov_b32 v7, s28
    ds_read_b128 v[64:67], v4 offset:0
    s_waitcnt lgkmcnt(3)
    v_mfma_f32_32x32x16_bf16 v[16:31], a[116:119], v[68:71], v[16:31]
    v_bitop3_b32 v12, v12, v68, s6 bitop3:96
    s_max_i32 s53, s53, 0
    buffer_store_dword v7, v2, s[8:11], s37 offen
    ds_read_b128 v[68:71], v4 offset:1024
    s_waitcnt lgkmcnt(3)
    v_mfma_f32_32x32x16_bf16 v[16:31], a[120:123], v[72:75], v[16:31]
    v_bitop3_b32 v12, v12, v72, s6 bitop3:96
    ds_read_b128 v[72:75], v4 offset:2048
    s_waitcnt lgkmcnt(3)
    v_mfma_f32_32x32x16_bf16 v[16:31], a[124:127], v[76:79], v[16:31]
    v_bitop3_b32 v12, v12, v76, s6 bitop3:96
    buffer_load_dword v3, v1, s[8:11], s33 offen sc1
    ds_read_b128 v[76:79], v4 offset:3072
    s_waitcnt lgkmcnt(3)
    v_mfma_f32_32x32x16_bf16 v[32:47], v[64:67], a[128:131], 0
    v_and_b32 v12, 1, v12
    v_cmp_eq_u32 vcc, 0, v12
    buffer_load_dword v9, v8, s[8:11], s63 offen sc1
    ds_read_b128 v[64:67], v4 offset:4096
    s_waitcnt lgkmcnt(3)
    v_mfma_f32_32x32x16_bf16 v[32:47], v[68:71], a[132:135], v[32:47]
    s_cbranch_vccnz L_redo_108
    ds_read_b128 v[68:71], v4 offset:5120
    s_waitcnt lgkmcnt(3)
    v_mfma_f32_32x32x16_bf16 v[32:47], v[72:75], a[136:139], v[32:47]
    v_cvt_pk_bf16_f32 v88, v16, v17
    v_cvt_pk_bf16_f32 v89, v18, v19
    ds_read_b128 v[72:75], v4 offset:6144
    s_waitcnt lgkmcnt(3)
    v_mfma_f32_32x32x16_bf16 v[32:47], v[76:79], a[140:143], v[32:47]
    v_cvt_pk_bf16_f32 v90, v20, v21
    v_cvt_pk_bf16_f32 v91, v22, v23
    ds_read_b128 v[76:79], v4 offset:7168
    s_waitcnt lgkmcnt(3)
    v_mfma_f32_32x32x16_bf16 v[32:47], v[64:67], a[144:147], v[32:47]
    buffer_store_dwordx4 v[88:91], v5, s[8:11], s30 offen offset:0 sc1
    v_cvt_pk_bf16_f32 v92, v24, v25
    ds_read_b128 v[64:67], v4 offset:8192
    s_waitcnt lgkmcnt(3)
    v_mfma_f32_32x32x16_bf16 v[32:47], v[68:71], a[148:151], v[32:47]
    v_cvt_pk_bf16_f32 v93, v26, v27
    v_cvt_pk_bf16_f32 v94, v28, v29
    ds_read_b128 v[68:71], v4 offset:9216
    s_waitcnt lgkmcnt(3)
    v_mfma_f32_32x32x16_bf16 v[32:47], v[72:75], a[152:155], v[32:47]
    v_cvt_pk_bf16_f32 v95, v30, v31
    buffer_store_dwordx4 v[92:95], v5, s[8:11], s30 offen offset:512 sc1
    ds_read_b128 v[72:75], v4 offset:10240
    s_waitcnt lgkmcnt(3)
    v_mfma_f32_32x32x16_bf16 v[32:47], v[76:79], a[156:159], v[32:47]
    ds_read_b128 v[76:79], v4 offset:11264
    s_waitcnt lgkmcnt(3)
    v_mfma_f32_32x32x16_bf16 v[32:47], v[64:67], a[160:163], v[32:47]
    ds_read_b128 v[64:67], v4 offset:12288
    s_waitcnt lgkmcnt(3)
    v_mfma_f32_32x32x16_bf16 v[32:47], v[68:71], a[164:167], v[32:47]
    ds_read_b128 v[68:71], v4 offset:13312
    s_waitcnt lgkmcnt(3)
    v_mfma_f32_32x32x16_bf16 v[32:47], v[72:75], a[168:171], v[32:47]
    ds_read_b128 v[72:75], v4 offset:14336
    s_waitcnt lgkmcnt(3)
    v_mfma_f32_32x32x16_bf16 v[32:47], v[76:79], a[172:175], v[32:47]
    ds_read_b128 v[76:79], v4 offset:15360
    s_waitcnt lgkmcnt(3)
    v_mfma_f32_32x32x16_bf16 v[32:47], v[64:67], a[176:179], v[32:47]
    ds_read_b128 v[64:67], v4 offset:16384
    s_waitcnt lgkmcnt(3)
    v_mfma_f32_32x32x16_bf16 v[32:47], v[68:71], a[180:183], v[32:47]
    ds_read_b128 v[68:71], v4 offset:17408
    s_waitcnt lgkmcnt(3)
    v_mfma_f32_32x32x16_bf16 v[32:47], v[72:75], a[184:187], v[32:47]
    ds_read_b128 v[72:75], v4 offset:18432
    s_waitcnt lgkmcnt(3)
    v_mfma_f32_32x32x16_bf16 v[32:47], v[76:79], a[188:191], v[32:47]
    ds_read_b128 v[76:79], v4 offset:19456
    s_waitcnt lgkmcnt(3)
    v_mfma_f32_32x32x16_bf16 v[32:47], v[64:67], a[192:195], v[32:47]
    ds_read_b128 v[64:67], v4 offset:20480
    s_waitcnt lgkmcnt(3)
    v_mfma_f32_32x32x16_bf16 v[32:47], v[68:71], a[196:199], v[32:47]
    s_and_b32 s43, s36, 63
    s_mul_i32 s43, s43, 32768
    ds_read_b128 v[68:71], v4 offset:21504
    s_waitcnt lgkmcnt(3)
    v_mfma_f32_32x32x16_bf16 v[32:47], v[72:75], a[200:203], v[32:47]
    s_add_u32 s46, s43, s48
    s_add_u32 s47, s43, s49
    ds_read_b128 v[72:75], v4 offset:22528
    s_waitcnt lgkmcnt(3)
    v_mfma_f32_32x32x16_bf16 v[32:47], v[76:79], a[204:207], v[32:47]
    s_add_u32 s36, s36, 1
    s_sub_u32 s44, s44, s35
    ds_read_b128 v[76:79], v4 offset:23552
    s_waitcnt lgkmcnt(3)
    v_mfma_f32_32x32x16_bf16 v[32:47], v[64:67], a[208:211], v[32:47]
    s_sub_u32 s45, s45, s35
    s_sub_u32 s35, 32768, s35
    ds_read_b128 v[64:67], v4 offset:24576
    s_waitcnt lgkmcnt(3)
    v_mfma_f32_32x32x16_bf16 v[32:47], v[68:71], a[212:215], v[32:47]
    s_add_u32 s44, s44, s35
    s_add_u32 s45, s45, s35
    ds_read_b128 v[68:71], v4 offset:25600
    s_waitcnt lgkmcnt(3)
    v_mfma_f32_32x32x16_bf16 v[32:47], v[72:75], a[216:219], v[32:47]
    s_waitcnt vmcnt(2)
    v_cmp_gt_u32 vcc, s36, v3
    v_cmp_gt_u32 s[54:55], s53, v9
L_mid_109:
    ds_read_b128 v[72:75], v4 offset:26624
    s_waitcnt lgkmcnt(3)
    v_mfma_f32_32x32x16_bf16 v[32:47], v[76:79], a[220:223], v[32:47]
    s_or_b64 vcc, vcc, s[54:55]
    s_cbranch_scc1 L_tail0_110
    ds_read_b128 v[76:79], v4 offset:27648
    s_waitcnt lgkmcnt(3)
    v_mfma_f32_32x32x16_bf16 v[32:47], v[64:67], a[224:227], v[32:47]
    s_add_u32 m0, s44, 0
    s_add_u32 s42, s46, 0
    buffer_load_dwordx4 v0, s[8:11], s42 offen offset:0 sc1  lds
    ds_read_b128 v[64:67], v4 offset:28672
    s_waitcnt lgkmcnt(3)
    v_mfma_f32_32x32x16_bf16 v[32:47], v[68:71], a[228:231], v[32:47]
    ds_read_b128 v[68:71], v4 offset:29696
    s_waitcnt lgkmcnt(3)
    v_mfma_f32_32x32x16_bf16 v[32:47], v[72:75], a[232:235], v[32:47]
    buffer_load_dwordx4 v0, s[8:11], s42 offen offset:1024 sc1  lds
    ds_read_b128 v[72:75], v4 offset:30720
    s_waitcnt lgkmcnt(3)
    v_mfma_f32_32x32x16_bf16 v[32:47], v[76:79], a[236:239], v[32:47]
    s_add_u32 m0, s44, 8192
    s_add_u32 s42, s46, 8192
    ds_read_b128 v[76:79], v4 offset:31744
    s_waitcnt lgkmcnt(3)
    v_mfma_f32_32x32x16_bf16 v[32:47], v[64:67], a[240:243], v[32:47]
    buffer_load_dwordx4 v0, s[8:11], s42 offen offset:0 sc1  lds
    ds_read_b128 v[64:67], v4 offset:0
    s_waitcnt lgkmcnt(3)
    v_mfma_f32_32x32x16_bf16 v[32:47], v[68:71], a[244:247], v[32:47]
    ds_read_b128 v[68:71], v4 offset:1024
    s_waitcnt lgkmcnt(3)
    v_mfma_f32_32x32x16_bf16 v[32:47], v[72:75], a[248:251], v[32:47]
    buffer_load_dwordx4 v0, s[8:11], s42 offen offset:1024 sc1  lds
    ds_read_b128 v[72:75], v4 offset:2048
    s_waitcnt lgkmcnt(3)
    v_mfma_f32_32x32x16_bf16 v[32:47], v[76:79], a[252:255], v[32:47]
    s_add_u32 m0, s44, 16384
    s_add_u32 s42, s46, 16384
    ds_read_b128 v[76:79], v4 offset:3072
    s_waitcnt lgkmcnt(3)
    v_mfma_f32_32x32x16_bf16 v[48:63], v[128:131], v[64:67], 0
    buffer_load_dwordx4 v0, s[8:11], s42 offen offset:0 sc1  lds
    ds_read_b128 v[64:67], v4 offset:4096
    s_waitcnt lgkmcnt(3)
    v_mfma_f32_32x32x16_bf16 v[48:63], v[132:135], v[68:71], v[48:63]
    ds_read_b128 v[68:71], v4 offset:5120
    s_waitcnt lgkmcnt(3)
    v_mfma_f32_32x32x16_bf16 v[48:63], v[136:139], v[72:75], v[48:63]
    v_cvt_pk_bf16_f32 v88, v32, v33
    v_cvt_pk_bf16_f32 v89, v34, v35
    buffer_load_dwordx4 v0, s[8:11], s42 offen offset:1024 sc1  lds
    ds_read_b128 v[72:75], v4 offset:6144
    s_waitcnt lgkmcnt(3)
    v_mfma_f32_32x32x16_bf16 v[48:63], v[140:143], v[76:79], v[48:63]
    v_cvt_pk_bf16_f32 v90, v40, v41
    v_cvt_pk_bf16_f32 v91, v42, v43
    s_add_u32 m0, s44, 24576
    s_add_u32 s42, s46, 24576
    ds_read_b128 v[76:79], v4 offset:7168
    s_waitcnt lgkmcnt(3)
    v_mfma_f32_32x32x16_bf16 v[48:63], v[144:147], v[64:67], v[48:63]
    buffer_store_dwordx4 v[88:91], v6, s[8:11], s31 offen offset:0 sc1
    v_cvt_pk_bf16_f32 v92, v36, v37
    buffer_load_dwordx4 v0, s[8:11], s42 offen offset:0 sc1  lds
    ds_read_b128 v[64:67], v4 offset:8192
    s_waitcnt lgkmcnt(3)
    v_mfma_f32_32x32x16_bf16 v[48:63], v[148:151], v[68:71], v[48:63]
    v_cvt_pk_bf16_f32 v93, v38, v39
    v_cvt_pk_bf16_f32 v94, v44, v45
    ds_read_b128 v[68:71], v4 offset:9216
    s_waitcnt lgkmcnt(3)
    v_mfma_f32_32x32x16_bf16 v[48:63], v[152:155], v[72:75], v[48:63]
    v_cvt_pk_bf16_f32 v95, v46, v47
    buffer_store_dwordx4 v[92:95], v6, s[8:11], s31 offen offset:512 sc1
    buffer_load_dwordx4 v0, s[8:11], s42 offen offset:1024 sc1  lds
    ds_read_b128 v[72:75], v4 offset:10240
    s_waitcnt lgkmcnt(3)
    v_mfma_f32_32x32x16_bf16 v[48:63], v[156:159], v[76:79], v[48:63]
    ds_read_b128 v[76:79], v4 offset:11264
    s_waitcnt lgkmcnt(3)
    v_mfma_f32_32x32x16_bf16 v[48:63], v[160:163], v[64:67], v[48:63]
    ds_read_b128 v[64:67], v4 offset:12288
    s_waitcnt lgkmcnt(3)
    v_mfma_f32_32x32x16_bf16 v[48:63], v[164:167], v[68:71], v[48:63]
    v_add_u32 v11, 1, v7
    ds_read_b128 v[68:71], v4 offset:13312
    s_waitcnt lgkmcnt(3)
    v_mfma_f32_32x32x16_bf16 v[48:63], v[168:171], v[72:75], v[48:63]
    s_waitcnt vmcnt(10)
    buffer_store_dword v11, v2, s[8:11], s34 offen sc1
    ds_read_b128 v[72:75], v4 offset:14336
    s_waitcnt lgkmcnt(3)
    v_mfma_f32_32x32x16_bf16 v[48:63], v[172:175], v[76:79], v[48:63]
    ds_read_b128 v[76:79], v4 offset:15360
    s_waitcnt lgkmcnt(3)
    v_mfma_f32_32x32x16_bf16 v[48:63], v[176:179], v[64:67], v[48:63]
    ds_read_b128 v[64:67], v4 offset:16384
    s_waitcnt lgkmcnt(3)
    v_mfma_f32_32x32x16_bf16 v[48:63], v[180:183], v[68:71], v[48:63]
    ds_read_b128 v[68:71], v4 offset:17408
    s_waitcnt lgkmcnt(3)
    v_mfma_f32_32x32x16_bf16 v[48:63], v[184:187], v[72:75], v[48:63]
    ds_read_b128 v[72:75], v4 offset:18432
    s_waitcnt lgkmcnt(3)
    v_mfma_f32_32x32x16_bf16 v[48:63], v[188:191], v[76:79], v[48:63]
    ds_read_b128 v[76:79], v4 offset:19456
    s_waitcnt lgkmcnt(3)
    v_mfma_f32_32x32x16_bf16 v[48:63], v[192:195], v[64:67], v[48:63]
    ds_read_b128 v[64:67], v4 offset:20480
    s_waitcnt lgkmcnt(3)
    v_mfma_f32_32x32x16_bf16 v[48:63], v[196:199], v[68:71], v[48:63]
    ds_read_b128 v[68:71], v4 offset:21504
    s_waitcnt lgkmcnt(3)
    v_mfma_f32_32x32x16_bf16 v[48:63], v[200:203], v[72:75], v[48:63]
    ds_read_b128 v[72:75], v4 offset:22528
    s_waitcnt lgkmcnt(3)
    v_mfma_f32_32x32x16_bf16 v[48:63], v[204:207], v[76:79], v[48:63]
    ds_read_b128 v[76:79], v4 offset:23552
    s_waitcnt lgkmcnt(3)
    v_mfma_f32_32x32x16_bf16 v[48:63], v[208:211], v[64:67], v[48:63]
    ds_read_b128 v[64:67], v4 offset:24576
    s_waitcnt lgkmcnt(3)
    v_mfma_f32_32x32x16_bf16 v[48:63], v[212:215], v[68:71], v[48:63]
    ds_read_b128 v[68:71], v4 offset:25600
    s_waitcnt lgkmcnt(3)
    v_mfma_f32_32x32x16_bf16 v[48:63], v[216:219], v[72:75], v[48:63]
    ds_read_b128 v[72:75], v4 offset:26624
    s_waitcnt lgkmcnt(3)
    v_mfma_f32_32x32x16_bf16 v[48:63], v[220:223], v[76:79], v[48:63]
    ds_read_b128 v[76:79], v4 offset:27648
    s_waitcnt lgkmcnt(3)
    v_mfma_f32_32x32x16_bf16 v[48:63], v[224:227], v[64:67], v[48:63]
    ds_read_b128 v[64:67], v4 offset:28672
    s_waitcnt lgkmcnt(3)
    v_mfma_f32_32x32x16_bf16 v[48:63], v[228:231], v[68:71], v[48:63]
    ds_read_b128 v[68:71], v4 offset:29696
    s_waitcnt lgkmcnt(3)
    v_mfma_f32_32x32x16_bf16 v[48:63], v[232:235], v[72:75], v[48:63]
    ds_read_b128 v[72:75], v4 offset:30720
    s_waitcnt lgkmcnt(3)
    v_mfma_f32_32x32x16_bf16 v[48:63], v[236:239], v[76:79], v[48:63]
    ds_read_b128 v[76:79], v4 offset:31744
    s_waitcnt lgkmcnt(3)
    v_mfma_f32_32x32x16_bf16 v[48:63], v[240:243], v[64:67], v[48:63]
    v_add_u32 v4, s35, v0
    s_waitcnt vmcnt(9)
    s_barrier
    ds_read_b128 v[64:67], v4 offset:0
    s_waitcnt lgkmcnt(3)
    v_mfma_f32_32x32x16_bf16 v[48:63], v[244:247], v[68:71], v[48:63]
    ds_read_b128 v[68:71], v4 offset:1024
    s_waitcnt lgkmcnt(3)
    v_mfma_f32_32x32x16_bf16 v[48:63], v[248:251], v[72:75], v[48:63]
    ds_read_b128 v[72:75], v4 offset:2048
    s_waitcnt lgkmcnt(3)
    v_mfma_f32_32x32x16_bf16 v[48:63], v[252:255], v[76:79], v[48:63]
    s_add_u32 s28, s28, 1
    s_mov_b32 s6, 0
    ds_read_b128 v[76:79], v4 offset:3072
    s_waitcnt lgkmcnt(3)
    v_mfma_f32_32x32x16_bf16 v[16:31], a[0:3], v[64:67], 0
    v_xor_b32 v12, s6, v64
    v_mov_b32 v7, s28
    ds_read_b128 v[64:67], v4 offset:4096
    s_waitcnt lgkmcnt(3)
    v_mfma_f32_32x32x16_bf16 v[16:31], a[4:7], v[68:71], v[16:31]
    v_bitop3_b32 v12, v12, v68, s6 bitop3:96
    ds_read_b128 v[68:71], v4 offset:5120
    s_waitcnt lgkmcnt(3)
    v_mfma_f32_32x32x16_bf16 v[16:31], a[8:11], v[72:75], v[16:31]
    v_bitop3_b32 v12, v12, v72, s6 bitop3:96
    v_cvt_pk_bf16_f32 v88, v48, v49
    v_cvt_pk_bf16_f32 v89, v50, v51
    ds_read_b128 v[72:75], v4 offset:6144
    s_waitcnt lgkmcnt(3)
    v_mfma_f32_32x32x16_bf16 v[16:31], a[12:15], v[76:79], v[16:31]
    v_bitop3_b32 v12, v12, v76, s6 bitop3:96
    v_cvt_pk_bf16_f32 v90, v52, v53
    v_cvt_pk_bf16_f32 v91, v54, v55
    ds_read_b128 v[76:79], v4 offset:7168
    s_waitcnt lgkmcnt(3)
    v_mfma_f32_32x32x16_bf16 v[16:31], a[16:19], v[64:67], v[16:31]
    v_bitop3_b32 v12, v12, v64, s6 bitop3:96
    buffer_store_dwordx4 v[88:91], v5, s[8:11], s32 offen offset:0
    v_cvt_pk_bf16_f32 v92, v56, v57
    s_waitcnt vmcnt(8)
    s_barrier
    ds_read_b128 v[64:67], v4 offset:8192
    s_waitcnt lgkmcnt(3)
    v_mfma_f32_32x32x16_bf16 v[16:31], a[20:23], v[68:71], v[16:31]
    v_bitop3_b32 v12, v12, v68, s6 bitop3:96
    v_cvt_pk_bf16_f32 v93, v58, v59
    v_cvt_pk_bf16_f32 v94, v60, v61
    ds_read_b128 v[68:71], v4 offset:9216
    s_waitcnt lgkmcnt(3)
    v_mfma_f32_32x32x16_bf16 v[16:31], a[24:27], v[72:75], v[16:31]
    v_bitop3_b32 v12, v12, v72, s6 bitop3:96
    v_cvt_pk_bf16_f32 v95, v62, v63
    buffer_store_dwordx4 v[92:95], v5, s[8:11], s32 offen offset:512
    ds_read_b128 v[72:75], v4 offset:10240
    s_waitcnt lgkmcnt(3)
    v_mfma_f32_32x32x16_bf16 v[16:31], a[28:31], v[76:79], v[16:31]
    v_bitop3_b32 v12, v12, v76, s6 bitop3:96
    ds_read_b128 v[76:79], v4 offset:11264
    s_waitcnt lgkmcnt(3)
    v_mfma_f32_32x32x16_bf16 v[16:31], a[32:35], v[64:67], v[16:31]
    v_bitop3_b32 v12, v12, v64, s6 bitop3:96
    s_waitcnt vmcnt(4)
    v_add_u32 v11, 1, v7
    buffer_store_dword v11, v2, s[8:11], s34 offen offset:16 sc1
    ds_read_b128 v[64:67], v4 offset:12288
    s_waitcnt lgkmcnt(3)
    v_mfma_f32_32x32x16_bf16 v[16:31], a[36:39], v[68:71], v[16:31]
    v_bitop3_b32 v12, v12, v68, s6 bitop3:96
    ds_read_b128 v[68:71], v4 offset:13312
    s_waitcnt lgkmcnt(3)
    v_mfma_f32_32x32x16_bf16 v[16:31], a[40:43], v[72:75], v[16:31]
    v_bitop3_b32 v12, v12, v72, s6 bitop3:96
    s_and_b32 s43, s28, 7
    s_mul_i32 s32, s43, 262144
    ds_read_b128 v[72:75], v4 offset:14336
    s_waitcnt lgkmcnt(3)
    v_mfma_f32_32x32x16_bf16 v[16:31], a[44:47], v[76:79], v[16:31]
    v_bitop3_b32 v12, v12, v76, s6 bitop3:96
    s_add_u32 s32, s32, s62
    s_mul_i32 s30, s43, 524288
    ds_read_b128 v[76:79], v4 offset:15360
    s_waitcnt lgkmcnt(3)
    v_mfma_f32_32x32x16_bf16 v[16:31], a[48:51], v[64:67], v[16:31]
    v_bitop3_b32 v12, v12, v64, s6 bitop3:96
    s_add_u32 s30, s30, s60
    s_mul_i32 s31, s43, 524288
    s_barrier
    ds_read_b128 v[64:67], v4 offset:16384
    s_waitcnt lgkmcnt(3)
    v_mfma_f32_32x32x16_bf16 v[16:31], a[52:55], v[68:71], v[16:31]
    v_bitop3_b32 v12, v12, v68, s6 bitop3:96
    s_add_u32 s31, s31, s61
    ds_read_b128 v[68:71], v4 offset:17408
    s_waitcnt lgkmcnt(3)
    v_mfma_f32_32x32x16_bf16 v[16:31], a[56:59], v[72:75], v[16:31]
    v_bitop3_b32 v12, v12, v72, s6 bitop3:96
    ds_read_b128 v[72:75], v4 offset:18432
    s_waitcnt lgkmcnt(3)
    v_mfma_f32_32x32x16_bf16 v[16:31], a[60:63], v[76:79], v[16:31]
    v_bitop3_b32 v12, v12, v76, s6 bitop3:96
    ds_read_b128 v[76:79], v4 offset:19456
    s_waitcnt lgkmcnt(3)
    v_mfma_f32_32x32x16_bf16 v[16:31], a[64:67], v[64:67], v[16:31]
    v_bitop3_b32 v12, v12, v64, s6 bitop3:96
    ds_read_b128 v[64:67], v4 offset:20480
    s_waitcnt lgkmcnt(3)
    v_mfma_f32_32x32x16_bf16 v[16:31], a[68:71], v[68:71], v[16:31]
    v_bitop3_b32 v12, v12, v68, s6 bitop3:96
    ds_read_b128 v[68:71], v4 offset:21504
    s_waitcnt lgkmcnt(3)
    v_mfma_f32_32x32x16_bf16 v[16:31], a[72:75], v[72:75], v[16:31]
    v_bitop3_b32 v12, v12, v72, s6 bitop3:96
    ds_read_b128 v[72:75], v4 offset:22528
    s_waitcnt lgkmcnt(3)
    v_mfma_f32_32x32x16_bf16 v[16:31], a[76:79], v[76:79], v[16:31]
    v_bitop3_b32 v12, v12, v76, s6 bitop3:96
    ds_read_b128 v[76:79], v4 offset:23552
    s_waitcnt lgkmcnt(3)
    v_mfma_f32_32x32x16_bf16 v[16:31], a[80:83], v[64:67], v[16:31]
    v_bitop3_b32 v12, v12, v64, s6 bitop3:96
    s_waitcnt vmcnt(4)
    s_barrier
    ds_read_b128 v[64:67], v4 offset:24576
    s_waitcnt lgkmcnt(3)
    v_mfma_f32_32x32x16_bf16 v[16:31], a[84:87], v[68:71], v[16:31]
    v_bitop3_b32 v12, v12, v68, s6 bitop3:96
    ds_read_b128 v[68:71], v4 offset:25600
    s_waitcnt lgkmcnt(3)
    v_mfma_f32_32x32x16_bf16 v[16:31], a[88:91], v[72:75], v[16:31]
    v_bitop3_b32 v12, v12, v72, s6 bitop3:96
    ds_read_b128 v[72:75], v4 offset:26624
    s_waitcnt lgkmcnt(3)
    v_mfma_f32_32x32x16_bf16 v[16:31], a[92:95], v[76:79], v[16:31]
    v_bitop3_b32 v12, v12, v76, s6 bitop3:96
    ds_read_b128 v[76:79], v4 offset:27648
    s_waitcnt lgkmcnt(3)
    v_mfma_f32_32x32x16_bf16 v[16:31], a[96:99], v[64:67], v[16:31]
    v_bitop3_b32 v12, v12, v64, s6 bitop3:96
    ds_read_b128 v[64:67], v4 offset:28672
    s_waitcnt lgkmcnt(3)
    v_mfma_f32_32x32x16_bf16 v[16:31], a[100:103], v[68:71], v[16:31]
    v_bitop3_b32 v12, v12, v68, s6 bitop3:96
    ds_read_b128 v[68:71], v4 offset:29696
    s_waitcnt lgkmcnt(3)
    v_mfma_f32_32x32x16_bf16 v[16:31], a[104:107], v[72:75], v[16:31]
    v_bitop3_b32 v12, v12, v72, s6 bitop3:96
    ds_read_b128 v[72:75], v4 offset:30720
    s_waitcnt lgkmcnt(3)
    v_mfma_f32_32x32x16_bf16 v[16:31], a[108:111], v[76:79], v[16:31]
    v_bitop3_b32 v12, v12, v76, s6 bitop3:96
    ds_read_b128 v[76:79], v4 offset:31744
    s_waitcnt lgkmcnt(3)
    v_mfma_f32_32x32x16_bf16 v[16:31], a[112:115], v[64:67], v[16:31]
    v_bitop3_b32 v12, v12, v64, s6 bitop3:96
    v_mov_b32 v7, s28
    s_sub_u32 s53, s28, 6
    v_mov_b32 v7, s28
    ds_read_b128 v[64:67], v4 offset:0
    s_waitcnt lgkmcnt(3)
    v_mfma_f32_32x32x16_bf16 v[16:31], a[116:119], v[68:71], v[16:31]
    v_bitop3_b32 v12, v12, v68, s6 bitop3:96
    s_max_i32 s53, s53, 0
    s_waitcnt vmcnt(1)
    buffer_store_dword v7, v2, s[8:11], s37 offen
    ds_read_b128 v[68:71], v4 offset:1024
    s_waitcnt lgkmcnt(3)
    v_mfma_f32_32x32x16_bf16 v[16:31], a[120:123], v[72:75], v[16:31]
    v_bitop3_b32 v12, v12, v72, s6 bitop3:96
    ds_read_b128 v[72:75], v4 offset:2048
    s_waitcnt lgkmcnt(3)
    v_mfma_f32_32x32x16_bf16 v[16:31], a[124:127], v[76:79], v[16:31]
    v_bitop3_b32 v12, v12, v76, s6 bitop3:96
    buffer_load_dword v3, v1, s[8:11], s33 offen sc1
    ds_read_b128 v[76:79], v4 offset:3072
    s_waitcnt lgkmcnt(3)
    v_mfma_f32_32x32x16_bf16 v[32:47], v[64:67], a[128:131], 0
    v_and_b32 v12, 1, v12
    v_cmp_eq_u32 vcc, 0, v12
    buffer_load_dword v9, v8, s[8:11], s63 offen sc1
    ds_read_b128 v[64:67], v4 offset:4096
    s_waitcnt lgkmcnt(3)
    v_mfma_f32_32x32x16_bf16 v[32:47], v[68:71], a[132:135], v[32:47]
    s_cbranch_vccnz L_redo_108
    ds_read_b128 v[68:71], v4 offset:5120
    s_waitcnt lgkmcnt(3)
    v_mfma_f32_32x32x16_bf16 v[32:47], v[72:75], a[136:139], v[32:47]
    v_cvt_pk_bf16_f32 v88, v16, v17
    v_cvt_pk_bf16_f32 v89, v18, v19
    ds_read_b128 v[72:75], v4 offset:6144
    s_waitcnt lgkmcnt(3)
    v_mfma_f32_32x32x16_bf16 v[32:47], v[76:79], a[140:143], v[32:47]
    v_cvt_pk_bf16_f32 v90, v20, v21
    v_cvt_pk_bf16_f32 v91, v22, v23
    ds_read_b128 v[76:79], v4 offset:7168
    s_waitcnt lgkmcnt(3)
    v_mfma_f32_32x32x16_bf16 v[32:47], v[64:67], a[144:147], v[32:47]
    buffer_store_dwordx4 v[88:91], v5, s[8:11], s30 offen offset:0 sc1
    v_cvt_pk_bf16_f32 v92, v24, v25
    ds_read_b128 v[64:67], v4 offset:8192
    s_waitcnt lgkmcnt(3)
    v_mfma_f32_32x32x16_bf16 v[32:47], v[68:71], a[148:151], v[32:47]
    v_cvt_pk_bf16_f32 v93, v26, v27
    v_cvt_pk_bf16_f32 v94, v28, v29
    ds_read_b128 v[68:71], v4 offset:9216
    s_waitcnt lgkmcnt(3)
    v_mfma_f32_32x32x16_bf16 v[32:47], v[72:75], a[152:155], v[32:47]
    v_cvt_pk_bf16_f32 v95, v30, v31
    buffer_store_dwordx4 v[92:95], v5, s[8:11], s30 offen offset:512 sc1
    ds_read_b128 v[72:75], v4 offset:10240
    s_waitcnt lgkmcnt(3)
    v_mfma_f32_32x32x16_bf16 v[32:47], v[76:79], a[156:159], v[32:47]
    ds_read_b128 v[76:79], v4 offset:11264
    s_waitcnt lgkmcnt(3)
    v_mfma_f32_32x32x16_bf16 v[32:47], v[64:67], a[160:163], v[32:47]
    ds_read_b128 v[64:67], v4 offset:12288
    s_waitcnt lgkmcnt(3)
    v_mfma_f32_32x32x16_bf16 v[32:47], v[68:71], a[164:167], v[32:47]
    ds_read_b128 v[68:71], v4 offset:13312
    s_waitcnt lgkmcnt(3)
    v_mfma_f32_32x32x16_bf16 v[32:47], v[72:75], a[168:171], v[32:47]
    ds_read_b128 v[72:75], v4 offset:14336
    s_waitcnt lgkmcnt(3)
    v_mfma_f32_32x32x16_bf16 v[32:47], v[76:79], a[172:175], v[32:47]
    ds_read_b128 v[76:79], v4 offset:15360
    s_waitcnt lgkmcnt(3)
    v_mfma_f32_32x32x16_bf16 v[32:47], v[64:67], a[176:179], v[32:47]
    ds_read_b128 v[64:67], v4 offset:16384
    s_waitcnt lgkmcnt(3)
    v_mfma_f32_32x32x16_bf16 v[32:47], v[68:71], a[180:183], v[32:47]
    ds_read_b128 v[68:71], v4 offset:17408
    s_waitcnt lgkmcnt(3)
    v_mfma_f32_32x32x16_bf16 v[32:47], v[72:75], a[184:187], v[32:47]
    ds_read_b128 v[72:75], v4 offset:18432
    s_waitcnt lgkmcnt(3)
    v_mfma_f32_32x32x16_bf16 v[32:47], v[76:79], a[188:191], v[32:47]
    ds_read_b128 v[76:79], v4 offset:19456
    s_waitcnt lgkmcnt(3)
    v_mfma_f32_32x32x16_bf16 v[32:47], v[64:67], a[192:195], v[32:47]
    ds_read_b128 v[64:67], v4 offset:20480
    s_waitcnt lgkmcnt(3)
    v_mfma_f32_32x32x16_bf16 v[32:47], v[68:71], a[196:199], v[32:47]
    s_and_b32 s43, s36, 63
    s_mul_i32 s43, s43, 32768
    ds_read_b128 v[68:71], v4 offset:21504
    s_waitcnt lgkmcnt(3)
    v_mfma_f32_32x32x16_bf16 v[32:47], v[72:75], a[200:203], v[32:47]
    s_add_u32 s46, s43, s48
    s_add_u32 s47, s43, s49
    ds_read_b128 v[72:75], v4 offset:22528
    s_waitcnt lgkmcnt(3)
    v_mfma_f32_32x32x16_bf16 v[32:47], v[76:79], a[204:207], v[32:47]
    s_add_u32 s36, s36, 1
    s_sub_u32 s44, s44, s35
    ds_read_b128 v[76:79], v4 offset:23552
    s_waitcnt lgkmcnt(3)
    v_mfma_f32_32x32x16_bf16 v[32:47], v[64:67], a[208:211], v[32:47]
    s_sub_u32 s45, s45, s35
    s_sub_u32 s35, 32768, s35
    ds_read_b128 v[64:67], v4 offset:24576
    s_waitcnt lgkmcnt(3)
    v_mfma_f32_32x32x16_bf16 v[32:47], v[68:71], a[212:215], v[32:47]
    s_add_u32 s44, s44, s35
    s_add_u32 s45, s45, s35
    ds_read_b128 v[68:71], v4 offset:25600
    s_waitcnt lgkmcnt(3)
    v_mfma_f32_32x32x16_bf16 v[32:47], v[72:75], a[216:219], v[32:47]
    s_waitcnt vmcnt(2)
    v_cmp_gt_u32 vcc, s36, v3
    v_cmp_gt_u32 s[54:55], s53, v9
    s_branch L_mid_109
L_tail0_110:
    ds_read_b128 v[76:79], v4 offset:27648
    s_waitcnt lgkmcnt(3)
    v_mfma_f32_32x32x16_bf16 v[32:47], v[64:67], a[224:227], v[32:47]
    ds_read_b128 v[64:67], v4 offset:28672
    s_waitcnt lgkmcnt(3)
    v_mfma_f32_32x32x16_bf16 v[32:47], v[68:71], a[228:231], v[32:47]
    ds_read_b128 v[68:71], v4 offset:29696
    s_waitcnt lgkmcnt(3)
    v_mfma_f32_32x32x16_bf16 v[32:47], v[72:75], a[232:235], v[32:47]
    ds_read_b128 v[72:75], v4 offset:30720
    s_waitcnt lgkmcnt(3)
    v_mfma_f32_32x32x16_bf16 v[32:47], v[76:79], a[236:239], v[32:47]
    ds_read_b128 v[76:79], v4 offset:31744
    s_waitcnt lgkmcnt(3)
    v_mfma_f32_32x32x16_bf16 v[32:47], v[64:67], a[240:243], v[32:47]
    ds_read_b128 v[64:67], v4 offset:0
    s_waitcnt lgkmcnt(3)
    v_mfma_f32_32x32x16_bf16 v[32:47], v[68:71], a[244:247], v[32:47]
    ds_read_b128 v[68:71], v4 offset:1024
    s_waitcnt lgkmcnt(3)
    v_mfma_f32_32x32x16_bf16 v[32:47], v[72:75], a[248:251], v[32:47]
    ds_read_b128 v[72:75], v4 offset:2048
    s_waitcnt lgkmcnt(3)
    v_mfma_f32_32x32x16_bf16 v[32:47], v[76:79], a[252:255], v[32:47]
    ds_read_b128 v[76:79], v4 offset:3072
    s_waitcnt lgkmcnt(3)
    v_mfma_f32_32x32x16_bf16 v[48:63], v[128:131], v[64:67], 0
    ds_read_b128 v[64:67], v4 offset:4096
    s_waitcnt lgkmcnt(3)
    v_mfma_f32_32x32x16_bf16 v[48:63], v[132:135], v[68:71], v[48:63]
    ds_read_b128 v[68:71], v4 offset:5120
    s_waitcnt lgkmcnt(3)
    v_mfma_f32_32x32x16_bf16 v[48:63], v[136:139], v[72:75], v[48:63]
    v_cvt_pk_bf16_f32 v88, v32, v33
    v_cvt_pk_bf16_f32 v89, v34, v35
    ds_read_b128 v[72:75], v4 offset:6144
    s_waitcnt lgkmcnt(3)
    v_mfma_f32_32x32x16_bf16 v[48:63], v[140:143], v[76:79], v[48:63]
    v_cvt_pk_bf16_f32 v90, v40, v41
    v_cvt_pk_bf16_f32 v91, v42, v43
    ds_read_b128 v[76:79], v4 offset:7168
    s_waitcnt lgkmcnt(3)
    v_mfma_f32_32x32x16_bf16 v[48:63], v[144:147], v[64:67], v[48:63]
    buffer_store_dwordx4 v[88:91], v6, s[8:11], s31 offen offset:0 sc1
    v_cvt_pk_bf16_f32 v92, v36, v37
    ds_read_b128 v[64:67], v4 offset:8192
    s_waitcnt lgkmcnt(3)
    v_mfma_f32_32x32x16_bf16 v[48:63], v[148:151], v[68:71], v[48:63]
    v_cvt_pk_bf16_f32 v93, v38, v39
    v_cvt_pk_bf16_f32 v94, v44, v45
    ds_read_b128 v[68:71], v4 offset:9216
    s_waitcnt lgkmcnt(3)
    v_mfma_f32_32x32x16_bf16 v[48:63], v[152:155], v[72:75], v[48:63]
    v_cvt_pk_bf16_f32 v95, v46, v47
    buffer_store_dwordx4 v[92:95], v6, s[8:11], s31 offen offset:512 sc1
    ds_read_b128 v[72:75], v4 offset:10240
    s_waitcnt lgkmcnt(3)
    v_mfma_f32_32x32x16_bf16 v[48:63], v[156:159], v[76:79], v[48:63]
    ds_read_b128 v[76:79], v4 offset:11264
    s_waitcnt lgkmcnt(3)
    v_mfma_f32_32x32x16_bf16 v[48:63], v[160:163], v[64:67], v[48:63]
    ds_read_b128 v[64:67], v4 offset:12288
    s_waitcnt lgkmcnt(3)
    v_mfma_f32_32x32x16_bf16 v[48:63], v[164:167], v[68:71], v[48:63]
    v_add_u32 v11, 1, v7
    ds_read_b128 v[68:71], v4 offset:13312
    s_waitcnt lgkmcnt(3)
    v_mfma_f32_32x32x16_bf16 v[48:63], v[168:171], v[72:75], v[48:63]
    s_waitcnt vmcnt(2)
    buffer_store_dword v11, v2, s[8:11], s34 offen sc1
    ds_read_b128 v[72:75], v4 offset:14336
    s_waitcnt lgkmcnt(3)
    v_mfma_f32_32x32x16_bf16 v[48:63], v[172:175], v[76:79], v[48:63]
    ds_read_b128 v[76:79], v4 offset:15360
    s_waitcnt lgkmcnt(3)
    v_mfma_f32_32x32x16_bf16 v[48:63], v[176:179], v[64:67], v[48:63]
    ds_read_b128 v[64:67], v4 offset:16384
    s_waitcnt lgkmcnt(3)
    v_mfma_f32_32x32x16_bf16 v[48:63], v[180:183], v[68:71], v[48:63]
    ds_read_b128 v[68:71], v4 offset:17408
    s_waitcnt lgkmcnt(3)
    v_mfma_f32_32x32x16_bf16 v[48:63], v[184:187], v[72:75], v[48:63]
    ds_read_b128 v[72:75], v4 offset:18432
    s_waitcnt lgkmcnt(3)
    v_mfma_f32_32x32x16_bf16 v[48:63], v[188:191], v[76:79], v[48:63]
    ds_read_b128 v[76:79], v4 offset:19456
    s_waitcnt lgkmcnt(3)
    v_mfma_f32_32x32x16_bf16 v[48:63], v[192:195], v[64:67], v[48:63]
    ds_read_b128 v[64:67], v4 offset:20480
    s_waitcnt lgkmcnt(3)
    v_mfma_f32_32x32x16_bf16 v[48:63], v[196:199], v[68:71], v[48:63]
    ds_read_b128 v[68:71], v4 offset:21504
    s_waitcnt lgkmcnt(3)
    v_mfma_f32_32x32x16_bf16 v[48:63], v[200:203], v[72:75], v[48:63]
    ds_read_b128 v[72:75], v4 offset:22528
    s_waitcnt lgkmcnt(3)
    v_mfma_f32_32x32x16_bf16 v[48:63], v[204:207], v[76:79], v[48:63]
    ds_read_b128 v[76:79], v4 offset:23552
    s_waitcnt lgkmcnt(3)
    v_mfma_f32_32x32x16_bf16 v[48:63], v[208:211], v[64:67], v[48:63]
    ds_read_b128 v[64:67], v4 offset:24576
    s_waitcnt lgkmcnt(3)
    v_mfma_f32_32x32x16_bf16 v[48:63], v[212:215], v[68:71], v[48:63]
    ds_read_b128 v[68:71], v4 offset:25600
    s_waitcnt lgkmcnt(3)
    v_mfma_f32_32x32x16_bf16 v[48:63], v[216:219], v[72:75], v[48:63]
    ds_read_b128 v[72:75], v4 offset:26624
    s_waitcnt lgkmcnt(3)
    v_mfma_f32_32x32x16_bf16 v[48:63], v[220:223], v[76:79], v[48:63]
    ds_read_b128 v[76:79], v4 offset:27648
    s_waitcnt lgkmcnt(3)
    v_mfma_f32_32x32x16_bf16 v[48:63], v[224:227], v[64:67], v[48:63]
    ds_read_b128 v[64:67], v4 offset:28672
    s_waitcnt lgkmcnt(3)
    v_mfma_f32_32x32x16_bf16 v[48:63], v[228:231], v[68:71], v[48:63]
    ds_read_b128 v[68:71], v4 offset:29696
    s_waitcnt lgkmcnt(3)
    v_mfma_f32_32x32x16_bf16 v[48:63], v[232:235], v[72:75], v[48:63]
    ds_read_b128 v[72:75], v4 offset:30720
    s_waitcnt lgkmcnt(3)
    v_mfma_f32_32x32x16_bf16 v[48:63], v[236:239], v[76:79], v[48:63]
    ds_read_b128 v[76:79], v4 offset:31744
    s_waitcnt lgkmcnt(3)
    v_mfma_f32_32x32x16_bf16 v[48:63], v[240:243], v[64:67], v[48:63]
    s_waitcnt lgkmcnt(2)
    v_mfma_f32_32x32x16_bf16 v[48:63], v[244:247], v[68:71], v[48:63]
    s_waitcnt lgkmcnt(1)
    v_mfma_f32_32x32x16_bf16 v[48:63], v[248:251], v[72:75], v[48:63]
    s_waitcnt lgkmcnt(0)
    v_mfma_f32_32x32x16_bf16 v[48:63], v[252:255], v[76:79], v[48:63]
    s_add_u32 s28, s28, 1
    v_add_u32 v4, s35, v0
    v_mov_b32 v7, s28
    s_nop 8
    v_cvt_pk_bf16_f32 v88, v48, v49
    v_cvt_pk_bf16_f32 v89, v50, v51
    v_cvt_pk_bf16_f32 v90, v52, v53
    v_cvt_pk_bf16_f32 v91, v54, v55
    buffer_store_dwordx4 v[88:91], v5, s[8:11], s32 offen offset:0
    v_cvt_pk_bf16_f32 v92, v56, v57
    v_cvt_pk_bf16_f32 v93, v58, v59
    v_cvt_pk_bf16_f32 v94, v60, v61
    v_cvt_pk_bf16_f32 v95, v62, v63
    buffer_store_dwordx4 v[92:95], v5, s[8:11], s32 offen offset:512
    s_and_b32 s43, s28, 7
    s_mul_i32 s30, s43, 524288
    s_add_u32 s30, s30, s60
    s_mul_i32 s31, s43, 524288
    s_add_u32 s31, s31, s61
    s_mul_i32 s32, s43, 262144
    s_add_u32 s32, s32, s62
    s_waitcnt vmcnt(3)
    v_add_u32 v11, 1, v7
    buffer_store_dword v11, v2, s[8:11], s34 offen offset:16 sc1
    s_cmp_eq_u32 s28, 64
    s_cbranch_scc1 L_fin_107
    v_cmp_gt_u32 vcc, s53, v9
    s_cbranch_vccz L_bp_113_ok
L_bp_113:
    buffer_load_dword v9, v8, s[8:11], s63 offen sc1
    s_waitcnt vmcnt(0)
    v_cmp_gt_u32 vcc, s53, v9
    s_add_u32 s52, s52, 0x1000
    s_cmp_lt_u32 s52, 2147418112
    s_cbranch_vccz L_bp_113_ok
    s_cbranch_scc1 L_bp_113
    s_branch L_fail
L_bp_113_ok:
    s_branch L_item_105
L_fin_107:
    buffer_store_dword v11, v2, s[8:11], s34 offen sc1
    s_waitcnt vmcnt(0)
    buffer_store_dword v7, v2, s[8:11], s37 offen
    s_branch L_end_114
L_redo_108:
    s_add_u32 s52, s52, 0x1000
    s_cmp_lt_u32 s52, 2147418112
    s_cbranch_scc0 L_fail
    s_waitcnt vmcnt(0) lgkmcnt(0)
    s_barrier
    s_branch L_dma_106
L_end_114:
    s_branch L_done
L_nonlocal_104:
    s_mov_b32 s28, 0
    s_mov_b32 s36, 1
    s_mov_b32 s35, 0
    s_lshl_b32 s44, s24, 11
    s_lshl_b32 s45, s24, 12
    s_add_u32 s46, s29, s44
    s_add_u32 s47, s29, s45
    s_mov_b32 s48, s46
    s_mov_b32 s49, s47
    s_mov_b32 s60, s30
    s_mov_b32 s61, s31
    s_mov_b32 s62, s32
    v_mov_b32 v4, v0
L_item_115:
L_poll_121:
    buffer_load_dword v3, v1, s[8:11], s33 offen sc1
    s_waitcnt vmcnt(0)
    v_cmp_gt_u32 vcc, s36, v3
    s_add_u32 s52, s52, 0x1000
    s_cmp_lt_u32 s52, 2147418112
    s_cbranch_vccz L_poll_121_ok
    s_cbranch_scc1 L_poll_121
    s_branch L_fail
L_poll_121_ok:
L_dma_116:
    s_add_u32 m0, s44, 0
    s_add_u32 s42, s46, 0
    buffer_load_dwordx4 v0, s[8:11], s42 offen offset:0 sc1  lds
    buffer_load_dwordx4 v0, s[8:11], s42 offen offset:1024 sc1  lds
    s_add_u32 m0, s44, 8192
    s_add_u32 s42, s46, 8192
    buffer_load_dwordx4 v0, s[8:11], s42 offen offset:0 sc1  lds
    buffer_load_dwordx4 v0, s[8:11], s42 offen offset:1024 sc1  lds
    s_add_u32 m0, s44, 16384
    s_add_u32 s42, s46, 16384
    buffer_load_dwordx4 v0, s[8:11], s42 offen offset:0 sc1  lds
    buffer_load_dwordx4 v0, s[8:11], s42 offen offset:1024 sc1  lds
L_rd_122:
    s_mov_b32 s6, 0
    s_waitcnt vmcnt(4)
    s_barrier
    ds_read_b128 v[64:67], v4 offset:0
    ds_read_b128 v[68:71], v4 offset:1024
    ds_read_b128 v[72:75], v4 offset:2048
    ds_read_b128 v[76:79], v4 offset:3072
    s_waitcnt lgkmcnt(3)
    v_mfma_f32_32x32x16_bf16 v[16:31], a[0:3], v[64:67], 0
    v_xor_b32 v12, s6, v64
    s_add_u32 m0, s44, 24576
    s_add_u32 s42, s46, 24576
    buffer_load_dwordx4 v0, s[8:11], s42 offen offset:0 sc1  lds
    ds_read_b128 v[64:67], v4 offset:4096
    s_waitcnt lgkmcnt(3)
    v_mfma_f32_32x32x16_bf16 v[16:31], a[4:7], v[68:71], v[16:31]
    v_bitop3_b32 v12, v12, v68, s6 bitop3:96
    ds_read_b128 v[68:71], v4 offset:5120
    s_waitcnt lgkmcnt(3)
    v_mfma_f32_32x32x16_bf16 v[16:31], a[8:11], v[72:75], v[16:31]
    v_bitop3_b32 v12, v12, v72, s6 bitop3:96
    buffer_load_dwordx4 v0, s[8:11], s42 offen offset:1024 sc1  lds
    ds_read_b128 v[72:75], v4 offset:6144
    s_waitcnt lgkmcnt(3)
    v_mfma_f32_32x32x16_bf16 v[16:31], a[12:15], v[76:79], v[16:31]
    v_bitop3_b32 v12, v12, v76, s6 bitop3:96
    ds_read_b128 v[76:79], v4 offset:7168
    s_waitcnt lgkmcnt(3)
    v_mfma_f32_32x32x16_bf16 v[16:31], a[16:19], v[64:67], v[16:31]
    v_bitop3_b32 v12, v12, v64, s6 bitop3:96
    s_waitcnt vmcnt(4)
    s_barrier
    ds_read_b128 v[64:67], v4 offset:8192
    s_waitcnt lgkmcnt(3)
    v_mfma_f32_32x32x16_bf16 v[16:31], a[20:23], v[68:71], v[16:31]
    v_bitop3_b32 v12, v12, v68, s6 bitop3:96
    ds_read_b128 v[68:71], v4 offset:9216
    s_waitcnt lgkmcnt(3)
    v_mfma_f32_32x32x16_bf16 v[16:31], a[24:27], v[72:75], v[16:31]
    v_bitop3_b32 v12, v12, v72, s6 bitop3:96
    ds_read_b128 v[72:75], v4 offset:10240
    s_waitcnt lgkmcnt(3)
    v_mfma_f32_32x32x16_bf16 v[16:31], a[28:31], v[76:79], v[16:31]
    v_bitop3_b32 v12, v12, v76, s6 bitop3:96
    ds_read_b128 v[76:79], v4 offset:11264
    s_waitcnt lgkmcnt(3)
    v_mfma_f32_32x32x16_bf16 v[16:31], a[32:35], v[64:67], v[16:31]
    v_bitop3_b32 v12, v12, v64, s6 bitop3:96
    ds_read_b128 v[64:67], v4 offset:12288
    s_waitcnt lgkmcnt(3)
    v_mfma_f32_32x32x16_bf16 v[16:31], a[36:39], v[68:71], v[16:31]
    v_bitop3_b32 v12, v12, v68, s6 bitop3:96
    ds_read_b128 v[68:71], v4 offset:13312
    s_waitcnt lgkmcnt(3)
    v_mfma_f32_32x32x16_bf16 v[16:31], a[40:43], v[72:75], v[16:31]
    v_bitop3_b32 v12, v12, v72, s6 bitop3:96
    ds_read_b128 v[72:75], v4 offset:14336
    s_waitcnt lgkmcnt(3)
    v_mfma_f32_32x32x16_bf16 v[16:31], a[44:47], v[76:79], v[16:31]
    v_bitop3_b32 v12, v12, v76, s6 bitop3:96
    ds_read_b128 v[76:79], v4 offset:15360
    s_waitcnt lgkmcnt(3)
    v_mfma_f32_32x32x16_bf16 v[16:31], a[48:51], v[64:67], v[16:31]
    v_bitop3_b32 v12, v12, v64, s6 bitop3:96
    s_waitcnt vmcnt(2)
    s_barrier
    ds_read_b128 v[64:67], v4 offset:16384
    s_waitcnt lgkmcnt(3)
    v_mfma_f32_32x32x16_bf16 v[16:31], a[52:55], v[68:71], v[16:31]
    v_bitop3_b32 v12, v12, v68, s6 bitop3:96
    ds_read_b128 v[68:71], v4 offset:17408
    s_waitcnt lgkmcnt(3)
    v_mfma_f32_32x32x16_bf16 v[16:31], a[56:59], v[72:75], v[16:31]
    v_bitop3_b32 v12, v12, v72, s6 bitop3:96
    ds_read_b128 v[72:75], v4 offset:18432
    s_waitcnt lgkmcnt(3)
    v_mfma_f32_32x32x16_bf16 v[16:31], a[60:63], v[76:79], v[16:31]
    v_bitop3_b32 v12, v12, v76, s6 bitop3:96
    ds_read_b128 v[76:79], v4 offset:19456
    s_waitcnt lgkmcnt(3)
    v_mfma_f32_32x32x16_bf16 v[16:31], a[64:67], v[64:67], v[16:31]
    v_bitop3_b32 v12, v12, v64, s6 bitop3:96
    ds_read_b128 v[64:67], v4 offset:20480
    s_waitcnt lgkmcnt(3)
    v_mfma_f32_32x32x16_bf16 v[16:31], a[68:71], v[68:71], v[16:31]
    v_bitop3_b32 v12, v12, v68, s6 bitop3:96
    ds_read_b128 v[68:71], v4 offset:21504
    s_waitcnt lgkmcnt(3)
    v_mfma_f32_32x32x16_bf16 v[16:31], a[72:75], v[72:75], v[16:31]
    v_bitop3_b32 v12, v12, v72, s6 bitop3:96
    ds_read_b128 v[72:75], v4 offset:22528
    s_waitcnt lgkmcnt(3)
    v_mfma_f32_32x32x16_bf16 v[16:31], a[76:79], v[76:79], v[16:31]
    v_bitop3_b32 v12, v12, v76, s6 bitop3:96
    ds_read_b128 v[76:79], v4 offset:23552
    s_waitcnt lgkmcnt(3)
    v_mfma_f32_32x32x16_bf16 v[16:31], a[80:83], v[64:67], v[16:31]
    v_bitop3_b32 v12, v12, v64, s6 bitop3:96
    s_waitcnt vmcnt(0)
    s_barrier
    ds_read_b128 v[64:67], v4 offset:24576
    s_waitcnt lgkmcnt(3)
    v_mfma_f32_32x32x16_bf16 v[16:31], a[84:87], v[68:71], v[16:31]
    v_bitop3_b32 v12, v12, v68, s6 bitop3:96
    ds_read_b128 v[68:71], v4 offset:25600
    s_waitcnt lgkmcnt(3)
    v_mfma_f32_32x32x16_bf16 v[16:31], a[88:91], v[72:75], v[16:31]
    v_bitop3_b32 v12, v12, v72, s6 bitop3:96
    ds_read_b128 v[72:75], v4 offset:26624
    s_waitcnt lgkmcnt(3)
    v_mfma_f32_32x32x16_bf16 v[16:31], a[92:95], v[76:79], v[16:31]
    v_bitop3_b32 v12, v12, v76, s6 bitop3:96
    ds_read_b128 v[76:79], v4 offset:27648
    s_waitcnt lgkmcnt(3)
    v_mfma_f32_32x32x16_bf16 v[16:31], a[96:99], v[64:67], v[16:31]
    v_bitop3_b32 v12, v12, v64, s6 bitop3:96
    ds_read_b128 v[64:67], v4 offset:28672
    s_waitcnt lgkmcnt(3)
    v_mfma_f32_32x32x16_bf16 v[16:31], a[100:103], v[68:71], v[16:31]
    v_bitop3_b32 v12, v12, v68, s6 bitop3:96
    ds_read_b128 v[68:71], v4 offset:29696
    s_waitcnt lgkmcnt(3)
    v_mfma_f32_32x32x16_bf16 v[16:31], a[104:107], v[72:75], v[16:31]
    v_bitop3_b32 v12, v12, v72, s6 bitop3:96
    ds_read_b128 v[72:75], v4 offset:30720
    s_waitcnt lgkmcnt(3)
    v_mfma_f32_32x32x16_bf16 v[16:31], a[108:111], v[76:79], v[16:31]
    v_bitop3_b32 v12, v12, v76, s6 bitop3:96
    ds_read_b128 v[76:79], v4 offset:31744
    s_waitcnt lgkmcnt(3)
    v_mfma_f32_32x32x16_bf16 v[16:31], a[112:115], v[64:67], v[16:31]
    v_bitop3_b32 v12, v12, v64, s6 bitop3:96
    v_mov_b32 v7, s28
    s_sub_u32 s53, s28, 6
    v_mov_b32 v7, s28
    ds_read_b128 v[64:67], v4 offset:0
    s_waitcnt lgkmcnt(3)
    v_mfma_f32_32x32x16_bf16 v[16:31], a[116:119], v[68:71], v[16:31]
    v_bitop3_b32 v12, v12, v68, s6 bitop3:96
    s_max_i32 s53, s53, 0
    buffer_store_dword v7, v2, s[8:11], s37 offen sc1
    ds_read_b128 v[68:71], v4 offset:1024
    s_waitcnt lgkmcnt(3)
    v_mfma_f32_32x32x16_bf16 v[16:31], a[120:123], v[72:75], v[16:31]
    v_bitop3_b32 v12, v12, v72, s6 bitop3:96
    ds_read_b128 v[72:75], v4 offset:2048
    s_waitcnt lgkmcnt(3)
    v_mfma_f32_32x32x16_bf16 v[16:31], a[124:127], v[76:79], v[16:31]
    v_bitop3_b32 v12, v12, v76, s6 bitop3:96
    buffer_load_dword v3, v1, s[8:11], s33 offen sc1
    ds_read_b128 v[76:79], v4 offset:3072
    s_waitcnt lgkmcnt(3)
    v_mfma_f32_32x32x16_bf16 v[32:47], v[64:67], a[128:131], 0
    v_and_b32 v12, 1, v12
    v_cmp_eq_u32 vcc, 0, v12
    buffer_load_dword v9, v8, s[8:11], s63 offen sc1
    ds_read_b128 v[64:67], v4 offset:4096
    s_waitcnt lgkmcnt(3)
    v_mfma_f32_32x32x16_bf16 v[32:47], v[68:71], a[132:135], v[32:47]
    s_cbranch_vccnz L_redo_118
    ds_read_b128 v[68:71], v4 offset:5120
    s_waitcnt lgkmcnt(3)
    v_mfma_f32_32x32x16_bf16 v[32:47], v[72:75], a[136:139], v[32:47]
    v_cvt_pk_bf16_f32 v88, v16, v17
    v_cvt_pk_bf16_f32 v89, v18, v19
    ds_read_b128 v[72:75], v4 offset:6144
    s_waitcnt lgkmcnt(3)
    v_mfma_f32_32x32x16_bf16 v[32:47], v[76:79], a[140:143], v[32:47]
    v_cvt_pk_bf16_f32 v90, v20, v21
    v_cvt_pk_bf16_f32 v91, v22, v23
    ds_read_b128 v[76:79], v4 offset:7168
    s_waitcnt lgkmcnt(3)
    v_mfma_f32_32x32x16_bf16 v[32:47], v[64:67], a[144:147], v[32:47]
    buffer_store_dwordx4 v[88:91], v5, s[8:11], s30 offen offset:0 sc1
    v_cvt_pk_bf16_f32 v92, v24, v25
    ds_read_b128 v[64:67], v4 offset:8192
    s_waitcnt lgkmcnt(3)
    v_mfma_f32_32x32x16_bf16 v[32:47], v[68:71], a[148:151], v[32:47]
    v_cvt_pk_bf16_f32 v93, v26, v27
    v_cvt_pk_bf16_f32 v94, v28, v29
    ds_read_b128 v[68:71], v4 offset:9216
    s_waitcnt lgkmcnt(3)
    v_mfma_f32_32x32x16_bf16 v[32:47], v[72:75], a[152:155], v[32:47]
    v_cvt_pk_bf16_f32 v95, v30, v31
    buffer_store_dwordx4 v[92:95], v5, s[8:11], s30 offen offset:512 sc1
    ds_read_b128 v[72:75], v4 offset:10240
    s_waitcnt lgkmcnt(3)
    v_mfma_f32_32x32x16_bf16 v[32:47], v[76:79], a[156:159], v[32:47]
    ds_read_b128 v[76:79], v4 offset:11264
    s_waitcnt lgkmcnt(3)
    v_mfma_f32_32x32x16_bf16 v[32:47], v[64:67], a[160:163], v[32:47]
    ds_read_b128 v[64:67], v4 offset:12288
    s_waitcnt lgkmcnt(3)
    v_mfma_f32_32x32x16_bf16 v[32:47], v[68:71], a[164:167], v[32:47]
    ds_read_b128 v[68:71], v4 offset:13312
    s_waitcnt lgkmcnt(3)
    v_mfma_f32_32x32x16_bf16 v[32:47], v[72:75], a[168:171], v[32:47]
    ds_read_b128 v[72:75], v4 offset:14336
    s_waitcnt lgkmcnt(3)
    v_mfma_f32_32x32x16_bf16 v[32:47], v[76:79], a[172:175], v[32:47]
    ds_read_b128 v[76:79], v4 offset:15360
    s_waitcnt lgkmcnt(3)
    v_mfma_f32_32x32x16_bf16 v[32:47], v[64:67], a[176:179], v[32:47]
    ds_read_b128 v[64:67], v4 offset:16384
    s_waitcnt lgkmcnt(3)
    v_mfma_f32_32x32x16_bf16 v[32:47], v[68:71], a[180:183], v[32:47]
    ds_read_b128 v[68:71], v4 offset:17408
    s_waitcnt lgkmcnt(3)
    v_mfma_f32_32x32x16_bf16 v[32:47], v[72:75], a[184:187], v[32:47]
    ds_read_b128 v[72:75], v4 offset:18432
    s_waitcnt lgkmcnt(3)
    v_mfma_f32_32x32x16_bf16 v[32:47], v[76:79], a[188:191], v[32:47]
    ds_read_b128 v[76:79], v4 offset:19456
    s_waitcnt lgkmcnt(3)
    v_mfma_f32_32x32x16_bf16 v[32:47], v[64:67], a[192:195], v[32:47]
    ds_read_b128 v[64:67], v4 offset:20480
    s_waitcnt lgkmcnt(3)
    v_mfma_f32_32x32x16_bf16 v[32:47], v[68:71], a[196:199], v[32:47]
    s_and_b32 s43, s36, 63
    s_mul_i32 s43, s43, 32768
    ds_read_b128 v[68:71], v4 offset:21504
    s_waitcnt lgkmcnt(3)
    v_mfma_f32_32x32x16_bf16 v[32:47], v[72:75], a[200:203], v[32:47]
    s_add_u32 s46, s43, s48
    s_add_u32 s47, s43, s49
    ds_read_b128 v[72:75], v4 offset:22528
    s_waitcnt lgkmcnt(3)
    v_mfma_f32_32x32x16_bf16 v[32:47], v[76:79], a[204:207], v[32:47]
    s_add_u32 s36, s36, 1
    s_sub_u32 s44, s44, s35
    ds_read_b128 v[76:79], v4 offset:23552
    s_waitcnt lgkmcnt(3)
    v_mfma_f32_32x32x16_bf16 v[32:47], v[64:67], a[208:211], v[32:47]
    s_sub_u32 s45, s45, s35
    s_sub_u32 s35, 32768, s35
    ds_read_b128 v[64:67], v4 offset:24576
    s_waitcnt lgkmcnt(3)
    v_mfma_f32_32x32x16_bf16 v[32:47], v[68:71], a[212:215], v[32:47]
    s_add_u32 s44, s44, s35
    s_add_u32 s45, s45, s35
    ds_read_b128 v[68:71], v4 offset:25600
    s_waitcnt lgkmcnt(3)
    v_mfma_f32_32x32x16_bf16 v[32:47], v[72:75], a[216:219], v[32:47]
    s_waitcnt vmcnt(2)
    v_cmp_gt_u32 vcc, s36, v3
    v_cmp_gt_u32 s[54:55], s53, v9
L_mid_119:
    ds_read_b128 v[72:75], v4 offset:26624
    s_waitcnt lgkmcnt(3)
    v_mfma_f32_32x32x16_bf16 v[32:47], v[76:79], a[220:223], v[32:47]
    s_or_b64 vcc, vcc, s[54:55]
    s_cbranch_scc1 L_tail0_120
    ds_read_b128 v[76:79], v4 offset:27648
    s_waitcnt lgkmcnt(3)
    v_mfma_f32_32x32x16_bf16 v[32:47], v[64:67], a[224:227], v[32:47]
    s_add_u32 m0, s44, 0
    s_add_u32 s42, s46, 0
    buffer_load_dwordx4 v0, s[8:11], s42 offen offset:0 sc1  lds
    ds_read_b128 v[64:67], v4 offset:28672
    s_waitcnt lgkmcnt(3)
    v_mfma_f32_32x32x16_bf16 v[32:47], v[68:71], a[228:231], v[32:47]
    ds_read_b128 v[68:71], v4 offset:29696
    s_waitcnt lgkmcnt(3)
    v_mfma_f32_32x32x16_bf16 v[32:47], v[72:75], a[232:235], v[32:47]
    buffer_load_dwordx4 v0, s[8:11], s42 offen offset:1024 sc1  lds
    ds_read_b128 v[72:75], v4 offset:30720
    s_waitcnt lgkmcnt(3)
    v_mfma_f32_32x32x16_bf16 v[32:47], v[76:79], a[236:239], v[32:47]
    s_add_u32 m0, s44, 8192
    s_add_u32 s42, s46, 8192
    ds_read_b128 v[76:79], v4 offset:31744
    s_waitcnt lgkmcnt(3)
    v_mfma_f32_32x32x16_bf16 v[32:47], v[64:67], a[240:243], v[32:47]
    buffer_load_dwordx4 v0, s[8:11], s42 offen offset:0 sc1  lds
    ds_read_b128 v[64:67], v4 offset:0
    s_waitcnt lgkmcnt(3)
    v_mfma_f32_32x32x16_bf16 v[32:47], v[68:71], a[244:247], v[32:47]
    ds_read_b128 v[68:71], v4 offset:1024
    s_waitcnt lgkmcnt(3)
    v_mfma_f32_32x32x16_bf16 v[32:47], v[72:75], a[248:251], v[32:47]
    buffer_load_dwordx4 v0, s[8:11], s42 offen offset:1024 sc1  lds
    ds_read_b128 v[72:75], v4 offset:2048
    s_waitcnt lgkmcnt(3)
    v_mfma_f32_32x32x16_bf16 v[32:47], v[76:79], a[252:255], v[32:47]
    s_add_u32 m0, s44, 16384
    s_add_u32 s42, s46, 16384
    ds_read_b128 v[76:79], v4 offset:3072
    s_waitcnt lgkmcnt(3)
    v_mfma_f32_32x32x16_bf16 v[48:63], v[128:131], v[64:67], 0
    buffer_load_dwordx4 v0, s[8:11], s42 offen offset:0 sc1  lds
    ds_read_b128 v[64:67], v4 offset:4096
    s_waitcnt lgkmcnt(3)
    v_mfma_f32_32x32x16_bf16 v[48:63], v[132:135], v[68:71], v[48:63]
    ds_read_b128 v[68:71], v4 offset:5120
    s_waitcnt lgkmcnt(3)
    v_mfma_f32_32x32x16_bf16 v[48:63], v[136:139], v[72:75], v[48:63]
    v_cvt_pk_bf16_f32 v88, v32, v33
    v_cvt_pk_bf16_f32 v89, v34, v35
    buffer_load_dwordx4 v0, s[8:11], s42 offen offset:1024 sc1  lds
    ds_read_b128 v[72:75], v4 offset:6144
    s_waitcnt lgkmcnt(3)
    v_mfma_f32_32x32x16_bf16 v[48:63], v[140:143], v[76:79], v[48:63]
    v_cvt_pk_bf16_f32 v90, v40, v41
    v_cvt_pk_bf16_f32 v91, v42, v43
    s_add_u32 m0, s44, 24576
    s_add_u32 s42, s46, 24576
    ds_read_b128 v[76:79], v4 offset:7168
    s_waitcnt lgkmcnt(3)
    v_mfma_f32_32x32x16_bf16 v[48:63], v[144:147], v[64:67], v[48:63]
    buffer_store_dwordx4 v[88:91], v6, s[8:11], s31 offen offset:0 sc1
    v_cvt_pk_bf16_f32 v92, v36, v37
    buffer_load_dwordx4 v0, s[8:11], s42 offen offset:0 sc1  lds
    ds_read_b128 v[64:67], v4 offset:8192
    s_waitcnt lgkmcnt(3)
    v_mfma_f32_32x32x16_bf16 v[48:63], v[148:151], v[68:71], v[48:63]
    v_cvt_pk_bf16_f32 v93, v38, v39
    v_cvt_pk_bf16_f32 v94, v44, v45
    ds_read_b128 v[68:71], v4 offset:9216
    s_waitcnt lgkmcnt(3)
    v_mfma_f32_32x32x16_bf16 v[48:63], v[152:155], v[72:75], v[48:63]
    v_cvt_pk_bf16_f32 v95, v46, v47
    buffer_store_dwordx4 v[92:95], v6, s[8:11], s31 offen offset:512 sc1
    buffer_load_dwordx4 v0, s[8:11], s42 offen offset:1024 sc1  lds
    ds_read_b128 v[72:75], v4 offset:10240
    s_waitcnt lgkmcnt(3)
    v_mfma_f32_32x32x16_bf16 v[48:63], v[156:159], v[76:79], v[48:63]
    ds_read_b128 v[76:79], v4 offset:11264
    s_waitcnt lgkmcnt(3)
    v_mfma_f32_32x32x16_bf16 v[48:63], v[160:163], v[64:67], v[48:63]
    ds_read_b128 v[64:67], v4 offset:12288
    s_waitcnt lgkmcnt(3)
    v_mfma_f32_32x32x16_bf16 v[48:63], v[164:167], v[68:71], v[48:63]
    v_add_u32 v11, 1, v7
    ds_read_b128 v[68:71], v4 offset:13312
    s_waitcnt lgkmcnt(3)
    v_mfma_f32_32x32x16_bf16 v[48:63], v[168:171], v[72:75], v[48:63]
    s_waitcnt vmcnt(10)
    buffer_store_dword v11, v2, s[8:11], s34 offen sc1
    ds_read_b128 v[72:75], v4 offset:14336
    s_waitcnt lgkmcnt(3)
    v_mfma_f32_32x32x16_bf16 v[48:63], v[172:175], v[76:79], v[48:63]
    ds_read_b128 v[76:79], v4 offset:15360
    s_waitcnt lgkmcnt(3)
    v_mfma_f32_32x32x16_bf16 v[48:63], v[176:179], v[64:67], v[48:63]
    ds_read_b128 v[64:67], v4 offset:16384
    s_waitcnt lgkmcnt(3)
    v_mfma_f32_32x32x16_bf16 v[48:63], v[180:183], v[68:71], v[48:63]
    ds_read_b128 v[68:71], v4 offset:17408
    s_waitcnt lgkmcnt(3)
    v_mfma_f32_32x32x16_bf16 v[48:63], v[184:187], v[72:75], v[48:63]
    ds_read_b128 v[72:75], v4 offset:18432
    s_waitcnt lgkmcnt(3)
    v_mfma_f32_32x32x16_bf16 v[48:63], v[188:191], v[76:79], v[48:63]
    ds_read_b128 v[76:79], v4 offset:19456
    s_waitcnt lgkmcnt(3)
    v_mfma_f32_32x32x16_bf16 v[48:63], v[192:195], v[64:67], v[48:63]
    ds_read_b128 v[64:67], v4 offset:20480
    s_waitcnt lgkmcnt(3)
    v_mfma_f32_32x32x16_bf16 v[48:63], v[196:199], v[68:71], v[48:63]
    ds_read_b128 v[68:71], v4 offset:21504
    s_waitcnt lgkmcnt(3)
    v_mfma_f32_32x32x16_bf16 v[48:63], v[200:203], v[72:75], v[48:63]
    ds_read_b128 v[72:75], v4 offset:22528
    s_waitcnt lgkmcnt(3)
    v_mfma_f32_32x32x16_bf16 v[48:63], v[204:207], v[76:79], v[48:63]
    ds_read_b128 v[76:79], v4 offset:23552
    s_waitcnt lgkmcnt(3)
    v_mfma_f32_32x32x16_bf16 v[48:63], v[208:211], v[64:67], v[48:63]
    ds_read_b128 v[64:67], v4 offset:24576
    s_waitcnt lgkmcnt(3)
    v_mfma_f32_32x32x16_bf16 v[48:63], v[212:215], v[68:71], v[48:63]
    ds_read_b128 v[68:71], v4 offset:25600
    s_waitcnt lgkmcnt(3)
    v_mfma_f32_32x32x16_bf16 v[48:63], v[216:219], v[72:75], v[48:63]
    ds_read_b128 v[72:75], v4 offset:26624
    s_waitcnt lgkmcnt(3)
    v_mfma_f32_32x32x16_bf16 v[48:63], v[220:223], v[76:79], v[48:63]
    ds_read_b128 v[76:79], v4 offset:27648
    s_waitcnt lgkmcnt(3)
    v_mfma_f32_32x32x16_bf16 v[48:63], v[224:227], v[64:67], v[48:63]
    ds_read_b128 v[64:67], v4 offset:28672
    s_waitcnt lgkmcnt(3)
    v_mfma_f32_32x32x16_bf16 v[48:63], v[228:231], v[68:71], v[48:63]
    ds_read_b128 v[68:71], v4 offset:29696
    s_waitcnt lgkmcnt(3)
    v_mfma_f32_32x32x16_bf16 v[48:63], v[232:235], v[72:75], v[48:63]
    ds_read_b128 v[72:75], v4 offset:30720
    s_waitcnt lgkmcnt(3)
    v_mfma_f32_32x32x16_bf16 v[48:63], v[236:239], v[76:79], v[48:63]
    ds_read_b128 v[76:79], v4 offset:31744
    s_waitcnt lgkmcnt(3)
    v_mfma_f32_32x32x16_bf16 v[48:63], v[240:243], v[64:67], v[48:63]
    v_add_u32 v4, s35, v0
    s_waitcnt vmcnt(9)
    s_barrier
    ds_read_b128 v[64:67], v4 offset:0
    s_waitcnt lgkmcnt(3)
    v_mfma_f32_32x32x16_bf16 v[48:63], v[244:247], v[68:71], v[48:63]
    ds_read_b128 v[68:71], v4 offset:1024
    s_waitcnt lgkmcnt(3)
    v_mfma_f32_32x32x16_bf16 v[48:63], v[248:251], v[72:75], v[48:63]
    ds_read_b128 v[72:75], v4 offset:2048
    s_waitcnt lgkmcnt(3)
    v_mfma_f32_32x32x16_bf16 v[48:63], v[252:255], v[76:79], v[48:63]
    s_add_u32 s28, s28, 1
    s_mov_b32 s6, 0
    ds_read_b128 v[76:79], v4 offset:3072
    s_waitcnt lgkmcnt(3)
    v_mfma_f32_32x32x16_bf16 v[16:31], a[0:3], v[64:67], 0
    v_xor_b32 v12, s6, v64
    v_mov_b32 v7, s28
    ds_read_b128 v[64:67], v4 offset:4096
    s_waitcnt lgkmcnt(3)
    v_mfma_f32_32x32x16_bf16 v[16:31], a[4:7], v[68:71], v[16:31]
    v_bitop3_b32 v12, v12, v68, s6 bitop3:96
    ds_read_b128 v[68:71], v4 offset:5120
    s_waitcnt lgkmcnt(3)
    v_mfma_f32_32x32x16_bf16 v[16:31], a[8:11], v[72:75], v[16:31]
    v_bitop3_b32 v12, v12, v72, s6 bitop3:96
    v_cvt_pk_bf16_f32 v88, v48, v49
    v_cvt_pk_bf16_f32 v89, v50, v51
    ds_read_b128 v[72:75], v4 offset:6144
    s_waitcnt lgkmcnt(3)
    v_mfma_f32_32x32x16_bf16 v[16:31], a[12:15], v[76:79], v[16:31]
    v_bitop3_b32 v12, v12, v76, s6 bitop3:96
    v_cvt_pk_bf16_f32 v90, v52, v53
    v_cvt_pk_bf16_f32 v91, v54, v55
    ds_read_b128 v[76:79], v4 offset:7168
    s_waitcnt lgkmcnt(3)
    v_mfma_f32_32x32x16_bf16 v[16:31], a[16:19], v[64:67], v[16:31]
    v_bitop3_b32 v12, v12, v64, s6 bitop3:96
    buffer_store_dwordx4 v[88:91], v5, s[8:11], s32 offen offset:0 sc1
    v_cvt_pk_bf16_f32 v92, v56, v57
    s_waitcnt vmcnt(8)
    s_barrier
    ds_read_b128 v[64:67], v4 offset:8192
    s_waitcnt lgkmcnt(3)
    v_mfma_f32_32x32x16_bf16 v[16:31], a[20:23], v[68:71], v[16:31]
    v_bitop3_b32 v12, v12, v68, s6 bitop3:96
    v_cvt_pk_bf16_f32 v93, v58, v59
    v_cvt_pk_bf16_f32 v94, v60, v61
    ds_read_b128 v[68:71], v4 offset:9216
    s_waitcnt lgkmcnt(3)
    v_mfma_f32_32x32x16_bf16 v[16:31], a[24:27], v[72:75], v[16:31]
    v_bitop3_b32 v12, v12, v72, s6 bitop3:96
    v_cvt_pk_bf16_f32 v95, v62, v63
    buffer_store_dwordx4 v[92:95], v5, s[8:11], s32 offen offset:512 sc1
    ds_read_b128 v[72:75], v4 offset:10240
    s_waitcnt lgkmcnt(3)
    v_mfma_f32_32x32x16_bf16 v[16:31], a[28:31], v[76:79], v[16:31]
    v_bitop3_b32 v12, v12, v76, s6 bitop3:96
    ds_read_b128 v[76:79], v4 offset:11264
    s_waitcnt lgkmcnt(3)
    v_mfma_f32_32x32x16_bf16 v[16:31], a[32:35], v[64:67], v[16:31]
    v_bitop3_b32 v12, v12, v64, s6 bitop3:96
    s_waitcnt vmcnt(4)
    v_add_u32 v11, 1, v7
    buffer_store_dword v11, v2, s[8:11], s34 offen offset:16 sc1
    ds_read_b128 v[64:67], v4 offset:12288
    s_waitcnt lgkmcnt(3)
    v_mfma_f32_32x32x16_bf16 v[16:31], a[36:39], v[68:71], v[16:31]
    v_bitop3_b32 v12, v12, v68, s6 bitop3:96
    ds_read_b128 v[68:71], v4 offset:13312
    s_waitcnt lgkmcnt(3)
    v_mfma_f32_32x32x16_bf16 v[16:31], a[40:43], v[72:75], v[16:31]
    v_bitop3_b32 v12, v12, v72, s6 bitop3:96
    s_and_b32 s43, s28, 7
    s_mul_i32 s32, s43, 262144
    ds_read_b128 v[72:75], v4 offset:14336
    s_waitcnt lgkmcnt(3)
    v_mfma_f32_32x32x16_bf16 v[16:31], a[44:47], v[76:79], v[16:31]
    v_bitop3_b32 v12, v12, v76, s6 bitop3:96
    s_add_u32 s32, s32, s62
    s_mul_i32 s30, s43, 524288
    ds_read_b128 v[76:79], v4 offset:15360
    s_waitcnt lgkmcnt(3)
    v_mfma_f32_32x32x16_bf16 v[16:31], a[48:51], v[64:67], v[16:31]
    v_bitop3_b32 v12, v12, v64, s6 bitop3:96
    s_add_u32 s30, s30, s60
    s_mul_i32 s31, s43, 524288
    s_barrier
    ds_read_b128 v[64:67], v4 offset:16384
    s_waitcnt lgkmcnt(3)
    v_mfma_f32_32x32x16_bf16 v[16:31], a[52:55], v[68:71], v[16:31]
    v_bitop3_b32 v12, v12, v68, s6 bitop3:96
    s_add_u32 s31, s31, s61
    ds_read_b128 v[68:71], v4 offset:17408
    s_waitcnt lgkmcnt(3)
    v_mfma_f32_32x32x16_bf16 v[16:31], a[56:59], v[72:75], v[16:31]
    v_bitop3_b32 v12, v12, v72, s6 bitop3:96
    ds_read_b128 v[72:75], v4 offset:18432
    s_waitcnt lgkmcnt(3)
    v_mfma_f32_32x32x16_bf16 v[16:31], a[60:63], v[76:79], v[16:31]
    v_bitop3_b32 v12, v12, v76, s6 bitop3:96
    ds_read_b128 v[76:79], v4 offset:19456
    s_waitcnt lgkmcnt(3)
    v_mfma_f32_32x32x16_bf16 v[16:31], a[64:67], v[64:67], v[16:31]
    v_bitop3_b32 v12, v12, v64, s6 bitop3:96
    ds_read_b128 v[64:67], v4 offset:20480
    s_waitcnt lgkmcnt(3)
    v_mfma_f32_32x32x16_bf16 v[16:31], a[68:71], v[68:71], v[16:31]
    v_bitop3_b32 v12, v12, v68, s6 bitop3:96
    ds_read_b128 v[68:71], v4 offset:21504
    s_waitcnt lgkmcnt(3)
    v_mfma_f32_32x32x16_bf16 v[16:31], a[72:75], v[72:75], v[16:31]
    v_bitop3_b32 v12, v12, v72, s6 bitop3:96
    ds_read_b128 v[72:75], v4 offset:22528
    s_waitcnt lgkmcnt(3)
    v_mfma_f32_32x32x16_bf16 v[16:31], a[76:79], v[76:79], v[16:31]
    v_bitop3_b32 v12, v12, v76, s6 bitop3:96
    ds_read_b128 v[76:79], v4 offset:23552
    s_waitcnt lgkmcnt(3)
    v_mfma_f32_32x32x16_bf16 v[16:31], a[80:83], v[64:67], v[16:31]
    v_bitop3_b32 v12, v12, v64, s6 bitop3:96
    s_waitcnt vmcnt(4)
    s_barrier
    ds_read_b128 v[64:67], v4 offset:24576
    s_waitcnt lgkmcnt(3)
    v_mfma_f32_32x32x16_bf16 v[16:31], a[84:87], v[68:71], v[16:31]
    v_bitop3_b32 v12, v12, v68, s6 bitop3:96
    ds_read_b128 v[68:71], v4 offset:25600
    s_waitcnt lgkmcnt(3)
    v_mfma_f32_32x32x16_bf16 v[16:31], a[88:91], v[72:75], v[16:31]
    v_bitop3_b32 v12, v12, v72, s6 bitop3:96
    ds_read_b128 v[72:75], v4 offset:26624
    s_waitcnt lgkmcnt(3)
    v_mfma_f32_32x32x16_bf16 v[16:31], a[92:95], v[76:79], v[16:31]
    v_bitop3_b32 v12, v12, v76, s6 bitop3:96
    ds_read_b128 v[76:79], v4 offset:27648
    s_waitcnt lgkmcnt(3)
    v_mfma_f32_32x32x16_bf16 v[16:31], a[96:99], v[64:67], v[16:31]
    v_bitop3_b32 v12, v12, v64, s6 bitop3:96
    ds_read_b128 v[64:67], v4 offset:28672
    s_waitcnt lgkmcnt(3)
    v_mfma_f32_32x32x16_bf16 v[16:31], a[100:103], v[68:71], v[16:31]
    v_bitop3_b32 v12, v12, v68, s6 bitop3:96
    ds_read_b128 v[68:71], v4 offset:29696
    s_waitcnt lgkmcnt(3)
    v_mfma_f32_32x32x16_bf16 v[16:31], a[104:107], v[72:75], v[16:31]
    v_bitop3_b32 v12, v12, v72, s6 bitop3:96
    ds_read_b128 v[72:75], v4 offset:30720
    s_waitcnt lgkmcnt(3)
    v_mfma_f32_32x32x16_bf16 v[16:31], a[108:111], v[76:79], v[16:31]
    v_bitop3_b32 v12, v12, v76, s6 bitop3:96
    ds_read_b128 v[76:79], v4 offset:31744
    s_waitcnt lgkmcnt(3)
    v_mfma_f32_32x32x16_bf16 v[16:31], a[112:115], v[64:67], v[16:31]
    v_bitop3_b32 v12, v12, v64, s6 bitop3:96
    v_mov_b32 v7, s28
    s_sub_u32 s53, s28, 6
    v_mov_b32 v7, s28
    ds_read_b128 v[64:67], v4 offset:0
    s_waitcnt lgkmcnt(3)
    v_mfma_f32_32x32x16_bf16 v[16:31], a[116:119], v[68:71], v[16:31]
    v_bitop3_b32 v12, v12, v68, s6 bitop3:96
    s_max_i32 s53, s53, 0
    s_waitcnt vmcnt(1)
    buffer_store_dword v7, v2, s[8:11], s37 offen sc1
    ds_read_b128 v[68:71], v4 offset:1024
    s_waitcnt lgkmcnt(3)
    v_mfma_f32_32x32x16_bf16 v[16:31], a[120:123], v[72:75], v[16:31]
    v_bitop3_b32 v12, v12, v72, s6 bitop3:96
    ds_read_b128 v[72:75], v4 offset:2048
    s_waitcnt lgkmcnt(3)
    v_mfma_f32_32x32x16_bf16 v[16:31], a[124:127], v[76:79], v[16:31]
    v_bitop3_b32 v12, v12, v76, s6 bitop3:96
    buffer_load_dword v3, v1, s[8:11], s33 offen sc1
    ds_read_b128 v[76:79], v4 offset:3072
    s_waitcnt lgkmcnt(3)
    v_mfma_f32_32x32x16_bf16 v[32:47], v[64:67], a[128:131], 0
    v_and_b32 v12, 1, v12
    v_cmp_eq_u32 vcc, 0, v12
    buffer_load_dword v9, v8, s[8:11], s63 offen sc1
    ds_read_b128 v[64:67], v4 offset:4096
    s_waitcnt lgkmcnt(3)
    v_mfma_f32_32x32x16_bf16 v[32:47], v[68:71], a[132:135], v[32:47]
    s_cbranch_vccnz L_redo_118
    ds_read_b128 v[68:71], v4 offset:5120
    s_waitcnt lgkmcnt(3)
    v_mfma_f32_32x32x16_bf16 v[32:47], v[72:75], a[136:139], v[32:47]
    v_cvt_pk_bf16_f32 v88, v16, v17
    v_cvt_pk_bf16_f32 v89, v18, v19
    ds_read_b128 v[72:75], v4 offset:6144
    s_waitcnt lgkmcnt(3)
    v_mfma_f32_32x32x16_bf16 v[32:47], v[76:79], a[140:143], v[32:47]
    v_cvt_pk_bf16_f32 v90, v20, v21
    v_cvt_pk_bf16_f32 v91, v22, v23
    ds_read_b128 v[76:79], v4 offset:7168
    s_waitcnt lgkmcnt(3)
    v_mfma_f32_32x32x16_bf16 v[32:47], v[64:67], a[144:147], v[32:47]
    buffer_store_dwordx4 v[88:91], v5, s[8:11], s30 offen offset:0 sc1
    v_cvt_pk_bf16_f32 v92, v24, v25
    ds_read_b128 v[64:67], v4 offset:8192
    s_waitcnt lgkmcnt(3)
    v_mfma_f32_32x32x16_bf16 v[32:47], v[68:71], a[148:151], v[32:47]
    v_cvt_pk_bf16_f32 v93, v26, v27
    v_cvt_pk_bf16_f32 v94, v28, v29
    ds_read_b128 v[68:71], v4 offset:9216
    s_waitcnt lgkmcnt(3)
    v_mfma_f32_32x32x16_bf16 v[32:47], v[72:75], a[152:155], v[32:47]
    v_cvt_pk_bf16_f32 v95, v30, v31
    buffer_store_dwordx4 v[92:95], v5, s[8:11], s30 offen offset:512 sc1
    ds_read_b128 v[72:75], v4 offset:10240
    s_waitcnt lgkmcnt(3)
    v_mfma_f32_32x32x16_bf16 v[32:47], v[76:79], a[156:159], v[32:47]
    ds_read_b128 v[76:79], v4 offset:11264
    s_waitcnt lgkmcnt(3)
    v_mfma_f32_32x32x16_bf16 v[32:47], v[64:67], a[160:163], v[32:47]
    ds_read_b128 v[64:67], v4 offset:12288
    s_waitcnt lgkmcnt(3)
    v_mfma_f32_32x32x16_bf16 v[32:47], v[68:71], a[164:167], v[32:47]
    ds_read_b128 v[68:71], v4 offset:13312
    s_waitcnt lgkmcnt(3)
    v_mfma_f32_32x32x16_bf16 v[32:47], v[72:75], a[168:171], v[32:47]
    ds_read_b128 v[72:75], v4 offset:14336
    s_waitcnt lgkmcnt(3)
    v_mfma_f32_32x32x16_bf16 v[32:47], v[76:79], a[172:175], v[32:47]
    ds_read_b128 v[76:79], v4 offset:15360
    s_waitcnt lgkmcnt(3)
    v_mfma_f32_32x32x16_bf16 v[32:47], v[64:67], a[176:179], v[32:47]
    ds_read_b128 v[64:67], v4 offset:16384
    s_waitcnt lgkmcnt(3)
    v_mfma_f32_32x32x16_bf16 v[32:47], v[68:71], a[180:183], v[32:47]
    ds_read_b128 v[68:71], v4 offset:17408
    s_waitcnt lgkmcnt(3)
    v_mfma_f32_32x32x16_bf16 v[32:47], v[72:75], a[184:187], v[32:47]
    ds_read_b128 v[72:75], v4 offset:18432
    s_waitcnt lgkmcnt(3)
    v_mfma_f32_32x32x16_bf16 v[32:47], v[76:79], a[188:191], v[32:47]
    ds_read_b128 v[76:79], v4 offset:19456
    s_waitcnt lgkmcnt(3)
    v_mfma_f32_32x32x16_bf16 v[32:47], v[64:67], a[192:195], v[32:47]
    ds_read_b128 v[64:67], v4 offset:20480
    s_waitcnt lgkmcnt(3)
    v_mfma_f32_32x32x16_bf16 v[32:47], v[68:71], a[196:199], v[32:47]
    s_and_b32 s43, s36, 63
    s_mul_i32 s43, s43, 32768
    ds_read_b128 v[68:71], v4 offset:21504
    s_waitcnt lgkmcnt(3)
    v_mfma_f32_32x32x16_bf16 v[32:47], v[72:75], a[200:203], v[32:47]
    s_add_u32 s46, s43, s48
    s_add_u32 s47, s43, s49
    ds_read_b128 v[72:75], v4 offset:22528
    s_waitcnt lgkmcnt(3)
    v_mfma_f32_32x32x16_bf16 v[32:47], v[76:79], a[204:207], v[32:47]
    s_add_u32 s36, s36, 1
    s_sub_u32 s44, s44, s35
    ds_read_b128 v[76:79], v4 offset:23552
    s_waitcnt lgkmcnt(3)
    v_mfma_f32_32x32x16_bf16 v[32:47], v[64:67], a[208:211], v[32:47]
    s_sub_u32 s45, s45, s35
    s_sub_u32 s35, 32768, s35
    ds_read_b128 v[64:67], v4 offset:24576
    s_waitcnt lgkmcnt(3)
    v_mfma_f32_32x32x16_bf16 v[32:47], v[68:71], a[212:215], v[32:47]
    s_add_u32 s44, s44, s35
    s_add_u32 s45, s45, s35
    ds_read_b128 v[68:71], v4 offset:25600
    s_waitcnt lgkmcnt(3)
    v_mfma_f32_32x32x16_bf16 v[32:47], v[72:75], a[216:219], v[32:47]
    s_waitcnt vmcnt(2)
    v_cmp_gt_u32 vcc, s36, v3
    v_cmp_gt_u32 s[54:55], s53, v9
    s_branch L_mid_119
L_tail0_120:
    ds_read_b128 v[76:79], v4 offset:27648
    s_waitcnt lgkmcnt(3)
    v_mfma_f32_32x32x16_bf16 v[32:47], v[64:67], a[224:227], v[32:47]
    ds_read_b128 v[64:67], v4 offset:28672
    s_waitcnt lgkmcnt(3)
    v_mfma_f32_32x32x16_bf16 v[32:47], v[68:71], a[228:231], v[32:47]
    ds_read_b128 v[68:71], v4 offset:29696
    s_waitcnt lgkmcnt(3)
    v_mfma_f32_32x32x16_bf16 v[32:47], v[72:75], a[232:235], v[32:47]
    ds_read_b128 v[72:75], v4 offset:30720
    s_waitcnt lgkmcnt(3)
    v_mfma_f32_32x32x16_bf16 v[32:47], v[76:79], a[236:239], v[32:47]
    ds_read_b128 v[76:79], v4 offset:31744
    s_waitcnt lgkmcnt(3)
    v_mfma_f32_32x32x16_bf16 v[32:47], v[64:67], a[240:243], v[32:47]
    ds_read_b128 v[64:67], v4 offset:0
    s_waitcnt lgkmcnt(3)
    v_mfma_f32_32x32x16_bf16 v[32:47], v[68:71], a[244:247], v[32:47]
    ds_read_b128 v[68:71], v4 offset:1024
    s_waitcnt lgkmcnt(3)
    v_mfma_f32_32x32x16_bf16 v[32:47], v[72:75], a[248:251], v[32:47]
    ds_read_b128 v[72:75], v4 offset:2048
    s_waitcnt lgkmcnt(3)
    v_mfma_f32_32x32x16_bf16 v[32:47], v[76:79], a[252:255], v[32:47]
    ds_read_b128 v[76:79], v4 offset:3072
    s_waitcnt lgkmcnt(3)
    v_mfma_f32_32x32x16_bf16 v[48:63], v[128:131], v[64:67], 0
    ds_read_b128 v[64:67], v4 offset:4096
    s_waitcnt lgkmcnt(3)
    v_mfma_f32_32x32x16_bf16 v[48:63], v[132:135], v[68:71], v[48:63]
    ds_read_b128 v[68:71], v4 offset:5120
    s_waitcnt lgkmcnt(3)
    v_mfma_f32_32x32x16_bf16 v[48:63], v[136:139], v[72:75], v[48:63]
    v_cvt_pk_bf16_f32 v88, v32, v33
    v_cvt_pk_bf16_f32 v89, v34, v35
    ds_read_b128 v[72:75], v4 offset:6144
    s_waitcnt lgkmcnt(3)
    v_mfma_f32_32x32x16_bf16 v[48:63], v[140:143], v[76:79], v[48:63]
    v_cvt_pk_bf16_f32 v90, v40, v41
    v_cvt_pk_bf16_f32 v91, v42, v43
    ds_read_b128 v[76:79], v4 offset:7168
    s_waitcnt lgkmcnt(3)
    v_mfma_f32_32x32x16_bf16 v[48:63], v[144:147], v[64:67], v[48:63]
    buffer_store_dwordx4 v[88:91], v6, s[8:11], s31 offen offset:0 sc1
    v_cvt_pk_bf16_f32 v92, v36, v37
    ds_read_b128 v[64:67], v4 offset:8192
    s_waitcnt lgkmcnt(3)
    v_mfma_f32_32x32x16_bf16 v[48:63], v[148:151], v[68:71], v[48:63]
    v_cvt_pk_bf16_f32 v93, v38, v39
    v_cvt_pk_bf16_f32 v94, v44, v45
    ds_read_b128 v[68:71], v4 offset:9216
    s_waitcnt lgkmcnt(3)
    v_mfma_f32_32x32x16_bf16 v[48:63], v[152:155], v[72:75], v[48:63]
    v_cvt_pk_bf16_f32 v95, v46, v47
    buffer_store_dwordx4 v[92:95], v6, s[8:11], s31 offen offset:512 sc1
    ds_read_b128 v[72:75], v4 offset:10240
    s_waitcnt lgkmcnt(3)
    v_mfma_f32_32x32x16_bf16 v[48:63], v[156:159], v[76:79], v[48:63]
    ds_read_b128 v[76:79], v4 offset:11264
    s_waitcnt lgkmcnt(3)
    v_mfma_f32_32x32x16_bf16 v[48:63], v[160:163], v[64:67], v[48:63]
    ds_read_b128 v[64:67], v4 offset:12288
    s_waitcnt lgkmcnt(3)
    v_mfma_f32_32x32x16_bf16 v[48:63], v[164:167], v[68:71], v[48:63]
    v_add_u32 v11, 1, v7
    ds_read_b128 v[68:71], v4 offset:13312
    s_waitcnt lgkmcnt(3)
    v_mfma_f32_32x32x16_bf16 v[48:63], v[168:171], v[72:75], v[48:63]
    s_waitcnt vmcnt(2)
    buffer_store_dword v11, v2, s[8:11], s34 offen sc1
    ds_read_b128 v[72:75], v4 offset:14336
    s_waitcnt lgkmcnt(3)
    v_mfma_f32_32x32x16_bf16 v[48:63], v[172:175], v[76:79], v[48:63]
    ds_read_b128 v[76:79], v4 offset:15360
    s_waitcnt lgkmcnt(3)
    v_mfma_f32_32x32x16_bf16 v[48:63], v[176:179], v[64:67], v[48:63]
    ds_read_b128 v[64:67], v4 offset:16384
    s_waitcnt lgkmcnt(3)
    v_mfma_f32_32x32x16_bf16 v[48:63], v[180:183], v[68:71], v[48:63]
    ds_read_b128 v[68:71], v4 offset:17408
    s_waitcnt lgkmcnt(3)
    v_mfma_f32_32x32x16_bf16 v[48:63], v[184:187], v[72:75], v[48:63]
    ds_read_b128 v[72:75], v4 offset:18432
    s_waitcnt lgkmcnt(3)
    v_mfma_f32_32x32x16_bf16 v[48:63], v[188:191], v[76:79], v[48:63]
    ds_read_b128 v[76:79], v4 offset:19456
    s_waitcnt lgkmcnt(3)
    v_mfma_f32_32x32x16_bf16 v[48:63], v[192:195], v[64:67], v[48:63]
    ds_read_b128 v[64:67], v4 offset:20480
    s_waitcnt lgkmcnt(3)
    v_mfma_f32_32x32x16_bf16 v[48:63], v[196:199], v[68:71], v[48:63]
    ds_read_b128 v[68:71], v4 offset:21504
    s_waitcnt lgkmcnt(3)
    v_mfma_f32_32x32x16_bf16 v[48:63], v[200:203], v[72:75], v[48:63]
    ds_read_b128 v[72:75], v4 offset:22528
    s_waitcnt lgkmcnt(3)
    v_mfma_f32_32x32x16_bf16 v[48:63], v[204:207], v[76:79], v[48:63]
    ds_read_b128 v[76:79], v4 offset:23552
    s_waitcnt lgkmcnt(3)
    v_mfma_f32_32x32x16_bf16 v[48:63], v[208:211], v[64:67], v[48:63]
    ds_read_b128 v[64:67], v4 offset:24576
    s_waitcnt lgkmcnt(3)
    v_mfma_f32_32x32x16_bf16 v[48:63], v[212:215], v[68:71], v[48:63]
    ds_read_b128 v[68:71], v4 offset:25600
    s_waitcnt lgkmcnt(3)
    v_mfma_f32_32x32x16_bf16 v[48:63], v[216:219], v[72:75], v[48:63]
    ds_read_b128 v[72:75], v4 offset:26624
    s_waitcnt lgkmcnt(3)
    v_mfma_f32_32x32x16_bf16 v[48:63], v[220:223], v[76:79], v[48:63]
    ds_read_b128 v[76:79], v4 offset:27648
    s_waitcnt lgkmcnt(3)
    v_mfma_f32_32x32x16_bf16 v[48:63], v[224:227], v[64:67], v[48:63]
    ds_read_b128 v[64:67], v4 offset:28672
    s_waitcnt lgkmcnt(3)
    v_mfma_f32_32x32x16_bf16 v[48:63], v[228:231], v[68:71], v[48:63]
    ds_read_b128 v[68:71], v4 offset:29696
    s_waitcnt lgkmcnt(3)
    v_mfma_f32_32x32x16_bf16 v[48:63], v[232:235], v[72:75], v[48:63]
    ds_read_b128 v[72:75], v4 offset:30720
    s_waitcnt lgkmcnt(3)
    v_mfma_f32_32x32x16_bf16 v[48:63], v[236:239], v[76:79], v[48:63]
    ds_read_b128 v[76:79], v4 offset:31744
    s_waitcnt lgkmcnt(3)
    v_mfma_f32_32x32x16_bf16 v[48:63], v[240:243], v[64:67], v[48:63]
    s_waitcnt lgkmcnt(2)
    v_mfma_f32_32x32x16_bf16 v[48:63], v[244:247], v[68:71], v[48:63]
    s_waitcnt lgkmcnt(1)
    v_mfma_f32_32x32x16_bf16 v[48:63], v[248:251], v[72:75], v[48:63]
    s_waitcnt lgkmcnt(0)
    v_mfma_f32_32x32x16_bf16 v[48:63], v[252:255], v[76:79], v[48:63]
    s_add_u32 s28, s28, 1
    v_add_u32 v4, s35, v0
    v_mov_b32 v7, s28
    s_nop 8
    v_cvt_pk_bf16_f32 v88, v48, v49
    v_cvt_pk_bf16_f32 v89, v50, v51
    v_cvt_pk_bf16_f32 v90, v52, v53
    v_cvt_pk_bf16_f32 v91, v54, v55
    buffer_store_dwordx4 v[88:91], v5, s[8:11], s32 offen offset:0 sc1
    v_cvt_pk_bf16_f32 v92, v56, v57
    v_cvt_pk_bf16_f32 v93, v58, v59
    v_cvt_pk_bf16_f32 v94, v60, v61
    v_cvt_pk_bf16_f32 v95, v62, v63
    buffer_store_dwordx4 v[92:95], v5, s[8:11], s32 offen offset:512 sc1
    s_and_b32 s43, s28, 7
    s_mul_i32 s30, s43, 524288
    s_add_u32 s30, s30, s60
    s_mul_i32 s31, s43, 524288
    s_add_u32 s31, s31, s61
    s_mul_i32 s32, s43, 262144
    s_add_u32 s32, s32, s62
    s_waitcnt vmcnt(3)
    v_add_u32 v11, 1, v7
    buffer_store_dword v11, v2, s[8:11], s34 offen offset:16 sc1
    s_cmp_eq_u32 s28, 64
    s_cbranch_scc1 L_fin_117
    v_cmp_gt_u32 vcc, s53, v9
    s_cbranch_vccz L_bp_123_ok
L_bp_123:
    buffer_load_dword v9, v8, s[8:11], s63 offen sc1
    s_waitcnt vmcnt(0)
    v_cmp_gt_u32 vcc, s53, v9
    s_add_u32 s52, s52, 0x1000
    s_cmp_lt_u32 s52, 2147418112
    s_cbranch_vccz L_bp_123_ok
    s_cbranch_scc1 L_bp_123
    s_branch L_fail
L_bp_123_ok:
    s_branch L_item_115
L_fin_117:
    buffer_store_dword v11, v2, s[8:11], s34 offen sc1
    s_waitcnt vmcnt(0)
    buffer_store_dword v7, v2, s[8:11], s37 offen sc1
    s_branch L_end_124
L_redo_118:
    s_add_u32 s52, s52, 0x1000
    s_cmp_lt_u32 s52, 2147418112
    s_cbranch_scc0 L_fail
    s_waitcnt vmcnt(0) lgkmcnt(0)
    s_barrier
    s_branch L_dma_116
L_end_124:
    s_branch L_done
    .p2align 6
L_w:
    v_mov_b32 v112, v0
    v_lshlrev_b32 v0, 4, v112
    v_mov_b32 v2, 0
    s_mov_b32 s52, 0
    s_cmp_eq_u32 s24, 0
    s_cselect_b32 s42, 0, 0x40000000
    v_mov_b32 v10, s42
    s_lshr_b32 s42, s26, 2
    s_and_b32 s43, s26, 3
    s_mul_i32 s38, s42, 1048576
    s_lshl_b32 s30, s43, 8
    s_add_u32 s38, s38, s30
    s_mul_i32 s29, s27, 16777216
    s_mul_i32 s30, s42, 65536
    s_add_u32 s29, s29, s30
    s_lshr_b32 s30, s42, 1
    s_mul_i32 s30, s30, 0
    s_add_u32 s29, s29, s30
    s_add_u32 s29, s29, 142606336
    s_mul_i32 s30, s27, 8388608
    s_add_u32 s30, s30, 176160768
    s_lshl_b32 s33, s42, 15
    s_add_u32 s30, s30, s33
    s_lshl_b32 s33, s43, 13
    s_add_u32 s30, s30, s33
    s_lshl_b32 s33, s24, 11
    s_add_u32 s30, s30, s33
    s_lshl_b32 s34, s27, 15
    s_add_u32 s34, s34, 163840
    s_mul_i32 s43, s26, 1024
    s_add_u32 s34, s34, s43
    s_lshl_b32 s43, s24, 2
    s_add_u32 s34, s34, s43
    s_lshl_b32 s42, s42, 2
    s_lshl_b32 s33, s27, 15
    s_add_u32 s33, s33, 425984
    s_mul_i32 s43, s42, 128
    s_add_u32 s33, s33, s43
    v_lshrrev_b32 v1, 2, v112
    v_and_b32 v1, 3, v1
    v_mul_u32_u24 v1, 128, v1
    v_and_b32 v113, 3, v112
    v_lshl_add_u32 v1, v113, 2, v1
    v_lshrrev_b32 v8, 2, v112
    v_and_b32 v8, 3, v8
    v_mul_u32_u24 v8, 1024, v8
    v_and_b32 v113, 3, v112
    v_lshl_add_u32 v8, v113, 2, v8
    s_lshl_b32 s63, s27, 15
    s_add_u32 s63, s63, 98304
    s_cmp_lg_u32 s24, 0
    s_cbranch_scc1 L_na_125
    v_lshlrev_b32 v7, 2, v112
    s_mov_b64 exec, 15
    buffer_store_dword v2, v7, s[8:11], s34 offen sc1
    s_mov_b64 exec, -1
    v_mov_b64 v[16:17], 0
    v_mov_b64 v[18:19], 0
    s_add_u32 s42, s30, 0
    buffer_store_dwordx4 v[16:19], v0, s[8:11], s42 offen offset:0 sc1
    buffer_store_dwordx4 v[16:19], v0, s[8:11], s42 offen offset:1024 sc1
    buffer_store_dwordx4 v[16:19], v0, s[8:11], s42 offen offset:2048 sc1
    buffer_store_dwordx4 v[16:19], v0, s[8:11], s42 offen offset:3072 sc1
    s_add_u32 s42, s30, 4096
    buffer_store_dwordx4 v[16:19], v0, s[8:11], s42 offen offset:0 sc1
    buffer_store_dwordx4 v[16:19], v0, s[8:11], s42 offen offset:1024 sc1
    buffer_store_dwordx4 v[16:19], v0, s[8:11], s42 offen offset:2048 sc1
    buffer_store_dwordx4 v[16:19], v0, s[8:11], s42 offen offset:3072 sc1
    s_add_u32 s42, s30, 131072
    buffer_store_dwordx4 v[16:19], v0, s[8:11], s42 offen offset:0 sc1
    buffer_store_dwordx4 v[16:19], v0, s[8:11], s42 offen offset:1024 sc1
    buffer_store_dwordx4 v[16:19], v0, s[8:11], s42 offen offset:2048 sc1
    buffer_store_dwordx4 v[16:19], v0, s[8:11], s42 offen offset:3072 sc1
    s_add_u32 s42, s30, 135168
    buffer_store_dwordx4 v[16:19], v0, s[8:11], s42 offen offset:0 sc1
    buffer_store_dwordx4 v[16:19], v0, s[8:11], s42 offen offset:1024 sc1
    buffer_store_dwordx4 v[16:19], v0, s[8:11], s42 offen offset:2048 sc1
    buffer_store_dwordx4 v[16:19], v0, s[8:11], s42 offen offset:3072 sc1
    s_add_u32 s42, s30, 262144
    buffer_store_dwordx4 v[16:19], v0, s[8:11], s42 offen offset:0 sc1
    buffer_store_dwordx4 v[16:19], v0, s[8:11], s42 offen offset:1024 sc1
    buffer_store_dwordx4 v[16:19], v0, s[8:11], s42 offen offset:2048 sc1
    buffer_store_dwordx4 v[16:19], v0, s[8:11], s42 offen offset:3072 sc1
    s_add_u32 s42, s30, 266240
    buffer_store_dwordx4 v[16:19], v0, s[8:11], s42 offen offset:0 sc1
    buffer_store_dwordx4 v[16:19], v0, s[8:11], s42 offen offset:1024 sc1
    buffer_store_dwordx4 v[16:19], v0, s[8:11], s42 offen offset:2048 sc1
    buffer_store_dwordx4 v[16:19], v0, s[8:11], s42 offen offset:3072 sc1
    s_add_u32 s42, s30, 393216
    buffer_store_dwordx4 v[16:19], v0, s[8:11], s42 offen offset:0 sc1
    buffer_store_dwordx4 v[16:19], v0, s[8:11], s42 offen offset:1024 sc1
    buffer_store_dwordx4 v[16:19], v0, s[8:11], s42 offen offset:2048 sc1
    buffer_store_dwordx4 v[16:19], v0, s[8:11], s42 offen offset:3072 sc1
    s_add_u32 s42, s30, 397312
    buffer_store_dwordx4 v[16:19], v0, s[8:11], s42 offen offset:0 sc1
    buffer_store_dwordx4 v[16:19], v0, s[8:11], s42 offen offset:1024 sc1
    buffer_store_dwordx4 v[16:19], v0, s[8:11], s42 offen offset:2048 sc1
    buffer_store_dwordx4 v[16:19], v0, s[8:11], s42 offen offset:3072 sc1
    s_add_u32 s42, s30, 524288
    buffer_store_dwordx4 v[16:19], v0, s[8:11], s42 offen offset:0 sc1
    buffer_store_dwordx4 v[16:19], v0, s[8:11], s42 offen offset:1024 sc1
    buffer_store_dwordx4 v[16:19], v0, s[8:11], s42 offen offset:2048 sc1
    buffer_store_dwordx4 v[16:19], v0, s[8:11], s42 offen offset:3072 sc1
    s_add_u32 s42, s30, 528384
    buffer_store_dwordx4 v[16:19], v0, s[8:11], s42 offen offset:0 sc1
    buffer_store_dwordx4 v[16:19], v0, s[8:11], s42 offen offset:1024 sc1
    buffer_store_dwordx4 v[16:19], v0, s[8:11], s42 offen offset:2048 sc1
    buffer_store_dwordx4 v[16:19], v0, s[8:11], s42 offen offset:3072 sc1
    s_add_u32 s42, s30, 655360
    buffer_store_dwordx4 v[16:19], v0, s[8:11], s42 offen offset:0 sc1
    buffer_store_dwordx4 v[16:19], v0, s[8:11], s42 offen offset:1024 sc1
    buffer_store_dwordx4 v[16:19], v0, s[8:11], s42 offen offset:2048 sc1
    buffer_store_dwordx4 v[16:19], v0, s[8:11], s42 offen offset:3072 sc1
    s_add_u32 s42, s30, 659456
    buffer_store_dwordx4 v[16:19], v0, s[8:11], s42 offen offset:0 sc1
    buffer_store_dwordx4 v[16:19], v0, s[8:11], s42 offen offset:1024 sc1
    buffer_store_dwordx4 v[16:19], v0, s[8:11], s42 offen offset:2048 sc1
    buffer_store_dwordx4 v[16:19], v0, s[8:11], s42 offen offset:3072 sc1
    s_add_u32 s42, s30, 786432
    buffer_store_dwordx4 v[16:19], v0, s[8:11], s42 offen offset:0 sc1
    buffer_store_dwordx4 v[16:19], v0, s[8:11], s42 offen offset:1024 sc1
    buffer_store_dwordx4 v[16:19], v0, s[8:11], s42 offen offset:2048 sc1
    buffer_store_dwordx4 v[16:19], v0, s[8:11], s42 offen offset:3072 sc1
    s_add_u32 s42, s30, 790528
    buffer_store_dwordx4 v[16:19], v0, s[8:11], s42 offen offset:0 sc1
    buffer_store_dwordx4 v[16:19], v0, s[8:11], s42 offen offset:1024 sc1
    buffer_store_dwordx4 v[16:19], v0, s[8:11], s42 offen offset:2048 sc1
    buffer_store_dwordx4 v[16:19], v0, s[8:11], s42 offen offset:3072 sc1
    s_add_u32 s42, s30, 917504
    buffer_store_dwordx4 v[16:19], v0, s[8:11], s42 offen offset:0 sc1
    buffer_store_dwordx4 v[16:19], v0, s[8:11], s42 offen offset:1024 sc1
    buffer_store_dwordx4 v[16:19], v0, s[8:11], s42 offen offset:2048 sc1
    buffer_store_dwordx4 v[16:19], v0, s[8:11], s42 offen offset:3072 sc1
    s_add_u32 s42, s30, 921600
    buffer_store_dwordx4 v[16:19], v0, s[8:11], s42 offen offset:0 sc1
    buffer_store_dwordx4 v[16:19], v0, s[8:11], s42 offen offset:1024 sc1
    buffer_store_dwordx4 v[16:19], v0, s[8:11], s42 offen offset:2048 sc1
    buffer_store_dwordx4 v[16:19], v0, s[8:11], s42 offen offset:3072 sc1
    s_waitcnt vmcnt(0)
    v_mov_b32 v126, 1
    v_mov_b32 v127, 4
    s_mov_b64 exec, 1
    buffer_atomic_add v126, v127, s[12:15], 0 offen
    s_mov_b64 exec, -1
L_na_126:
L_na_125:
    s_mov_b32 s16, s74
    s_mov_b32 s17, s75
    s_mov_b32 s18, 4194304
    s_mov_b32 s19, 0x00020000
    v_mov_b32 v114, 0
    v_bfe_i32 v113, v112, 0, 1
    v_and_b32 v113, 16, v113
    v_xor_b32 v114, v114, v113
    v_bfe_i32 v113, v112, 1, 1
    v_and_b32 v113, 32, v113
    v_xor_b32 v114, v114, v113
    v_bfe_i32 v113, v112, 2, 1
    v_and_b32 v113, 64, v113
    v_xor_b32 v114, v114, v113
    v_bfe_i32 v113, v112, 3, 1
    v_and_b32 v113, 128, v113
    v_xor_b32 v114, v114, v113
    v_bfe_i32 v113, v112, 4, 1
    v_and_b32 v113, 64, v113
    v_xor_b32 v114, v114, v113
    v_bfe_i32 v113, v112, 5, 1
    v_and_b32 v113, 128, v113
    v_xor_b32 v114, v114, v113
    v_lshrrev_b32 v113, 4, v112
    v_mul_u32_u24 v113, 1024, v113
    v_xor_b32 v115, 32, v114
    v_add_u32 v114, v113, v114
    v_add_u32 v115, v113, v115
    s_mul_i32 s42, s24, 16384
    s_add_u32 s38, s38, s42
    s_lshl_b32 s39, s24, 12
    v_mov_b32 v116, 0
    v_bfe_i32 v113, v112, 0, 1
    v_and_b32 v113, 8, v113
    v_xor_b32 v116, v116, v113
    v_bfe_i32 v113, v112, 1, 1
    v_and_b32 v113, 16, v113
    v_xor_b32 v116, v116, v113
    v_bfe_i32 v113, v112, 2, 1
    v_and_b32 v113, 320, v113
    v_xor_b32 v116, v116, v113
    v_bfe_i32 v113, v112, 3, 1
    v_and_b32 v113, 640, v113
    v_xor_b32 v116, v116, v113
    v_bfe_i32 v113, v112, 4, 1
    v_and_b32 v113, 32, v113
    v_xor_b32 v116, v116, v113
    v_bfe_i32 v113, v112, 5, 1
    v_and_b32 v113, 1024, v113
    v_xor_b32 v116, v116, v113
    s_lshl_b32 s42, s24, 6
    v_xor_b32 v116, s42, v116
    s_cmp_eq_u32 s27, 0
    s_cselect_b32 s99, 0, 64
    v_mov_b32 v126, 132
    s_cmp_eq_u32 s99, 0
    s_cbranch_scc1 L_gate_127_ok
L_gate_127:
    s_sleep 8
    buffer_load_dword v127, v126, s[12:15], 0 offen sc1
    s_add_u32 s52, s52, 0x1000
    s_cmp_ge_u32 s52, 2147418112
    s_cbranch_scc1 L_fail
    s_waitcnt vmcnt(0)
    v_cmp_gt_u32 vcc, s99, v127
    s_cbranch_vccnz L_gate_127
L_gate_127_ok:
    s_add_u32 m0, s39, 0
    s_add_u32 s42, s38, 0
    buffer_load_dwordx4 v114, s[16:19], s42 offen  lds
    s_add_u32 m0, s39, 1024
    s_add_u32 s42, s38, 4096
    buffer_load_dwordx4 v114, s[16:19], s42 offen  lds
    s_add_u32 m0, s39, 2048
    s_add_u32 s42, s38, 8192
    buffer_load_dwordx4 v114, s[16:19], s42 offen  lds
    s_add_u32 m0, s39, 3072
    s_add_u32 s42, s38, 12288
    buffer_load_dwordx4 v114, s[16:19], s42 offen  lds
    s_add_u32 m0, s39, 16384
    s_add_u32 s42, s38, 65536
    buffer_load_dwordx4 v114, s[16:19], s42 offen  lds
    s_add_u32 m0, s39, 17408
    s_add_u32 s42, s38, 69632
    buffer_load_dwordx4 v114, s[16:19], s42 offen  lds
    s_add_u32 m0, s39, 18432
    s_add_u32 s42, s38, 73728
    buffer_load_dwordx4 v114, s[16:19], s42 offen  lds
    s_add_u32 m0, s39, 19456
    s_add_u32 s42, s38, 77824
    buffer_load_dwordx4 v114, s[16:19], s42 offen  lds
    s_add_u32 m0, s39, 32768
    s_add_u32 s42, s38, 131072
    buffer_load_dwordx4 v114, s[16:19], s42 offen  lds
    s_add_u32 m0, s39, 33792
    s_add_u32 s42, s38, 135168
    buffer_load_dwordx4 v114, s[16:19], s42 offen  lds
    s_add_u32 m0, s39, 34816
    s_add_u32 s42, s38, 139264
    buffer_load_dwordx4 v114, s[16:19], s42 offen  lds
    s_add_u32 m0, s39, 35840
    s_add_u32 s42, s38, 143360
    buffer_load_dwordx4 v114, s[16:19], s42 offen  lds
    s_add_u32 m0, s39, 49152
    s_add_u32 s42, s38, 196608
    buffer_load_dwordx4 v114, s[16:19], s42 offen  lds
    s_add_u32 m0, s39, 50176
    s_add_u32 s42, s38, 200704
    buffer_load_dwordx4 v114, s[16:19], s42 offen  lds
    s_add_u32 m0, s39, 51200
    s_add_u32 s42, s38, 204800
    buffer_load_dwordx4 v114, s[16:19], s42 offen  lds
    s_add_u32 m0, s39, 52224
    s_add_u32 s42, s38, 208896
    buffer_load_dwordx4 v114, s[16:19], s42 offen  lds
    s_add_u32 m0, s39, 65536
    s_add_u32 s42, s38, 262144
    buffer_load_dwordx4 v114, s[16:19], s42 offen  lds
    s_add_u32 m0, s39, 66560
    s_add_u32 s42, s38, 266240
    buffer_load_dwordx4 v114, s[16:19], s42 offen  lds
    s_add_u32 m0, s39, 67584
    s_add_u32 s42, s38, 270336
    buffer_load_dwordx4 v114, s[16:19], s42 offen  lds
    s_add_u32 m0, s39, 68608
    s_add_u32 s42, s38, 274432
    buffer_load_dwordx4 v114, s[16:19], s42 offen  lds
    s_add_u32 m0, s39, 81920
    s_add_u32 s42, s38, 327680
    buffer_load_dwordx4 v114, s[16:19], s42 offen  lds
    s_add_u32 m0, s39, 82944
    s_add_u32 s42, s38, 331776
    buffer_load_dwordx4 v114, s[16:19], s42 offen  lds
    s_add_u32 m0, s39, 83968
    s_add_u32 s42, s38, 335872
    buffer_load_dwordx4 v114, s[16:19], s42 offen  lds
    s_add_u32 m0, s39, 84992
    s_add_u32 s42, s38, 339968
    buffer_load_dwordx4 v114, s[16:19], s42 offen  lds
    s_add_u32 m0, s39, 98304
    s_add_u32 s42, s38, 393216
    buffer_load_dwordx4 v114, s[16:19], s42 offen  lds
    s_add_u32 m0, s39, 99328
    s_add_u32 s42, s38, 397312
    buffer_load_dwordx4 v114, s[16:19], s42 offen  lds
    s_add_u32 m0, s39, 100352
    s_add_u32 s42, s38, 401408
    buffer_load_dwordx4 v114, s[16:19], s42 offen  lds
    s_add_u32 m0, s39, 101376
    s_add_u32 s42, s38, 405504
    buffer_load_dwordx4 v114, s[16:19], s42 offen  lds
    s_add_u32 m0, s39, 114688
    s_add_u32 s42, s38, 458752
    buffer_load_dwordx4 v114, s[16:19], s42 offen  lds
    s_add_u32 m0, s39, 115712
    s_add_u32 s42, s38, 462848
    buffer_load_dwordx4 v114, s[16:19], s42 offen  lds
    s_add_u32 m0, s39, 116736
    s_add_u32 s42, s38, 466944
    buffer_load_dwordx4 v114, s[16:19], s42 offen  lds
    s_add_u32 m0, s39, 117760
    s_add_u32 s42, s38, 471040
    buffer_load_dwordx4 v114, s[16:19], s42 offen  lds
    s_add_u32 m0, s39, 131072
    s_add_u32 s42, s38, 524288
    buffer_load_dwordx4 v114, s[16:19], s42 offen  lds
    s_add_u32 m0, s39, 132096
    s_add_u32 s42, s38, 528384
    buffer_load_dwordx4 v114, s[16:19], s42 offen  lds
    s_add_u32 m0, s39, 133120
    s_add_u32 s42, s38, 532480
    buffer_load_dwordx4 v114, s[16:19], s42 offen  lds
    s_add_u32 m0, s39, 134144
    s_add_u32 s42, s38, 536576
    buffer_load_dwordx4 v114, s[16:19], s42 offen  lds
    s_add_u32 m0, s39, 147456
    s_add_u32 s42, s38, 589824
    buffer_load_dwordx4 v114, s[16:19], s42 offen  lds
    s_add_u32 m0, s39, 148480
    s_add_u32 s42, s38, 593920
    buffer_load_dwordx4 v114, s[16:19], s42 offen  lds
    s_add_u32 m0, s39, 149504
    s_add_u32 s42, s38, 598016
    buffer_load_dwordx4 v114, s[16:19], s42 offen  lds
    s_add_u32 m0, s39, 150528
    s_add_u32 s42, s38, 602112
    buffer_load_dwordx4 v114, s[16:19], s42 offen  lds
    s_waitcnt vmcnt(36) lgkmcnt(0)
    s_barrier
    v_add_u32 v117, 0, v116
    ds_read_b64_tr_b16 a[0:1], v117 offset:0
    ds_read_b64_tr_b16 a[2:3], v117 offset:4096
    ds_read_b64_tr_b16 a[4:5], v117 offset:2048
    ds_read_b64_tr_b16 a[6:7], v117 offset:6144
    ds_read_b64_tr_b16 a[8:9], v117 offset:8192
    ds_read_b64_tr_b16 a[10:11], v117 offset:12288
    ds_read_b64_tr_b16 a[12:13], v117 offset:10240
    ds_read_b64_tr_b16 a[14:15], v117 offset:14336
    s_waitcnt vmcnt(32) lgkmcnt(0)
    s_barrier
    s_add_u32 m0, s39, 0
    s_add_u32 s42, s38, 655360
    buffer_load_dwordx4 v114, s[16:19], s42 offen  lds
    s_add_u32 m0, s39, 1024
    s_add_u32 s42, s38, 659456
    buffer_load_dwordx4 v114, s[16:19], s42 offen  lds
    s_add_u32 m0, s39, 2048
    s_add_u32 s42, s38, 663552
    buffer_load_dwordx4 v114, s[16:19], s42 offen  lds
    s_add_u32 m0, s39, 3072
    s_add_u32 s42, s38, 667648
    buffer_load_dwordx4 v114, s[16:19], s42 offen  lds
    v_add_u32 v117, 16384, v116
    ds_read_b64_tr_b16 a[16:17], v117 offset:0
    ds_read_b64_tr_b16 a[18:19], v117 offset:4096
    ds_read_b64_tr_b16 a[20:21], v117 offset:2048
    ds_read_b64_tr_b16 a[22:23], v117 offset:6144
    ds_read_b64_tr_b16 a[24:25], v117 offset:8192
    ds_read_b64_tr_b16 a[26:27], v117 offset:12288
    ds_read_b64_tr_b16 a[28:29], v117 offset:10240
    ds_read_b64_tr_b16 a[30:31], v117 offset:14336
    s_waitcnt vmcnt(32) lgkmcnt(0)
    s_barrier
    s_add_u32 m0, s39, 16384
    s_add_u32 s42, s38, 720896
    buffer_load_dwordx4 v114, s[16:19], s42 offen  lds
    s_add_u32 m0, s39, 17408
    s_add_u32 s42, s38, 724992
    buffer_load_dwordx4 v114, s[16:19], s42 offen  lds
    s_add_u32 m0, s39, 18432
    s_add_u32 s42, s38, 729088
    buffer_load_dwordx4 v114, s[16:19], s42 offen  lds
    s_add_u32 m0, s39, 19456
    s_add_u32 s42, s38, 733184
    buffer_load_dwordx4 v114, s[16:19], s42 offen  lds
    v_add_u32 v117, 32768, v116
    ds_read_b64_tr_b16 a[32:33], v117 offset:0
    ds_read_b64_tr_b16 a[34:35], v117 offset:4096
    ds_read_b64_tr_b16 a[36:37], v117 offset:2048
    ds_read_b64_tr_b16 a[38:39], v117 offset:6144
    ds_read_b64_tr_b16 a[40:41], v117 offset:8192
    ds_read_b64_tr_b16 a[42:43], v117 offset:12288
    ds_read_b64_tr_b16 a[44:45], v117 offset:10240
    ds_read_b64_tr_b16 a[46:47], v117 offset:14336
    s_waitcnt vmcnt(32) lgkmcnt(0)
    s_barrier
    s_add_u32 m0, s39, 32768
    s_add_u32 s42, s38, 786432
    buffer_load_dwordx4 v114, s[16:19], s42 offen  lds
    s_add_u32 m0, s39, 33792
    s_add_u32 s42, s38, 790528
    buffer_load_dwordx4 v114, s[16:19], s42 offen  lds
    s_add_u32 m0, s39, 34816
    s_add_u32 s42, s38, 794624
    buffer_load_dwordx4 v114, s[16:19], s42 offen  lds
    s_add_u32 m0, s39, 35840
    s_add_u32 s42, s38, 798720
    buffer_load_dwordx4 v114, s[16:19], s42 offen  lds
    v_add_u32 v117, 49152, v116
    ds_read_b64_tr_b16 a[48:49], v117 offset:0
    ds_read_b64_tr_b16 a[50:51], v117 offset:4096
    ds_read_b64_tr_b16 a[52:53], v117 offset:2048
    ds_read_b64_tr_b16 a[54:55], v117 offset:6144
    ds_read_b64_tr_b16 a[56:57], v117 offset:8192
    ds_read_b64_tr_b16 a[58:59], v117 offset:12288
    ds_read_b64_tr_b16 a[60:61], v117 offset:10240
    ds_read_b64_tr_b16 a[62:63], v117 offset:14336
    s_waitcnt vmcnt(32) lgkmcnt(0)
    s_barrier
    s_add_u32 m0, s39, 49152
    s_add_u32 s42, s38, 851968
    buffer_load_dwordx4 v114, s[16:19], s42 offen  lds
    s_add_u32 m0, s39, 50176
    s_add_u32 s42, s38, 856064
    buffer_load_dwordx4 v114, s[16:19], s42 offen  lds
    s_add_u32 m0, s39, 51200
    s_add_u32 s42, s38, 860160
    buffer_load_dwordx4 v114, s[16:19], s42 offen  lds
    s_add_u32 m0, s39, 52224
    s_add_u32 s42, s38, 864256
    buffer_load_dwordx4 v114, s[16:19], s42 offen  lds
    v_add_u32 v117, 65536, v116
    ds_read_b64_tr_b16 a[64:65], v117 offset:0
    ds_read_b64_tr_b16 a[66:67], v117 offset:4096
    ds_read_b64_tr_b16 a[68:69], v117 offset:2048
    ds_read_b64_tr_b16 a[70:71], v117 offset:6144
    ds_read_b64_tr_b16 a[72:73], v117 offset:8192
    ds_read_b64_tr_b16 a[74:75], v117 offset:12288
    ds_read_b64_tr_b16 a[76:77], v117 offset:10240
    ds_read_b64_tr_b16 a[78:79], v117 offset:14336
    s_waitcnt vmcnt(32) lgkmcnt(0)
    s_barrier
    s_add_u32 m0, s39, 65536
    s_add_u32 s42, s38, 917504
    buffer_load_dwordx4 v114, s[16:19], s42 offen  lds
    s_add_u32 m0, s39, 66560
    s_add_u32 s42, s38, 921600
    buffer_load_dwordx4 v114, s[16:19], s42 offen  lds
    s_add_u32 m0, s39, 67584
    s_add_u32 s42, s38, 925696
    buffer_load_dwordx4 v114, s[16:19], s42 offen  lds
    s_add_u32 m0, s39, 68608
    s_add_u32 s42, s38, 929792
    buffer_load_dwordx4 v114, s[16:19], s42 offen  lds
    v_add_u32 v117, 81920, v116
    ds_read_b64_tr_b16 a[80:81], v117 offset:0
    ds_read_b64_tr_b16 a[82:83], v117 offset:4096
    ds_read_b64_tr_b16 a[84:85], v117 offset:2048
    ds_read_b64_tr_b16 a[86:87], v117 offset:6144
    ds_read_b64_tr_b16 a[88:89], v117 offset:8192
    ds_read_b64_tr_b16 a[90:91], v117 offset:12288
    ds_read_b64_tr_b16 a[92:93], v117 offset:10240
    ds_read_b64_tr_b16 a[94:95], v117 offset:14336
    s_waitcnt vmcnt(32) lgkmcnt(0)
    s_barrier
    s_add_u32 m0, s39, 81920
    s_add_u32 s42, s38, 983040
    buffer_load_dwordx4 v114, s[16:19], s42 offen  lds
    s_add_u32 m0, s39, 82944
    s_add_u32 s42, s38, 987136
    buffer_load_dwordx4 v114, s[16:19], s42 offen  lds
    s_add_u32 m0, s39, 83968
    s_add_u32 s42, s38, 991232
    buffer_load_dwordx4 v114, s[16:19], s42 offen  lds
    s_add_u32 m0, s39, 84992
    s_add_u32 s42, s38, 995328
    buffer_load_dwordx4 v114, s[16:19], s42 offen  lds
    v_add_u32 v117, 98304, v116
    ds_read_b64_tr_b16 a[96:97], v117 offset:0
    ds_read_b64_tr_b16 a[98:99], v117 offset:4096
    ds_read_b64_tr_b16 a[100:101], v117 offset:2048
    ds_read_b64_tr_b16 a[102:103], v117 offset:6144
    ds_read_b64_tr_b16 a[104:105], v117 offset:8192
    ds_read_b64_tr_b16 a[106:107], v117 offset:12288
    ds_read_b64_tr_b16 a[108:109], v117 offset:10240
    ds_read_b64_tr_b16 a[110:111], v117 offset:14336
    s_waitcnt vmcnt(32) lgkmcnt(0)
    s_barrier
    v_add_u32 v117, 114688, v116
    ds_read_b64_tr_b16 a[112:113], v117 offset:0
    ds_read_b64_tr_b16 a[114:115], v117 offset:4096
    ds_read_b64_tr_b16 a[116:117], v117 offset:2048
    ds_read_b64_tr_b16 a[118:119], v117 offset:6144
    ds_read_b64_tr_b16 a[120:121], v117 offset:8192
    ds_read_b64_tr_b16 a[122:123], v117 offset:12288
    ds_read_b64_tr_b16 a[124:125], v117 offset:10240
    ds_read_b64_tr_b16 a[126:127], v117 offset:14336
    s_waitcnt vmcnt(28) lgkmcnt(0)
    s_barrier
    v_add_u32 v117, 131072, v116
    ds_read_b64_tr_b16 a[128:129], v117 offset:0
    ds_read_b64_tr_b16 a[130:131], v117 offset:4096
    ds_read_b64_tr_b16 a[132:133], v117 offset:2048
    ds_read_b64_tr_b16 a[134:135], v117 offset:6144
    ds_read_b64_tr_b16 a[136:137], v117 offset:8192
    ds_read_b64_tr_b16 a[138:139], v117 offset:12288
    ds_read_b64_tr_b16 a[140:141], v117 offset:10240
    ds_read_b64_tr_b16 a[142:143], v117 offset:14336
    s_waitcnt vmcnt(24) lgkmcnt(0)
    s_barrier
    v_add_u32 v117, 147456, v116
    ds_read_b64_tr_b16 a[144:145], v117 offset:0
    ds_read_b64_tr_b16 a[146:147], v117 offset:4096
    ds_read_b64_tr_b16 a[148:149], v117 offset:2048
    ds_read_b64_tr_b16 a[150:151], v117 offset:6144
    ds_read_b64_tr_b16 a[152:153], v117 offset:8192
    ds_read_b64_tr_b16 a[154:155], v117 offset:12288
    ds_read_b64_tr_b16 a[156:157], v117 offset:10240
    ds_read_b64_tr_b16 a[158:159], v117 offset:14336
    s_waitcnt vmcnt(20) lgkmcnt(0)
    s_barrier
    v_add_u32 v117, 0, v116
    ds_read_b64_tr_b16 a[160:161], v117 offset:0
    ds_read_b64_tr_b16 a[162:163], v117 offset:4096
    ds_read_b64_tr_b16 a[164:165], v117 offset:2048
    ds_read_b64_tr_b16 a[166:167], v117 offset:6144
    ds_read_b64_tr_b16 a[168:169], v117 offset:8192
    ds_read_b64_tr_b16 a[170:171], v117 offset:12288
    ds_read_b64_tr_b16 a[172:173], v117 offset:10240
    ds_read_b64_tr_b16 a[174:175], v117 offset:14336
    s_waitcnt vmcnt(16) lgkmcnt(0)
    s_barrier
    v_add_u32 v117, 16384, v116
    ds_read_b64_tr_b16 a[176:177], v117 offset:0
    ds_read_b64_tr_b16 a[178:179], v117 offset:4096
    ds_read_b64_tr_b16 a[180:181], v117 offset:2048
    ds_read_b64_tr_b16 a[182:183], v117 offset:6144
    ds_read_b64_tr_b16 a[184:185], v117 offset:8192
    ds_read_b64_tr_b16 a[186:187], v117 offset:12288
    ds_read_b64_tr_b16 a[188:189], v117 offset:10240
    ds_read_b64_tr_b16 a[190:191], v117 offset:14336
    s_waitcnt vmcnt(12) lgkmcnt(0)
    s_barrier
    v_add_u32 v117, 32768, v116
    ds_read_b64_tr_b16 a[192:193], v117 offset:0
    ds_read_b64_tr_b16 a[194:195], v117 offset:4096
    ds_read_b64_tr_b16 a[196:197], v117 offset:2048
    ds_read_b64_tr_b16 a[198:199], v117 offset:6144
    ds_read_b64_tr_b16 a[200:201], v117 offset:8192
    ds_read_b64_tr_b16 a[202:203], v117 offset:12288
    ds_read_b64_tr_b16 a[204:205], v117 offset:10240
    ds_read_b64_tr_b16 a[206:207], v117 offset:14336
    s_waitcnt vmcnt(8) lgkmcnt(0)
    s_barrier
    v_add_u32 v117, 49152, v116
    ds_read_b64_tr_b16 a[208:209], v117 offset:0
    ds_read_b64_tr_b16 a[210:211], v117 offset:4096
    ds_read_b64_tr_b16 a[212:213], v117 offset:2048
    ds_read_b64_tr_b16 a[214:215], v117 offset:6144
    ds_read_b64_tr_b16 a[216:217], v117 offset:8192
    ds_read_b64_tr_b16 a[218:219], v117 offset:12288
    ds_read_b64_tr_b16 a[220:221], v117 offset:10240
    ds_read_b64_tr_b16 a[222:223], v117 offset:14336
    s_waitcnt vmcnt(4) lgkmcnt(0)
    s_barrier
    v_add_u32 v117, 65536, v116
    ds_read_b64_tr_b16 a[224:225], v117 offset:0
    ds_read_b64_tr_b16 a[226:227], v117 offset:4096
    ds_read_b64_tr_b16 a[228:229], v117 offset:2048
    ds_read_b64_tr_b16 a[230:231], v117 offset:6144
    ds_read_b64_tr_b16 a[232:233], v117 offset:8192
    ds_read_b64_tr_b16 a[234:235], v117 offset:12288
    ds_read_b64_tr_b16 a[236:237], v117 offset:10240
    ds_read_b64_tr_b16 a[238:239], v117 offset:14336
    s_waitcnt vmcnt(0) lgkmcnt(0)
    s_barrier
    v_add_u32 v117, 81920, v116
    ds_read_b64_tr_b16 a[240:241], v117 offset:0
    ds_read_b64_tr_b16 a[242:243], v117 offset:4096
    ds_read_b64_tr_b16 a[244:245], v117 offset:2048
    ds_read_b64_tr_b16 a[246:247], v117 offset:6144
    ds_read_b64_tr_b16 a[248:249], v117 offset:8192
    ds_read_b64_tr_b16 a[250:251], v117 offset:12288
    ds_read_b64_tr_b16 a[252:253], v117 offset:10240
    ds_read_b64_tr_b16 a[254:255], v117 offset:14336
    s_waitcnt lgkmcnt(0)
    s_barrier
    v_mbcnt_lo_u32_b32 v126, -1, 0
    v_mbcnt_hi_u32_b32 v126, -1, v126
    v_lshlrev_b32 v126, 5, v126
    v_cmp_gt_u32 vcc, 256, v126
    s_nop 1
    v_cndmask_b32 v126, 4, v126, vcc
    buffer_load_dword v127, v126, s[12:15], 0 offen sc1
    s_waitcnt vmcnt(0)
    v_readlane_b32 s98, v127, 8
    v_cmp_ne_u32 vcc, 32, v127
    s_nop 3
    s_and_b32 s5, vcc_lo, 0xff
    s_cmp_lt_u32 s98, 256
    s_cselect_b32 s98, 1, s5
    s_cmp_eq_u32 s98, 0
    s_cbranch_scc1 L_gw_128_done
L_gw_128:
    buffer_load_dword v127, v126, s[12:15], 0 offen sc1
    s_add_u32 s52, s52, 0x1000
    s_cmp_ge_u32 s52, 2147418112
    s_cbranch_scc1 L_fail
    s_waitcnt vmcnt(0)
    v_readlane_b32 s98, v127, 8
    s_nop 3
    s_cmp_ge_u32 s98, 256
    s_cbranch_scc1 L_gw_128_ok
    s_sleep 4
    s_branch L_gw_128
L_gw_128_ok:
    buffer_load_dword v127, v126, s[12:15], 0 offen sc1
    s_waitcnt vmcnt(0)
    v_cmp_ne_u32 vcc, 32, v127
    s_nop 3
    s_and_b32 s5, vcc_lo, 0xff
L_gw_128_done:
    s_mov_b32 s28, 0
    s_mov_b32 s36, 1
    s_mov_b32 s35, 0
    s_lshl_b32 s44, s24, 11
    s_lshl_b32 s45, s24, 12
    s_add_u32 s46, s29, s44
    s_add_u32 s47, s29, s45
    s_mov_b32 s48, s46
    s_mov_b32 s49, s47
    s_mov_b32 s60, s30
    s_mov_b32 s61, s31
    s_mov_b32 s62, s32
    v_mov_b32 v4, v0
L_item_129:
L_poll_135:
    buffer_load_dword v3, v1, s[8:11], s33 offen sc1
    s_waitcnt vmcnt(0)
    v_cmp_gt_u32 vcc, s36, v3
    s_add_u32 s52, s52, 0x1000
    s_cmp_lt_u32 s52, 2147418112
    s_cbranch_vccz L_poll_135_ok
    s_cbranch_scc1 L_poll_135
    s_branch L_fail
L_poll_135_ok:
L_dma_130:
    s_add_u32 m0, s44, 0
    s_add_u32 s42, s46, 0
    buffer_load_dwordx4 v0, s[8:11], s42 offen offset:0 sc1  lds
    buffer_load_dwordx4 v0, s[8:11], s42 offen offset:1024 sc1  lds
    s_add_u32 m0, s44, 8192
    s_add_u32 s42, s46, 8192
    buffer_load_dwordx4 v0, s[8:11], s42 offen offset:0 sc1  lds
    buffer_load_dwordx4 v0, s[8:11], s42 offen offset:1024 sc1  lds
    s_add_u32 m0, s45, 16384
    s_add_u32 s42, s47, 16384
    buffer_load_dwordx4 v0, s[8:11], s42 offen offset:0 sc1  lds
    buffer_load_dwordx4 v0, s[8:11], s42 offen offset:1024 sc1  lds
    buffer_load_dwordx4 v0, s[8:11], s42 offen offset:2048 sc1  lds
    buffer_load_dwordx4 v0, s[8:11], s42 offen offset:3072 sc1  lds
L_rd_136:
    s_bfe_u32 s6, s28, 65539
    s_waitcnt vmcnt(6)
    s_barrier
    ds_read_b128 v[64:67], v4 offset:0
    ds_read_b128 v[68:71], v4 offset:1024
    ds_read_b128 v[72:75], v4 offset:2048
    ds_read_b128 v[76:79], v4 offset:3072
    s_waitcnt lgkmcnt(3)
    v_mfma_f32_32x32x16_bf16 v[16:31], a[0:3], v[64:67], 0
    v_xor_b32 v12, s6, v64
    s_add_u32 m0, s45, 32768
    s_add_u32 s42, s47, 32768
    buffer_load_dwordx4 v0, s[8:11], s42 offen offset:0 sc1  lds
    ds_read_b128 v[64:67], v4 offset:4096
    s_waitcnt lgkmcnt(3)
    v_mfma_f32_32x32x16_bf16 v[16:31], a[4:7], v[68:71], v[16:31]
    v_bitop3_b32 v12, v12, v68, s6 bitop3:96
    ds_read_b128 v[68:71], v4 offset:5120
    s_waitcnt lgkmcnt(3)
    v_mfma_f32_32x32x16_bf16 v[16:31], a[8:11], v[72:75], v[16:31]
    v_bitop3_b32 v12, v12, v72, s6 bitop3:96
    buffer_load_dwordx4 v0, s[8:11], s42 offen offset:1024 sc1  lds
    ds_read_b128 v[72:75], v4 offset:6144
    s_waitcnt lgkmcnt(3)
    v_mfma_f32_32x32x16_bf16 v[16:31], a[12:15], v[76:79], v[16:31]
    v_bitop3_b32 v12, v12, v76, s6 bitop3:96
    ds_read_b128 v[76:79], v4 offset:7168
    s_waitcnt lgkmcnt(3)
    v_mfma_f32_32x32x16_bf16 v[16:31], a[16:19], v[64:67], v[16:31]
    v_bitop3_b32 v12, v12, v64, s6 bitop3:96
    buffer_load_dwordx4 v0, s[8:11], s42 offen offset:2048 sc1  lds
    s_waitcnt vmcnt(7)
    s_barrier
    ds_read_b128 v[64:67], v4 offset:8192
    s_waitcnt lgkmcnt(3)
    v_mfma_f32_32x32x16_bf16 v[16:31], a[20:23], v[68:71], v[16:31]
    v_bitop3_b32 v12, v12, v68, s6 bitop3:96
    ds_read_b128 v[68:71], v4 offset:9216
    s_waitcnt lgkmcnt(3)
    v_mfma_f32_32x32x16_bf16 v[16:31], a[24:27], v[72:75], v[16:31]
    v_bitop3_b32 v12, v12, v72, s6 bitop3:96
    buffer_load_dwordx4 v0, s[8:11], s42 offen offset:3072 sc1  lds
    ds_read_b128 v[72:75], v4 offset:10240
    s_waitcnt lgkmcnt(3)
    v_mfma_f32_32x32x16_bf16 v[16:31], a[28:31], v[76:79], v[16:31]
    v_bitop3_b32 v12, v12, v76, s6 bitop3:96
    s_add_u32 m0, s45, 49152
    s_add_u32 s42, s47, 49152
    ds_read_b128 v[76:79], v4 offset:11264
    s_waitcnt lgkmcnt(3)
    v_mfma_f32_32x32x16_bf16 v[16:31], a[32:35], v[64:67], v[16:31]
    v_bitop3_b32 v12, v12, v64, s6 bitop3:96
    buffer_load_dwordx4 v0, s[8:11], s42 offen offset:0 sc1  lds
    ds_read_b128 v[64:67], v4 offset:12288
    s_waitcnt lgkmcnt(3)
    v_mfma_f32_32x32x16_bf16 v[16:31], a[36:39], v[68:71], v[16:31]
    v_bitop3_b32 v12, v12, v68, s6 bitop3:96
    ds_read_b128 v[68:71], v4 offset:13312
    s_waitcnt lgkmcnt(3)
    v_mfma_f32_32x32x16_bf16 v[16:31], a[40:43], v[72:75], v[16:31]
    v_bitop3_b32 v12, v12, v72, s6 bitop3:96
    buffer_load_dwordx4 v0, s[8:11], s42 offen offset:1024 sc1  lds
    ds_read_b128 v[72:75], v4 offset:14336
    s_waitcnt lgkmcnt(3)
    v_mfma_f32_32x32x16_bf16 v[16:31], a[44:47], v[76:79], v[16:31]
    v_bitop3_b32 v12, v12, v76, s6 bitop3:96
    ds_read_b128 v[76:79], v4 offset:15360
    s_waitcnt lgkmcnt(3)
    v_mfma_f32_32x32x16_bf16 v[16:31], a[48:51], v[64:67], v[16:31]
    v_bitop3_b32 v12, v12, v64, s6 bitop3:96
    buffer_load_dwordx4 v0, s[8:11], s42 offen offset:2048 sc1  lds
    s_waitcnt vmcnt(7)
    s_barrier
    ds_read_b128 v[64:67], v4 offset:16384
    s_waitcnt lgkmcnt(3)
    v_mfma_f32_32x32x16_bf16 v[16:31], a[52:55], v[68:71], v[16:31]
    v_bitop3_b32 v12, v12, v68, s6 bitop3:96
    ds_read_b128 v[68:71], v4 offset:17408
    s_waitcnt lgkmcnt(3)
    v_mfma_f32_32x32x16_bf16 v[16:31], a[56:59], v[72:75], v[16:31]
    v_bitop3_b32 v12, v12, v72, s6 bitop3:96
    buffer_load_dwordx4 v0, s[8:11], s42 offen offset:3072 sc1  lds
    ds_read_b128 v[72:75], v4 offset:18432
    s_waitcnt lgkmcnt(3)
    v_mfma_f32_32x32x16_bf16 v[16:31], a[60:63], v[76:79], v[16:31]
    v_bitop3_b32 v12, v12, v76, s6 bitop3:96
    ds_read_b128 v[76:79], v4 offset:19456
    s_waitcnt lgkmcnt(3)
    v_mfma_f32_32x32x16_bf16 v[16:31], a[64:67], v[64:67], v[16:31]
    v_bitop3_b32 v12, v12, v64, s6 bitop3:96
    ds_read_b128 v[64:67], v4 offset:20480
    s_waitcnt lgkmcnt(3)
    v_mfma_f32_32x32x16_bf16 v[16:31], a[68:71], v[68:71], v[16:31]
    v_bitop3_b32 v12, v12, v68, s6 bitop3:96
    ds_read_b128 v[68:71], v4 offset:21504
    s_waitcnt lgkmcnt(3)
    v_mfma_f32_32x32x16_bf16 v[16:31], a[72:75], v[72:75], v[16:31]
    v_bitop3_b32 v12, v12, v72, s6 bitop3:96
    ds_read_b128 v[72:75], v4 offset:22528
    s_waitcnt lgkmcnt(3)
    v_mfma_f32_32x32x16_bf16 v[16:31], a[76:79], v[76:79], v[16:31]
    v_bitop3_b32 v12, v12, v76, s6 bitop3:96
    ds_read_b128 v[76:79], v4 offset:23552
    s_waitcnt lgkmcnt(3)
    v_mfma_f32_32x32x16_bf16 v[16:31], a[80:83], v[64:67], v[16:31]
    v_bitop3_b32 v12, v12, v64, s6 bitop3:96
    ds_read_b128 v[64:67], v4 offset:24576
    s_waitcnt lgkmcnt(3)
    v_mfma_f32_32x32x16_bf16 v[16:31], a[84:87], v[68:71], v[16:31]
    v_bitop3_b32 v12, v12, v68, s6 bitop3:96
    ds_read_b128 v[68:71], v4 offset:25600
    s_waitcnt lgkmcnt(3)
    v_mfma_f32_32x32x16_bf16 v[16:31], a[88:91], v[72:75], v[16:31]
    v_bitop3_b32 v12, v12, v72, s6 bitop3:96
    ds_read_b128 v[72:75], v4 offset:26624
    s_waitcnt lgkmcnt(3)
    v_mfma_f32_32x32x16_bf16 v[16:31], a[92:95], v[76:79], v[16:31]
    v_bitop3_b32 v12, v12, v76, s6 bitop3:96
    ds_read_b128 v[76:79], v4 offset:27648
    s_waitcnt lgkmcnt(3)
    v_mfma_f32_32x32x16_bf16 v[16:31], a[96:99], v[64:67], v[16:31]
    v_bitop3_b32 v12, v12, v64, s6 bitop3:96
    ds_read_b128 v[64:67], v4 offset:28672
    s_waitcnt lgkmcnt(3)
    v_mfma_f32_32x32x16_bf16 v[16:31], a[100:103], v[68:71], v[16:31]
    v_bitop3_b32 v12, v12, v68, s6 bitop3:96
    ds_read_b128 v[68:71], v4 offset:29696
    s_waitcnt lgkmcnt(3)
    v_mfma_f32_32x32x16_bf16 v[16:31], a[104:107], v[72:75], v[16:31]
    v_bitop3_b32 v12, v12, v72, s6 bitop3:96
    ds_read_b128 v[72:75], v4 offset:30720
    s_waitcnt lgkmcnt(3)
    v_mfma_f32_32x32x16_bf16 v[16:31], a[108:111], v[76:79], v[16:31]
    v_bitop3_b32 v12, v12, v76, s6 bitop3:96
    ds_read_b128 v[76:79], v4 offset:31744
    s_waitcnt lgkmcnt(3)
    v_mfma_f32_32x32x16_bf16 v[16:31], a[112:115], v[64:67], v[16:31]
    v_bitop3_b32 v12, v12, v64, s6 bitop3:96
    s_waitcnt vmcnt(4)
    s_barrier
    ds_read_b128 v[64:67], v4 offset:32768
    s_waitcnt lgkmcnt(3)
    v_mfma_f32_32x32x16_bf16 v[16:31], a[116:119], v[68:71], v[16:31]
    v_bitop3_b32 v12, v12, v68, s6 bitop3:96
    ds_read_b128 v[68:71], v4 offset:33792
    s_waitcnt lgkmcnt(3)
    v_mfma_f32_32x32x16_bf16 v[16:31], a[120:123], v[72:75], v[16:31]
    v_bitop3_b32 v12, v12, v72, s6 bitop3:96
    buffer_load_dword v3, v1, s[8:11], s33 offen sc1
    ds_read_b128 v[72:75], v4 offset:34816
    s_waitcnt lgkmcnt(3)
    v_mfma_f32_32x32x16_bf16 v[16:31], a[124:127], v[76:79], v[16:31]
    v_bitop3_b32 v12, v12, v76, s6 bitop3:96
    ds_read_b128 v[76:79], v4 offset:35840
    s_waitcnt lgkmcnt(3)
    v_mfma_f32_32x32x16_bf16 v[16:31], a[128:131], v[64:67], v[16:31]
    v_bitop3_b32 v12, v12, v64, s6 bitop3:96
    ds_read_b128 v[64:67], v4 offset:36864
    s_waitcnt lgkmcnt(3)
    v_mfma_f32_32x32x16_bf16 v[16:31], a[132:135], v[68:71], v[16:31]
    v_bitop3_b32 v12, v12, v68, s6 bitop3:96
    ds_read_b128 v[68:71], v4 offset:37888
    s_waitcnt lgkmcnt(3)
    v_mfma_f32_32x32x16_bf16 v[16:31], a[136:139], v[72:75], v[16:31]
    v_bitop3_b32 v12, v12, v72, s6 bitop3:96
    ds_read_b128 v[72:75], v4 offset:38912
    s_waitcnt lgkmcnt(3)
    v_mfma_f32_32x32x16_bf16 v[16:31], a[140:143], v[76:79], v[16:31]
    v_bitop3_b32 v12, v12, v76, s6 bitop3:96
    ds_read_b128 v[76:79], v4 offset:39936
    s_waitcnt lgkmcnt(3)
    v_mfma_f32_32x32x16_bf16 v[16:31], a[144:147], v[64:67], v[16:31]
    v_bitop3_b32 v12, v12, v64, s6 bitop3:96
    ds_read_b128 v[64:67], v4 offset:40960
    s_waitcnt lgkmcnt(3)
    v_mfma_f32_32x32x16_bf16 v[16:31], a[148:151], v[68:71], v[16:31]
    v_bitop3_b32 v12, v12, v68, s6 bitop3:96
    ds_read_b128 v[68:71], v4 offset:41984
    s_waitcnt lgkmcnt(3)
    v_mfma_f32_32x32x16_bf16 v[16:31], a[152:155], v[72:75], v[16:31]
    v_bitop3_b32 v12, v12, v72, s6 bitop3:96
    s_bfe_u32 s41, s28, 65539
    s_xor_b32 s41, s41, 1
    ds_read_b128 v[72:75], v4 offset:43008
    s_waitcnt lgkmcnt(3)
    v_mfma_f32_32x32x16_bf16 v[16:31], a[156:159], v[76:79], v[16:31]
    v_bitop3_b32 v12, v12, v76, s6 bitop3:96
    s_and_b32 s43, s36, 7
    s_mul_i32 s43, s43, 262144
    ds_read_b128 v[76:79], v4 offset:44032
    s_waitcnt lgkmcnt(3)
    v_mfma_f32_32x32x16_bf16 v[16:31], a[160:163], v[64:67], v[16:31]
    v_bitop3_b32 v12, v12, v64, s6 bitop3:96
    s_add_u32 s46, s43, s48
    s_add_u32 s47, s43, s49
    ds_read_b128 v[64:67], v4 offset:45056
    s_waitcnt lgkmcnt(3)
    v_mfma_f32_32x32x16_bf16 v[16:31], a[164:167], v[68:71], v[16:31]
    v_bitop3_b32 v12, v12, v68, s6 bitop3:96
    s_add_u32 s36, s36, 1
    s_sub_u32 s44, s44, s35
    ds_read_b128 v[68:71], v4 offset:46080
    s_waitcnt lgkmcnt(3)
    v_mfma_f32_32x32x16_bf16 v[16:31], a[168:171], v[72:75], v[16:31]
    v_bitop3_b32 v12, v12, v72, s6 bitop3:96
    s_sub_u32 s45, s45, s35
    s_sub_u32 s35, 65536, s35
    ds_read_b128 v[72:75], v4 offset:47104
    s_waitcnt lgkmcnt(3)
    v_mfma_f32_32x32x16_bf16 v[16:31], a[172:175], v[76:79], v[16:31]
    v_bitop3_b32 v12, v12, v76, s6 bitop3:96
    s_add_u32 s44, s44, s35
    s_add_u32 s45, s45, s35
    ds_read_b128 v[76:79], v4 offset:48128
    s_waitcnt lgkmcnt(3)
    v_mfma_f32_32x32x16_bf16 v[16:31], a[176:179], v[64:67], v[16:31]
    v_bitop3_b32 v12, v12, v64, s6 bitop3:96
    s_waitcnt vmcnt(0)
    v_cmp_gt_u32 vcc, s36, v3
L_mid_133:
    s_barrier
    ds_read_b128 v[64:67], v4 offset:49152
    s_waitcnt lgkmcnt(3)
    v_mfma_f32_32x32x16_bf16 v[16:31], a[180:183], v[68:71], v[16:31]
    v_bitop3_b32 v12, v12, v68, s6 bitop3:96
    s_cbranch_vccnz L_tail0_134
    ds_read_b128 v[68:71], v4 offset:50176
    s_waitcnt lgkmcnt(3)
    v_mfma_f32_32x32x16_bf16 v[16:31], a[184:187], v[72:75], v[16:31]
    v_bitop3_b32 v12, v12, v72, s6 bitop3:96
    s_add_u32 m0, s44, 0
    s_add_u32 s42, s46, 0
    buffer_load_dwordx4 v0, s[8:11], s42 offen offset:0 sc1  lds
    ds_read_b128 v[72:75], v4 offset:51200
    s_waitcnt lgkmcnt(3)
    v_mfma_f32_32x32x16_bf16 v[16:31], a[188:191], v[76:79], v[16:31]
    v_bitop3_b32 v12, v12, v76, s6 bitop3:96
    ds_read_b128 v[76:79], v4 offset:52224
    s_waitcnt lgkmcnt(3)
    v_mfma_f32_32x32x16_bf16 v[16:31], a[192:195], v[64:67], v[16:31]
    v_bitop3_b32 v12, v12, v64, s6 bitop3:96
    buffer_load_dwordx4 v0, s[8:11], s42 offen offset:1024 sc1  lds
    ds_read_b128 v[64:67], v4 offset:53248
    s_waitcnt lgkmcnt(3)
    v_mfma_f32_32x32x16_bf16 v[16:31], a[196:199], v[68:71], v[16:31]
    v_bitop3_b32 v12, v12, v68, s6 bitop3:96
    s_add_u32 m0, s44, 8192
    s_add_u32 s42, s46, 8192
    ds_read_b128 v[68:71], v4 offset:54272
    s_waitcnt lgkmcnt(3)
    v_mfma_f32_32x32x16_bf16 v[16:31], a[200:203], v[72:75], v[16:31]
    v_bitop3_b32 v12, v12, v72, s6 bitop3:96
    buffer_load_dwordx4 v0, s[8:11], s42 offen offset:0 sc1  lds
    ds_read_b128 v[72:75], v4 offset:55296
    s_waitcnt lgkmcnt(3)
    v_mfma_f32_32x32x16_bf16 v[16:31], a[204:207], v[76:79], v[16:31]
    v_bitop3_b32 v12, v12, v76, s6 bitop3:96
    ds_read_b128 v[76:79], v4 offset:56320
    s_waitcnt lgkmcnt(3)
    v_mfma_f32_32x32x16_bf16 v[16:31], a[208:211], v[64:67], v[16:31]
    v_bitop3_b32 v12, v12, v64, s6 bitop3:96
    buffer_load_dwordx4 v0, s[8:11], s42 offen offset:1024 sc1  lds
    ds_read_b128 v[64:67], v4 offset:57344
    s_waitcnt lgkmcnt(3)
    v_mfma_f32_32x32x16_bf16 v[16:31], a[212:215], v[68:71], v[16:31]
    v_bitop3_b32 v12, v12, v68, s6 bitop3:96
    s_add_u32 m0, s45, 16384
    s_add_u32 s42, s47, 16384
    ds_read_b128 v[68:71], v4 offset:58368
    s_waitcnt lgkmcnt(3)
    v_mfma_f32_32x32x16_bf16 v[16:31], a[216:219], v[72:75], v[16:31]
    v_bitop3_b32 v12, v12, v72, s6 bitop3:96
    buffer_load_dwordx4 v0, s[8:11], s42 offen offset:0 sc1  lds
    ds_read_b128 v[72:75], v4 offset:59392
    s_waitcnt lgkmcnt(3)
    v_mfma_f32_32x32x16_bf16 v[16:31], a[220:223], v[76:79], v[16:31]
    v_bitop3_b32 v12, v12, v76, s6 bitop3:96
    s_add_u32 s43, s28, 1
    v_mov_b32 v7, s43
    ds_read_b128 v[76:79], v4 offset:60416
    s_waitcnt lgkmcnt(3)
    v_mfma_f32_32x32x16_bf16 v[16:31], a[224:227], v[64:67], v[16:31]
    v_bitop3_b32 v12, v12, v64, s6 bitop3:96
    buffer_store_dword v7, v2, s[8:11], s34 offen sc1
    buffer_load_dwordx4 v0, s[8:11], s42 offen offset:1024 sc1  lds
    ds_read_b128 v[64:67], v4 offset:61440
    s_waitcnt lgkmcnt(3)
    v_mfma_f32_32x32x16_bf16 v[16:31], a[228:231], v[68:71], v[16:31]
    v_bitop3_b32 v12, v12, v68, s6 bitop3:96
    ds_read_b128 v[68:71], v4 offset:62464
    s_waitcnt lgkmcnt(3)
    v_mfma_f32_32x32x16_bf16 v[16:31], a[232:235], v[72:75], v[16:31]
    v_bitop3_b32 v12, v12, v72, s6 bitop3:96
    buffer_load_dwordx4 v0, s[8:11], s42 offen offset:2048 sc1  lds
    ds_read_b128 v[72:75], v4 offset:63488
    s_waitcnt lgkmcnt(3)
    v_mfma_f32_32x32x16_bf16 v[16:31], a[236:239], v[76:79], v[16:31]
    v_bitop3_b32 v12, v12, v76, s6 bitop3:96
    ds_read_b128 v[76:79], v4 offset:64512
    s_waitcnt lgkmcnt(3)
    v_mfma_f32_32x32x16_bf16 v[16:31], a[240:243], v[64:67], v[16:31]
    v_bitop3_b32 v12, v12, v64, s6 bitop3:96
    buffer_load_dwordx4 v0, s[8:11], s42 offen offset:3072 sc1  lds
    s_waitcnt lgkmcnt(2)
    v_mfma_f32_32x32x16_bf16 v[16:31], a[244:247], v[68:71], v[16:31]
    v_bitop3_b32 v12, v12, v68, s6 bitop3:96
    s_add_u32 m0, s45, 32768
    s_add_u32 s42, s47, 32768
    s_waitcnt lgkmcnt(1)
    v_mfma_f32_32x32x16_bf16 v[16:31], a[248:251], v[72:75], v[16:31]
    v_bitop3_b32 v12, v12, v72, s6 bitop3:96
    buffer_load_dwordx4 v0, s[8:11], s42 offen offset:0 sc1  lds
    s_waitcnt lgkmcnt(0)
    v_mfma_f32_32x32x16_bf16 v[16:31], a[252:255], v[76:79], v[16:31]
    v_bitop3_b32 v12, v12, v76, s6 bitop3:96
    v_and_b32 v12, 1, v12
    v_cmp_eq_u32 vcc, 0, v12
    s_nop 3
    s_cbranch_vccnz L_redo_132
    s_add_u32 s28, s28, 1
    s_bfe_u32 s6, s28, 65539
    v_add_u32 v4, s35, v0
    v_mov_b32 v7, s28
    s_nop 8
    v_cvt_pk_bf16_f32 v88, v16, v17
    v_cvt_pk_bf16_f32 v89, v18, v19
    v_cvt_pk_bf16_f32 v90, v20, v21
    v_cvt_pk_bf16_f32 v91, v22, v23
    v_and_or_b32 v88, v88, -2, s41
    buffer_store_dwordx4 v[88:91], v0, s[8:11], s30 offen offset:0 sc1
    v_cvt_pk_bf16_f32 v92, v24, v25
    v_cvt_pk_bf16_f32 v93, v26, v27
    v_cvt_pk_bf16_f32 v94, v28, v29
    v_cvt_pk_bf16_f32 v95, v30, v31
    v_and_or_b32 v92, v92, -2, s41
    buffer_store_dwordx4 v[92:95], v0, s[8:11], s30 offen offset:1024 sc1
    s_waitcnt vmcnt(10)
    s_barrier
    ds_read_b128 v[64:67], v4 offset:0
    ds_read_b128 v[68:71], v4 offset:1024
    ds_read_b128 v[72:75], v4 offset:2048
    ds_read_b128 v[76:79], v4 offset:3072
    s_waitcnt lgkmcnt(3)
    v_mfma_f32_32x32x16_bf16 v[16:31], a[0:3], v[64:67], 0
    v_xor_b32 v12, s6, v64
    buffer_load_dwordx4 v0, s[8:11], s42 offen offset:1024 sc1  lds
    ds_read_b128 v[64:67], v4 offset:4096
    s_waitcnt lgkmcnt(3)
    v_mfma_f32_32x32x16_bf16 v[16:31], a[4:7], v[68:71], v[16:31]
    v_bitop3_b32 v12, v12, v68, s6 bitop3:96
    s_and_b32 s43, s28, 7
    ds_read_b128 v[68:71], v4 offset:5120
    s_waitcnt lgkmcnt(3)
    v_mfma_f32_32x32x16_bf16 v[16:31], a[8:11], v[72:75], v[16:31]
    v_bitop3_b32 v12, v12, v72, s6 bitop3:96
    s_mul_i32 s30, s43, 131072
    buffer_load_dwordx4 v0, s[8:11], s42 offen offset:2048 sc1  lds
    ds_read_b128 v[72:75], v4 offset:6144
    s_waitcnt lgkmcnt(3)
    v_mfma_f32_32x32x16_bf16 v[16:31], a[12:15], v[76:79], v[16:31]
    v_bitop3_b32 v12, v12, v76, s6 bitop3:96
    s_add_u32 s30, s30, s60
    ds_read_b128 v[76:79], v4 offset:7168
    s_waitcnt lgkmcnt(3)
    v_mfma_f32_32x32x16_bf16 v[16:31], a[16:19], v[64:67], v[16:31]
    v_bitop3_b32 v12, v12, v64, s6 bitop3:96
    buffer_load_dwordx4 v0, s[8:11], s42 offen offset:3072 sc1  lds
    s_waitcnt vmcnt(11)
    s_barrier
    ds_read_b128 v[64:67], v4 offset:8192
    s_waitcnt lgkmcnt(3)
    v_mfma_f32_32x32x16_bf16 v[16:31], a[20:23], v[68:71], v[16:31]
    v_bitop3_b32 v12, v12, v68, s6 bitop3:96
    s_add_u32 m0, s45, 49152
    s_add_u32 s42, s47, 49152
    ds_read_b128 v[68:71], v4 offset:9216
    s_waitcnt lgkmcnt(3)
    v_mfma_f32_32x32x16_bf16 v[16:31], a[24:27], v[72:75], v[16:31]
    v_bitop3_b32 v12, v12, v72, s6 bitop3:96
    buffer_load_dwordx4 v0, s[8:11], s42 offen offset:0 sc1  lds
    ds_read_b128 v[72:75], v4 offset:10240
    s_waitcnt lgkmcnt(3)
    v_mfma_f32_32x32x16_bf16 v[16:31], a[28:31], v[76:79], v[16:31]
    v_bitop3_b32 v12, v12, v76, s6 bitop3:96
    ds_read_b128 v[76:79], v4 offset:11264
    s_waitcnt lgkmcnt(3)
    v_mfma_f32_32x32x16_bf16 v[16:31], a[32:35], v[64:67], v[16:31]
    v_bitop3_b32 v12, v12, v64, s6 bitop3:96
    buffer_load_dwordx4 v0, s[8:11], s42 offen offset:1024 sc1  lds
    ds_read_b128 v[64:67], v4 offset:12288
    s_waitcnt lgkmcnt(3)
    v_mfma_f32_32x32x16_bf16 v[16:31], a[36:39], v[68:71], v[16:31]
    v_bitop3_b32 v12, v12, v68, s6 bitop3:96
    ds_read_b128 v[68:71], v4 offset:13312
    s_waitcnt lgkmcnt(3)
    v_mfma_f32_32x32x16_bf16 v[16:31], a[40:43], v[72:75], v[16:31]
    v_bitop3_b32 v12, v12, v72, s6 bitop3:96
    buffer_load_dwordx4 v0, s[8:11], s42 offen offset:2048 sc1  lds
    ds_read_b128 v[72:75], v4 offset:14336
    s_waitcnt lgkmcnt(3)
    v_mfma_f32_32x32x16_bf16 v[16:31], a[44:47], v[76:79], v[16:31]
    v_bitop3_b32 v12, v12, v76, s6 bitop3:96
    ds_read_b128 v[76:79], v4 offset:15360
    s_waitcnt lgkmcnt(3)
    v_mfma_f32_32x32x16_bf16 v[16:31], a[48:51], v[64:67], v[16:31]
    v_bitop3_b32 v12, v12, v64, s6 bitop3:96
    buffer_load_dwordx4 v0, s[8:11], s42 offen offset:3072 sc1  lds
    s_waitcnt vmcnt(10)
    s_barrier
    ds_read_b128 v[64:67], v4 offset:16384
    s_waitcnt lgkmcnt(3)
    v_mfma_f32_32x32x16_bf16 v[16:31], a[52:55], v[68:71], v[16:31]
    v_bitop3_b32 v12, v12, v68, s6 bitop3:96
    ds_read_b128 v[68:71], v4 offset:17408
    s_waitcnt lgkmcnt(3)
    v_mfma_f32_32x32x16_bf16 v[16:31], a[56:59], v[72:75], v[16:31]
    v_bitop3_b32 v12, v12, v72, s6 bitop3:96
    ds_read_b128 v[72:75], v4 offset:18432
    s_waitcnt lgkmcnt(3)
    v_mfma_f32_32x32x16_bf16 v[16:31], a[60:63], v[76:79], v[16:31]
    v_bitop3_b32 v12, v12, v76, s6 bitop3:96
    ds_read_b128 v[76:79], v4 offset:19456
    s_waitcnt lgkmcnt(3)
    v_mfma_f32_32x32x16_bf16 v[16:31], a[64:67], v[64:67], v[16:31]
    v_bitop3_b32 v12, v12, v64, s6 bitop3:96
    ds_read_b128 v[64:67], v4 offset:20480
    s_waitcnt lgkmcnt(3)
    v_mfma_f32_32x32x16_bf16 v[16:31], a[68:71], v[68:71], v[16:31]
    v_bitop3_b32 v12, v12, v68, s6 bitop3:96
    ds_read_b128 v[68:71], v4 offset:21504
    s_waitcnt lgkmcnt(3)
    v_mfma_f32_32x32x16_bf16 v[16:31], a[72:75], v[72:75], v[16:31]
    v_bitop3_b32 v12, v12, v72, s6 bitop3:96
    ds_read_b128 v[72:75], v4 offset:22528
    s_waitcnt lgkmcnt(3)
    v_mfma_f32_32x32x16_bf16 v[16:31], a[76:79], v[76:79], v[16:31]
    v_bitop3_b32 v12, v12, v76, s6 bitop3:96
    ds_read_b128 v[76:79], v4 offset:23552
    s_waitcnt lgkmcnt(3)
    v_mfma_f32_32x32x16_bf16 v[16:31], a[80:83], v[64:67], v[16:31]
    v_bitop3_b32 v12, v12, v64, s6 bitop3:96
    ds_read_b128 v[64:67], v4 offset:24576
    s_waitcnt lgkmcnt(3)
    v_mfma_f32_32x32x16_bf16 v[16:31], a[84:87], v[68:71], v[16:31]
    v_bitop3_b32 v12, v12, v68, s6 bitop3:96
    ds_read_b128 v[68:71], v4 offset:25600
    s_waitcnt lgkmcnt(3)
    v_mfma_f32_32x32x16_bf16 v[16:31], a[88:91], v[72:75], v[16:31]
    v_bitop3_b32 v12, v12, v72, s6 bitop3:96
    ds_read_b128 v[72:75], v4 offset:26624
    s_waitcnt lgkmcnt(3)
    v_mfma_f32_32x32x16_bf16 v[16:31], a[92:95], v[76:79], v[16:31]
    v_bitop3_b32 v12, v12, v76, s6 bitop3:96
    ds_read_b128 v[76:79], v4 offset:27648
    s_waitcnt lgkmcnt(3)
    v_mfma_f32_32x32x16_bf16 v[16:31], a[96:99], v[64:67], v[16:31]
    v_bitop3_b32 v12, v12, v64, s6 bitop3:96
    ds_read_b128 v[64:67], v4 offset:28672
    s_waitcnt lgkmcnt(3)
    v_mfma_f32_32x32x16_bf16 v[16:31], a[100:103], v[68:71], v[16:31]
    v_bitop3_b32 v12, v12, v68, s6 bitop3:96
    ds_read_b128 v[68:71], v4 offset:29696
    s_waitcnt lgkmcnt(3)
    v_mfma_f32_32x32x16_bf16 v[16:31], a[104:107], v[72:75], v[16:31]
    v_bitop3_b32 v12, v12, v72, s6 bitop3:96
    ds_read_b128 v[72:75], v4 offset:30720
    s_waitcnt lgkmcnt(3)
    v_mfma_f32_32x32x16_bf16 v[16:31], a[108:111], v[76:79], v[16:31]
    v_bitop3_b32 v12, v12, v76, s6 bitop3:96
    ds_read_b128 v[76:79], v4 offset:31744
    s_waitcnt lgkmcnt(3)
    v_mfma_f32_32x32x16_bf16 v[16:31], a[112:115], v[64:67], v[16:31]
    v_bitop3_b32 v12, v12, v64, s6 bitop3:96
    s_waitcnt vmcnt(4)
    s_barrier
    ds_read_b128 v[64:67], v4 offset:32768
    s_waitcnt lgkmcnt(3)
    v_mfma_f32_32x32x16_bf16 v[16:31], a[116:119], v[68:71], v[16:31]
    v_bitop3_b32 v12, v12, v68, s6 bitop3:96
    ds_read_b128 v[68:71], v4 offset:33792
    s_waitcnt lgkmcnt(3)
    v_mfma_f32_32x32x16_bf16 v[16:31], a[120:123], v[72:75], v[16:31]
    v_bitop3_b32 v12, v12, v72, s6 bitop3:96
    buffer_load_dword v3, v1, s[8:11], s33 offen sc1
    ds_read_b128 v[72:75], v4 offset:34816
    s_waitcnt lgkmcnt(3)
    v_mfma_f32_32x32x16_bf16 v[16:31], a[124:127], v[76:79], v[16:31]
    v_bitop3_b32 v12, v12, v76, s6 bitop3:96
    ds_read_b128 v[76:79], v4 offset:35840
    s_waitcnt lgkmcnt(3)
    v_mfma_f32_32x32x16_bf16 v[16:31], a[128:131], v[64:67], v[16:31]
    v_bitop3_b32 v12, v12, v64, s6 bitop3:96
    ds_read_b128 v[64:67], v4 offset:36864
    s_waitcnt lgkmcnt(3)
    v_mfma_f32_32x32x16_bf16 v[16:31], a[132:135], v[68:71], v[16:31]
    v_bitop3_b32 v12, v12, v68, s6 bitop3:96
    ds_read_b128 v[68:71], v4 offset:37888
    s_waitcnt lgkmcnt(3)
    v_mfma_f32_32x32x16_bf16 v[16:31], a[136:139], v[72:75], v[16:31]
    v_bitop3_b32 v12, v12, v72, s6 bitop3:96
    ds_read_b128 v[72:75], v4 offset:38912
    s_waitcnt lgkmcnt(3)
    v_mfma_f32_32x32x16_bf16 v[16:31], a[140:143], v[76:79], v[16:31]
    v_bitop3_b32 v12, v12, v76, s6 bitop3:96
    ds_read_b128 v[76:79], v4 offset:39936
    s_waitcnt lgkmcnt(3)
    v_mfma_f32_32x32x16_bf16 v[16:31], a[144:147], v[64:67], v[16:31]
    v_bitop3_b32 v12, v12, v64, s6 bitop3:96
    ds_read_b128 v[64:67], v4 offset:40960
    s_waitcnt lgkmcnt(3)
    v_mfma_f32_32x32x16_bf16 v[16:31], a[148:151], v[68:71], v[16:31]
    v_bitop3_b32 v12, v12, v68, s6 bitop3:96
    ds_read_b128 v[68:71], v4 offset:41984
    s_waitcnt lgkmcnt(3)
    v_mfma_f32_32x32x16_bf16 v[16:31], a[152:155], v[72:75], v[16:31]
    v_bitop3_b32 v12, v12, v72, s6 bitop3:96
    s_bfe_u32 s41, s28, 65539
    s_xor_b32 s41, s41, 1
    ds_read_b128 v[72:75], v4 offset:43008
    s_waitcnt lgkmcnt(3)
    v_mfma_f32_32x32x16_bf16 v[16:31], a[156:159], v[76:79], v[16:31]
    v_bitop3_b32 v12, v12, v76, s6 bitop3:96
    s_and_b32 s43, s36, 7
    s_mul_i32 s43, s43, 262144
    ds_read_b128 v[76:79], v4 offset:44032
    s_waitcnt lgkmcnt(3)
    v_mfma_f32_32x32x16_bf16 v[16:31], a[160:163], v[64:67], v[16:31]
    v_bitop3_b32 v12, v12, v64, s6 bitop3:96
    s_add_u32 s46, s43, s48
    s_add_u32 s47, s43, s49
    ds_read_b128 v[64:67], v4 offset:45056
    s_waitcnt lgkmcnt(3)
    v_mfma_f32_32x32x16_bf16 v[16:31], a[164:167], v[68:71], v[16:31]
    v_bitop3_b32 v12, v12, v68, s6 bitop3:96
    s_add_u32 s36, s36, 1
    s_sub_u32 s44, s44, s35
    ds_read_b128 v[68:71], v4 offset:46080
    s_waitcnt lgkmcnt(3)
    v_mfma_f32_32x32x16_bf16 v[16:31], a[168:171], v[72:75], v[16:31]
    v_bitop3_b32 v12, v12, v72, s6 bitop3:96
    s_sub_u32 s45, s45, s35
    s_sub_u32 s35, 65536, s35
    ds_read_b128 v[72:75], v4 offset:47104
    s_waitcnt lgkmcnt(3)
    v_mfma_f32_32x32x16_bf16 v[16:31], a[172:175], v[76:79], v[16:31]
    v_bitop3_b32 v12, v12, v76, s6 bitop3:96
    s_add_u32 s44, s44, s35
    s_add_u32 s45, s45, s35
    ds_read_b128 v[76:79], v4 offset:48128
    s_waitcnt lgkmcnt(3)
    v_mfma_f32_32x32x16_bf16 v[16:31], a[176:179], v[64:67], v[16:31]
    v_bitop3_b32 v12, v12, v64, s6 bitop3:96
    s_waitcnt vmcnt(0)
    v_cmp_gt_u32 vcc, s36, v3
    s_branch L_mid_133
L_tail0_134:
    ds_read_b128 v[68:71], v4 offset:50176
    s_waitcnt lgkmcnt(3)
    v_mfma_f32_32x32x16_bf16 v[16:31], a[184:187], v[72:75], v[16:31]
    v_bitop3_b32 v12, v12, v72, s6 bitop3:96
    ds_read_b128 v[72:75], v4 offset:51200
    s_waitcnt lgkmcnt(3)
    v_mfma_f32_32x32x16_bf16 v[16:31], a[188:191], v[76:79], v[16:31]
    v_bitop3_b32 v12, v12, v76, s6 bitop3:96
    ds_read_b128 v[76:79], v4 offset:52224
    s_waitcnt lgkmcnt(3)
    v_mfma_f32_32x32x16_bf16 v[16:31], a[192:195], v[64:67], v[16:31]
    v_bitop3_b32 v12, v12, v64, s6 bitop3:96
    ds_read_b128 v[64:67], v4 offset:53248
    s_waitcnt lgkmcnt(3)
    v_mfma_f32_32x32x16_bf16 v[16:31], a[196:199], v[68:71], v[16:31]
    v_bitop3_b32 v12, v12, v68, s6 bitop3:96
    ds_read_b128 v[68:71], v4 offset:54272
    s_waitcnt lgkmcnt(3)
    v_mfma_f32_32x32x16_bf16 v[16:31], a[200:203], v[72:75], v[16:31]
    v_bitop3_b32 v12, v12, v72, s6 bitop3:96
    ds_read_b128 v[72:75], v4 offset:55296
    s_waitcnt lgkmcnt(3)
    v_mfma_f32_32x32x16_bf16 v[16:31], a[204:207], v[76:79], v[16:31]
    v_bitop3_b32 v12, v12, v76, s6 bitop3:96
    ds_read_b128 v[76:79], v4 offset:56320
    s_waitcnt lgkmcnt(3)
    v_mfma_f32_32x32x16_bf16 v[16:31], a[208:211], v[64:67], v[16:31]
    v_bitop3_b32 v12, v12, v64, s6 bitop3:96
    buffer_load_dword v3, v1, s[8:11], s33 offen sc1
    ds_read_b128 v[64:67], v4 offset:57344
    s_waitcnt lgkmcnt(3)
    v_mfma_f32_32x32x16_bf16 v[16:31], a[212:215], v[68:71], v[16:31]
    v_bitop3_b32 v12, v12, v68, s6 bitop3:96
    ds_read_b128 v[68:71], v4 offset:58368
    s_waitcnt lgkmcnt(3)
    v_mfma_f32_32x32x16_bf16 v[16:31], a[216:219], v[72:75], v[16:31]
    v_bitop3_b32 v12, v12, v72, s6 bitop3:96
    ds_read_b128 v[72:75], v4 offset:59392
    s_waitcnt lgkmcnt(3)
    v_mfma_f32_32x32x16_bf16 v[16:31], a[220:223], v[76:79], v[16:31]
    v_bitop3_b32 v12, v12, v76, s6 bitop3:96
    s_add_u32 s43, s28, 1
    v_mov_b32 v7, s43
    ds_read_b128 v[76:79], v4 offset:60416
    s_waitcnt lgkmcnt(3)
    v_mfma_f32_32x32x16_bf16 v[16:31], a[224:227], v[64:67], v[16:31]
    v_bitop3_b32 v12, v12, v64, s6 bitop3:96
    buffer_store_dword v7, v2, s[8:11], s34 offen sc1
    ds_read_b128 v[64:67], v4 offset:61440
    s_waitcnt lgkmcnt(3)
    v_mfma_f32_32x32x16_bf16 v[16:31], a[228:231], v[68:71], v[16:31]
    v_bitop3_b32 v12, v12, v68, s6 bitop3:96
    ds_read_b128 v[68:71], v4 offset:62464
    s_waitcnt lgkmcnt(3)
    v_mfma_f32_32x32x16_bf16 v[16:31], a[232:235], v[72:75], v[16:31]
    v_bitop3_b32 v12, v12, v72, s6 bitop3:96
    ds_read_b128 v[72:75], v4 offset:63488
    s_waitcnt lgkmcnt(3)
    v_mfma_f32_32x32x16_bf16 v[16:31], a[236:239], v[76:79], v[16:31]
    v_bitop3_b32 v12, v12, v76, s6 bitop3:96
    ds_read_b128 v[76:79], v4 offset:64512
    s_waitcnt lgkmcnt(3)
    v_mfma_f32_32x32x16_bf16 v[16:31], a[240:243], v[64:67], v[16:31]
    v_bitop3_b32 v12, v12, v64, s6 bitop3:96
    s_waitcnt lgkmcnt(2)
    v_mfma_f32_32x32x16_bf16 v[16:31], a[244:247], v[68:71], v[16:31]
    v_bitop3_b32 v12, v12, v68, s6 bitop3:96
    s_waitcnt lgkmcnt(1)
    v_mfma_f32_32x32x16_bf16 v[16:31], a[248:251], v[72:75], v[16:31]
    v_bitop3_b32 v12, v12, v72, s6 bitop3:96
    s_waitcnt lgkmcnt(0)
    v_mfma_f32_32x32x16_bf16 v[16:31], a[252:255], v[76:79], v[16:31]
    v_bitop3_b32 v12, v12, v76, s6 bitop3:96
    v_and_b32 v12, 1, v12
    v_cmp_eq_u32 vcc, 0, v12
    s_nop 3
    s_cbranch_vccnz L_redo_132
    s_add_u32 s28, s28, 1
    v_add_u32 v4, s35, v0
    v_mov_b32 v7, s28
    s_waitcnt vmcnt(1)
    v_cmp_gt_u32 vcc, s36, v3
    s_nop 2
    s_cbranch_vccnz L_notyet_137
    s_add_u32 m0, s44, 0
    s_add_u32 s42, s46, 0
    buffer_load_dwordx4 v0, s[8:11], s42 offen offset:0 sc1  lds
    buffer_load_dwordx4 v0, s[8:11], s42 offen offset:1024 sc1  lds
    s_add_u32 m0, s44, 8192
    s_add_u32 s42, s46, 8192
    buffer_load_dwordx4 v0, s[8:11], s42 offen offset:0 sc1  lds
    buffer_load_dwordx4 v0, s[8:11], s42 offen offset:1024 sc1  lds
    v_cvt_pk_bf16_f32 v88, v16, v17
    v_cvt_pk_bf16_f32 v89, v18, v19
    v_cvt_pk_bf16_f32 v90, v20, v21
    v_cvt_pk_bf16_f32 v91, v22, v23
    v_and_or_b32 v88, v88, -2, s41
    buffer_store_dwordx4 v[88:91], v0, s[8:11], s30 offen offset:0 sc1
    v_cvt_pk_bf16_f32 v92, v24, v25
    v_cvt_pk_bf16_f32 v93, v26, v27
    v_cvt_pk_bf16_f32 v94, v28, v29
    v_cvt_pk_bf16_f32 v95, v30, v31
    v_and_or_b32 v92, v92, -2, s41
    buffer_store_dwordx4 v[92:95], v0, s[8:11], s30 offen offset:1024 sc1
    s_and_b32 s43, s28, 7
    s_mul_i32 s30, s43, 131072
    s_add_u32 s30, s30, s60
    s_add_u32 m0, s45, 16384
    s_add_u32 s42, s47, 16384
    buffer_load_dwordx4 v0, s[8:11], s42 offen offset:0 sc1  lds
    buffer_load_dwordx4 v0, s[8:11], s42 offen offset:1024 sc1  lds
    buffer_load_dwordx4 v0, s[8:11], s42 offen offset:2048 sc1  lds
    buffer_load_dwordx4 v0, s[8:11], s42 offen offset:3072 sc1  lds
    s_branch L_rd_136
L_notyet_137:
    s_nop 3
    v_cvt_pk_bf16_f32 v88, v16, v17
    v_cvt_pk_bf16_f32 v89, v18, v19
    v_cvt_pk_bf16_f32 v90, v20, v21
    v_cvt_pk_bf16_f32 v91, v22, v23
    v_and_or_b32 v88, v88, -2, s41
    buffer_store_dwordx4 v[88:91], v0, s[8:11], s30 offen offset:0 sc1
    v_cvt_pk_bf16_f32 v92, v24, v25
    v_cvt_pk_bf16_f32 v93, v26, v27
    v_cvt_pk_bf16_f32 v94, v28, v29
    v_cvt_pk_bf16_f32 v95, v30, v31
    v_and_or_b32 v92, v92, -2, s41
    buffer_store_dwordx4 v[92:95], v0, s[8:11], s30 offen offset:1024 sc1
    s_and_b32 s43, s28, 7
    s_mul_i32 s30, s43, 131072
    s_add_u32 s30, s30, s60
    buffer_load_dword v3, v1, s[8:11], s33 offen sc1
    s_waitcnt vmcnt(0)
    s_cmp_eq_u32 s28, 64
    s_cbranch_scc1 L_fin_131
    v_cmp_gt_u32 vcc, s36, v3
    s_cbranch_vccz L_dma_130
    s_branch L_item_129
L_fin_131:
    s_branch L_end_138
L_redo_132:
    s_add_u32 s52, s52, 0x1000
    s_cmp_lt_u32 s52, 2147418112
    s_cbranch_scc0 L_fail
    s_waitcnt vmcnt(0) lgkmcnt(0)
    s_barrier
    s_sub_u32 s36, s36, 1
    s_sub_u32 s44, s44, s35
    s_sub_u32 s45, s45, s35
    s_sub_u32 s35, 65536, s35
    s_add_u32 s44, s44, s35
    s_add_u32 s45, s45, s35
    s_and_b32 s43, s28, 7
    s_mul_i32 s46, s43, 262144
    s_add_u32 s46, s46, s48
    s_mul_i32 s47, s43, 262144
    s_add_u32 s47, s47, s49
    s_branch L_dma_130
L_end_138:
    s_branch L_done
    .p2align 6
L_u:
    v_mov_b32 v112, v0
    v_lshlrev_b32 v0, 4, v112
    v_mov_b32 v2, 0
    s_mov_b32 s52, 0
    s_cmp_eq_u32 s24, 0
    s_cselect_b32 s42, 0, 0x40000000
    v_mov_b32 v10, s42
    s_lshl_b32 s38, s26, 8
    s_lshl_b32 s42, s27, 21
    s_add_u32 s29, s42, 255852544
    s_lshl_b32 s30, s27, 23
    s_add_u32 s30, s30, 226492416
    s_lshl_b32 s42, s26, 13
    s_add_u32 s30, s30, s42
    s_lshl_b32 s42, s24, 11
    s_add_u32 s30, s30, s42
    s_lshl_b32 s33, s27, 15
    s_add_u32 s33, s33, 229376
    s_lshl_b32 s34, s27, 15
    s_add_u32 s34, s34, 294912
    s_mul_i32 s43, s26, 128
    s_add_u32 s34, s34, s43
    s_lshl_b32 s43, s24, 2
    s_add_u32 s34, s34, s43
    v_lshrrev_b32 v1, 2, v112
    v_and_b32 v1, 3, v1
    v_mul_u32_u24 v1, 128, v1
    v_and_b32 v113, 3, v112
    v_lshl_add_u32 v1, v113, 2, v1
    s_cmp_lg_u32 s24, 0
    s_cbranch_scc1 L_na_139
    v_lshlrev_b32 v7, 2, v112
    s_mov_b64 exec, 15
    buffer_store_dword v2, v7, s[8:11], s34 offen sc1
    s_mov_b64 exec, -1
    s_waitcnt vmcnt(0)
    v_mov_b32 v126, 1
    v_mov_b32 v127, 4
    s_mov_b64 exec, 1
    buffer_atomic_add v126, v127, s[12:15], 0 offen
    s_mov_b64 exec, -1
L_na_140:
L_na_139:
    s_mov_b32 s16, s80
    s_mov_b32 s17, s81
    s_mov_b32 s18, 1835008
    s_mov_b32 s19, 0x00020000
    s_mov_b32 s20, s82
    s_mov_b32 s21, s83
    s_mov_b32 s22, 1835008
    s_mov_b32 s23, 0x00020000
    v_mov_b32 v114, 0
    v_bfe_i32 v113, v112, 0, 1
    v_and_b32 v113, 16, v113
    v_xor_b32 v114, v114, v113
    v_bfe_i32 v113, v112, 1, 1
    v_and_b32 v113, 32, v113
    v_xor_b32 v114, v114, v113
    v_bfe_i32 v113, v112, 2, 1
    v_and_b32 v113, 64, v113
    v_xor_b32 v114, v114, v113
    v_bfe_i32 v113, v112, 3, 1
    v_and_b32 v113, 128, v113
    v_xor_b32 v114, v114, v113
    v_bfe_i32 v113, v112, 4, 1
    v_and_b32 v113, 64, v113
    v_xor_b32 v114, v114, v113
    v_bfe_i32 v113, v112, 5, 1
    v_and_b32 v113, 128, v113
    v_xor_b32 v114, v114, v113
    v_lshrrev_b32 v113, 4, v112
    v_mul_u32_u24 v113, 3584, v113
    v_xor_b32 v115, 32, v114
    v_add_u32 v114, v113, v114
    v_add_u32 v115, v113, v115
    s_mul_i32 s42, s24, 57344
    s_add_u32 s38, s38, s42
    s_lshl_b32 s39, s24, 12
    v_mov_b32 v116, 0
    v_bfe_i32 v113, v112, 0, 1
    v_and_b32 v113, 8, v113
    v_xor_b32 v116, v116, v113
    v_bfe_i32 v113, v112, 1, 1
    v_and_b32 v113, 16, v113
    v_xor_b32 v116, v116, v113
    v_bfe_i32 v113, v112, 2, 1
    v_and_b32 v113, 320, v113
    v_xor_b32 v116, v116, v113
    v_bfe_i32 v113, v112, 3, 1
    v_and_b32 v113, 640, v113
    v_xor_b32 v116, v116, v113
    v_bfe_i32 v113, v112, 4, 1
    v_and_b32 v113, 16416, v113
    v_xor_b32 v116, v116, v113
    v_bfe_i32 v113, v112, 5, 1
    v_and_b32 v113, 1024, v113
    v_xor_b32 v116, v116, v113
    s_lshl_b32 s42, s24, 6
    v_xor_b32 v116, s42, v116
    s_cmp_eq_u32 s27, 0
    s_cselect_b32 s99, 32, 64
    v_mov_b32 v126, 132
    s_cmp_eq_u32 s99, 0
    s_cbranch_scc1 L_gate_141_ok
L_gate_141:
    s_sleep 8
    buffer_load_dword v127, v126, s[12:15], 0 offen sc1
    s_add_u32 s52, s52, 0x1000
    s_cmp_ge_u32 s52, 2147418112
    s_cbranch_scc1 L_fail
    s_waitcnt vmcnt(0)
    v_cmp_gt_u32 vcc, s99, v127
    s_cbranch_vccnz L_gate_141
L_gate_141_ok:
    s_add_u32 m0, s39, 0
    s_add_u32 s42, s38, 0
    buffer_load_dwordx4 v114, s[16:19], s42 offen  lds
    s_add_u32 m0, s39, 1024
    s_add_u32 s42, s38, 14336
    buffer_load_dwordx4 v114, s[16:19], s42 offen  lds
    s_add_u32 m0, s39, 2048
    s_add_u32 s42, s38, 28672
    buffer_load_dwordx4 v114, s[16:19], s42 offen  lds
    s_add_u32 m0, s39, 3072
    s_add_u32 s42, s38, 43008
    buffer_load_dwordx4 v114, s[16:19], s42 offen  lds
    s_add_u32 m0, s39, 16384
    s_add_u32 s42, s38, 0
    buffer_load_dwordx4 v115, s[20:23], s42 offen  lds
    s_add_u32 m0, s39, 17408
    s_add_u32 s42, s38, 14336
    buffer_load_dwordx4 v115, s[20:23], s42 offen  lds
    s_add_u32 m0, s39, 18432
    s_add_u32 s42, s38, 28672
    buffer_load_dwordx4 v115, s[20:23], s42 offen  lds
    s_add_u32 m0, s39, 19456
    s_add_u32 s42, s38, 43008
    buffer_load_dwordx4 v115, s[20:23], s42 offen  lds
    s_add_u32 m0, s39, 32768
    s_add_u32 s42, s38, 229376
    buffer_load_dwordx4 v114, s[16:19], s42 offen  lds
    s_add_u32 m0, s39, 33792
    s_add_u32 s42, s38, 243712
    buffer_load_dwordx4 v114, s[16:19], s42 offen  lds
    s_add_u32 m0, s39, 34816
    s_add_u32 s42, s38, 258048
    buffer_load_dwordx4 v114, s[16:19], s42 offen  lds
    s_add_u32 m0, s39, 35840
    s_add_u32 s42, s38, 272384
    buffer_load_dwordx4 v114, s[16:19], s42 offen  lds
    s_add_u32 m0, s39, 49152
    s_add_u32 s42, s38, 229376
    buffer_load_dwordx4 v115, s[20:23], s42 offen  lds
    s_add_u32 m0, s39, 50176
    s_add_u32 s42, s38, 243712
    buffer_load_dwordx4 v115, s[20:23], s42 offen  lds
    s_add_u32 m0, s39, 51200
    s_add_u32 s42, s38, 258048
    buffer_load_dwordx4 v115, s[20:23], s42 offen  lds
    s_add_u32 m0, s39, 52224
    s_add_u32 s42, s38, 272384
    buffer_load_dwordx4 v115, s[20:23], s42 offen  lds
    s_add_u32 m0, s39, 65536
    s_add_u32 s42, s38, 458752
    buffer_load_dwordx4 v114, s[16:19], s42 offen  lds
    s_add_u32 m0, s39, 66560
    s_add_u32 s42, s38, 473088
    buffer_load_dwordx4 v114, s[16:19], s42 offen  lds
    s_add_u32 m0, s39, 67584
    s_add_u32 s42, s38, 487424
    buffer_load_dwordx4 v114, s[16:19], s42 offen  lds
    s_add_u32 m0, s39, 68608
    s_add_u32 s42, s38, 501760
    buffer_load_dwordx4 v114, s[16:19], s42 offen  lds
    s_add_u32 m0, s39, 81920
    s_add_u32 s42, s38, 458752
    buffer_load_dwordx4 v115, s[20:23], s42 offen  lds
    s_add_u32 m0, s39, 82944
    s_add_u32 s42, s38, 473088
    buffer_load_dwordx4 v115, s[20:23], s42 offen  lds
    s_add_u32 m0, s39, 83968
    s_add_u32 s42, s38, 487424
    buffer_load_dwordx4 v115, s[20:23], s42 offen  lds
    s_add_u32 m0, s39, 84992
    s_add_u32 s42, s38, 501760
    buffer_load_dwordx4 v115, s[20:23], s42 offen  lds
    s_add_u32 m0, s39, 98304
    s_add_u32 s42, s38, 688128
    buffer_load_dwordx4 v114, s[16:19], s42 offen  lds
    s_add_u32 m0, s39, 99328
    s_add_u32 s42, s38, 702464
    buffer_load_dwordx4 v114, s[16:19], s42 offen  lds
    s_add_u32 m0, s39, 100352
    s_add_u32 s42, s38, 716800
    buffer_load_dwordx4 v114, s[16:19], s42 offen  lds
    s_add_u32 m0, s39, 101376
    s_add_u32 s42, s38, 731136
    buffer_load_dwordx4 v114, s[16:19], s42 offen  lds
    s_add_u32 m0, s39, 114688
    s_add_u32 s42, s38, 688128
    buffer_load_dwordx4 v115, s[20:23], s42 offen  lds
    s_add_u32 m0, s39, 115712
    s_add_u32 s42, s38, 702464
    buffer_load_dwordx4 v115, s[20:23], s42 offen  lds
    s_add_u32 m0, s39, 116736
    s_add_u32 s42, s38, 716800
    buffer_load_dwordx4 v115, s[20:23], s42 offen  lds
    s_add_u32 m0, s39, 117760
    s_add_u32 s42, s38, 731136
    buffer_load_dwordx4 v115, s[20:23], s42 offen  lds
    s_add_u32 m0, s39, 131072
    s_add_u32 s42, s38, 917504
    buffer_load_dwordx4 v114, s[16:19], s42 offen  lds
    s_add_u32 m0, s39, 132096
    s_add_u32 s42, s38, 931840
    buffer_load_dwordx4 v114, s[16:19], s42 offen  lds
    s_add_u32 m0, s39, 133120
    s_add_u32 s42, s38, 946176
    buffer_load_dwordx4 v114, s[16:19], s42 offen  lds
    s_add_u32 m0, s39, 134144
    s_add_u32 s42, s38, 960512
    buffer_load_dwordx4 v114, s[16:19], s42 offen  lds
    s_add_u32 m0, s39, 147456
    s_add_u32 s42, s38, 917504
    buffer_load_dwordx4 v115, s[20:23], s42 offen  lds
    s_add_u32 m0, s39, 148480
    s_add_u32 s42, s38, 931840
    buffer_load_dwordx4 v115, s[20:23], s42 offen  lds
    s_add_u32 m0, s39, 149504
    s_add_u32 s42, s38, 946176
    buffer_load_dwordx4 v115, s[20:23], s42 offen  lds
    s_add_u32 m0, s39, 150528
    s_add_u32 s42, s38, 960512
    buffer_load_dwordx4 v115, s[20:23], s42 offen  lds
    s_waitcnt vmcnt(36) lgkmcnt(0)
    s_barrier
    s_waitcnt vmcnt(32) lgkmcnt(0)
    s_barrier
    v_add_u32 v117, 0, v116
    v_xor_b32 v118, 32, v117
    ds_read_b64_tr_b16 a[0:1], v117 offset:0
    ds_read_b64_tr_b16 a[2:3], v117 offset:2048
    ds_read_b64_tr_b16 a[128:129], v118 offset:0
    ds_read_b64_tr_b16 a[130:131], v118 offset:2048
    ds_read_b64_tr_b16 a[4:5], v117 offset:4096
    ds_read_b64_tr_b16 a[6:7], v117 offset:6144
    ds_read_b64_tr_b16 a[132:133], v118 offset:4096
    ds_read_b64_tr_b16 a[134:135], v118 offset:6144
    ds_read_b64_tr_b16 a[8:9], v117 offset:8192
    ds_read_b64_tr_b16 a[10:11], v117 offset:10240
    ds_read_b64_tr_b16 a[136:137], v118 offset:8192
    ds_read_b64_tr_b16 a[138:139], v118 offset:10240
    ds_read_b64_tr_b16 a[12:13], v117 offset:12288
    ds_read_b64_tr_b16 a[14:15], v117 offset:14336
    ds_read_b64_tr_b16 a[140:141], v118 offset:12288
    ds_read_b64_tr_b16 a[142:143], v118 offset:14336
    s_waitcnt vmcnt(28) lgkmcnt(0)
    s_barrier
    s_add_u32 m0, s39, 0
    s_add_u32 s42, s38, 1146880
    buffer_load_dwordx4 v114, s[16:19], s42 offen  lds
    s_add_u32 m0, s39, 1024
    s_add_u32 s42, s38, 1161216
    buffer_load_dwordx4 v114, s[16:19], s42 offen  lds
    s_add_u32 m0, s39, 2048
    s_add_u32 s42, s38, 1175552
    buffer_load_dwordx4 v114, s[16:19], s42 offen  lds
    s_add_u32 m0, s39, 3072
    s_add_u32 s42, s38, 1189888
    buffer_load_dwordx4 v114, s[16:19], s42 offen  lds
    s_add_u32 m0, s39, 16384
    s_add_u32 s42, s38, 1146880
    buffer_load_dwordx4 v115, s[20:23], s42 offen  lds
    s_add_u32 m0, s39, 17408
    s_add_u32 s42, s38, 1161216
    buffer_load_dwordx4 v115, s[20:23], s42 offen  lds
    s_add_u32 m0, s39, 18432
    s_add_u32 s42, s38, 1175552
    buffer_load_dwordx4 v115, s[20:23], s42 offen  lds
    s_add_u32 m0, s39, 19456
    s_add_u32 s42, s38, 1189888
    buffer_load_dwordx4 v115, s[20:23], s42 offen  lds
    s_waitcnt vmcnt(32) lgkmcnt(0)
    s_barrier
    v_add_u32 v117, 32768, v116
    v_xor_b32 v118, 32, v117
    ds_read_b64_tr_b16 a[16:17], v117 offset:0
    ds_read_b64_tr_b16 a[18:19], v117 offset:2048
    ds_read_b64_tr_b16 a[144:145], v118 offset:0
    ds_read_b64_tr_b16 a[146:147], v118 offset:2048
    ds_read_b64_tr_b16 a[20:21], v117 offset:4096
    ds_read_b64_tr_b16 a[22:23], v117 offset:6144
    ds_read_b64_tr_b16 a[148:149], v118 offset:4096
    ds_read_b64_tr_b16 a[150:151], v118 offset:6144
    ds_read_b64_tr_b16 a[24:25], v117 offset:8192
    ds_read_b64_tr_b16 a[26:27], v117 offset:10240
    ds_read_b64_tr_b16 a[152:153], v118 offset:8192
    ds_read_b64_tr_b16 a[154:155], v118 offset:10240
    ds_read_b64_tr_b16 a[28:29], v117 offset:12288
    ds_read_b64_tr_b16 a[30:31], v117 offset:14336
    ds_read_b64_tr_b16 a[156:157], v118 offset:12288
    ds_read_b64_tr_b16 a[158:159], v118 offset:14336
    s_waitcnt vmcnt(28) lgkmcnt(0)
    s_barrier
    s_add_u32 m0, s39, 32768
    s_add_u32 s42, s38, 1376256
    buffer_load_dwordx4 v114, s[16:19], s42 offen  lds
    s_add_u32 m0, s39, 33792
    s_add_u32 s42, s38, 1390592
    buffer_load_dwordx4 v114, s[16:19], s42 offen  lds
    s_add_u32 m0, s39, 34816
    s_add_u32 s42, s38, 1404928
    buffer_load_dwordx4 v114, s[16:19], s42 offen  lds
    s_add_u32 m0, s39, 35840
    s_add_u32 s42, s38, 1419264
    buffer_load_dwordx4 v114, s[16:19], s42 offen  lds
    s_add_u32 m0, s39, 49152
    s_add_u32 s42, s38, 1376256
    buffer_load_dwordx4 v115, s[20:23], s42 offen  lds
    s_add_u32 m0, s39, 50176
    s_add_u32 s42, s38, 1390592
    buffer_load_dwordx4 v115, s[20:23], s42 offen  lds
    s_add_u32 m0, s39, 51200
    s_add_u32 s42, s38, 1404928
    buffer_load_dwordx4 v115, s[20:23], s42 offen  lds
    s_add_u32 m0, s39, 52224
    s_add_u32 s42, s38, 1419264
    buffer_load_dwordx4 v115, s[20:23], s42 offen  lds
    s_waitcnt vmcnt(32) lgkmcnt(0)
    s_barrier
    v_add_u32 v117, 65536, v116
    v_xor_b32 v118, 32, v117
    ds_read_b64_tr_b16 a[32:33], v117 offset:0
    ds_read_b64_tr_b16 a[34:35], v117 offset:2048
    ds_read_b64_tr_b16 a[160:161], v118 offset:0
    ds_read_b64_tr_b16 a[162:163], v118 offset:2048
    ds_read_b64_tr_b16 a[36:37], v117 offset:4096
    ds_read_b64_tr_b16 a[38:39], v117 offset:6144
    ds_read_b64_tr_b16 a[164:165], v118 offset:4096
    ds_read_b64_tr_b16 a[166:167], v118 offset:6144
    ds_read_b64_tr_b16 a[40:41], v117 offset:8192
    ds_read_b64_tr_b16 a[42:43], v117 offset:10240
    ds_read_b64_tr_b16 a[168:169], v118 offset:8192
    ds_read_b64_tr_b16 a[170:171], v118 offset:10240
    ds_read_b64_tr_b16 a[44:45], v117 offset:12288
    ds_read_b64_tr_b16 a[46:47], v117 offset:14336
    ds_read_b64_tr_b16 a[172:173], v118 offset:12288
    ds_read_b64_tr_b16 a[174:175], v118 offset:14336
    s_waitcnt vmcnt(28) lgkmcnt(0)
    s_barrier
    s_add_u32 m0, s39, 65536
    s_add_u32 s42, s38, 1605632
    buffer_load_dwordx4 v114, s[16:19], s42 offen  lds
    s_add_u32 m0, s39, 66560
    s_add_u32 s42, s38, 1619968
    buffer_load_dwordx4 v114, s[16:19], s42 offen  lds
    s_add_u32 m0, s39, 67584
    s_add_u32 s42, s38, 1634304
    buffer_load_dwordx4 v114, s[16:19], s42 offen  lds
    s_add_u32 m0, s39, 68608
    s_add_u32 s42, s38, 1648640
    buffer_load_dwordx4 v114, s[16:19], s42 offen  lds
    s_add_u32 m0, s39, 81920
    s_add_u32 s42, s38, 1605632
    buffer_load_dwordx4 v115, s[20:23], s42 offen  lds
    s_add_u32 m0, s39, 82944
    s_add_u32 s42, s38, 1619968
    buffer_load_dwordx4 v115, s[20:23], s42 offen  lds
    s_add_u32 m0, s39, 83968
    s_add_u32 s42, s38, 1634304
    buffer_load_dwordx4 v115, s[20:23], s42 offen  lds
    s_add_u32 m0, s39, 84992
    s_add_u32 s42, s38, 1648640
    buffer_load_dwordx4 v115, s[20:23], s42 offen  lds
    s_waitcnt vmcnt(32) lgkmcnt(0)
    s_barrier
    v_add_u32 v117, 98304, v116
    v_xor_b32 v118, 32, v117
    ds_read_b64_tr_b16 a[48:49], v117 offset:0
    ds_read_b64_tr_b16 a[50:51], v117 offset:2048
    ds_read_b64_tr_b16 a[176:177], v118 offset:0
    ds_read_b64_tr_b16 a[178:179], v118 offset:2048
    ds_read_b64_tr_b16 a[52:53], v117 offset:4096
    ds_read_b64_tr_b16 a[54:55], v117 offset:6144
    ds_read_b64_tr_b16 a[180:181], v118 offset:4096
    ds_read_b64_tr_b16 a[182:183], v118 offset:6144
    ds_read_b64_tr_b16 a[56:57], v117 offset:8192
    ds_read_b64_tr_b16 a[58:59], v117 offset:10240
    ds_read_b64_tr_b16 a[184:185], v118 offset:8192
    ds_read_b64_tr_b16 a[186:187], v118 offset:10240
    ds_read_b64_tr_b16 a[60:61], v117 offset:12288
    ds_read_b64_tr_b16 a[62:63], v117 offset:14336
    ds_read_b64_tr_b16 a[188:189], v118 offset:12288
    ds_read_b64_tr_b16 a[190:191], v118 offset:14336
    s_waitcnt vmcnt(28) lgkmcnt(0)
    s_barrier
    s_waitcnt vmcnt(24) lgkmcnt(0)
    s_barrier
    v_add_u32 v117, 131072, v116
    v_xor_b32 v118, 32, v117
    ds_read_b64_tr_b16 a[64:65], v117 offset:0
    ds_read_b64_tr_b16 a[66:67], v117 offset:2048
    ds_read_b64_tr_b16 a[192:193], v118 offset:0
    ds_read_b64_tr_b16 a[194:195], v118 offset:2048
    ds_read_b64_tr_b16 a[68:69], v117 offset:4096
    ds_read_b64_tr_b16 a[70:71], v117 offset:6144
    ds_read_b64_tr_b16 a[196:197], v118 offset:4096
    ds_read_b64_tr_b16 a[198:199], v118 offset:6144
    ds_read_b64_tr_b16 a[72:73], v117 offset:8192
    ds_read_b64_tr_b16 a[74:75], v117 offset:10240
    ds_read_b64_tr_b16 a[200:201], v118 offset:8192
    ds_read_b64_tr_b16 a[202:203], v118 offset:10240
    ds_read_b64_tr_b16 a[76:77], v117 offset:12288
    ds_read_b64_tr_b16 a[78:79], v117 offset:14336
    ds_read_b64_tr_b16 a[204:205], v118 offset:12288
    ds_read_b64_tr_b16 a[206:207], v118 offset:14336
    s_waitcnt vmcnt(20) lgkmcnt(0)
    s_barrier
    s_waitcnt vmcnt(16) lgkmcnt(0)
    s_barrier
    v_add_u32 v117, 0, v116
    v_xor_b32 v118, 32, v117
    ds_read_b64_tr_b16 a[80:81], v117 offset:0
    ds_read_b64_tr_b16 a[82:83], v117 offset:2048
    ds_read_b64_tr_b16 a[208:209], v118 offset:0
    ds_read_b64_tr_b16 a[210:211], v118 offset:2048
    ds_read_b64_tr_b16 a[84:85], v117 offset:4096
    ds_read_b64_tr_b16 a[86:87], v117 offset:6144
    ds_read_b64_tr_b16 a[212:213], v118 offset:4096
    ds_read_b64_tr_b16 a[214:215], v118 offset:6144
    ds_read_b64_tr_b16 a[88:89], v117 offset:8192
    ds_read_b64_tr_b16 a[90:91], v117 offset:10240
    ds_read_b64_tr_b16 a[216:217], v118 offset:8192
    ds_read_b64_tr_b16 a[218:219], v118 offset:10240
    ds_read_b64_tr_b16 a[92:93], v117 offset:12288
    ds_read_b64_tr_b16 a[94:95], v117 offset:14336
    ds_read_b64_tr_b16 a[220:221], v118 offset:12288
    ds_read_b64_tr_b16 a[222:223], v118 offset:14336
    s_waitcnt vmcnt(12) lgkmcnt(0)
    s_barrier
    s_waitcnt vmcnt(8) lgkmcnt(0)
    s_barrier
    v_add_u32 v117, 32768, v116
    v_xor_b32 v118, 32, v117
    ds_read_b64_tr_b16 a[96:97], v117 offset:0
    ds_read_b64_tr_b16 a[98:99], v117 offset:2048
    ds_read_b64_tr_b16 a[224:225], v118 offset:0
    ds_read_b64_tr_b16 a[226:227], v118 offset:2048
    ds_read_b64_tr_b16 a[100:101], v117 offset:4096
    ds_read_b64_tr_b16 a[102:103], v117 offset:6144
    ds_read_b64_tr_b16 a[228:229], v118 offset:4096
    ds_read_b64_tr_b16 a[230:231], v118 offset:6144
    ds_read_b64_tr_b16 a[104:105], v117 offset:8192
    ds_read_b64_tr_b16 a[106:107], v117 offset:10240
    ds_read_b64_tr_b16 a[232:233], v118 offset:8192
    ds_read_b64_tr_b16 a[234:235], v118 offset:10240
    ds_read_b64_tr_b16 a[108:109], v117 offset:12288
    ds_read_b64_tr_b16 a[110:111], v117 offset:14336
    ds_read_b64_tr_b16 a[236:237], v118 offset:12288
    ds_read_b64_tr_b16 a[238:239], v118 offset:14336
    s_waitcnt vmcnt(4) lgkmcnt(0)
    s_barrier
    s_waitcnt vmcnt(0) lgkmcnt(0)
    s_barrier
    v_add_u32 v117, 65536, v116
    v_xor_b32 v118, 32, v117
    ds_read_b64_tr_b16 a[112:113], v117 offset:0
    ds_read_b64_tr_b16 a[114:115], v117 offset:2048
    ds_read_b64_tr_b16 a[240:241], v118 offset:0
    ds_read_b64_tr_b16 a[242:243], v118 offset:2048
    ds_read_b64_tr_b16 a[116:117], v117 offset:4096
    ds_read_b64_tr_b16 a[118:119], v117 offset:6144
    ds_read_b64_tr_b16 a[244:245], v118 offset:4096
    ds_read_b64_tr_b16 a[246:247], v118 offset:6144
    ds_read_b64_tr_b16 a[120:121], v117 offset:8192
    ds_read_b64_tr_b16 a[122:123], v117 offset:10240
    ds_read_b64_tr_b16 a[248:249], v118 offset:8192
    ds_read_b64_tr_b16 a[250:251], v118 offset:10240
    ds_read_b64_tr_b16 a[124:125], v117 offset:12288
    ds_read_b64_tr_b16 a[126:127], v117 offset:14336
    ds_read_b64_tr_b16 a[252:253], v118 offset:12288
    ds_read_b64_tr_b16 a[254:255], v118 offset:14336
    s_waitcnt lgkmcnt(0)
    s_barrier
    s_mov_b32 s42, s30
    s_mov_b32 s99, 8
L_warm_142:
    buffer_load_dwordx4 v[16:19], v0, s[8:11], s42 offen offset:0 sc1
    buffer_load_dwordx4 v[20:23], v0, s[8:11], s42 offen offset:1024 sc1
    s_add_u32 s42, s42, 131072
    s_sub_u32 s99, s99, 1
    s_cmp_lg_u32 s99, 0
    s_cbranch_scc1 L_warm_142
    s_waitcnt vmcnt(0)
    v_mbcnt_lo_u32_b32 v126, -1, 0
    v_mbcnt_hi_u32_b32 v126, -1, v126
    v_lshlrev_b32 v126, 5, v126
    v_cmp_gt_u32 vcc, 256, v126
    s_nop 1
    v_cndmask_b32 v126, 4, v126, vcc
    buffer_load_dword v127, v126, s[12:15], 0 offen sc1
    s_waitcnt vmcnt(0)
    v_readlane_b32 s98, v127, 8
    v_cmp_ne_u32 vcc, 32, v127
    s_nop 3
    s_and_b32 s5, vcc_lo, 0xff
    s_cmp_lt_u32 s98, 256
    s_cselect_b32 s98, 1, s5
    s_cmp_eq_u32 s98, 0
    s_cbranch_scc1 L_gw_143_done
L_gw_143:
    buffer_load_dword v127, v126, s[12:15], 0 offen sc1
    s_add_u32 s52, s52, 0x1000
    s_cmp_ge_u32 s52, 2147418112
    s_cbranch_scc1 L_fail
    s_waitcnt vmcnt(0)
    v_readlane_b32 s98, v127, 8
    s_nop 3
    s_cmp_ge_u32 s98, 256
    s_cbranch_scc1 L_gw_143_ok
    s_sleep 4
    s_branch L_gw_143
L_gw_143_ok:
    buffer_load_dword v127, v126, s[12:15], 0 offen sc1
    s_waitcnt vmcnt(0)
    v_cmp_ne_u32 vcc, 32, v127
    s_nop 3
    s_and_b32 s5, vcc_lo, 0xff
L_gw_143_done:
    s_cmp_lg_u32 s5, 0
    s_cbranch_scc1 L_nonlocal_144
    s_mov_b32 s28, 0
    s_mov_b32 s36, 1
    s_mov_b32 s35, 0
    s_lshl_b32 s44, s24, 11
    s_lshl_b32 s45, s24, 12
    s_add_u32 s46, s29, s44
    s_add_u32 s47, s29, s45
    s_mov_b32 s48, s46
    s_mov_b32 s49, s47
    s_mov_b32 s60, s30
    s_mov_b32 s61, s31
    s_mov_b32 s62, s32
    v_mov_b32 v4, v0
    s_mov_b32 s40, 3216550459
    s_mov_b32 s41, s40
L_item_145:
L_poll_151:
    buffer_load_dword v3, v1, s[8:11], s33 offen sc1
    s_waitcnt vmcnt(0)
    v_cmp_gt_u32 vcc, s36, v3
    s_add_u32 s52, s52, 0x1000
    s_cmp_lt_u32 s52, 2147418112
    s_cbranch_vccz L_poll_151_ok
    s_cbranch_scc1 L_poll_151
    s_branch L_fail
L_poll_151_ok:
L_dma_146:
    s_add_u32 m0, s44, 0
    s_add_u32 s42, s46, 0
    buffer_load_dwordx4 v0, s[8:11], s42 offen offset:0 sc1  lds
    buffer_load_dwordx4 v0, s[8:11], s42 offen offset:1024 sc1  lds
    s_add_u32 m0, s44, 8192
    s_add_u32 s42, s46, 8192
    buffer_load_dwordx4 v0, s[8:11], s42 offen offset:0 sc1  lds
    buffer_load_dwordx4 v0, s[8:11], s42 offen offset:1024 sc1  lds
    s_add_u32 m0, s44, 16384
    s_add_u32 s42, s46, 16384
    buffer_load_dwordx4 v0, s[8:11], s42 offen offset:0 sc1  lds
    buffer_load_dwordx4 v0, s[8:11], s42 offen offset:1024 sc1  lds
L_rd_152:
    s_bfe_u32 s6, s28, 65539
    s_waitcnt vmcnt(4)
    s_barrier
    ds_read_b128 v[64:67], v4 offset:0
    ds_read_b128 v[68:71], v4 offset:1024
    ds_read_b128 v[72:75], v4 offset:2048
    ds_read_b128 v[76:79], v4 offset:3072
    s_waitcnt lgkmcnt(3)
    v_mfma_f32_32x32x16_bf16 v[16:31], a[0:3], v[64:67], 0
    v_xor_b32 v12, s6, v64
    s_add_u32 m0, s44, 24576
    s_add_u32 s42, s46, 24576
    buffer_load_dwordx4 v0, s[8:11], s42 offen offset:0 sc1  lds
    ds_read_b128 v[64:67], v4 offset:4096
    s_waitcnt lgkmcnt(3)
    v_mfma_f32_32x32x16_bf16 v[16:31], a[4:7], v[68:71], v[16:31]
    v_bitop3_b32 v12, v12, v68, s6 bitop3:96
    ds_read_b128 v[68:71], v4 offset:5120
    s_waitcnt lgkmcnt(3)
    v_mfma_f32_32x32x16_bf16 v[16:31], a[8:11], v[72:75], v[16:31]
    v_bitop3_b32 v12, v12, v72, s6 bitop3:96
    buffer_load_dwordx4 v0, s[8:11], s42 offen offset:1024 sc1  lds
    ds_read_b128 v[72:75], v4 offset:6144
    s_waitcnt lgkmcnt(3)
    v_mfma_f32_32x32x16_bf16 v[16:31], a[12:15], v[76:79], v[16:31]
    v_bitop3_b32 v12, v12, v76, s6 bitop3:96
    ds_read_b128 v[76:79], v4 offset:7168
    s_waitcnt lgkmcnt(3)
    v_mfma_f32_32x32x16_bf16 v[16:31], a[16:19], v[64:67], v[16:31]
    v_bitop3_b32 v12, v12, v64, s6 bitop3:96
    s_waitcnt vmcnt(4)
    s_barrier
    ds_read_b128 v[64:67], v4 offset:8192
    s_waitcnt lgkmcnt(3)
    v_mfma_f32_32x32x16_bf16 v[16:31], a[20:23], v[68:71], v[16:31]
    v_bitop3_b32 v12, v12, v68, s6 bitop3:96
    ds_read_b128 v[68:71], v4 offset:9216
    s_waitcnt lgkmcnt(3)
    v_mfma_f32_32x32x16_bf16 v[16:31], a[24:27], v[72:75], v[16:31]
    v_bitop3_b32 v12, v12, v72, s6 bitop3:96
    ds_read_b128 v[72:75], v4 offset:10240
    s_waitcnt lgkmcnt(3)
    v_mfma_f32_32x32x16_bf16 v[16:31], a[28:31], v[76:79], v[16:31]
    v_bitop3_b32 v12, v12, v76, s6 bitop3:96
    ds_read_b128 v[76:79], v4 offset:11264
    s_waitcnt lgkmcnt(3)
    v_mfma_f32_32x32x16_bf16 v[16:31], a[32:35], v[64:67], v[16:31]
    v_bitop3_b32 v12, v12, v64, s6 bitop3:96
    ds_read_b128 v[64:67], v4 offset:12288
    s_waitcnt lgkmcnt(3)
    v_mfma_f32_32x32x16_bf16 v[16:31], a[36:39], v[68:71], v[16:31]
    v_bitop3_b32 v12, v12, v68, s6 bitop3:96
    ds_read_b128 v[68:71], v4 offset:13312
    s_waitcnt lgkmcnt(3)
    v_mfma_f32_32x32x16_bf16 v[16:31], a[40:43], v[72:75], v[16:31]
    v_bitop3_b32 v12, v12, v72, s6 bitop3:96
    ds_read_b128 v[72:75], v4 offset:14336
    s_waitcnt lgkmcnt(3)
    v_mfma_f32_32x32x16_bf16 v[16:31], a[44:47], v[76:79], v[16:31]
    v_bitop3_b32 v12, v12, v76, s6 bitop3:96
    ds_read_b128 v[76:79], v4 offset:15360
    s_waitcnt lgkmcnt(3)
    v_mfma_f32_32x32x16_bf16 v[16:31], a[48:51], v[64:67], v[16:31]
    v_bitop3_b32 v12, v12, v64, s6 bitop3:96
    s_waitcnt vmcnt(2)
    s_barrier
    ds_read_b128 v[64:67], v4 offset:16384
    s_waitcnt lgkmcnt(3)
    v_mfma_f32_32x32x16_bf16 v[16:31], a[52:55], v[68:71], v[16:31]
    v_bitop3_b32 v12, v12, v68, s6 bitop3:96
    ds_read_b128 v[68:71], v4 offset:17408
    s_waitcnt lgkmcnt(3)
    v_mfma_f32_32x32x16_bf16 v[16:31], a[56:59], v[72:75], v[16:31]
    v_bitop3_b32 v12, v12, v72, s6 bitop3:96
    ds_read_b128 v[72:75], v4 offset:18432
    s_waitcnt lgkmcnt(3)
    v_mfma_f32_32x32x16_bf16 v[16:31], a[60:63], v[76:79], v[16:31]
    v_bitop3_b32 v12, v12, v76, s6 bitop3:96
    ds_read_b128 v[76:79], v4 offset:19456
    s_waitcnt lgkmcnt(3)
    v_mfma_f32_32x32x16_bf16 v[16:31], a[64:67], v[64:67], v[16:31]
    v_bitop3_b32 v12, v12, v64, s6 bitop3:96
    ds_read_b128 v[64:67], v4 offset:20480
    s_waitcnt lgkmcnt(3)
    v_mfma_f32_32x32x16_bf16 v[16:31], a[68:71], v[68:71], v[16:31]
    v_bitop3_b32 v12, v12, v68, s6 bitop3:96
    ds_read_b128 v[68:71], v4 offset:21504
    s_waitcnt lgkmcnt(3)
    v_mfma_f32_32x32x16_bf16 v[16:31], a[72:75], v[72:75], v[16:31]
    v_bitop3_b32 v12, v12, v72, s6 bitop3:96
    ds_read_b128 v[72:75], v4 offset:22528
    s_waitcnt lgkmcnt(3)
    v_mfma_f32_32x32x16_bf16 v[16:31], a[76:79], v[76:79], v[16:31]
    v_bitop3_b32 v12, v12, v76, s6 bitop3:96
    ds_read_b128 v[76:79], v4 offset:23552
    s_waitcnt lgkmcnt(3)
    v_mfma_f32_32x32x16_bf16 v[16:31], a[80:83], v[64:67], v[16:31]
    v_bitop3_b32 v12, v12, v64, s6 bitop3:96
    s_waitcnt vmcnt(0)
    s_barrier
    ds_read_b128 v[64:67], v4 offset:24576
    s_waitcnt lgkmcnt(3)
    v_mfma_f32_32x32x16_bf16 v[16:31], a[84:87], v[68:71], v[16:31]
    v_bitop3_b32 v12, v12, v68, s6 bitop3:96
    ds_read_b128 v[68:71], v4 offset:25600
    s_waitcnt lgkmcnt(3)
    v_mfma_f32_32x32x16_bf16 v[16:31], a[88:91], v[72:75], v[16:31]
    v_bitop3_b32 v12, v12, v72, s6 bitop3:96
    ds_read_b128 v[72:75], v4 offset:26624
    s_waitcnt lgkmcnt(3)
    v_mfma_f32_32x32x16_bf16 v[16:31], a[92:95], v[76:79], v[16:31]
    v_bitop3_b32 v12, v12, v76, s6 bitop3:96
    ds_read_b128 v[76:79], v4 offset:27648
    s_waitcnt lgkmcnt(3)
    v_mfma_f32_32x32x16_bf16 v[16:31], a[96:99], v[64:67], v[16:31]
    v_bitop3_b32 v12, v12, v64, s6 bitop3:96
    buffer_load_dword v3, v1, s[8:11], s33 offen sc1
    ds_read_b128 v[64:67], v4 offset:28672
    s_waitcnt lgkmcnt(3)
    v_mfma_f32_32x32x16_bf16 v[16:31], a[100:103], v[68:71], v[16:31]
    v_bitop3_b32 v12, v12, v68, s6 bitop3:96
    ds_read_b128 v[68:71], v4 offset:29696
    s_waitcnt lgkmcnt(3)
    v_mfma_f32_32x32x16_bf16 v[16:31], a[104:107], v[72:75], v[16:31]
    v_bitop3_b32 v12, v12, v72, s6 bitop3:96
    ds_read_b128 v[72:75], v4 offset:30720
    s_waitcnt lgkmcnt(3)
    v_mfma_f32_32x32x16_bf16 v[16:31], a[108:111], v[76:79], v[16:31]
    v_bitop3_b32 v12, v12, v76, s6 bitop3:96
    ds_read_b128 v[76:79], v4 offset:31744
    s_waitcnt lgkmcnt(3)
    v_mfma_f32_32x32x16_bf16 v[16:31], a[112:115], v[64:67], v[16:31]
    v_bitop3_b32 v12, v12, v64, s6 bitop3:96
    ds_read_b128 v[64:67], v4 offset:0
    s_waitcnt lgkmcnt(3)
    v_mfma_f32_32x32x16_bf16 v[16:31], a[116:119], v[68:71], v[16:31]
    v_bitop3_b32 v12, v12, v68, s6 bitop3:96
    ds_read_b128 v[68:71], v4 offset:1024
    s_waitcnt lgkmcnt(3)
    v_mfma_f32_32x32x16_bf16 v[16:31], a[120:123], v[72:75], v[16:31]
    v_bitop3_b32 v12, v12, v72, s6 bitop3:96
    ds_read_b128 v[72:75], v4 offset:2048
    s_waitcnt lgkmcnt(3)
    v_mfma_f32_32x32x16_bf16 v[16:31], a[124:127], v[76:79], v[16:31]
    v_bitop3_b32 v12, v12, v76, s6 bitop3:96
    ds_read_b128 v[76:79], v4 offset:3072
    s_waitcnt lgkmcnt(3)
    v_mfma_f32_32x32x16_bf16 v[32:47], a[128:131], v[64:67], 0
    v_and_b32 v12, 1, v12
    v_cmp_eq_u32 vcc, 0, v12
    ds_read_b128 v[64:67], v4 offset:4096
    s_waitcnt lgkmcnt(3)
    v_mfma_f32_32x32x16_bf16 v[32:47], a[132:135], v[68:71], v[32:47]
    s_cbranch_vccnz L_redo_148
    ds_read_b128 v[68:71], v4 offset:5120
    s_waitcnt lgkmcnt(3)
    v_mfma_f32_32x32x16_bf16 v[32:47], a[136:139], v[72:75], v[32:47]
    v_mul_f32 v96, s40, v16
    v_mul_f32 v97, s40, v17
    ds_read_b128 v[72:75], v4 offset:6144
    s_waitcnt lgkmcnt(3)
    v_mfma_f32_32x32x16_bf16 v[32:47], a[140:143], v[76:79], v[32:47]
    s_and_b32 s43, s36, 7
    s_mul_i32 s43, s43, 32768
    v_mul_f32 v98, s40, v18
    v_mul_f32 v99, s40, v19
    ds_read_b128 v[76:79], v4 offset:7168
    s_waitcnt lgkmcnt(3)
    v_mfma_f32_32x32x16_bf16 v[32:47], a[144:147], v[64:67], v[32:47]
    s_add_u32 s46, s43, s48
    s_add_u32 s47, s43, s49
    v_mul_f32 v100, s40, v20
    v_mul_f32 v101, s40, v21
    ds_read_b128 v[64:67], v4 offset:8192
    s_waitcnt lgkmcnt(3)
    v_mfma_f32_32x32x16_bf16 v[32:47], a[148:151], v[68:71], v[32:47]
    s_add_u32 s36, s36, 1
    s_sub_u32 s44, s44, s35
    v_mul_f32 v102, s40, v22
    v_mul_f32 v103, s40, v23
    ds_read_b128 v[68:71], v4 offset:9216
    s_waitcnt lgkmcnt(3)
    v_mfma_f32_32x32x16_bf16 v[32:47], a[152:155], v[72:75], v[32:47]
    s_sub_u32 s45, s45, s35
    s_sub_u32 s35, 32768, s35
    v_exp_f32 v96, v96
    v_exp_f32 v97, v97
    ds_read_b128 v[72:75], v4 offset:10240
    s_waitcnt lgkmcnt(3)
    v_mfma_f32_32x32x16_bf16 v[32:47], a[156:159], v[76:79], v[32:47]
    s_add_u32 s44, s44, s35
    s_add_u32 s45, s45, s35
    v_exp_f32 v98, v98
    v_exp_f32 v99, v99
    ds_read_b128 v[76:79], v4 offset:11264
    s_waitcnt lgkmcnt(3)
    v_mfma_f32_32x32x16_bf16 v[32:47], a[160:163], v[64:67], v[32:47]
    v_exp_f32 v100, v100
    v_exp_f32 v101, v101
    s_waitcnt vmcnt(0)
    v_cmp_gt_u32 vcc, s36, v3
L_mid_149:
    ds_read_b128 v[64:67], v4 offset:12288
    s_waitcnt lgkmcnt(3)
    v_mfma_f32_32x32x16_bf16 v[32:47], a[164:167], v[68:71], v[32:47]
    v_exp_f32 v102, v102
    v_exp_f32 v103, v103
    s_cbranch_vccnz L_tail0_150
    ds_read_b128 v[68:71], v4 offset:13312
    s_waitcnt lgkmcnt(3)
    v_mfma_f32_32x32x16_bf16 v[32:47], a[168:171], v[72:75], v[32:47]
    v_add_f32 v96, 1.0, v96
    v_add_f32 v97, 1.0, v97
    s_add_u32 m0, s44, 0
    s_add_u32 s42, s46, 0
    buffer_load_dwordx4 v0, s[8:11], s42 offen offset:0 sc1  lds
    ds_read_b128 v[72:75], v4 offset:14336
    s_waitcnt lgkmcnt(3)
    v_mfma_f32_32x32x16_bf16 v[32:47], a[172:175], v[76:79], v[32:47]
    v_add_f32 v98, 1.0, v98
    v_add_f32 v99, 1.0, v99
    ds_read_b128 v[76:79], v4 offset:15360
    s_waitcnt lgkmcnt(3)
    v_mfma_f32_32x32x16_bf16 v[32:47], a[176:179], v[64:67], v[32:47]
    v_add_f32 v100, 1.0, v100
    v_add_f32 v101, 1.0, v101
    buffer_load_dwordx4 v0, s[8:11], s42 offen offset:1024 sc1  lds
    ds_read_b128 v[64:67], v4 offset:16384
    s_waitcnt lgkmcnt(3)
    v_mfma_f32_32x32x16_bf16 v[32:47], a[180:183], v[68:71], v[32:47]
    v_add_f32 v102, 1.0, v102
    v_add_f32 v103, 1.0, v103
    s_add_u32 m0, s44, 8192
    s_add_u32 s42, s46, 8192
    ds_read_b128 v[68:71], v4 offset:17408
    s_waitcnt lgkmcnt(3)
    v_mfma_f32_32x32x16_bf16 v[32:47], a[184:187], v[72:75], v[32:47]
    v_rcp_f32 v96, v96
    v_rcp_f32 v97, v97
    buffer_load_dwordx4 v0, s[8:11], s42 offen offset:0 sc1  lds
    ds_read_b128 v[72:75], v4 offset:18432
    s_waitcnt lgkmcnt(3)
    v_mfma_f32_32x32x16_bf16 v[32:47], a[188:191], v[76:79], v[32:47]
    v_rcp_f32 v98, v98
    v_rcp_f32 v99, v99
    ds_read_b128 v[76:79], v4 offset:19456
    s_waitcnt lgkmcnt(3)
    v_mfma_f32_32x32x16_bf16 v[32:47], a[192:195], v[64:67], v[32:47]
    v_rcp_f32 v100, v100
    v_rcp_f32 v101, v101
    buffer_load_dwordx4 v0, s[8:11], s42 offen offset:1024 sc1  lds
    ds_read_b128 v[64:67], v4 offset:20480
    s_waitcnt lgkmcnt(3)
    v_mfma_f32_32x32x16_bf16 v[32:47], a[196:199], v[68:71], v[32:47]
    v_rcp_f32 v102, v102
    v_rcp_f32 v103, v103
    s_add_u32 m0, s44, 16384
    s_add_u32 s42, s46, 16384
    ds_read_b128 v[68:71], v4 offset:21504
    s_waitcnt lgkmcnt(3)
    v_mfma_f32_32x32x16_bf16 v[32:47], a[200:203], v[72:75], v[32:47]
    v_mul_f32 v16, v16, v24
    v_mul_f32 v17, v17, v25
    buffer_load_dwordx4 v0, s[8:11], s42 offen offset:0 sc1  lds
    ds_read_b128 v[72:75], v4 offset:22528
    s_waitcnt lgkmcnt(3)
    v_mfma_f32_32x32x16_bf16 v[32:47], a[204:207], v[76:79], v[32:47]
    v_mul_f32 v18, v18, v26
    v_mul_f32 v19, v19, v27
    ds_read_b128 v[76:79], v4 offset:23552
    s_waitcnt lgkmcnt(3)
    v_mfma_f32_32x32x16_bf16 v[32:47], a[208:211], v[64:67], v[32:47]
    v_mul_f32 v20, v20, v28
    v_mul_f32 v21, v21, v29
    buffer_load_dwordx4 v0, s[8:11], s42 offen offset:1024 sc1  lds
    ds_read_b128 v[64:67], v4 offset:24576
    s_waitcnt lgkmcnt(3)
    v_mfma_f32_32x32x16_bf16 v[32:47], a[212:215], v[68:71], v[32:47]
    v_mul_f32 v22, v22, v30
    v_mul_f32 v23, v23, v31
    s_add_u32 m0, s44, 24576
    s_add_u32 s42, s46, 24576
    ds_read_b128 v[68:71], v4 offset:25600
    s_waitcnt lgkmcnt(3)
    v_mfma_f32_32x32x16_bf16 v[32:47], a[216:219], v[72:75], v[32:47]
    v_mul_f32 v96, v96, v16
    v_mul_f32 v97, v97, v17
    buffer_load_dwordx4 v0, s[8:11], s42 offen offset:0 sc1  lds
    ds_read_b128 v[72:75], v4 offset:26624
    s_waitcnt lgkmcnt(3)
    v_mfma_f32_32x32x16_bf16 v[32:47], a[220:223], v[76:79], v[32:47]
    v_mul_f32 v98, v98, v18
    v_mul_f32 v99, v99, v19
    ds_read_b128 v[76:79], v4 offset:27648
    s_waitcnt lgkmcnt(3)
    v_mfma_f32_32x32x16_bf16 v[32:47], a[224:227], v[64:67], v[32:47]
    v_mul_f32 v100, v100, v20
    v_mul_f32 v101, v101, v21
    buffer_load_dwordx4 v0, s[8:11], s42 offen offset:1024 sc1  lds
    ds_read_b128 v[64:67], v4 offset:28672
    s_waitcnt lgkmcnt(3)
    v_mfma_f32_32x32x16_bf16 v[32:47], a[228:231], v[68:71], v[32:47]
    v_mul_f32 v102, v102, v22
    v_mul_f32 v103, v103, v23
    ds_read_b128 v[68:71], v4 offset:29696
    s_waitcnt lgkmcnt(3)
    v_mfma_f32_32x32x16_bf16 v[32:47], a[232:235], v[72:75], v[32:47]
    v_cvt_pk_bf16_f32 v88, v96, v97
    v_cvt_pk_bf16_f32 v89, v98, v99
    ds_read_b128 v[72:75], v4 offset:30720
    s_waitcnt lgkmcnt(3)
    v_mfma_f32_32x32x16_bf16 v[32:47], a[236:239], v[76:79], v[32:47]
    v_cvt_pk_bf16_f32 v90, v100, v101
    v_cvt_pk_bf16_f32 v91, v102, v103
    ds_read_b128 v[76:79], v4 offset:31744
    s_waitcnt lgkmcnt(3)
    v_mfma_f32_32x32x16_bf16 v[32:47], a[240:243], v[64:67], v[32:47]
    buffer_store_dwordx4 v[88:91], v0, s[8:11], s30 offen offset:0
    s_waitcnt lgkmcnt(2)
    v_mfma_f32_32x32x16_bf16 v[32:47], a[244:247], v[68:71], v[32:47]
    s_waitcnt lgkmcnt(1)
    v_mfma_f32_32x32x16_bf16 v[32:47], a[248:251], v[72:75], v[32:47]
    s_waitcnt lgkmcnt(0)
    v_mfma_f32_32x32x16_bf16 v[32:47], a[252:255], v[76:79], v[32:47]
    s_add_u32 s28, s28, 1
    s_bfe_u32 s6, s28, 65539
    v_add_u32 v4, s35, v0
    v_mov_b32 v7, s28
    s_nop 8
    v_pk_mul_f32 v[96:97], v[32:33], s[40:41]
    v_pk_mul_f32 v[98:99], v[34:35], s[40:41]
    v_pk_mul_f32 v[100:101], v[36:37], s[40:41]
    v_pk_mul_f32 v[102:103], v[38:39], s[40:41]
    v_exp_f32 v96, v96
    v_exp_f32 v97, v97
    v_exp_f32 v98, v98
    v_exp_f32 v99, v99
    v_exp_f32 v100, v100
    v_exp_f32 v101, v101
    v_exp_f32 v102, v102
    v_exp_f32 v103, v103
    v_pk_mul_f32 v[32:33], v[32:33], v[40:41]
    v_pk_mul_f32 v[34:35], v[34:35], v[42:43]
    v_pk_mul_f32 v[36:37], v[36:37], v[44:45]
    v_pk_mul_f32 v[38:39], v[38:39], v[46:47]
    v_pk_add_f32 v[96:97], v[96:97], 1.0 op_sel_hi:[1,0]
    v_pk_add_f32 v[98:99], v[98:99], 1.0 op_sel_hi:[1,0]
    v_pk_add_f32 v[100:101], v[100:101], 1.0 op_sel_hi:[1,0]
    v_pk_add_f32 v[102:103], v[102:103], 1.0 op_sel_hi:[1,0]
    v_rcp_f32 v96, v96
    v_rcp_f32 v97, v97
    v_rcp_f32 v98, v98
    v_rcp_f32 v99, v99
    v_rcp_f32 v100, v100
    v_rcp_f32 v101, v101
    v_rcp_f32 v102, v102
    v_rcp_f32 v103, v103
    s_nop 0
    v_pk_mul_f32 v[96:97], v[96:97], v[32:33]
    v_pk_mul_f32 v[98:99], v[98:99], v[34:35]
    v_pk_mul_f32 v[100:101], v[100:101], v[36:37]
    v_pk_mul_f32 v[102:103], v[102:103], v[38:39]
    v_cvt_pk_bf16_f32 v92, v96, v97
    v_cvt_pk_bf16_f32 v93, v98, v99
    v_cvt_pk_bf16_f32 v94, v100, v101
    v_cvt_pk_bf16_f32 v95, v102, v103
    buffer_store_dwordx4 v[92:95], v0, s[8:11], s30 offen offset:1024
    s_waitcnt vmcnt(0)
    buffer_store_dword v7, v2, s[8:11], s34 offen
    s_barrier
    ds_read_b128 v[64:67], v4 offset:0
    ds_read_b128 v[68:71], v4 offset:1024
    ds_read_b128 v[72:75], v4 offset:2048
    ds_read_b128 v[76:79], v4 offset:3072
    s_waitcnt lgkmcnt(3)
    v_mfma_f32_32x32x16_bf16 v[16:31], a[0:3], v[64:67], 0
    v_xor_b32 v12, s6, v64
    ds_read_b128 v[64:67], v4 offset:4096
    s_waitcnt lgkmcnt(3)
    v_mfma_f32_32x32x16_bf16 v[16:31], a[4:7], v[68:71], v[16:31]
    v_bitop3_b32 v12, v12, v68, s6 bitop3:96
    s_and_b32 s43, s28, 7
    ds_read_b128 v[68:71], v4 offset:5120
    s_waitcnt lgkmcnt(3)
    v_mfma_f32_32x32x16_bf16 v[16:31], a[8:11], v[72:75], v[16:31]
    v_bitop3_b32 v12, v12, v72, s6 bitop3:96
    s_mul_i32 s30, s43, 131072
    ds_read_b128 v[72:75], v4 offset:6144
    s_waitcnt lgkmcnt(3)
    v_mfma_f32_32x32x16_bf16 v[16:31], a[12:15], v[76:79], v[16:31]
    v_bitop3_b32 v12, v12, v76, s6 bitop3:96
    s_add_u32 s30, s30, s60
    ds_read_b128 v[76:79], v4 offset:7168
    s_waitcnt lgkmcnt(3)
    v_mfma_f32_32x32x16_bf16 v[16:31], a[16:19], v[64:67], v[16:31]
    v_bitop3_b32 v12, v12, v64, s6 bitop3:96
    s_barrier
    ds_read_b128 v[64:67], v4 offset:8192
    s_waitcnt lgkmcnt(3)
    v_mfma_f32_32x32x16_bf16 v[16:31], a[20:23], v[68:71], v[16:31]
    v_bitop3_b32 v12, v12, v68, s6 bitop3:96
    ds_read_b128 v[68:71], v4 offset:9216
    s_waitcnt lgkmcnt(3)
    v_mfma_f32_32x32x16_bf16 v[16:31], a[24:27], v[72:75], v[16:31]
    v_bitop3_b32 v12, v12, v72, s6 bitop3:96
    ds_read_b128 v[72:75], v4 offset:10240
    s_waitcnt lgkmcnt(3)
    v_mfma_f32_32x32x16_bf16 v[16:31], a[28:31], v[76:79], v[16:31]
    v_bitop3_b32 v12, v12, v76, s6 bitop3:96
    ds_read_b128 v[76:79], v4 offset:11264
    s_waitcnt lgkmcnt(3)
    v_mfma_f32_32x32x16_bf16 v[16:31], a[32:35], v[64:67], v[16:31]
    v_bitop3_b32 v12, v12, v64, s6 bitop3:96
    ds_read_b128 v[64:67], v4 offset:12288
    s_waitcnt lgkmcnt(3)
    v_mfma_f32_32x32x16_bf16 v[16:31], a[36:39], v[68:71], v[16:31]
    v_bitop3_b32 v12, v12, v68, s6 bitop3:96
    ds_read_b128 v[68:71], v4 offset:13312
    s_waitcnt lgkmcnt(3)
    v_mfma_f32_32x32x16_bf16 v[16:31], a[40:43], v[72:75], v[16:31]
    v_bitop3_b32 v12, v12, v72, s6 bitop3:96
    ds_read_b128 v[72:75], v4 offset:14336
    s_waitcnt lgkmcnt(3)
    v_mfma_f32_32x32x16_bf16 v[16:31], a[44:47], v[76:79], v[16:31]
    v_bitop3_b32 v12, v12, v76, s6 bitop3:96
    ds_read_b128 v[76:79], v4 offset:15360
    s_waitcnt lgkmcnt(3)
    v_mfma_f32_32x32x16_bf16 v[16:31], a[48:51], v[64:67], v[16:31]
    v_bitop3_b32 v12, v12, v64, s6 bitop3:96
    s_barrier
    ds_read_b128 v[64:67], v4 offset:16384
    s_waitcnt lgkmcnt(3)
    v_mfma_f32_32x32x16_bf16 v[16:31], a[52:55], v[68:71], v[16:31]
    v_bitop3_b32 v12, v12, v68, s6 bitop3:96
    ds_read_b128 v[68:71], v4 offset:17408
    s_waitcnt lgkmcnt(3)
    v_mfma_f32_32x32x16_bf16 v[16:31], a[56:59], v[72:75], v[16:31]
    v_bitop3_b32 v12, v12, v72, s6 bitop3:96
    ds_read_b128 v[72:75], v4 offset:18432
    s_waitcnt lgkmcnt(3)
    v_mfma_f32_32x32x16_bf16 v[16:31], a[60:63], v[76:79], v[16:31]
    v_bitop3_b32 v12, v12, v76, s6 bitop3:96
    ds_read_b128 v[76:79], v4 offset:19456
    s_waitcnt lgkmcnt(3)
    v_mfma_f32_32x32x16_bf16 v[16:31], a[64:67], v[64:67], v[16:31]
    v_bitop3_b32 v12, v12, v64, s6 bitop3:96
    ds_read_b128 v[64:67], v4 offset:20480
    s_waitcnt lgkmcnt(3)
    v_mfma_f32_32x32x16_bf16 v[16:31], a[68:71], v[68:71], v[16:31]
    v_bitop3_b32 v12, v12, v68, s6 bitop3:96
    ds_read_b128 v[68:71], v4 offset:21504
    s_waitcnt lgkmcnt(3)
    v_mfma_f32_32x32x16_bf16 v[16:31], a[72:75], v[72:75], v[16:31]
    v_bitop3_b32 v12, v12, v72, s6 bitop3:96
    ds_read_b128 v[72:75], v4 offset:22528
    s_waitcnt lgkmcnt(3)
    v_mfma_f32_32x32x16_bf16 v[16:31], a[76:79], v[76:79], v[16:31]
    v_bitop3_b32 v12, v12, v76, s6 bitop3:96
    ds_read_b128 v[76:79], v4 offset:23552
    s_waitcnt lgkmcnt(3)
    v_mfma_f32_32x32x16_bf16 v[16:31], a[80:83], v[64:67], v[16:31]
    v_bitop3_b32 v12, v12, v64, s6 bitop3:96
    s_barrier
    ds_read_b128 v[64:67], v4 offset:24576
    s_waitcnt lgkmcnt(3)
    v_mfma_f32_32x32x16_bf16 v[16:31], a[84:87], v[68:71], v[16:31]
    v_bitop3_b32 v12, v12, v68, s6 bitop3:96
    ds_read_b128 v[68:71], v4 offset:25600
    s_waitcnt lgkmcnt(3)
    v_mfma_f32_32x32x16_bf16 v[16:31], a[88:91], v[72:75], v[16:31]
    v_bitop3_b32 v12, v12, v72, s6 bitop3:96
    ds_read_b128 v[72:75], v4 offset:26624
    s_waitcnt lgkmcnt(3)
    v_mfma_f32_32x32x16_bf16 v[16:31], a[92:95], v[76:79], v[16:31]
    v_bitop3_b32 v12, v12, v76, s6 bitop3:96
    ds_read_b128 v[76:79], v4 offset:27648
    s_waitcnt lgkmcnt(3)
    v_mfma_f32_32x32x16_bf16 v[16:31], a[96:99], v[64:67], v[16:31]
    v_bitop3_b32 v12, v12, v64, s6 bitop3:96
    buffer_load_dword v3, v1, s[8:11], s33 offen sc1
    ds_read_b128 v[64:67], v4 offset:28672
    s_waitcnt lgkmcnt(3)
    v_mfma_f32_32x32x16_bf16 v[16:31], a[100:103], v[68:71], v[16:31]
    v_bitop3_b32 v12, v12, v68, s6 bitop3:96
    ds_read_b128 v[68:71], v4 offset:29696
    s_waitcnt lgkmcnt(3)
    v_mfma_f32_32x32x16_bf16 v[16:31], a[104:107], v[72:75], v[16:31]
    v_bitop3_b32 v12, v12, v72, s6 bitop3:96
    ds_read_b128 v[72:75], v4 offset:30720
    s_waitcnt lgkmcnt(3)
    v_mfma_f32_32x32x16_bf16 v[16:31], a[108:111], v[76:79], v[16:31]
    v_bitop3_b32 v12, v12, v76, s6 bitop3:96
    ds_read_b128 v[76:79], v4 offset:31744
    s_waitcnt lgkmcnt(3)
    v_mfma_f32_32x32x16_bf16 v[16:31], a[112:115], v[64:67], v[16:31]
    v_bitop3_b32 v12, v12, v64, s6 bitop3:96
    ds_read_b128 v[64:67], v4 offset:0
    s_waitcnt lgkmcnt(3)
    v_mfma_f32_32x32x16_bf16 v[16:31], a[116:119], v[68:71], v[16:31]
    v_bitop3_b32 v12, v12, v68, s6 bitop3:96
    ds_read_b128 v[68:71], v4 offset:1024
    s_waitcnt lgkmcnt(3)
    v_mfma_f32_32x32x16_bf16 v[16:31], a[120:123], v[72:75], v[16:31]
    v_bitop3_b32 v12, v12, v72, s6 bitop3:96
    ds_read_b128 v[72:75], v4 offset:2048
    s_waitcnt lgkmcnt(3)
    v_mfma_f32_32x32x16_bf16 v[16:31], a[124:127], v[76:79], v[16:31]
    v_bitop3_b32 v12, v12, v76, s6 bitop3:96
    ds_read_b128 v[76:79], v4 offset:3072
    s_waitcnt lgkmcnt(3)
    v_mfma_f32_32x32x16_bf16 v[32:47], a[128:131], v[64:67], 0
    v_and_b32 v12, 1, v12
    v_cmp_eq_u32 vcc, 0, v12
    ds_read_b128 v[64:67], v4 offset:4096
    s_waitcnt lgkmcnt(3)
    v_mfma_f32_32x32x16_bf16 v[32:47], a[132:135], v[68:71], v[32:47]
    s_cbranch_vccnz L_redo_148
    ds_read_b128 v[68:71], v4 offset:5120
    s_waitcnt lgkmcnt(3)
    v_mfma_f32_32x32x16_bf16 v[32:47], a[136:139], v[72:75], v[32:47]
    v_mul_f32 v96, s40, v16
    v_mul_f32 v97, s40, v17
    ds_read_b128 v[72:75], v4 offset:6144
    s_waitcnt lgkmcnt(3)
    v_mfma_f32_32x32x16_bf16 v[32:47], a[140:143], v[76:79], v[32:47]
    s_and_b32 s43, s36, 7
    s_mul_i32 s43, s43, 32768
    v_mul_f32 v98, s40, v18
    v_mul_f32 v99, s40, v19
    ds_read_b128 v[76:79], v4 offset:7168
    s_waitcnt lgkmcnt(3)
    v_mfma_f32_32x32x16_bf16 v[32:47], a[144:147], v[64:67], v[32:47]
    s_add_u32 s46, s43, s48
    s_add_u32 s47, s43, s49
    v_mul_f32 v100, s40, v20
    v_mul_f32 v101, s40, v21
    ds_read_b128 v[64:67], v4 offset:8192
    s_waitcnt lgkmcnt(3)
    v_mfma_f32_32x32x16_bf16 v[32:47], a[148:151], v[68:71], v[32:47]
    s_add_u32 s36, s36, 1
    s_sub_u32 s44, s44, s35
    v_mul_f32 v102, s40, v22
    v_mul_f32 v103, s40, v23
    ds_read_b128 v[68:71], v4 offset:9216
    s_waitcnt lgkmcnt(3)
    v_mfma_f32_32x32x16_bf16 v[32:47], a[152:155], v[72:75], v[32:47]
    s_sub_u32 s45, s45, s35
    s_sub_u32 s35, 32768, s35
    v_exp_f32 v96, v96
    v_exp_f32 v97, v97
    ds_read_b128 v[72:75], v4 offset:10240
    s_waitcnt lgkmcnt(3)
    v_mfma_f32_32x32x16_bf16 v[32:47], a[156:159], v[76:79], v[32:47]
    s_add_u32 s44, s44, s35
    s_add_u32 s45, s45, s35
    v_exp_f32 v98, v98
    v_exp_f32 v99, v99
    ds_read_b128 v[76:79], v4 offset:11264
    s_waitcnt lgkmcnt(3)
    v_mfma_f32_32x32x16_bf16 v[32:47], a[160:163], v[64:67], v[32:47]
    v_exp_f32 v100, v100
    v_exp_f32 v101, v101
    s_waitcnt vmcnt(0)
    v_cmp_gt_u32 vcc, s36, v3
    s_branch L_mid_149
L_tail0_150:
    ds_read_b128 v[68:71], v4 offset:13312
    s_waitcnt lgkmcnt(3)
    v_mfma_f32_32x32x16_bf16 v[32:47], a[168:171], v[72:75], v[32:47]
    v_add_f32 v96, 1.0, v96
    v_add_f32 v97, 1.0, v97
    ds_read_b128 v[72:75], v4 offset:14336
    s_waitcnt lgkmcnt(3)
    v_mfma_f32_32x32x16_bf16 v[32:47], a[172:175], v[76:79], v[32:47]
    v_add_f32 v98, 1.0, v98
    v_add_f32 v99, 1.0, v99
    ds_read_b128 v[76:79], v4 offset:15360
    s_waitcnt lgkmcnt(3)
    v_mfma_f32_32x32x16_bf16 v[32:47], a[176:179], v[64:67], v[32:47]
    v_add_f32 v100, 1.0, v100
    v_add_f32 v101, 1.0, v101
    ds_read_b128 v[64:67], v4 offset:16384
    s_waitcnt lgkmcnt(3)
    v_mfma_f32_32x32x16_bf16 v[32:47], a[180:183], v[68:71], v[32:47]
    v_add_f32 v102, 1.0, v102
    v_add_f32 v103, 1.0, v103
    ds_read_b128 v[68:71], v4 offset:17408
    s_waitcnt lgkmcnt(3)
    v_mfma_f32_32x32x16_bf16 v[32:47], a[184:187], v[72:75], v[32:47]
    v_rcp_f32 v96, v96
    v_rcp_f32 v97, v97
    ds_read_b128 v[72:75], v4 offset:18432
    s_waitcnt lgkmcnt(3)
    v_mfma_f32_32x32x16_bf16 v[32:47], a[188:191], v[76:79], v[32:47]
    v_rcp_f32 v98, v98
    v_rcp_f32 v99, v99
    ds_read_b128 v[76:79], v4 offset:19456
    s_waitcnt lgkmcnt(3)
    v_mfma_f32_32x32x16_bf16 v[32:47], a[192:195], v[64:67], v[32:47]
    v_rcp_f32 v100, v100
    v_rcp_f32 v101, v101
    ds_read_b128 v[64:67], v4 offset:20480
    s_waitcnt lgkmcnt(3)
    v_mfma_f32_32x32x16_bf16 v[32:47], a[196:199], v[68:71], v[32:47]
    v_rcp_f32 v102, v102
    v_rcp_f32 v103, v103
    ds_read_b128 v[68:71], v4 offset:21504
    s_waitcnt lgkmcnt(3)
    v_mfma_f32_32x32x16_bf16 v[32:47], a[200:203], v[72:75], v[32:47]
    v_mul_f32 v16, v16, v24
    v_mul_f32 v17, v17, v25
    ds_read_b128 v[72:75], v4 offset:22528
    s_waitcnt lgkmcnt(3)
    v_mfma_f32_32x32x16_bf16 v[32:47], a[204:207], v[76:79], v[32:47]
    v_mul_f32 v18, v18, v26
    v_mul_f32 v19, v19, v27
    ds_read_b128 v[76:79], v4 offset:23552
    s_waitcnt lgkmcnt(3)
    v_mfma_f32_32x32x16_bf16 v[32:47], a[208:211], v[64:67], v[32:47]
    v_mul_f32 v20, v20, v28
    v_mul_f32 v21, v21, v29
    ds_read_b128 v[64:67], v4 offset:24576
    s_waitcnt lgkmcnt(3)
    v_mfma_f32_32x32x16_bf16 v[32:47], a[212:215], v[68:71], v[32:47]
    v_mul_f32 v22, v22, v30
    v_mul_f32 v23, v23, v31
    ds_read_b128 v[68:71], v4 offset:25600
    s_waitcnt lgkmcnt(3)
    v_mfma_f32_32x32x16_bf16 v[32:47], a[216:219], v[72:75], v[32:47]
    v_mul_f32 v96, v96, v16
    v_mul_f32 v97, v97, v17
    ds_read_b128 v[72:75], v4 offset:26624
    s_waitcnt lgkmcnt(3)
    v_mfma_f32_32x32x16_bf16 v[32:47], a[220:223], v[76:79], v[32:47]
    v_mul_f32 v98, v98, v18
    v_mul_f32 v99, v99, v19
    ds_read_b128 v[76:79], v4 offset:27648
    s_waitcnt lgkmcnt(3)
    v_mfma_f32_32x32x16_bf16 v[32:47], a[224:227], v[64:67], v[32:47]
    v_mul_f32 v100, v100, v20
    v_mul_f32 v101, v101, v21
    ds_read_b128 v[64:67], v4 offset:28672
    s_waitcnt lgkmcnt(3)
    v_mfma_f32_32x32x16_bf16 v[32:47], a[228:231], v[68:71], v[32:47]
    v_mul_f32 v102, v102, v22
    v_mul_f32 v103, v103, v23
    ds_read_b128 v[68:71], v4 offset:29696
    s_waitcnt lgkmcnt(3)
    v_mfma_f32_32x32x16_bf16 v[32:47], a[232:235], v[72:75], v[32:47]
    v_cvt_pk_bf16_f32 v88, v96, v97
    v_cvt_pk_bf16_f32 v89, v98, v99
    ds_read_b128 v[72:75], v4 offset:30720
    s_waitcnt lgkmcnt(3)
    v_mfma_f32_32x32x16_bf16 v[32:47], a[236:239], v[76:79], v[32:47]
    v_cvt_pk_bf16_f32 v90, v100, v101
    v_cvt_pk_bf16_f32 v91, v102, v103
    ds_read_b128 v[76:79], v4 offset:31744
    s_waitcnt lgkmcnt(3)
    v_mfma_f32_32x32x16_bf16 v[32:47], a[240:243], v[64:67], v[32:47]
    buffer_store_dwordx4 v[88:91], v0, s[8:11], s30 offen offset:0
    s_waitcnt lgkmcnt(2)
    v_mfma_f32_32x32x16_bf16 v[32:47], a[244:247], v[68:71], v[32:47]
    s_waitcnt lgkmcnt(1)
    v_mfma_f32_32x32x16_bf16 v[32:47], a[248:251], v[72:75], v[32:47]
    s_waitcnt lgkmcnt(0)
    v_mfma_f32_32x32x16_bf16 v[32:47], a[252:255], v[76:79], v[32:47]
    s_add_u32 s28, s28, 1
    v_add_u32 v4, s35, v0
    v_mov_b32 v7, s28
    s_nop 8
    v_pk_mul_f32 v[96:97], v[32:33], s[40:41]
    v_pk_mul_f32 v[98:99], v[34:35], s[40:41]
    v_pk_mul_f32 v[100:101], v[36:37], s[40:41]
    v_pk_mul_f32 v[102:103], v[38:39], s[40:41]
    v_exp_f32 v96, v96
    v_exp_f32 v97, v97
    v_exp_f32 v98, v98
    v_exp_f32 v99, v99
    v_exp_f32 v100, v100
    v_exp_f32 v101, v101
    v_exp_f32 v102, v102
    v_exp_f32 v103, v103
    v_pk_mul_f32 v[32:33], v[32:33], v[40:41]
    v_pk_mul_f32 v[34:35], v[34:35], v[42:43]
    v_pk_mul_f32 v[36:37], v[36:37], v[44:45]
    v_pk_mul_f32 v[38:39], v[38:39], v[46:47]
    v_pk_add_f32 v[96:97], v[96:97], 1.0 op_sel_hi:[1,0]
    v_pk_add_f32 v[98:99], v[98:99], 1.0 op_sel_hi:[1,0]
    v_pk_add_f32 v[100:101], v[100:101], 1.0 op_sel_hi:[1,0]
    v_pk_add_f32 v[102:103], v[102:103], 1.0 op_sel_hi:[1,0]
    v_rcp_f32 v96, v96
    v_rcp_f32 v97, v97
    v_rcp_f32 v98, v98
    v_rcp_f32 v99, v99
    v_rcp_f32 v100, v100
    v_rcp_f32 v101, v101
    v_rcp_f32 v102, v102
    v_rcp_f32 v103, v103
    s_nop 0
    v_pk_mul_f32 v[96:97], v[96:97], v[32:33]
    v_pk_mul_f32 v[98:99], v[98:99], v[34:35]
    v_pk_mul_f32 v[100:101], v[100:101], v[36:37]
    v_pk_mul_f32 v[102:103], v[102:103], v[38:39]
    v_cvt_pk_bf16_f32 v92, v96, v97
    v_cvt_pk_bf16_f32 v93, v98, v99
    v_cvt_pk_bf16_f32 v94, v100, v101
    v_cvt_pk_bf16_f32 v95, v102, v103
    buffer_store_dwordx4 v[92:95], v0, s[8:11], s30 offen offset:1024
    s_and_b32 s43, s28, 7
    s_mul_i32 s30, s43, 131072
    s_add_u32 s30, s30, s60
    buffer_load_dword v3, v1, s[8:11], s33 offen sc1
    s_waitcnt vmcnt(1)
    buffer_store_dword v7, v2, s[8:11], s34 offen
    s_waitcnt vmcnt(1)
    s_cmp_eq_u32 s28, 64
    s_cbranch_scc1 L_fin_147
    v_cmp_gt_u32 vcc, s36, v3
    s_cbranch_vccz L_dma_146
    s_branch L_item_145
L_fin_147:
    s_branch L_end_153
L_redo_148:
    s_add_u32 s52, s52, 0x1000
    s_cmp_lt_u32 s52, 2147418112
    s_cbranch_scc0 L_fail
    s_waitcnt vmcnt(0) lgkmcnt(0)
    s_barrier
    s_branch L_dma_146
L_end_153:
    s_branch L_done
L_nonlocal_144:
    s_mov_b32 s28, 0
    s_mov_b32 s36, 1
    s_mov_b32 s35, 0
    s_lshl_b32 s44, s24, 11
    s_lshl_b32 s45, s24, 12
    s_add_u32 s46, s29, s44
    s_add_u32 s47, s29, s45
    s_mov_b32 s48, s46
    s_mov_b32 s49, s47
    s_mov_b32 s60, s30
    s_mov_b32 s61, s31
    s_mov_b32 s62, s32
    v_mov_b32 v4, v0
    s_mov_b32 s40, 3216550459
    s_mov_b32 s41, s40
L_item_154:
L_poll_160:
    buffer_load_dword v3, v1, s[8:11], s33 offen sc1
    s_waitcnt vmcnt(0)
    v_cmp_gt_u32 vcc, s36, v3
    s_add_u32 s52, s52, 0x1000
    s_cmp_lt_u32 s52, 2147418112
    s_cbranch_vccz L_poll_160_ok
    s_cbranch_scc1 L_poll_160
    s_branch L_fail
L_poll_160_ok:
L_dma_155:
    s_add_u32 m0, s44, 0
    s_add_u32 s42, s46, 0
    buffer_load_dwordx4 v0, s[8:11], s42 offen offset:0 sc1  lds
    buffer_load_dwordx4 v0, s[8:11], s42 offen offset:1024 sc1  lds
    s_add_u32 m0, s44, 8192
    s_add_u32 s42, s46, 8192
    buffer_load_dwordx4 v0, s[8:11], s42 offen offset:0 sc1  lds
    buffer_load_dwordx4 v0, s[8:11], s42 offen offset:1024 sc1  lds
    s_add_u32 m0, s44, 16384
    s_add_u32 s42, s46, 16384
    buffer_load_dwordx4 v0, s[8:11], s42 offen offset:0 sc1  lds
    buffer_load_dwordx4 v0, s[8:11], s42 offen offset:1024 sc1  lds
L_rd_161:
    s_bfe_u32 s6, s28, 65539
    s_waitcnt vmcnt(4)
    s_barrier
    ds_read_b128 v[64:67], v4 offset:0
    ds_read_b128 v[68:71], v4 offset:1024
    ds_read_b128 v[72:75], v4 offset:2048
    ds_read_b128 v[76:79], v4 offset:3072
    s_waitcnt lgkmcnt(3)
    v_mfma_f32_32x32x16_bf16 v[16:31], a[0:3], v[64:67], 0
    v_xor_b32 v12, s6, v64
    s_add_u32 m0, s44, 24576
    s_add_u32 s42, s46, 24576
    buffer_load_dwordx4 v0, s[8:11], s42 offen offset:0 sc1  lds
    ds_read_b128 v[64:67], v4 offset:4096
    s_waitcnt lgkmcnt(3)
    v_mfma_f32_32x32x16_bf16 v[16:31], a[4:7], v[68:71], v[16:31]
    v_bitop3_b32 v12, v12, v68, s6 bitop3:96
    ds_read_b128 v[68:71], v4 offset:5120
    s_waitcnt lgkmcnt(3)
    v_mfma_f32_32x32x16_bf16 v[16:31], a[8:11], v[72:75], v[16:31]
    v_bitop3_b32 v12, v12, v72, s6 bitop3:96
    buffer_load_dwordx4 v0, s[8:11], s42 offen offset:1024 sc1  lds
    ds_read_b128 v[72:75], v4 offset:6144
    s_waitcnt lgkmcnt(3)
    v_mfma_f32_32x32x16_bf16 v[16:31], a[12:15], v[76:79], v[16:31]
    v_bitop3_b32 v12, v12, v76, s6 bitop3:96
    ds_read_b128 v[76:79], v4 offset:7168
    s_waitcnt lgkmcnt(3)
    v_mfma_f32_32x32x16_bf16 v[16:31], a[16:19], v[64:67], v[16:31]
    v_bitop3_b32 v12, v12, v64, s6 bitop3:96
    s_waitcnt vmcnt(4)
    s_barrier
    ds_read_b128 v[64:67], v4 offset:8192
    s_waitcnt lgkmcnt(3)
    v_mfma_f32_32x32x16_bf16 v[16:31], a[20:23], v[68:71], v[16:31]
    v_bitop3_b32 v12, v12, v68, s6 bitop3:96
    ds_read_b128 v[68:71], v4 offset:9216
    s_waitcnt lgkmcnt(3)
    v_mfma_f32_32x32x16_bf16 v[16:31], a[24:27], v[72:75], v[16:31]
    v_bitop3_b32 v12, v12, v72, s6 bitop3:96
    ds_read_b128 v[72:75], v4 offset:10240
    s_waitcnt lgkmcnt(3)
    v_mfma_f32_32x32x16_bf16 v[16:31], a[28:31], v[76:79], v[16:31]
    v_bitop3_b32 v12, v12, v76, s6 bitop3:96
    ds_read_b128 v[76:79], v4 offset:11264
    s_waitcnt lgkmcnt(3)
    v_mfma_f32_32x32x16_bf16 v[16:31], a[32:35], v[64:67], v[16:31]
    v_bitop3_b32 v12, v12, v64, s6 bitop3:96
    ds_read_b128 v[64:67], v4 offset:12288
    s_waitcnt lgkmcnt(3)
    v_mfma_f32_32x32x16_bf16 v[16:31], a[36:39], v[68:71], v[16:31]
    v_bitop3_b32 v12, v12, v68, s6 bitop3:96
    ds_read_b128 v[68:71], v4 offset:13312
    s_waitcnt lgkmcnt(3)
    v_mfma_f32_32x32x16_bf16 v[16:31], a[40:43], v[72:75], v[16:31]
    v_bitop3_b32 v12, v12, v72, s6 bitop3:96
    ds_read_b128 v[72:75], v4 offset:14336
    s_waitcnt lgkmcnt(3)
    v_mfma_f32_32x32x16_bf16 v[16:31], a[44:47], v[76:79], v[16:31]
    v_bitop3_b32 v12, v12, v76, s6 bitop3:96
    ds_read_b128 v[76:79], v4 offset:15360
    s_waitcnt lgkmcnt(3)
    v_mfma_f32_32x32x16_bf16 v[16:31], a[48:51], v[64:67], v[16:31]
    v_bitop3_b32 v12, v12, v64, s6 bitop3:96
    s_waitcnt vmcnt(2)
    s_barrier
    ds_read_b128 v[64:67], v4 offset:16384
    s_waitcnt lgkmcnt(3)
    v_mfma_f32_32x32x16_bf16 v[16:31], a[52:55], v[68:71], v[16:31]
    v_bitop3_b32 v12, v12, v68, s6 bitop3:96
    ds_read_b128 v[68:71], v4 offset:17408
    s_waitcnt lgkmcnt(3)
    v_mfma_f32_32x32x16_bf16 v[16:31], a[56:59], v[72:75], v[16:31]
    v_bitop3_b32 v12, v12, v72, s6 bitop3:96
    ds_read_b128 v[72:75], v4 offset:18432
    s_waitcnt lgkmcnt(3)
    v_mfma_f32_32x32x16_bf16 v[16:31], a[60:63], v[76:79], v[16:31]
    v_bitop3_b32 v12, v12, v76, s6 bitop3:96
    ds_read_b128 v[76:79], v4 offset:19456
    s_waitcnt lgkmcnt(3)
    v_mfma_f32_32x32x16_bf16 v[16:31], a[64:67], v[64:67], v[16:31]
    v_bitop3_b32 v12, v12, v64, s6 bitop3:96
    ds_read_b128 v[64:67], v4 offset:20480
    s_waitcnt lgkmcnt(3)
    v_mfma_f32_32x32x16_bf16 v[16:31], a[68:71], v[68:71], v[16:31]
    v_bitop3_b32 v12, v12, v68, s6 bitop3:96
    ds_read_b128 v[68:71], v4 offset:21504
    s_waitcnt lgkmcnt(3)
    v_mfma_f32_32x32x16_bf16 v[16:31], a[72:75], v[72:75], v[16:31]
    v_bitop3_b32 v12, v12, v72, s6 bitop3:96
    ds_read_b128 v[72:75], v4 offset:22528
    s_waitcnt lgkmcnt(3)
    v_mfma_f32_32x32x16_bf16 v[16:31], a[76:79], v[76:79], v[16:31]
    v_bitop3_b32 v12, v12, v76, s6 bitop3:96
    ds_read_b128 v[76:79], v4 offset:23552
    s_waitcnt lgkmcnt(3)
    v_mfma_f32_32x32x16_bf16 v[16:31], a[80:83], v[64:67], v[16:31]
    v_bitop3_b32 v12, v12, v64, s6 bitop3:96
    s_waitcnt vmcnt(0)
    s_barrier
    ds_read_b128 v[64:67], v4 offset:24576
    s_waitcnt lgkmcnt(3)
    v_mfma_f32_32x32x16_bf16 v[16:31], a[84:87], v[68:71], v[16:31]
    v_bitop3_b32 v12, v12, v68, s6 bitop3:96
    ds_read_b128 v[68:71], v4 offset:25600
    s_waitcnt lgkmcnt(3)
    v_mfma_f32_32x32x16_bf16 v[16:31], a[88:91], v[72:75], v[16:31]
    v_bitop3_b32 v12, v12, v72, s6 bitop3:96
    ds_read_b128 v[72:75], v4 offset:26624
    s_waitcnt lgkmcnt(3)
    v_mfma_f32_32x32x16_bf16 v[16:31], a[92:95], v[76:79], v[16:31]
    v_bitop3_b32 v12, v12, v76, s6 bitop3:96
    ds_read_b128 v[76:79], v4 offset:27648
    s_waitcnt lgkmcnt(3)
    v_mfma_f32_32x32x16_bf16 v[16:31], a[96:99], v[64:67], v[16:31]
    v_bitop3_b32 v12, v12, v64, s6 bitop3:96
    buffer_load_dword v3, v1, s[8:11], s33 offen sc1
    ds_read_b128 v[64:67], v4 offset:28672
    s_waitcnt lgkmcnt(3)
    v_mfma_f32_32x32x16_bf16 v[16:31], a[100:103], v[68:71], v[16:31]
    v_bitop3_b32 v12, v12, v68, s6 bitop3:96
    ds_read_b128 v[68:71], v4 offset:29696
    s_waitcnt lgkmcnt(3)
    v_mfma_f32_32x32x16_bf16 v[16:31], a[104:107], v[72:75], v[16:31]
    v_bitop3_b32 v12, v12, v72, s6 bitop3:96
    ds_read_b128 v[72:75], v4 offset:30720
    s_waitcnt lgkmcnt(3)
    v_mfma_f32_32x32x16_bf16 v[16:31], a[108:111], v[76:79], v[16:31]
    v_bitop3_b32 v12, v12, v76, s6 bitop3:96
    ds_read_b128 v[76:79], v4 offset:31744
    s_waitcnt lgkmcnt(3)
    v_mfma_f32_32x32x16_bf16 v[16:31], a[112:115], v[64:67], v[16:31]
    v_bitop3_b32 v12, v12, v64, s6 bitop3:96
    ds_read_b128 v[64:67], v4 offset:0
    s_waitcnt lgkmcnt(3)
    v_mfma_f32_32x32x16_bf16 v[16:31], a[116:119], v[68:71], v[16:31]
    v_bitop3_b32 v12, v12, v68, s6 bitop3:96
    ds_read_b128 v[68:71], v4 offset:1024
    s_waitcnt lgkmcnt(3)
    v_mfma_f32_32x32x16_bf16 v[16:31], a[120:123], v[72:75], v[16:31]
    v_bitop3_b32 v12, v12, v72, s6 bitop3:96
    ds_read_b128 v[72:75], v4 offset:2048
    s_waitcnt lgkmcnt(3)
    v_mfma_f32_32x32x16_bf16 v[16:31], a[124:127], v[76:79], v[16:31]
    v_bitop3_b32 v12, v12, v76, s6 bitop3:96
    ds_read_b128 v[76:79], v4 offset:3072
    s_waitcnt lgkmcnt(3)
    v_mfma_f32_32x32x16_bf16 v[32:47], a[128:131], v[64:67], 0
    v_and_b32 v12, 1, v12
    v_cmp_eq_u32 vcc, 0, v12
    ds_read_b128 v[64:67], v4 offset:4096
    s_waitcnt lgkmcnt(3)
    v_mfma_f32_32x32x16_bf16 v[32:47], a[132:135], v[68:71], v[32:47]
    s_cbranch_vccnz L_redo_157
    ds_read_b128 v[68:71], v4 offset:5120
    s_waitcnt lgkmcnt(3)
    v_mfma_f32_32x32x16_bf16 v[32:47], a[136:139], v[72:75], v[32:47]
    v_mul_f32 v96, s40, v16
    v_mul_f32 v97, s40, v17
    ds_read_b128 v[72:75], v4 offset:6144
    s_waitcnt lgkmcnt(3)
    v_mfma_f32_32x32x16_bf16 v[32:47], a[140:143], v[76:79], v[32:47]
    s_and_b32 s43, s36, 7
    s_mul_i32 s43, s43, 32768
    v_mul_f32 v98, s40, v18
    v_mul_f32 v99, s40, v19
    ds_read_b128 v[76:79], v4 offset:7168
    s_waitcnt lgkmcnt(3)
    v_mfma_f32_32x32x16_bf16 v[32:47], a[144:147], v[64:67], v[32:47]
    s_add_u32 s46, s43, s48
    s_add_u32 s47, s43, s49
    v_mul_f32 v100, s40, v20
    v_mul_f32 v101, s40, v21
    ds_read_b128 v[64:67], v4 offset:8192
    s_waitcnt lgkmcnt(3)
    v_mfma_f32_32x32x16_bf16 v[32:47], a[148:151], v[68:71], v[32:47]
    s_add_u32 s36, s36, 1
    s_sub_u32 s44, s44, s35
    v_mul_f32 v102, s40, v22
    v_mul_f32 v103, s40, v23
    ds_read_b128 v[68:71], v4 offset:9216
    s_waitcnt lgkmcnt(3)
    v_mfma_f32_32x32x16_bf16 v[32:47], a[152:155], v[72:75], v[32:47]
    s_sub_u32 s45, s45, s35
    s_sub_u32 s35, 32768, s35
    v_exp_f32 v96, v96
    v_exp_f32 v97, v97
    ds_read_b128 v[72:75], v4 offset:10240
    s_waitcnt lgkmcnt(3)
    v_mfma_f32_32x32x16_bf16 v[32:47], a[156:159], v[76:79], v[32:47]
    s_add_u32 s44, s44, s35
    s_add_u32 s45, s45, s35
    v_exp_f32 v98, v98
    v_exp_f32 v99, v99
    ds_read_b128 v[76:79], v4 offset:11264
    s_waitcnt lgkmcnt(3)
    v_mfma_f32_32x32x16_bf16 v[32:47], a[160:163], v[64:67], v[32:47]
    v_exp_f32 v100, v100
    v_exp_f32 v101, v101
    s_waitcnt vmcnt(0)
    v_cmp_gt_u32 vcc, s36, v3
L_mid_158:
    ds_read_b128 v[64:67], v4 offset:12288
    s_waitcnt lgkmcnt(3)
    v_mfma_f32_32x32x16_bf16 v[32:47], a[164:167], v[68:71], v[32:47]
    v_exp_f32 v102, v102
    v_exp_f32 v103, v103
    s_cbranch_vccnz L_tail0_159
    ds_read_b128 v[68:71], v4 offset:13312
    s_waitcnt lgkmcnt(3)
    v_mfma_f32_32x32x16_bf16 v[32:47], a[168:171], v[72:75], v[32:47]
    v_add_f32 v96, 1.0, v96
    v_add_f32 v97, 1.0, v97
    s_add_u32 m0, s44, 0
    s_add_u32 s42, s46, 0
    buffer_load_dwordx4 v0, s[8:11], s42 offen offset:0 sc1  lds
    ds_read_b128 v[72:75], v4 offset:14336
    s_waitcnt lgkmcnt(3)
    v_mfma_f32_32x32x16_bf16 v[32:47], a[172:175], v[76:79], v[32:47]
    v_add_f32 v98, 1.0, v98
    v_add_f32 v99, 1.0, v99
    ds_read_b128 v[76:79], v4 offset:15360
    s_waitcnt lgkmcnt(3)
    v_mfma_f32_32x32x16_bf16 v[32:47], a[176:179], v[64:67], v[32:47]
    v_add_f32 v100, 1.0, v100
    v_add_f32 v101, 1.0, v101
    buffer_load_dwordx4 v0, s[8:11], s42 offen offset:1024 sc1  lds
    ds_read_b128 v[64:67], v4 offset:16384
    s_waitcnt lgkmcnt(3)
    v_mfma_f32_32x32x16_bf16 v[32:47], a[180:183], v[68:71], v[32:47]
    v_add_f32 v102, 1.0, v102
    v_add_f32 v103, 1.0, v103
    s_add_u32 m0, s44, 8192
    s_add_u32 s42, s46, 8192
    ds_read_b128 v[68:71], v4 offset:17408
    s_waitcnt lgkmcnt(3)
    v_mfma_f32_32x32x16_bf16 v[32:47], a[184:187], v[72:75], v[32:47]
    v_rcp_f32 v96, v96
    v_rcp_f32 v97, v97
    buffer_load_dwordx4 v0, s[8:11], s42 offen offset:0 sc1  lds
    ds_read_b128 v[72:75], v4 offset:18432
    s_waitcnt lgkmcnt(3)
    v_mfma_f32_32x32x16_bf16 v[32:47], a[188:191], v[76:79], v[32:47]
    v_rcp_f32 v98, v98
    v_rcp_f32 v99, v99
    ds_read_b128 v[76:79], v4 offset:19456
    s_waitcnt lgkmcnt(3)
    v_mfma_f32_32x32x16_bf16 v[32:47], a[192:195], v[64:67], v[32:47]
    v_rcp_f32 v100, v100
    v_rcp_f32 v101, v101
    buffer_load_dwordx4 v0, s[8:11], s42 offen offset:1024 sc1  lds
    ds_read_b128 v[64:67], v4 offset:20480
    s_waitcnt lgkmcnt(3)
    v_mfma_f32_32x32x16_bf16 v[32:47], a[196:199], v[68:71], v[32:47]
    v_rcp_f32 v102, v102
    v_rcp_f32 v103, v103
    s_add_u32 m0, s44, 16384
    s_add_u32 s42, s46, 16384
    ds_read_b128 v[68:71], v4 offset:21504
    s_waitcnt lgkmcnt(3)
    v_mfma_f32_32x32x16_bf16 v[32:47], a[200:203], v[72:75], v[32:47]
    v_mul_f32 v16, v16, v24
    v_mul_f32 v17, v17, v25
    buffer_load_dwordx4 v0, s[8:11], s42 offen offset:0 sc1  lds
    ds_read_b128 v[72:75], v4 offset:22528
    s_waitcnt lgkmcnt(3)
    v_mfma_f32_32x32x16_bf16 v[32:47], a[204:207], v[76:79], v[32:47]
    v_mul_f32 v18, v18, v26
    v_mul_f32 v19, v19, v27
    ds_read_b128 v[76:79], v4 offset:23552
    s_waitcnt lgkmcnt(3)
    v_mfma_f32_32x32x16_bf16 v[32:47], a[208:211], v[64:67], v[32:47]
    v_mul_f32 v20, v20, v28
    v_mul_f32 v21, v21, v29
    buffer_load_dwordx4 v0, s[8:11], s42 offen offset:1024 sc1  lds
    ds_read_b128 v[64:67], v4 offset:24576
    s_waitcnt lgkmcnt(3)
    v_mfma_f32_32x32x16_bf16 v[32:47], a[212:215], v[68:71], v[32:47]
    v_mul_f32 v22, v22, v30
    v_mul_f32 v23, v23, v31
    s_add_u32 m0, s44, 24576
    s_add_u32 s42, s46, 24576
    ds_read_b128 v[68:71], v4 offset:25600
    s_waitcnt lgkmcnt(3)
    v_mfma_f32_32x32x16_bf16 v[32:47], a[216:219], v[72:75], v[32:47]
    v_mul_f32 v96, v96, v16
    v_mul_f32 v97, v97, v17
    buffer_load_dwordx4 v0, s[8:11], s42 offen offset:0 sc1  lds
    ds_read_b128 v[72:75], v4 offset:26624
    s_waitcnt lgkmcnt(3)
    v_mfma_f32_32x32x16_bf16 v[32:47], a[220:223], v[76:79], v[32:47]
    v_mul_f32 v98, v98, v18
    v_mul_f32 v99, v99, v19
    ds_read_b128 v[76:79], v4 offset:27648
    s_waitcnt lgkmcnt(3)
    v_mfma_f32_32x32x16_bf16 v[32:47], a[224:227], v[64:67], v[32:47]
    v_mul_f32 v100, v100, v20
    v_mul_f32 v101, v101, v21
    buffer_load_dwordx4 v0, s[8:11], s42 offen offset:1024 sc1  lds
    ds_read_b128 v[64:67], v4 offset:28672
    s_waitcnt lgkmcnt(3)
    v_mfma_f32_32x32x16_bf16 v[32:47], a[228:231], v[68:71], v[32:47]
    v_mul_f32 v102, v102, v22
    v_mul_f32 v103, v103, v23
    ds_read_b128 v[68:71], v4 offset:29696
    s_waitcnt lgkmcnt(3)
    v_mfma_f32_32x32x16_bf16 v[32:47], a[232:235], v[72:75], v[32:47]
    v_cvt_pk_bf16_f32 v88, v96, v97
    v_cvt_pk_bf16_f32 v89, v98, v99
    ds_read_b128 v[72:75], v4 offset:30720
    s_waitcnt lgkmcnt(3)
    v_mfma_f32_32x32x16_bf16 v[32:47], a[236:239], v[76:79], v[32:47]
    v_cvt_pk_bf16_f32 v90, v100, v101
    v_cvt_pk_bf16_f32 v91, v102, v103
    ds_read_b128 v[76:79], v4 offset:31744
    s_waitcnt lgkmcnt(3)
    v_mfma_f32_32x32x16_bf16 v[32:47], a[240:243], v[64:67], v[32:47]
    buffer_store_dwordx4 v[88:91], v0, s[8:11], s30 offen offset:0 sc1
    s_waitcnt lgkmcnt(2)
    v_mfma_f32_32x32x16_bf16 v[32:47], a[244:247], v[68:71], v[32:47]
    s_waitcnt lgkmcnt(1)
    v_mfma_f32_32x32x16_bf16 v[32:47], a[248:251], v[72:75], v[32:47]
    s_waitcnt lgkmcnt(0)
    v_mfma_f32_32x32x16_bf16 v[32:47], a[252:255], v[76:79], v[32:47]
    s_add_u32 s28, s28, 1
    s_bfe_u32 s6, s28, 65539
    v_add_u32 v4, s35, v0
    v_mov_b32 v7, s28
    s_nop 8
    v_pk_mul_f32 v[96:97], v[32:33], s[40:41]
    v_pk_mul_f32 v[98:99], v[34:35], s[40:41]
    v_pk_mul_f32 v[100:101], v[36:37], s[40:41]
    v_pk_mul_f32 v[102:103], v[38:39], s[40:41]
    v_exp_f32 v96, v96
    v_exp_f32 v97, v97
    v_exp_f32 v98, v98
    v_exp_f32 v99, v99
    v_exp_f32 v100, v100
    v_exp_f32 v101, v101
    v_exp_f32 v102, v102
    v_exp_f32 v103, v103
    v_pk_mul_f32 v[32:33], v[32:33], v[40:41]
    v_pk_mul_f32 v[34:35], v[34:35], v[42:43]
    v_pk_mul_f32 v[36:37], v[36:37], v[44:45]
    v_pk_mul_f32 v[38:39], v[38:39], v[46:47]
    v_pk_add_f32 v[96:97], v[96:97], 1.0 op_sel_hi:[1,0]
    v_pk_add_f32 v[98:99], v[98:99], 1.0 op_sel_hi:[1,0]
    v_pk_add_f32 v[100:101], v[100:101], 1.0 op_sel_hi:[1,0]
    v_pk_add_f32 v[102:103], v[102:103], 1.0 op_sel_hi:[1,0]
    v_rcp_f32 v96, v96
    v_rcp_f32 v97, v97
    v_rcp_f32 v98, v98
    v_rcp_f32 v99, v99
    v_rcp_f32 v100, v100
    v_rcp_f32 v101, v101
    v_rcp_f32 v102, v102
    v_rcp_f32 v103, v103
    s_nop 0
    v_pk_mul_f32 v[96:97], v[96:97], v[32:33]
    v_pk_mul_f32 v[98:99], v[98:99], v[34:35]
    v_pk_mul_f32 v[100:101], v[100:101], v[36:37]
    v_pk_mul_f32 v[102:103], v[102:103], v[38:39]
    v_cvt_pk_bf16_f32 v92, v96, v97
    v_cvt_pk_bf16_f32 v93, v98, v99
    v_cvt_pk_bf16_f32 v94, v100, v101
    v_cvt_pk_bf16_f32 v95, v102, v103
    buffer_store_dwordx4 v[92:95], v0, s[8:11], s30 offen offset:1024 sc1
    s_waitcnt vmcnt(0)
    buffer_store_dword v7, v2, s[8:11], s34 offen sc1
    s_barrier
    ds_read_b128 v[64:67], v4 offset:0
    ds_read_b128 v[68:71], v4 offset:1024
    ds_read_b128 v[72:75], v4 offset:2048
    ds_read_b128 v[76:79], v4 offset:3072
    s_waitcnt lgkmcnt(3)
    v_mfma_f32_32x32x16_bf16 v[16:31], a[0:3], v[64:67], 0
    v_xor_b32 v12, s6, v64
    ds_read_b128 v[64:67], v4 offset:4096
    s_waitcnt lgkmcnt(3)
    v_mfma_f32_32x32x16_bf16 v[16:31], a[4:7], v[68:71], v[16:31]
    v_bitop3_b32 v12, v12, v68, s6 bitop3:96
    s_and_b32 s43, s28, 7
    ds_read_b128 v[68:71], v4 offset:5120
    s_waitcnt lgkmcnt(3)
    v_mfma_f32_32x32x16_bf16 v[16:31], a[8:11], v[72:75], v[16:31]
    v_bitop3_b32 v12, v12, v72, s6 bitop3:96
    s_mul_i32 s30, s43, 131072
    ds_read_b128 v[72:75], v4 offset:6144
    s_waitcnt lgkmcnt(3)
    v_mfma_f32_32x32x16_bf16 v[16:31], a[12:15], v[76:79], v[16:31]
    v_bitop3_b32 v12, v12, v76, s6 bitop3:96
    s_add_u32 s30, s30, s60
    ds_read_b128 v[76:79], v4 offset:7168
    s_waitcnt lgkmcnt(3)
    v_mfma_f32_32x32x16_bf16 v[16:31], a[16:19], v[64:67], v[16:31]
    v_bitop3_b32 v12, v12, v64, s6 bitop3:96
    s_barrier
    ds_read_b128 v[64:67], v4 offset:8192
    s_waitcnt lgkmcnt(3)
    v_mfma_f32_32x32x16_bf16 v[16:31], a[20:23], v[68:71], v[16:31]
    v_bitop3_b32 v12, v12, v68, s6 bitop3:96
    ds_read_b128 v[68:71], v4 offset:9216
    s_waitcnt lgkmcnt(3)
    v_mfma_f32_32x32x16_bf16 v[16:31], a[24:27], v[72:75], v[16:31]
    v_bitop3_b32 v12, v12, v72, s6 bitop3:96
    ds_read_b128 v[72:75], v4 offset:10240
    s_waitcnt lgkmcnt(3)
    v_mfma_f32_32x32x16_bf16 v[16:31], a[28:31], v[76:79], v[16:31]
    v_bitop3_b32 v12, v12, v76, s6 bitop3:96
    ds_read_b128 v[76:79], v4 offset:11264
    s_waitcnt lgkmcnt(3)
    v_mfma_f32_32x32x16_bf16 v[16:31], a[32:35], v[64:67], v[16:31]
    v_bitop3_b32 v12, v12, v64, s6 bitop3:96
    ds_read_b128 v[64:67], v4 offset:12288
    s_waitcnt lgkmcnt(3)
    v_mfma_f32_32x32x16_bf16 v[16:31], a[36:39], v[68:71], v[16:31]
    v_bitop3_b32 v12, v12, v68, s6 bitop3:96
    ds_read_b128 v[68:71], v4 offset:13312
    s_waitcnt lgkmcnt(3)
    v_mfma_f32_32x32x16_bf16 v[16:31], a[40:43], v[72:75], v[16:31]
    v_bitop3_b32 v12, v12, v72, s6 bitop3:96
    ds_read_b128 v[72:75], v4 offset:14336
    s_waitcnt lgkmcnt(3)
    v_mfma_f32_32x32x16_bf16 v[16:31], a[44:47], v[76:79], v[16:31]
    v_bitop3_b32 v12, v12, v76, s6 bitop3:96
    ds_read_b128 v[76:79], v4 offset:15360
    s_waitcnt lgkmcnt(3)
    v_mfma_f32_32x32x16_bf16 v[16:31], a[48:51], v[64:67], v[16:31]
    v_bitop3_b32 v12, v12, v64, s6 bitop3:96
    s_barrier
    ds_read_b128 v[64:67], v4 offset:16384
    s_waitcnt lgkmcnt(3)
    v_mfma_f32_32x32x16_bf16 v[16:31], a[52:55], v[68:71], v[16:31]
    v_bitop3_b32 v12, v12, v68, s6 bitop3:96
    ds_read_b128 v[68:71], v4 offset:17408
    s_waitcnt lgkmcnt(3)
    v_mfma_f32_32x32x16_bf16 v[16:31], a[56:59], v[72:75], v[16:31]
    v_bitop3_b32 v12, v12, v72, s6 bitop3:96
    ds_read_b128 v[72:75], v4 offset:18432
    s_waitcnt lgkmcnt(3)
    v_mfma_f32_32x32x16_bf16 v[16:31], a[60:63], v[76:79], v[16:31]
    v_bitop3_b32 v12, v12, v76, s6 bitop3:96
    ds_read_b128 v[76:79], v4 offset:19456
    s_waitcnt lgkmcnt(3)
    v_mfma_f32_32x32x16_bf16 v[16:31], a[64:67], v[64:67], v[16:31]
    v_bitop3_b32 v12, v12, v64, s6 bitop3:96
    ds_read_b128 v[64:67], v4 offset:20480
    s_waitcnt lgkmcnt(3)
    v_mfma_f32_32x32x16_bf16 v[16:31], a[68:71], v[68:71], v[16:31]
    v_bitop3_b32 v12, v12, v68, s6 bitop3:96
    ds_read_b128 v[68:71], v4 offset:21504
    s_waitcnt lgkmcnt(3)
    v_mfma_f32_32x32x16_bf16 v[16:31], a[72:75], v[72:75], v[16:31]
    v_bitop3_b32 v12, v12, v72, s6 bitop3:96
    ds_read_b128 v[72:75], v4 offset:22528
    s_waitcnt lgkmcnt(3)
    v_mfma_f32_32x32x16_bf16 v[16:31], a[76:79], v[76:79], v[16:31]
    v_bitop3_b32 v12, v12, v76, s6 bitop3:96
    ds_read_b128 v[76:79], v4 offset:23552
    s_waitcnt lgkmcnt(3)
    v_mfma_f32_32x32x16_bf16 v[16:31], a[80:83], v[64:67], v[16:31]
    v_bitop3_b32 v12, v12, v64, s6 bitop3:96
    s_barrier
    ds_read_b128 v[64:67], v4 offset:24576
    s_waitcnt lgkmcnt(3)
    v_mfma_f32_32x32x16_bf16 v[16:31], a[84:87], v[68:71], v[16:31]
    v_bitop3_b32 v12, v12, v68, s6 bitop3:96
    ds_read_b128 v[68:71], v4 offset:25600
    s_waitcnt lgkmcnt(3)
    v_mfma_f32_32x32x16_bf16 v[16:31], a[88:91], v[72:75], v[16:31]
    v_bitop3_b32 v12, v12, v72, s6 bitop3:96
    ds_read_b128 v[72:75], v4 offset:26624
    s_waitcnt lgkmcnt(3)
    v_mfma_f32_32x32x16_bf16 v[16:31], a[92:95], v[76:79], v[16:31]
    v_bitop3_b32 v12, v12, v76, s6 bitop3:96
    ds_read_b128 v[76:79], v4 offset:27648
    s_waitcnt lgkmcnt(3)
    v_mfma_f32_32x32x16_bf16 v[16:31], a[96:99], v[64:67], v[16:31]
    v_bitop3_b32 v12, v12, v64, s6 bitop3:96
    buffer_load_dword v3, v1, s[8:11], s33 offen sc1
    ds_read_b128 v[64:67], v4 offset:28672
    s_waitcnt lgkmcnt(3)
    v_mfma_f32_32x32x16_bf16 v[16:31], a[100:103], v[68:71], v[16:31]
    v_bitop3_b32 v12, v12, v68, s6 bitop3:96
    ds_read_b128 v[68:71], v4 offset:29696
    s_waitcnt lgkmcnt(3)
    v_mfma_f32_32x32x16_bf16 v[16:31], a[104:107], v[72:75], v[16:31]
    v_bitop3_b32 v12, v12, v72, s6 bitop3:96
    ds_read_b128 v[72:75], v4 offset:30720
    s_waitcnt lgkmcnt(3)
    v_mfma_f32_32x32x16_bf16 v[16:31], a[108:111], v[76:79], v[16:31]
    v_bitop3_b32 v12, v12, v76, s6 bitop3:96
    ds_read_b128 v[76:79], v4 offset:31744
    s_waitcnt lgkmcnt(3)
    v_mfma_f32_32x32x16_bf16 v[16:31], a[112:115], v[64:67], v[16:31]
    v_bitop3_b32 v12, v12, v64, s6 bitop3:96
    ds_read_b128 v[64:67], v4 offset:0
    s_waitcnt lgkmcnt(3)
    v_mfma_f32_32x32x16_bf16 v[16:31], a[116:119], v[68:71], v[16:31]
    v_bitop3_b32 v12, v12, v68, s6 bitop3:96
    ds_read_b128 v[68:71], v4 offset:1024
    s_waitcnt lgkmcnt(3)
    v_mfma_f32_32x32x16_bf16 v[16:31], a[120:123], v[72:75], v[16:31]
    v_bitop3_b32 v12, v12, v72, s6 bitop3:96
    ds_read_b128 v[72:75], v4 offset:2048
    s_waitcnt lgkmcnt(3)
    v_mfma_f32_32x32x16_bf16 v[16:31], a[124:127], v[76:79], v[16:31]
    v_bitop3_b32 v12, v12, v76, s6 bitop3:96
    ds_read_b128 v[76:79], v4 offset:3072
    s_waitcnt lgkmcnt(3)
    v_mfma_f32_32x32x16_bf16 v[32:47], a[128:131], v[64:67], 0
    v_and_b32 v12, 1, v12
    v_cmp_eq_u32 vcc, 0, v12
    ds_read_b128 v[64:67], v4 offset:4096
    s_waitcnt lgkmcnt(3)
    v_mfma_f32_32x32x16_bf16 v[32:47], a[132:135], v[68:71], v[32:47]
    s_cbranch_vccnz L_redo_157
    ds_read_b128 v[68:71], v4 offset:5120
    s_waitcnt lgkmcnt(3)
    v_mfma_f32_32x32x16_bf16 v[32:47], a[136:139], v[72:75], v[32:47]
    v_mul_f32 v96, s40, v16
    v_mul_f32 v97, s40, v17
    ds_read_b128 v[72:75], v4 offset:6144
    s_waitcnt lgkmcnt(3)
    v_mfma_f32_32x32x16_bf16 v[32:47], a[140:143], v[76:79], v[32:47]
    s_and_b32 s43, s36, 7
    s_mul_i32 s43, s43, 32768
    v_mul_f32 v98, s40, v18
    v_mul_f32 v99, s40, v19
    ds_read_b128 v[76:79], v4 offset:7168
    s_waitcnt lgkmcnt(3)
    v_mfma_f32_32x32x16_bf16 v[32:47], a[144:147], v[64:67], v[32:47]
    s_add_u32 s46, s43, s48
    s_add_u32 s47, s43, s49
    v_mul_f32 v100, s40, v20
    v_mul_f32 v101, s40, v21
    ds_read_b128 v[64:67], v4 offset:8192
    s_waitcnt lgkmcnt(3)
    v_mfma_f32_32x32x16_bf16 v[32:47], a[148:151], v[68:71], v[32:47]
    s_add_u32 s36, s36, 1
    s_sub_u32 s44, s44, s35
    v_mul_f32 v102, s40, v22
    v_mul_f32 v103, s40, v23
    ds_read_b128 v[68:71], v4 offset:9216
    s_waitcnt lgkmcnt(3)
    v_mfma_f32_32x32x16_bf16 v[32:47], a[152:155], v[72:75], v[32:47]
    s_sub_u32 s45, s45, s35
    s_sub_u32 s35, 32768, s35
    v_exp_f32 v96, v96
    v_exp_f32 v97, v97
    ds_read_b128 v[72:75], v4 offset:10240
    s_waitcnt lgkmcnt(3)
    v_mfma_f32_32x32x16_bf16 v[32:47], a[156:159], v[76:79], v[32:47]
    s_add_u32 s44, s44, s35
    s_add_u32 s45, s45, s35
    v_exp_f32 v98, v98
    v_exp_f32 v99, v99
    ds_read_b128 v[76:79], v4 offset:11264
    s_waitcnt lgkmcnt(3)
    v_mfma_f32_32x32x16_bf16 v[32:47], a[160:163], v[64:67], v[32:47]
    v_exp_f32 v100, v100
    v_exp_f32 v101, v101
    s_waitcnt vmcnt(0)
    v_cmp_gt_u32 vcc, s36, v3
    s_branch L_mid_158
L_tail0_159:
    ds_read_b128 v[68:71], v4 offset:13312
    s_waitcnt lgkmcnt(3)
    v_mfma_f32_32x32x16_bf16 v[32:47], a[168:171], v[72:75], v[32:47]
    v_add_f32 v96, 1.0, v96
    v_add_f32 v97, 1.0, v97
    ds_read_b128 v[72:75], v4 offset:14336
    s_waitcnt lgkmcnt(3)
    v_mfma_f32_32x32x16_bf16 v[32:47], a[172:175], v[76:79], v[32:47]
    v_add_f32 v98, 1.0, v98
    v_add_f32 v99, 1.0, v99
    ds_read_b128 v[76:79], v4 offset:15360
    s_waitcnt lgkmcnt(3)
    v_mfma_f32_32x32x16_bf16 v[32:47], a[176:179], v[64:67], v[32:47]
    v_add_f32 v100, 1.0, v100
    v_add_f32 v101, 1.0, v101
    ds_read_b128 v[64:67], v4 offset:16384
    s_waitcnt lgkmcnt(3)
    v_mfma_f32_32x32x16_bf16 v[32:47], a[180:183], v[68:71], v[32:47]
    v_add_f32 v102, 1.0, v102
    v_add_f32 v103, 1.0, v103
    ds_read_b128 v[68:71], v4 offset:17408
    s_waitcnt lgkmcnt(3)
    v_mfma_f32_32x32x16_bf16 v[32:47], a[184:187], v[72:75], v[32:47]
    v_rcp_f32 v96, v96
    v_rcp_f32 v97, v97
    ds_read_b128 v[72:75], v4 offset:18432
    s_waitcnt lgkmcnt(3)
    v_mfma_f32_32x32x16_bf16 v[32:47], a[188:191], v[76:79], v[32:47]
    v_rcp_f32 v98, v98
    v_rcp_f32 v99, v99
    ds_read_b128 v[76:79], v4 offset:19456
    s_waitcnt lgkmcnt(3)
    v_mfma_f32_32x32x16_bf16 v[32:47], a[192:195], v[64:67], v[32:47]
    v_rcp_f32 v100, v100
    v_rcp_f32 v101, v101
    ds_read_b128 v[64:67], v4 offset:20480
    s_waitcnt lgkmcnt(3)
    v_mfma_f32_32x32x16_bf16 v[32:47], a[196:199], v[68:71], v[32:47]
    v_rcp_f32 v102, v102
    v_rcp_f32 v103, v103
    ds_read_b128 v[68:71], v4 offset:21504
    s_waitcnt lgkmcnt(3)
    v_mfma_f32_32x32x16_bf16 v[32:47], a[200:203], v[72:75], v[32:47]
    v_mul_f32 v16, v16, v24
    v_mul_f32 v17, v17, v25
    ds_read_b128 v[72:75], v4 offset:22528
    s_waitcnt lgkmcnt(3)
    v_mfma_f32_32x32x16_bf16 v[32:47], a[204:207], v[76:79], v[32:47]
    v_mul_f32 v18, v18, v26
    v_mul_f32 v19, v19, v27
    ds_read_b128 v[76:79], v4 offset:23552
    s_waitcnt lgkmcnt(3)
    v_mfma_f32_32x32x16_bf16 v[32:47], a[208:211], v[64:67], v[32:47]
    v_mul_f32 v20, v20, v28
    v_mul_f32 v21, v21, v29
    ds_read_b128 v[64:67], v4 offset:24576
    s_waitcnt lgkmcnt(3)
    v_mfma_f32_32x32x16_bf16 v[32:47], a[212:215], v[68:71], v[32:47]
    v_mul_f32 v22, v22, v30
    v_mul_f32 v23, v23, v31
    ds_read_b128 v[68:71], v4 offset:25600
    s_waitcnt lgkmcnt(3)
    v_mfma_f32_32x32x16_bf16 v[32:47], a[216:219], v[72:75], v[32:47]
    v_mul_f32 v96, v96, v16
    v_mul_f32 v97, v97, v17
    ds_read_b128 v[72:75], v4 offset:26624
    s_waitcnt lgkmcnt(3)
    v_mfma_f32_32x32x16_bf16 v[32:47], a[220:223], v[76:79], v[32:47]
    v_mul_f32 v98, v98, v18
    v_mul_f32 v99, v99, v19
    ds_read_b128 v[76:79], v4 offset:27648
    s_waitcnt lgkmcnt(3)
    v_mfma_f32_32x32x16_bf16 v[32:47], a[224:227], v[64:67], v[32:47]
    v_mul_f32 v100, v100, v20
    v_mul_f32 v101, v101, v21
    ds_read_b128 v[64:67], v4 offset:28672
    s_waitcnt lgkmcnt(3)
    v_mfma_f32_32x32x16_bf16 v[32:47], a[228:231], v[68:71], v[32:47]
    v_mul_f32 v102, v102, v22
    v_mul_f32 v103, v103, v23
    ds_read_b128 v[68:71], v4 offset:29696
    s_waitcnt lgkmcnt(3)
    v_mfma_f32_32x32x16_bf16 v[32:47], a[232:235], v[72:75], v[32:47]
    v_cvt_pk_bf16_f32 v88, v96, v97
    v_cvt_pk_bf16_f32 v89, v98, v99
    ds_read_b128 v[72:75], v4 offset:30720
    s_waitcnt lgkmcnt(3)
    v_mfma_f32_32x32x16_bf16 v[32:47], a[236:239], v[76:79], v[32:47]
    v_cvt_pk_bf16_f32 v90, v100, v101
    v_cvt_pk_bf16_f32 v91, v102, v103
    ds_read_b128 v[76:79], v4 offset:31744
    s_waitcnt lgkmcnt(3)
    v_mfma_f32_32x32x16_bf16 v[32:47], a[240:243], v[64:67], v[32:47]
    buffer_store_dwordx4 v[88:91], v0, s[8:11], s30 offen offset:0 sc1
    s_waitcnt lgkmcnt(2)
    v_mfma_f32_32x32x16_bf16 v[32:47], a[244:247], v[68:71], v[32:47]
    s_waitcnt lgkmcnt(1)
    v_mfma_f32_32x32x16_bf16 v[32:47], a[248:251], v[72:75], v[32:47]
    s_waitcnt lgkmcnt(0)
    v_mfma_f32_32x32x16_bf16 v[32:47], a[252:255], v[76:79], v[32:47]
    s_add_u32 s28, s28, 1
    v_add_u32 v4, s35, v0
    v_mov_b32 v7, s28
    s_nop 8
    v_pk_mul_f32 v[96:97], v[32:33], s[40:41]
    v_pk_mul_f32 v[98:99], v[34:35], s[40:41]
    v_pk_mul_f32 v[100:101], v[36:37], s[40:41]
    v_pk_mul_f32 v[102:103], v[38:39], s[40:41]
    v_exp_f32 v96, v96
    v_exp_f32 v97, v97
    v_exp_f32 v98, v98
    v_exp_f32 v99, v99
    v_exp_f32 v100, v100
    v_exp_f32 v101, v101
    v_exp_f32 v102, v102
    v_exp_f32 v103, v103
    v_pk_mul_f32 v[32:33], v[32:33], v[40:41]
    v_pk_mul_f32 v[34:35], v[34:35], v[42:43]
    v_pk_mul_f32 v[36:37], v[36:37], v[44:45]
    v_pk_mul_f32 v[38:39], v[38:39], v[46:47]
    v_pk_add_f32 v[96:97], v[96:97], 1.0 op_sel_hi:[1,0]
    v_pk_add_f32 v[98:99], v[98:99], 1.0 op_sel_hi:[1,0]
    v_pk_add_f32 v[100:101], v[100:101], 1.0 op_sel_hi:[1,0]
    v_pk_add_f32 v[102:103], v[102:103], 1.0 op_sel_hi:[1,0]
    v_rcp_f32 v96, v96
    v_rcp_f32 v97, v97
    v_rcp_f32 v98, v98
    v_rcp_f32 v99, v99
    v_rcp_f32 v100, v100
    v_rcp_f32 v101, v101
    v_rcp_f32 v102, v102
    v_rcp_f32 v103, v103
    s_nop 0
    v_pk_mul_f32 v[96:97], v[96:97], v[32:33]
    v_pk_mul_f32 v[98:99], v[98:99], v[34:35]
    v_pk_mul_f32 v[100:101], v[100:101], v[36:37]
    v_pk_mul_f32 v[102:103], v[102:103], v[38:39]
    v_cvt_pk_bf16_f32 v92, v96, v97
    v_cvt_pk_bf16_f32 v93, v98, v99
    v_cvt_pk_bf16_f32 v94, v100, v101
    v_cvt_pk_bf16_f32 v95, v102, v103
    buffer_store_dwordx4 v[92:95], v0, s[8:11], s30 offen offset:1024 sc1
    s_and_b32 s43, s28, 7
    s_mul_i32 s30, s43, 131072
    s_add_u32 s30, s30, s60
    buffer_load_dword v3, v1, s[8:11], s33 offen sc1
    s_waitcnt vmcnt(1)
    buffer_store_dword v7, v2, s[8:11], s34 offen sc1
    s_waitcnt vmcnt(1)
    s_cmp_eq_u32 s28, 64
    s_cbranch_scc1 L_fin_156
    v_cmp_gt_u32 vcc, s36, v3
    s_cbranch_vccz L_dma_155
    s_branch L_item_154
L_fin_156:
    s_branch L_end_162
L_redo_157:
    s_add_u32 s52, s52, 0x1000
    s_cmp_lt_u32 s52, 2147418112
    s_cbranch_scc0 L_fail
    s_waitcnt vmcnt(0) lgkmcnt(0)
    s_barrier
    s_branch L_dma_155
L_end_162:
    s_branch L_done
    .p2align 6
L_d:
    v_mov_b32 v112, v0
    v_lshlrev_b32 v0, 4, v112
    v_mov_b32 v2, 0
    s_mov_b32 s52, 0
    s_cmp_eq_u32 s24, 0
    s_cselect_b32 s42, 0, 0x40000000
    v_mov_b32 v10, s42
    s_lshr_b32 s42, s26, 2
    s_and_b32 s43, s26, 3
    s_mul_i32 s38, s42, 917504
    s_lshl_b32 s30, s43, 8
    s_add_u32 s38, s38, s30
    s_mul_i32 s29, s27, 8388608
    s_mul_i32 s30, s42, 57344
    s_add_u32 s29, s29, s30
    s_lshr_b32 s30, s42, 1
    s_mul_i32 s30, s30, 0
    s_add_u32 s29, s29, s30
    s_add_u32 s29, s29, 226492416
    s_mul_i32 s30, s27, 4194304
    s_add_u32 s30, s30, 209715200
    s_lshl_b32 s33, s42, 15
    s_add_u32 s30, s30, s33
    s_lshl_b32 s33, s43, 13
    s_add_u32 s30, s30, s33
    s_lshl_b32 s33, s24, 11
    s_add_u32 s30, s30, s33
    s_lshl_b32 s34, s27, 15
    s_add_u32 s34, s34, 360448
    s_mul_i32 s43, s26, 128
    s_add_u32 s34, s34, s43
    s_lshl_b32 s43, s24, 2
    s_add_u32 s34, s34, s43
    s_mul_i32 s42, s42, 7
    s_lshl_b32 s33, s27, 15
    s_add_u32 s33, s33, 294912
    s_mul_i32 s43, s42, 128
    s_add_u32 s33, s33, s43
    v_lshrrev_b32 v1, 2, v112
    v_min_u32 v1, 6, v1
    v_mul_u32_u24 v1, 128, v1
    v_and_b32 v113, 3, v112
    v_lshl_add_u32 v1, v113, 2, v1
    s_cmp_lg_u32 s24, 0
    s_cbranch_scc1 L_na_163
    v_lshlrev_b32 v7, 2, v112
    s_mov_b64 exec, 15
    buffer_store_dword v2, v7, s[8:11], s34 offen sc1
    s_mov_b64 exec, -1
    v_mov_b64 v[16:17], 0
    v_mov_b64 v[18:19], 0
    s_add_u32 s42, s30, 0
    buffer_store_dwordx4 v[16:19], v0, s[8:11], s42 offen offset:0 sc1
    buffer_store_dwordx4 v[16:19], v0, s[8:11], s42 offen offset:1024 sc1
    buffer_store_dwordx4 v[16:19], v0, s[8:11], s42 offen offset:2048 sc1
    buffer_store_dwordx4 v[16:19], v0, s[8:11], s42 offen offset:3072 sc1
    s_add_u32 s42, s30, 4096
    buffer_store_dwordx4 v[16:19], v0, s[8:11], s42 offen offset:0 sc1
    buffer_store_dwordx4 v[16:19], v0, s[8:11], s42 offen offset:1024 sc1
    buffer_store_dwordx4 v[16:19], v0, s[8:11], s42 offen offset:2048 sc1
    buffer_store_dwordx4 v[16:19], v0, s[8:11], s42 offen offset:3072 sc1
    s_add_u32 s42, s30, 65536
    buffer_store_dwordx4 v[16:19], v0, s[8:11], s42 offen offset:0 sc1
    buffer_store_dwordx4 v[16:19], v0, s[8:11], s42 offen offset:1024 sc1
    buffer_store_dwordx4 v[16:19], v0, s[8:11], s42 offen offset:2048 sc1
    buffer_store_dwordx4 v[16:19], v0, s[8:11], s42 offen offset:3072 sc1
    s_add_u32 s42, s30, 69632
    buffer_store_dwordx4 v[16:19], v0, s[8:11], s42 offen offset:0 sc1
    buffer_store_dwordx4 v[16:19], v0, s[8:11], s42 offen offset:1024 sc1
    buffer_store_dwordx4 v[16:19], v0, s[8:11], s42 offen offset:2048 sc1
    buffer_store_dwordx4 v[16:19], v0, s[8:11], s42 offen offset:3072 sc1
    s_add_u32 s42, s30, 131072
    buffer_store_dwordx4 v[16:19], v0, s[8:11], s42 offen offset:0 sc1
    buffer_store_dwordx4 v[16:19], v0, s[8:11], s42 offen offset:1024 sc1
    buffer_store_dwordx4 v[16:19], v0, s[8:11], s42 offen offset:2048 sc1
    buffer_store_dwordx4 v[16:19], v0, s[8:11], s42 offen offset:3072 sc1
    s_add_u32 s42, s30, 135168
    buffer_store_dwordx4 v[16:19], v0, s[8:11], s42 offen offset:0 sc1
    buffer_store_dwordx4 v[16:19], v0, s[8:11], s42 offen offset:1024 sc1
    buffer_store_dwordx4 v[16:19], v0, s[8:11], s42 offen offset:2048 sc1
    buffer_store_dwordx4 v[16:19], v0, s[8:11], s42 offen offset:3072 sc1
    s_add_u32 s42, s30, 196608
    buffer_store_dwordx4 v[16:19], v0, s[8:11], s42 offen offset:0 sc1
    buffer_store_dwordx4 v[16:19], v0, s[8:11], s42 offen offset:1024 sc1
    buffer_store_dwordx4 v[16:19], v0, s[8:11], s42 offen offset:2048 sc1
    buffer_store_dwordx4 v[16:19], v0, s[8:11], s42 offen offset:3072 sc1
    s_add_u32 s42, s30, 200704
    buffer_store_dwordx4 v[16:19], v0, s[8:11], s42 offen offset:0 sc1
    buffer_store_dwordx4 v[16:19], v0, s[8:11], s42 offen offset:1024 sc1
    buffer_store_dwordx4 v[16:19], v0, s[8:11], s42 offen offset:2048 sc1
    buffer_store_dwordx4 v[16:19], v0, s[8:11], s42 offen offset:3072 sc1
    s_add_u32 s42, s30, 262144
    buffer_store_dwordx4 v[16:19], v0, s[8:11], s42 offen offset:0 sc1
    buffer_store_dwordx4 v[16:19], v0, s[8:11], s42 offen offset:1024 sc1
    buffer_store_dwordx4 v[16:19], v0, s[8:11], s42 offen offset:2048 sc1
    buffer_store_dwordx4 v[16:19], v0, s[8:11], s42 offen offset:3072 sc1
    s_add_u32 s42, s30, 266240
    buffer_store_dwordx4 v[16:19], v0, s[8:11], s42 offen offset:0 sc1
    buffer_store_dwordx4 v[16:19], v0, s[8:11], s42 offen offset:1024 sc1
    buffer_store_dwordx4 v[16:19], v0, s[8:11], s42 offen offset:2048 sc1
    buffer_store_dwordx4 v[16:19], v0, s[8:11], s42 offen offset:3072 sc1
    s_add_u32 s42, s30, 327680
    buffer_store_dwordx4 v[16:19], v0, s[8:11], s42 offen offset:0 sc1
    buffer_store_dwordx4 v[16:19], v0, s[8:11], s42 offen offset:1024 sc1
    buffer_store_dwordx4 v[16:19], v0, s[8:11], s42 offen offset:2048 sc1
    buffer_store_dwordx4 v[16:19], v0, s[8:11], s42 offen offset:3072 sc1
    s_add_u32 s42, s30, 331776
    buffer_store_dwordx4 v[16:19], v0, s[8:11], s42 offen offset:0 sc1
    buffer_store_dwordx4 v[16:19], v0, s[8:11], s42 offen offset:1024 sc1
    buffer_store_dwordx4 v[16:19], v0, s[8:11], s42 offen offset:2048 sc1
    buffer_store_dwordx4 v[16:19], v0, s[8:11], s42 offen offset:3072 sc1
    s_add_u32 s42, s30, 393216
    buffer_store_dwordx4 v[16:19], v0, s[8:11], s42 offen offset:0 sc1
    buffer_store_dwordx4 v[16:19], v0, s[8:11], s42 offen offset:1024 sc1
    buffer_store_dwordx4 v[16:19], v0, s[8:11], s42 offen offset:2048 sc1
    buffer_store_dwordx4 v[16:19], v0, s[8:11], s42 offen offset:3072 sc1
    s_add_u32 s42, s30, 397312
    buffer_store_dwordx4 v[16:19], v0, s[8:11], s42 offen offset:0 sc1
    buffer_store_dwordx4 v[16:19], v0, s[8:11], s42 offen offset:1024 sc1
    buffer_store_dwordx4 v[16:19], v0, s[8:11], s42 offen offset:2048 sc1
    buffer_store_dwordx4 v[16:19], v0, s[8:11], s42 offen offset:3072 sc1
    s_add_u32 s42, s30, 458752
    buffer_store_dwordx4 v[16:19], v0, s[8:11], s42 offen offset:0 sc1
    buffer_store_dwordx4 v[16:19], v0, s[8:11], s42 offen offset:1024 sc1
    buffer_store_dwordx4 v[16:19], v0, s[8:11], s42 offen offset:2048 sc1
    buffer_store_dwordx4 v[16:19], v0, s[8:11], s42 offen offset:3072 sc1
    s_add_u32 s42, s30, 462848
    buffer_store_dwordx4 v[16:19], v0, s[8:11], s42 offen offset:0 sc1
    buffer_store_dwordx4 v[16:19], v0, s[8:11], s42 offen offset:1024 sc1
    buffer_store_dwordx4 v[16:19], v0, s[8:11], s42 offen offset:2048 sc1
    buffer_store_dwordx4 v[16:19], v0, s[8:11], s42 offen offset:3072 sc1
    s_waitcnt vmcnt(0)
    v_mov_b32 v126, 1
    v_mov_b32 v127, 4
    s_mov_b64 exec, 1
    buffer_atomic_add v126, v127, s[12:15], 0 offen
    s_mov_b64 exec, -1
L_na_164:
L_na_163:
    s_mov_b32 s16, s84
    s_mov_b32 s17, s85
    s_mov_b32 s18, 1835008
    s_mov_b32 s19, 0x00020000
    v_mov_b32 v114, 0
    v_bfe_i32 v113, v112, 0, 1
    v_and_b32 v113, 16, v113
    v_xor_b32 v114, v114, v113
    v_bfe_i32 v113, v112, 1, 1
    v_and_b32 v113, 32, v113
    v_xor_b32 v114, v114, v113
    v_bfe_i32 v113, v112, 2, 1
    v_and_b32 v113, 64, v113
    v_xor_b32 v114, v114, v113
    v_bfe_i32 v113, v112, 3, 1
    v_and_b32 v113, 128, v113
    v_xor_b32 v114, v114, v113
    v_bfe_i32 v113, v112, 4, 1
    v_and_b32 v113, 64, v113
    v_xor_b32 v114, v114, v113
    v_bfe_i32 v113, v112, 5, 1
    v_and_b32 v113, 128, v113
    v_xor_b32 v114, v114, v113
    v_lshrrev_b32 v113, 4, v112
    v_mul_u32_u24 v113, 1024, v113
    v_xor_b32 v115, 32, v114
    v_add_u32 v114, v113, v114
    v_add_u32 v115, v113, v115
    s_mul_i32 s42, s24, 16384
    s_add_u32 s38, s38, s42
    s_lshl_b32 s39, s24, 12
    v_mov_b32 v116, 0
    v_bfe_i32 v113, v112, 0, 1
    v_and_b32 v113, 8, v113
    v_xor_b32 v116, v116, v113
    v_bfe_i32 v113, v112, 1, 1
    v_and_b32 v113, 16, v113
    v_xor_b32 v116, v116, v113
    v_bfe_i32 v113, v112, 2, 1
    v_and_b32 v113, 320, v113
    v_xor_b32 v116, v116, v113
    v_bfe_i32 v113, v112, 3, 1
    v_and_b32 v113, 640, v113
    v_xor_b32 v116, v116, v113
    v_bfe_i32 v113, v112, 4, 1
    v_and_b32 v113, 32, v113
    v_xor_b32 v116, v116, v113
    v_bfe_i32 v113, v112, 5, 1
    v_and_b32 v113, 1024, v113
    v_xor_b32 v116, v116, v113
    s_lshl_b32 s42, s24, 6
    v_xor_b32 v116, s42, v116
    s_cmp_eq_u32 s27, 0
    s_cselect_b32 s99, 32, 64
    v_mov_b32 v126, 132
    s_cmp_eq_u32 s99, 0
    s_cbranch_scc1 L_gate_165_ok
L_gate_165:
    s_sleep 8
    buffer_load_dword v127, v126, s[12:15], 0 offen sc1
    s_add_u32 s52, s52, 0x1000
    s_cmp_ge_u32 s52, 2147418112
    s_cbranch_scc1 L_fail
    s_waitcnt vmcnt(0)
    v_cmp_gt_u32 vcc, s99, v127
    s_cbranch_vccnz L_gate_165
L_gate_165_ok:
    s_add_u32 m0, s39, 0
    s_add_u32 s42, s38, 0
    buffer_load_dwordx4 v114, s[16:19], s42 offen  lds
    s_add_u32 m0, s39, 1024
    s_add_u32 s42, s38, 4096
    buffer_load_dwordx4 v114, s[16:19], s42 offen  lds
    s_add_u32 m0, s39, 2048
    s_add_u32 s42, s38, 8192
    buffer_load_dwordx4 v114, s[16:19], s42 offen  lds
    s_add_u32 m0, s39, 3072
    s_add_u32 s42, s38, 12288
    buffer_load_dwordx4 v114, s[16:19], s42 offen  lds
    s_add_u32 m0, s39, 16384
    s_add_u32 s42, s38, 65536
    buffer_load_dwordx4 v114, s[16:19], s42 offen  lds
    s_add_u32 m0, s39, 17408
    s_add_u32 s42, s38, 69632
    buffer_load_dwordx4 v114, s[16:19], s42 offen  lds
    s_add_u32 m0, s39, 18432
    s_add_u32 s42, s38, 73728
    buffer_load_dwordx4 v114, s[16:19], s42 offen  lds
    s_add_u32 m0, s39, 19456
    s_add_u32 s42, s38, 77824
    buffer_load_dwordx4 v114, s[16:19], s42 offen  lds
    s_add_u32 m0, s39, 32768
    s_add_u32 s42, s38, 131072
    buffer_load_dwordx4 v114, s[16:19], s42 offen  lds
    s_add_u32 m0, s39, 33792
    s_add_u32 s42, s38, 135168
    buffer_load_dwordx4 v114, s[16:19], s42 offen  lds
    s_add_u32 m0, s39, 34816
    s_add_u32 s42, s38, 139264
    buffer_load_dwordx4 v114, s[16:19], s42 offen  lds
    s_add_u32 m0, s39, 35840
    s_add_u32 s42, s38, 143360
    buffer_load_dwordx4 v114, s[16:19], s42 offen  lds
    s_add_u32 m0, s39, 49152
    s_add_u32 s42, s38, 196608
    buffer_load_dwordx4 v114, s[16:19], s42 offen  lds
    s_add_u32 m0, s39, 50176
    s_add_u32 s42, s38, 200704
    buffer_load_dwordx4 v114, s[16:19], s42 offen  lds
    s_add_u32 m0, s39, 51200
    s_add_u32 s42, s38, 204800
    buffer_load_dwordx4 v114, s[16:19], s42 offen  lds
    s_add_u32 m0, s39, 52224
    s_add_u32 s42, s38, 208896
    buffer_load_dwordx4 v114, s[16:19], s42 offen  lds
    s_add_u32 m0, s39, 65536
    s_add_u32 s42, s38, 262144
    buffer_load_dwordx4 v114, s[16:19], s42 offen  lds
    s_add_u32 m0, s39, 66560
    s_add_u32 s42, s38, 266240
    buffer_load_dwordx4 v114, s[16:19], s42 offen  lds
    s_add_u32 m0, s39, 67584
    s_add_u32 s42, s38, 270336
    buffer_load_dwordx4 v114, s[16:19], s42 offen  lds
    s_add_u32 m0, s39, 68608
    s_add_u32 s42, s38, 274432
    buffer_load_dwordx4 v114, s[16:19], s42 offen  lds
    s_add_u32 m0, s39, 81920
    s_add_u32 s42, s38, 327680
    buffer_load_dwordx4 v114, s[16:19], s42 offen  lds
    s_add_u32 m0, s39, 82944
    s_add_u32 s42, s38, 331776
    buffer_load_dwordx4 v114, s[16:19], s42 offen  lds
    s_add_u32 m0, s39, 83968
    s_add_u32 s42, s38, 335872
    buffer_load_dwordx4 v114, s[16:19], s42 offen  lds
    s_add_u32 m0, s39, 84992
    s_add_u32 s42, s38, 339968
    buffer_load_dwordx4 v114, s[16:19], s42 offen  lds
    s_add_u32 m0, s39, 98304
    s_add_u32 s42, s38, 393216
    buffer_load_dwordx4 v114, s[16:19], s42 offen  lds
    s_add_u32 m0, s39, 99328
    s_add_u32 s42, s38, 397312
    buffer_load_dwordx4 v114, s[16:19], s42 offen  lds
    s_add_u32 m0, s39, 100352
    s_add_u32 s42, s38, 401408
    buffer_load_dwordx4 v114, s[16:19], s42 offen  lds
    s_add_u32 m0, s39, 101376
    s_add_u32 s42, s38, 405504
    buffer_load_dwordx4 v114, s[16:19], s42 offen  lds
    s_add_u32 m0, s39, 114688
    s_add_u32 s42, s38, 458752
    buffer_load_dwordx4 v114, s[16:19], s42 offen  lds
    s_add_u32 m0, s39, 115712
    s_add_u32 s42, s38, 462848
    buffer_load_dwordx4 v114, s[16:19], s42 offen  lds
    s_add_u32 m0, s39, 116736
    s_add_u32 s42, s38, 466944
    buffer_load_dwordx4 v114, s[16:19], s42 offen  lds
    s_add_u32 m0, s39, 117760
    s_add_u32 s42, s38, 471040
    buffer_load_dwordx4 v114, s[16:19], s42 offen  lds
    s_add_u32 m0, s39, 131072
    s_add_u32 s42, s38, 524288
    buffer_load_dwordx4 v114, s[16:19], s42 offen  lds
    s_add_u32 m0, s39, 132096
    s_add_u32 s42, s38, 528384
    buffer_load_dwordx4 v114, s[16:19], s42 offen  lds
    s_add_u32 m0, s39, 133120
    s_add_u32 s42, s38, 532480
    buffer_load_dwordx4 v114, s[16:19], s42 offen  lds
    s_add_u32 m0, s39, 134144
    s_add_u32 s42, s38, 536576
    buffer_load_dwordx4 v114, s[16:19], s42 offen  lds
    s_add_u32 m0, s39, 147456
    s_add_u32 s42, s38, 589824
    buffer_load_dwordx4 v114, s[16:19], s42 offen  lds
    s_add_u32 m0, s39, 148480
    s_add_u32 s42, s38, 593920
    buffer_load_dwordx4 v114, s[16:19], s42 offen  lds
    s_add_u32 m0, s39, 149504
    s_add_u32 s42, s38, 598016
    buffer_load_dwordx4 v114, s[16:19], s42 offen  lds
    s_add_u32 m0, s39, 150528
    s_add_u32 s42, s38, 602112
    buffer_load_dwordx4 v114, s[16:19], s42 offen  lds
    s_waitcnt vmcnt(36) lgkmcnt(0)
    s_barrier
    v_add_u32 v117, 0, v116
    ds_read_b64_tr_b16 a[0:1], v117 offset:0
    ds_read_b64_tr_b16 a[2:3], v117 offset:2048
    ds_read_b64_tr_b16 a[4:5], v117 offset:4096
    ds_read_b64_tr_b16 a[6:7], v117 offset:6144
    ds_read_b64_tr_b16 a[8:9], v117 offset:8192
    ds_read_b64_tr_b16 a[10:11], v117 offset:10240
    ds_read_b64_tr_b16 a[12:13], v117 offset:12288
    ds_read_b64_tr_b16 a[14:15], v117 offset:14336
    s_waitcnt vmcnt(32) lgkmcnt(0)
    s_barrier
    s_add_u32 m0, s39, 0
    s_add_u32 s42, s38, 655360
    buffer_load_dwordx4 v114, s[16:19], s42 offen  lds
    s_add_u32 m0, s39, 1024
    s_add_u32 s42, s38, 659456
    buffer_load_dwordx4 v114, s[16:19], s42 offen  lds
    s_add_u32 m0, s39, 2048
    s_add_u32 s42, s38, 663552
    buffer_load_dwordx4 v114, s[16:19], s42 offen  lds
    s_add_u32 m0, s39, 3072
    s_add_u32 s42, s38, 667648
    buffer_load_dwordx4 v114, s[16:19], s42 offen  lds
    v_add_u32 v117, 16384, v116
    ds_read_b64_tr_b16 a[16:17], v117 offset:0
    ds_read_b64_tr_b16 a[18:19], v117 offset:2048
    ds_read_b64_tr_b16 a[20:21], v117 offset:4096
    ds_read_b64_tr_b16 a[22:23], v117 offset:6144
    ds_read_b64_tr_b16 a[24:25], v117 offset:8192
    ds_read_b64_tr_b16 a[26:27], v117 offset:10240
    ds_read_b64_tr_b16 a[28:29], v117 offset:12288
    ds_read_b64_tr_b16 a[30:31], v117 offset:14336
    s_waitcnt vmcnt(32) lgkmcnt(0)
    s_barrier
    s_add_u32 m0, s39, 16384
    s_add_u32 s42, s38, 720896
    buffer_load_dwordx4 v114, s[16:19], s42 offen  lds
    s_add_u32 m0, s39, 17408
    s_add_u32 s42, s38, 724992
    buffer_load_dwordx4 v114, s[16:19], s42 offen  lds
    s_add_u32 m0, s39, 18432
    s_add_u32 s42, s38, 729088
    buffer_load_dwordx4 v114, s[16:19], s42 offen  lds
    s_add_u32 m0, s39, 19456
    s_add_u32 s42, s38, 733184
    buffer_load_dwordx4 v114, s[16:19], s42 offen  lds
    v_add_u32 v117, 32768, v116
    ds_read_b64_tr_b16 a[32:33], v117 offset:0
    ds_read_b64_tr_b16 a[34:35], v117 offset:2048
    ds_read_b64_tr_b16 a[36:37], v117 offset:4096
    ds_read_b64_tr_b16 a[38:39], v117 offset:6144
    ds_read_b64_tr_b16 a[40:41], v117 offset:8192
    ds_read_b64_tr_b16 a[42:43], v117 offset:10240
    ds_read_b64_tr_b16 a[44:45], v117 offset:12288
    ds_read_b64_tr_b16 a[46:47], v117 offset:14336
    s_waitcnt vmcnt(32) lgkmcnt(0)
    s_barrier
    s_add_u32 m0, s39, 32768
    s_add_u32 s42, s38, 786432
    buffer_load_dwordx4 v114, s[16:19], s42 offen  lds
    s_add_u32 m0, s39, 33792
    s_add_u32 s42, s38, 790528
    buffer_load_dwordx4 v114, s[16:19], s42 offen  lds
    s_add_u32 m0, s39, 34816
    s_add_u32 s42, s38, 794624
    buffer_load_dwordx4 v114, s[16:19], s42 offen  lds
    s_add_u32 m0, s39, 35840
    s_add_u32 s42, s38, 798720
    buffer_load_dwordx4 v114, s[16:19], s42 offen  lds
    v_add_u32 v117, 49152, v116
    ds_read_b64_tr_b16 a[48:49], v117 offset:0
    ds_read_b64_tr_b16 a[50:51], v117 offset:2048
    ds_read_b64_tr_b16 a[52:53], v117 offset:4096
    ds_read_b64_tr_b16 a[54:55], v117 offset:6144
    ds_read_b64_tr_b16 a[56:57], v117 offset:8192
    ds_read_b64_tr_b16 a[58:59], v117 offset:10240
    ds_read_b64_tr_b16 a[60:61], v117 offset:12288
    ds_read_b64_tr_b16 a[62:63], v117 offset:14336
    s_waitcnt vmcnt(32) lgkmcnt(0)
    s_barrier
    s_add_u32 m0, s39, 49152
    s_add_u32 s42, s38, 851968
    buffer_load_dwordx4 v114, s[16:19], s42 offen  lds
    s_add_u32 m0, s39, 50176
    s_add_u32 s42, s38, 856064
    buffer_load_dwordx4 v114, s[16:19], s42 offen  lds
    s_add_u32 m0, s39, 51200
    s_add_u32 s42, s38, 860160
    buffer_load_dwordx4 v114, s[16:19], s42 offen  lds
    s_add_u32 m0, s39, 52224
    s_add_u32 s42, s38, 864256
    buffer_load_dwordx4 v114, s[16:19], s42 offen  lds
    v_add_u32 v117, 65536, v116
    ds_read_b64_tr_b16 a[64:65], v117 offset:0
    ds_read_b64_tr_b16 a[66:67], v117 offset:2048
    ds_read_b64_tr_b16 a[68:69], v117 offset:4096
    ds_read_b64_tr_b16 a[70:71], v117 offset:6144
    ds_read_b64_tr_b16 a[72:73], v117 offset:8192
    ds_read_b64_tr_b16 a[74:75], v117 offset:10240
    ds_read_b64_tr_b16 a[76:77], v117 offset:12288
    ds_read_b64_tr_b16 a[78:79], v117 offset:14336
    s_waitcnt vmcnt(32) lgkmcnt(0)
    s_barrier
    v_add_u32 v117, 81920, v116
    ds_read_b64_tr_b16 a[80:81], v117 offset:0
    ds_read_b64_tr_b16 a[82:83], v117 offset:2048
    ds_read_b64_tr_b16 a[84:85], v117 offset:4096
    ds_read_b64_tr_b16 a[86:87], v117 offset:6144
    ds_read_b64_tr_b16 a[88:89], v117 offset:8192
    ds_read_b64_tr_b16 a[90:91], v117 offset:10240
    ds_read_b64_tr_b16 a[92:93], v117 offset:12288
    ds_read_b64_tr_b16 a[94:95], v117 offset:14336
    s_waitcnt vmcnt(28) lgkmcnt(0)
    s_barrier
    v_add_u32 v117, 98304, v116
    ds_read_b64_tr_b16 a[96:97], v117 offset:0
    ds_read_b64_tr_b16 a[98:99], v117 offset:2048
    ds_read_b64_tr_b16 a[100:101], v117 offset:4096
    ds_read_b64_tr_b16 a[102:103], v117 offset:6144
    ds_read_b64_tr_b16 a[104:105], v117 offset:8192
    ds_read_b64_tr_b16 a[106:107], v117 offset:10240
    ds_read_b64_tr_b16 a[108:109], v117 offset:12288
    ds_read_b64_tr_b16 a[110:111], v117 offset:14336
    s_waitcnt vmcnt(24) lgkmcnt(0)
    s_barrier
    v_add_u32 v117, 114688, v116
    ds_read_b64_tr_b16 a[112:113], v117 offset:0
    ds_read_b64_tr_b16 a[114:115], v117 offset:2048
    ds_read_b64_tr_b16 a[116:117], v117 offset:4096
    ds_read_b64_tr_b16 a[118:119], v117 offset:6144
    ds_read_b64_tr_b16 a[120:121], v117 offset:8192
    ds_read_b64_tr_b16 a[122:123], v117 offset:10240
    ds_read_b64_tr_b16 a[124:125], v117 offset:12288
    ds_read_b64_tr_b16 a[126:127], v117 offset:14336
    s_waitcnt vmcnt(20) lgkmcnt(0)
    s_barrier
    v_add_u32 v117, 131072, v116
    ds_read_b64_tr_b16 a[128:129], v117 offset:0
    ds_read_b64_tr_b16 a[130:131], v117 offset:2048
    ds_read_b64_tr_b16 a[132:133], v117 offset:4096
    ds_read_b64_tr_b16 a[134:135], v117 offset:6144
    ds_read_b64_tr_b16 a[136:137], v117 offset:8192
    ds_read_b64_tr_b16 a[138:139], v117 offset:10240
    ds_read_b64_tr_b16 a[140:141], v117 offset:12288
    ds_read_b64_tr_b16 a[142:143], v117 offset:14336
    s_waitcnt vmcnt(16) lgkmcnt(0)
    s_barrier
    v_add_u32 v117, 147456, v116
    ds_read_b64_tr_b16 a[144:145], v117 offset:0
    ds_read_b64_tr_b16 a[146:147], v117 offset:2048
    ds_read_b64_tr_b16 a[148:149], v117 offset:4096
    ds_read_b64_tr_b16 a[150:151], v117 offset:6144
    ds_read_b64_tr_b16 a[152:153], v117 offset:8192
    ds_read_b64_tr_b16 a[154:155], v117 offset:10240
    ds_read_b64_tr_b16 a[156:157], v117 offset:12288
    ds_read_b64_tr_b16 a[158:159], v117 offset:14336
    s_waitcnt vmcnt(12) lgkmcnt(0)
    s_barrier
    v_add_u32 v117, 0, v116
    ds_read_b64_tr_b16 a[160:161], v117 offset:0
    ds_read_b64_tr_b16 a[162:163], v117 offset:2048
    ds_read_b64_tr_b16 a[164:165], v117 offset:4096
    ds_read_b64_tr_b16 a[166:167], v117 offset:6144
    ds_read_b64_tr_b16 a[168:169], v117 offset:8192
    ds_read_b64_tr_b16 a[170:171], v117 offset:10240
    ds_read_b64_tr_b16 a[172:173], v117 offset:12288
    ds_read_b64_tr_b16 a[174:175], v117 offset:14336
    s_waitcnt vmcnt(8) lgkmcnt(0)
    s_barrier
    v_add_u32 v117, 16384, v116
    ds_read_b64_tr_b16 a[176:177], v117 offset:0
    ds_read_b64_tr_b16 a[178:179], v117 offset:2048
    ds_read_b64_tr_b16 a[180:181], v117 offset:4096
    ds_read_b64_tr_b16 a[182:183], v117 offset:6144
    ds_read_b64_tr_b16 a[184:185], v117 offset:8192
    ds_read_b64_tr_b16 a[186:187], v117 offset:10240
    ds_read_b64_tr_b16 a[188:189], v117 offset:12288
    ds_read_b64_tr_b16 a[190:191], v117 offset:14336
    s_waitcnt vmcnt(4) lgkmcnt(0)
    s_barrier
    v_add_u32 v117, 32768, v116
    ds_read_b64_tr_b16 a[192:193], v117 offset:0
    ds_read_b64_tr_b16 a[194:195], v117 offset:2048
    ds_read_b64_tr_b16 a[196:197], v117 offset:4096
    ds_read_b64_tr_b16 a[198:199], v117 offset:6144
    ds_read_b64_tr_b16 a[200:201], v117 offset:8192
    ds_read_b64_tr_b16 a[202:203], v117 offset:10240
    ds_read_b64_tr_b16 a[204:205], v117 offset:12288
    ds_read_b64_tr_b16 a[206:207], v117 offset:14336
    s_waitcnt vmcnt(0) lgkmcnt(0)
    s_barrier
    v_add_u32 v117, 49152, v116
    ds_read_b64_tr_b16 a[208:209], v117 offset:0
    ds_read_b64_tr_b16 a[210:211], v117 offset:2048
    ds_read_b64_tr_b16 a[212:213], v117 offset:4096
    ds_read_b64_tr_b16 a[214:215], v117 offset:6144
    ds_read_b64_tr_b16 a[216:217], v117 offset:8192
    ds_read_b64_tr_b16 a[218:219], v117 offset:10240
    ds_read_b64_tr_b16 a[220:221], v117 offset:12288
    ds_read_b64_tr_b16 a[222:223], v117 offset:14336
    s_waitcnt lgkmcnt(0)
    s_barrier
    s_mov_b32 s42, s30
    s_mov_b32 s99, 8
L_warm_166:
    buffer_load_dwordx4 v[16:19], v0, s[8:11], s42 offen offset:0 sc1
    buffer_load_dwordx4 v[20:23], v0, s[8:11], s42 offen offset:1024 sc1
    s_add_u32 s42, s42, 65536
    s_sub_u32 s99, s99, 1
    s_cmp_lg_u32 s99, 0
    s_cbranch_scc1 L_warm_166
    s_waitcnt vmcnt(0)
    v_mbcnt_lo_u32_b32 v126, -1, 0
    v_mbcnt_hi_u32_b32 v126, -1, v126
    v_lshlrev_b32 v126, 5, v126
    v_cmp_gt_u32 vcc, 256, v126
    s_nop 1
    v_cndmask_b32 v126, 4, v126, vcc
    buffer_load_dword v127, v126, s[12:15], 0 offen sc1
    s_waitcnt vmcnt(0)
    v_readlane_b32 s98, v127, 8
    v_cmp_ne_u32 vcc, 32, v127
    s_nop 3
    s_and_b32 s5, vcc_lo, 0xff
    s_cmp_lt_u32 s98, 256
    s_cselect_b32 s98, 1, s5
    s_cmp_eq_u32 s98, 0
    s_cbranch_scc1 L_gw_167_done
L_gw_167:
    buffer_load_dword v127, v126, s[12:15], 0 offen sc1
    s_add_u32 s52, s52, 0x1000
    s_cmp_ge_u32 s52, 2147418112
    s_cbranch_scc1 L_fail
    s_waitcnt vmcnt(0)
    v_readlane_b32 s98, v127, 8
    s_nop 3
    s_cmp_ge_u32 s98, 256
    s_cbranch_scc1 L_gw_167_ok
    s_sleep 4
    s_branch L_gw_167
L_gw_167_ok:
    buffer_load_dword v127, v126, s[12:15], 0 offen sc1
    s_waitcnt vmcnt(0)
    v_cmp_ne_u32 vcc, 32, v127
    s_nop 3
    s_and_b32 s5, vcc_lo, 0xff
L_gw_167_done:
    s_cmp_lg_u32 s5, 0
    s_cbranch_scc1 L_nonlocal_168
    s_mov_b32 s28, 0
    s_mov_b32 s36, 1
    s_mov_b32 s35, 0
    s_lshl_b32 s44, s24, 11
    s_lshl_b32 s45, s24, 12
    s_add_u32 s46, s29, s44
    s_add_u32 s47, s29, s45
    s_mov_b32 s48, s46
    s_mov_b32 s49, s47
    s_mov_b32 s60, s30
    s_mov_b32 s61, s31
    s_mov_b32 s62, s32
    v_mov_b32 v4, v0
L_item_169:
L_poll_175:
    buffer_load_dword v3, v1, s[8:11], s33 offen sc1
    s_waitcnt vmcnt(0)
    v_cmp_gt_u32 vcc, s36, v3
    s_add_u32 s52, s52, 0x1000
    s_cmp_lt_u32 s52, 2147418112
    s_cbranch_vccz L_poll_175_ok
    s_cbranch_scc1 L_poll_175
    s_branch L_fail
L_poll_175_ok:
L_dma_170:
    s_add_u32 m0, s44, 0
    s_add_u32 s42, s46, 0
    buffer_load_dwordx4 v0, s[8:11], s42 offen offset:0 sc1  lds
    buffer_load_dwordx4 v0, s[8:11], s42 offen offset:1024 sc1  lds
    s_add_u32 m0, s44, 8192
    s_add_u32 s42, s46, 8192
    buffer_load_dwordx4 v0, s[8:11], s42 offen offset:0 sc1  lds
    buffer_load_dwordx4 v0, s[8:11], s42 offen offset:1024 sc1  lds
    s_add_u32 m0, s44, 16384
    s_add_u32 s42, s46, 16384
    buffer_load_dwordx4 v0, s[8:11], s42 offen offset:0 sc1  lds
    buffer_load_dwordx4 v0, s[8:11], s42 offen offset:1024 sc1  lds
L_rd_176:
    s_waitcnt vmcnt(4)
    s_barrier
    ds_read_b128 v[64:67], v4 offset:0
    ds_read_b128 v[68:71], v4 offset:1024
    ds_read_b128 v[72:75], v4 offset:2048
    ds_read_b128 v[76:79], v4 offset:3072
    s_waitcnt lgkmcnt(3)
    v_mfma_f32_32x32x16_bf16 v[16:31], a[0:3], v[64:67], 0
    s_add_u32 m0, s45, 24576
    s_add_u32 s42, s47, 24576
    buffer_load_dwordx4 v0, s[8:11], s42 offen offset:0 sc1  lds
    ds_read_b128 v[64:67], v4 offset:4096
    s_waitcnt lgkmcnt(3)
    v_mfma_f32_32x32x16_bf16 v[16:31], a[4:7], v[68:71], v[16:31]
    ds_read_b128 v[68:71], v4 offset:5120
    s_waitcnt lgkmcnt(3)
    v_mfma_f32_32x32x16_bf16 v[16:31], a[8:11], v[72:75], v[16:31]
    buffer_load_dwordx4 v0, s[8:11], s42 offen offset:1024 sc1  lds
    ds_read_b128 v[72:75], v4 offset:6144
    s_waitcnt lgkmcnt(3)
    v_mfma_f32_32x32x16_bf16 v[16:31], a[12:15], v[76:79], v[16:31]
    ds_read_b128 v[76:79], v4 offset:7168
    s_waitcnt lgkmcnt(3)
    v_mfma_f32_32x32x16_bf16 v[16:31], a[16:19], v[64:67], v[16:31]
    buffer_load_dwordx4 v0, s[8:11], s42 offen offset:2048 sc1  lds
    s_waitcnt vmcnt(5)
    s_barrier
    ds_read_b128 v[64:67], v4 offset:8192
    s_waitcnt lgkmcnt(3)
    v_mfma_f32_32x32x16_bf16 v[16:31], a[20:23], v[68:71], v[16:31]
    ds_read_b128 v[68:71], v4 offset:9216
    s_waitcnt lgkmcnt(3)
    v_mfma_f32_32x32x16_bf16 v[16:31], a[24:27], v[72:75], v[16:31]
    buffer_load_dwordx4 v0, s[8:11], s42 offen offset:3072 sc1  lds
    ds_read_b128 v[72:75], v4 offset:10240
    s_waitcnt lgkmcnt(3)
    v_mfma_f32_32x32x16_bf16 v[16:31], a[28:31], v[76:79], v[16:31]
    s_add_u32 m0, s45, 40960
    s_add_u32 s42, s47, 40960
    ds_read_b128 v[76:79], v4 offset:11264
    s_waitcnt lgkmcnt(3)
    v_mfma_f32_32x32x16_bf16 v[16:31], a[32:35], v[64:67], v[16:31]
    buffer_load_dwordx4 v0, s[8:11], s42 offen offset:0 sc1  lds
    ds_read_b128 v[64:67], v4 offset:12288
    s_waitcnt lgkmcnt(3)
    v_mfma_f32_32x32x16_bf16 v[16:31], a[36:39], v[68:71], v[16:31]
    ds_read_b128 v[68:71], v4 offset:13312
    s_waitcnt lgkmcnt(3)
    v_mfma_f32_32x32x16_bf16 v[16:31], a[40:43], v[72:75], v[16:31]
    buffer_load_dwordx4 v0, s[8:11], s42 offen offset:1024 sc1  lds
    ds_read_b128 v[72:75], v4 offset:14336
    s_waitcnt lgkmcnt(3)
    v_mfma_f32_32x32x16_bf16 v[16:31], a[44:47], v[76:79], v[16:31]
    ds_read_b128 v[76:79], v4 offset:15360
    s_waitcnt lgkmcnt(3)
    v_mfma_f32_32x32x16_bf16 v[16:31], a[48:51], v[64:67], v[16:31]
    buffer_load_dwordx4 v0, s[8:11], s42 offen offset:2048 sc1  lds
    s_waitcnt vmcnt(7)
    s_barrier
    ds_read_b128 v[64:67], v4 offset:16384
    s_waitcnt lgkmcnt(3)
    v_mfma_f32_32x32x16_bf16 v[16:31], a[52:55], v[68:71], v[16:31]
    ds_read_b128 v[68:71], v4 offset:17408
    s_waitcnt lgkmcnt(3)
    v_mfma_f32_32x32x16_bf16 v[16:31], a[56:59], v[72:75], v[16:31]
    buffer_load_dwordx4 v0, s[8:11], s42 offen offset:3072 sc1  lds
    ds_read_b128 v[72:75], v4 offset:18432
    s_waitcnt lgkmcnt(3)
    v_mfma_f32_32x32x16_bf16 v[16:31], a[60:63], v[76:79], v[16:31]
    ds_read_b128 v[76:79], v4 offset:19456
    s_waitcnt lgkmcnt(3)
    v_mfma_f32_32x32x16_bf16 v[16:31], a[64:67], v[64:67], v[16:31]
    ds_read_b128 v[64:67], v4 offset:20480
    s_waitcnt lgkmcnt(3)
    v_mfma_f32_32x32x16_bf16 v[16:31], a[68:71], v[68:71], v[16:31]
    ds_read_b128 v[68:71], v4 offset:21504
    s_waitcnt lgkmcnt(3)
    v_mfma_f32_32x32x16_bf16 v[16:31], a[72:75], v[72:75], v[16:31]
    ds_read_b128 v[72:75], v4 offset:22528
    s_waitcnt lgkmcnt(3)
    v_mfma_f32_32x32x16_bf16 v[16:31], a[76:79], v[76:79], v[16:31]
    ds_read_b128 v[76:79], v4 offset:23552
    s_waitcnt lgkmcnt(3)
    v_mfma_f32_32x32x16_bf16 v[16:31], a[80:83], v[64:67], v[16:31]
    s_waitcnt vmcnt(4)
    s_barrier
    ds_read_b128 v[64:67], v4 offset:24576
    s_waitcnt lgkmcnt(3)
    v_mfma_f32_32x32x16_bf16 v[16:31], a[84:87], v[68:71], v[16:31]
    ds_read_b128 v[68:71], v4 offset:25600
    s_waitcnt lgkmcnt(3)
    v_mfma_f32_32x32x16_bf16 v[16:31], a[88:91], v[72:75], v[16:31]
    ds_read_b128 v[72:75], v4 offset:26624
    s_waitcnt lgkmcnt(3)
    v_mfma_f32_32x32x16_bf16 v[16:31], a[92:95], v[76:79], v[16:31]
    ds_read_b128 v[76:79], v4 offset:27648
    s_waitcnt lgkmcnt(3)
    v_mfma_f32_32x32x16_bf16 v[16:31], a[96:99], v[64:67], v[16:31]
    buffer_load_dword v3, v1, s[8:11], s33 offen sc1
    ds_read_b128 v[64:67], v4 offset:28672
    s_waitcnt lgkmcnt(3)
    v_mfma_f32_32x32x16_bf16 v[16:31], a[100:103], v[68:71], v[16:31]
    ds_read_b128 v[68:71], v4 offset:29696
    s_waitcnt lgkmcnt(3)
    v_mfma_f32_32x32x16_bf16 v[16:31], a[104:107], v[72:75], v[16:31]
    ds_read_b128 v[72:75], v4 offset:30720
    s_waitcnt lgkmcnt(3)
    v_mfma_f32_32x32x16_bf16 v[16:31], a[108:111], v[76:79], v[16:31]
    ds_read_b128 v[76:79], v4 offset:31744
    s_waitcnt lgkmcnt(3)
    v_mfma_f32_32x32x16_bf16 v[16:31], a[112:115], v[64:67], v[16:31]
    ds_read_b128 v[64:67], v4 offset:32768
    s_waitcnt lgkmcnt(3)
    v_mfma_f32_32x32x16_bf16 v[16:31], a[116:119], v[68:71], v[16:31]
    ds_read_b128 v[68:71], v4 offset:33792
    s_waitcnt lgkmcnt(3)
    v_mfma_f32_32x32x16_bf16 v[16:31], a[120:123], v[72:75], v[16:31]
    s_bfe_u32 s41, s28, 65539
    s_xor_b32 s41, s41, 1
    ds_read_b128 v[72:75], v4 offset:34816
    s_waitcnt lgkmcnt(3)
    v_mfma_f32_32x32x16_bf16 v[16:31], a[124:127], v[76:79], v[16:31]
    s_and_b32 s43, s36, 7
    s_mul_i32 s43, s43, 131072
    ds_read_b128 v[76:79], v4 offset:35840
    s_waitcnt lgkmcnt(3)
    v_mfma_f32_32x32x16_bf16 v[16:31], a[128:131], v[64:67], v[16:31]
    s_add_u32 s46, s43, s48
    s_add_u32 s47, s43, s49
    ds_read_b128 v[64:67], v4 offset:36864
    s_waitcnt lgkmcnt(3)
    v_mfma_f32_32x32x16_bf16 v[16:31], a[132:135], v[68:71], v[16:31]
    s_add_u32 s36, s36, 1
    s_sub_u32 s44, s44, s35
    ds_read_b128 v[68:71], v4 offset:37888
    s_waitcnt lgkmcnt(3)
    v_mfma_f32_32x32x16_bf16 v[16:31], a[136:139], v[72:75], v[16:31]
    s_sub_u32 s45, s45, s35
    s_sub_u32 s35, 57344, s35
    ds_read_b128 v[72:75], v4 offset:38912
    s_waitcnt lgkmcnt(3)
    v_mfma_f32_32x32x16_bf16 v[16:31], a[140:143], v[76:79], v[16:31]
    s_add_u32 s44, s44, s35
    s_add_u32 s45, s45, s35
    ds_read_b128 v[76:79], v4 offset:39936
    s_waitcnt lgkmcnt(3)
    v_mfma_f32_32x32x16_bf16 v[16:31], a[144:147], v[64:67], v[16:31]
    s_waitcnt vmcnt(0)
    v_cmp_gt_u32 vcc, s36, v3
L_mid_173:
    s_barrier
    ds_read_b128 v[64:67], v4 offset:40960
    s_waitcnt lgkmcnt(3)
    v_mfma_f32_32x32x16_bf16 v[16:31], a[148:151], v[68:71], v[16:31]
    s_cbranch_vccnz L_tail0_174
    ds_read_b128 v[68:71], v4 offset:41984
    s_waitcnt lgkmcnt(3)
    v_mfma_f32_32x32x16_bf16 v[16:31], a[152:155], v[72:75], v[16:31]
    s_add_u32 m0, s44, 0
    s_add_u32 s42, s46, 0
    buffer_load_dwordx4 v0, s[8:11], s42 offen offset:0 sc1  lds
    ds_read_b128 v[72:75], v4 offset:43008
    s_waitcnt lgkmcnt(3)
    v_mfma_f32_32x32x16_bf16 v[16:31], a[156:159], v[76:79], v[16:31]
    ds_read_b128 v[76:79], v4 offset:44032
    s_waitcnt lgkmcnt(3)
    v_mfma_f32_32x32x16_bf16 v[16:31], a[160:163], v[64:67], v[16:31]
    buffer_load_dwordx4 v0, s[8:11], s42 offen offset:1024 sc1  lds
    ds_read_b128 v[64:67], v4 offset:45056
    s_waitcnt lgkmcnt(3)
    v_mfma_f32_32x32x16_bf16 v[16:31], a[164:167], v[68:71], v[16:31]
    s_add_u32 m0, s44, 8192
    s_add_u32 s42, s46, 8192
    ds_read_b128 v[68:71], v4 offset:46080
    s_waitcnt lgkmcnt(3)
    v_mfma_f32_32x32x16_bf16 v[16:31], a[168:171], v[72:75], v[16:31]
    buffer_load_dwordx4 v0, s[8:11], s42 offen offset:0 sc1  lds
    ds_read_b128 v[72:75], v4 offset:47104
    s_waitcnt lgkmcnt(3)
    v_mfma_f32_32x32x16_bf16 v[16:31], a[172:175], v[76:79], v[16:31]
    ds_read_b128 v[76:79], v4 offset:48128
    s_waitcnt lgkmcnt(3)
    v_mfma_f32_32x32x16_bf16 v[16:31], a[176:179], v[64:67], v[16:31]
    buffer_load_dwordx4 v0, s[8:11], s42 offen offset:1024 sc1  lds
    ds_read_b128 v[64:67], v4 offset:49152
    s_waitcnt lgkmcnt(3)
    v_mfma_f32_32x32x16_bf16 v[16:31], a[180:183], v[68:71], v[16:31]
    s_add_u32 m0, s44, 16384
    s_add_u32 s42, s46, 16384
    ds_read_b128 v[68:71], v4 offset:50176
    s_waitcnt lgkmcnt(3)
    v_mfma_f32_32x32x16_bf16 v[16:31], a[184:187], v[72:75], v[16:31]
    buffer_load_dwordx4 v0, s[8:11], s42 offen offset:0 sc1  lds
    ds_read_b128 v[72:75], v4 offset:51200
    s_waitcnt lgkmcnt(3)
    v_mfma_f32_32x32x16_bf16 v[16:31], a[188:191], v[76:79], v[16:31]
    ds_read_b128 v[76:79], v4 offset:52224
    s_waitcnt lgkmcnt(3)
    v_mfma_f32_32x32x16_bf16 v[16:31], a[192:195], v[64:67], v[16:31]
    buffer_load_dwordx4 v0, s[8:11], s42 offen offset:1024 sc1  lds
    ds_read_b128 v[64:67], v4 offset:53248
    s_waitcnt lgkmcnt(3)
    v_mfma_f32_32x32x16_bf16 v[16:31], a[196:199], v[68:71], v[16:31]
    s_add_u32 s43, s28, 1
    v_mov_b32 v7, s43
    s_add_u32 m0, s45, 24576
    s_add_u32 s42, s47, 24576
    ds_read_b128 v[68:71], v4 offset:54272
    s_waitcnt lgkmcnt(3)
    v_mfma_f32_32x32x16_bf16 v[16:31], a[200:203], v[72:75], v[16:31]
    buffer_store_dword v7, v2, s[8:11], s34 offen
    buffer_load_dwordx4 v0, s[8:11], s42 offen offset:0 sc1  lds
    ds_read_b128 v[72:75], v4 offset:55296
    s_waitcnt lgkmcnt(3)
    v_mfma_f32_32x32x16_bf16 v[16:31], a[204:207], v[76:79], v[16:31]
    ds_read_b128 v[76:79], v4 offset:56320
    s_waitcnt lgkmcnt(3)
    v_mfma_f32_32x32x16_bf16 v[16:31], a[208:211], v[64:67], v[16:31]
    buffer_load_dwordx4 v0, s[8:11], s42 offen offset:1024 sc1  lds
    s_waitcnt lgkmcnt(2)
    v_mfma_f32_32x32x16_bf16 v[16:31], a[212:215], v[68:71], v[16:31]
    s_waitcnt lgkmcnt(1)
    v_mfma_f32_32x32x16_bf16 v[16:31], a[216:219], v[72:75], v[16:31]
    buffer_load_dwordx4 v0, s[8:11], s42 offen offset:2048 sc1  lds
    s_waitcnt lgkmcnt(0)
    v_mfma_f32_32x32x16_bf16 v[16:31], a[220:223], v[76:79], v[16:31]
    s_add_u32 s28, s28, 1
    v_add_u32 v4, s35, v0
    v_mov_b32 v7, s28
    s_nop 8
    v_cvt_pk_bf16_f32 v88, v16, v17
    v_cvt_pk_bf16_f32 v89, v18, v19
    v_cvt_pk_bf16_f32 v90, v20, v21
    v_cvt_pk_bf16_f32 v91, v22, v23
    v_and_or_b32 v88, v88, -2, s41
    buffer_store_dwordx4 v[88:91], v0, s[8:11], s30 offen offset:0
    v_cvt_pk_bf16_f32 v92, v24, v25
    v_cvt_pk_bf16_f32 v93, v26, v27
    v_cvt_pk_bf16_f32 v94, v28, v29
    v_cvt_pk_bf16_f32 v95, v30, v31
    v_and_or_b32 v92, v92, -2, s41
    buffer_store_dwordx4 v[92:95], v0, s[8:11], s30 offen offset:1024
    s_waitcnt vmcnt(10)
    s_barrier
    ds_read_b128 v[64:67], v4 offset:0
    ds_read_b128 v[68:71], v4 offset:1024
    ds_read_b128 v[72:75], v4 offset:2048
    ds_read_b128 v[76:79], v4 offset:3072
    s_waitcnt lgkmcnt(3)
    v_mfma_f32_32x32x16_bf16 v[16:31], a[0:3], v[64:67], 0
    buffer_load_dwordx4 v0, s[8:11], s42 offen offset:3072 sc1  lds
    ds_read_b128 v[64:67], v4 offset:4096
    s_waitcnt lgkmcnt(3)
    v_mfma_f32_32x32x16_bf16 v[16:31], a[4:7], v[68:71], v[16:31]
    s_and_b32 s43, s28, 7
    s_add_u32 m0, s45, 40960
    s_add_u32 s42, s47, 40960
    ds_read_b128 v[68:71], v4 offset:5120
    s_waitcnt lgkmcnt(3)
    v_mfma_f32_32x32x16_bf16 v[16:31], a[8:11], v[72:75], v[16:31]
    s_mul_i32 s30, s43, 65536
    buffer_load_dwordx4 v0, s[8:11], s42 offen offset:0 sc1  lds
    ds_read_b128 v[72:75], v4 offset:6144
    s_waitcnt lgkmcnt(3)
    v_mfma_f32_32x32x16_bf16 v[16:31], a[12:15], v[76:79], v[16:31]
    s_add_u32 s30, s30, s60
    ds_read_b128 v[76:79], v4 offset:7168
    s_waitcnt lgkmcnt(3)
    v_mfma_f32_32x32x16_bf16 v[16:31], a[16:19], v[64:67], v[16:31]
    buffer_load_dwordx4 v0, s[8:11], s42 offen offset:1024 sc1  lds
    s_waitcnt vmcnt(11)
    s_barrier
    ds_read_b128 v[64:67], v4 offset:8192
    s_waitcnt lgkmcnt(3)
    v_mfma_f32_32x32x16_bf16 v[16:31], a[20:23], v[68:71], v[16:31]
    ds_read_b128 v[68:71], v4 offset:9216
    s_waitcnt lgkmcnt(3)
    v_mfma_f32_32x32x16_bf16 v[16:31], a[24:27], v[72:75], v[16:31]
    buffer_load_dwordx4 v0, s[8:11], s42 offen offset:2048 sc1  lds
    ds_read_b128 v[72:75], v4 offset:10240
    s_waitcnt lgkmcnt(3)
    v_mfma_f32_32x32x16_bf16 v[16:31], a[28:31], v[76:79], v[16:31]
    ds_read_b128 v[76:79], v4 offset:11264
    s_waitcnt lgkmcnt(3)
    v_mfma_f32_32x32x16_bf16 v[16:31], a[32:35], v[64:67], v[16:31]
    buffer_load_dwordx4 v0, s[8:11], s42 offen offset:3072 sc1  lds
    ds_read_b128 v[64:67], v4 offset:12288
    s_waitcnt lgkmcnt(3)
    v_mfma_f32_32x32x16_bf16 v[16:31], a[36:39], v[68:71], v[16:31]
    ds_read_b128 v[68:71], v4 offset:13312
    s_waitcnt lgkmcnt(3)
    v_mfma_f32_32x32x16_bf16 v[16:31], a[40:43], v[72:75], v[16:31]
    ds_read_b128 v[72:75], v4 offset:14336
    s_waitcnt lgkmcnt(3)
    v_mfma_f32_32x32x16_bf16 v[16:31], a[44:47], v[76:79], v[16:31]
    ds_read_b128 v[76:79], v4 offset:15360
    s_waitcnt lgkmcnt(3)
    v_mfma_f32_32x32x16_bf16 v[16:31], a[48:51], v[64:67], v[16:31]
    s_waitcnt vmcnt(11)
    s_barrier
    ds_read_b128 v[64:67], v4 offset:16384
    s_waitcnt lgkmcnt(3)
    v_mfma_f32_32x32x16_bf16 v[16:31], a[52:55], v[68:71], v[16:31]
    ds_read_b128 v[68:71], v4 offset:17408
    s_waitcnt lgkmcnt(3)
    v_mfma_f32_32x32x16_bf16 v[16:31], a[56:59], v[72:75], v[16:31]
    ds_read_b128 v[72:75], v4 offset:18432
    s_waitcnt lgkmcnt(3)
    v_mfma_f32_32x32x16_bf16 v[16:31], a[60:63], v[76:79], v[16:31]
    ds_read_b128 v[76:79], v4 offset:19456
    s_waitcnt lgkmcnt(3)
    v_mfma_f32_32x32x16_bf16 v[16:31], a[64:67], v[64:67], v[16:31]
    ds_read_b128 v[64:67], v4 offset:20480
    s_waitcnt lgkmcnt(3)
    v_mfma_f32_32x32x16_bf16 v[16:31], a[68:71], v[68:71], v[16:31]
    ds_read_b128 v[68:71], v4 offset:21504
    s_waitcnt lgkmcnt(3)
    v_mfma_f32_32x32x16_bf16 v[16:31], a[72:75], v[72:75], v[16:31]
    ds_read_b128 v[72:75], v4 offset:22528
    s_waitcnt lgkmcnt(3)
    v_mfma_f32_32x32x16_bf16 v[16:31], a[76:79], v[76:79], v[16:31]
    ds_read_b128 v[76:79], v4 offset:23552
    s_waitcnt lgkmcnt(3)
    v_mfma_f32_32x32x16_bf16 v[16:31], a[80:83], v[64:67], v[16:31]
    s_waitcnt vmcnt(4)
    s_barrier
    ds_read_b128 v[64:67], v4 offset:24576
    s_waitcnt lgkmcnt(3)
    v_mfma_f32_32x32x16_bf16 v[16:31], a[84:87], v[68:71], v[16:31]
    ds_read_b128 v[68:71], v4 offset:25600
    s_waitcnt lgkmcnt(3)
    v_mfma_f32_32x32x16_bf16 v[16:31], a[88:91], v[72:75], v[16:31]
    ds_read_b128 v[72:75], v4 offset:26624
    s_waitcnt lgkmcnt(3)
    v_mfma_f32_32x32x16_bf16 v[16:31], a[92:95], v[76:79], v[16:31]
    ds_read_b128 v[76:79], v4 offset:27648
    s_waitcnt lgkmcnt(3)
    v_mfma_f32_32x32x16_bf16 v[16:31], a[96:99], v[64:67], v[16:31]
    buffer_load_dword v3, v1, s[8:11], s33 offen sc1
    ds_read_b128 v[64:67], v4 offset:28672
    s_waitcnt lgkmcnt(3)
    v_mfma_f32_32x32x16_bf16 v[16:31], a[100:103], v[68:71], v[16:31]
    ds_read_b128 v[68:71], v4 offset:29696
    s_waitcnt lgkmcnt(3)
    v_mfma_f32_32x32x16_bf16 v[16:31], a[104:107], v[72:75], v[16:31]
    ds_read_b128 v[72:75], v4 offset:30720
    s_waitcnt lgkmcnt(3)
    v_mfma_f32_32x32x16_bf16 v[16:31], a[108:111], v[76:79], v[16:31]
    ds_read_b128 v[76:79], v4 offset:31744
    s_waitcnt lgkmcnt(3)
    v_mfma_f32_32x32x16_bf16 v[16:31], a[112:115], v[64:67], v[16:31]
    ds_read_b128 v[64:67], v4 offset:32768
    s_waitcnt lgkmcnt(3)
    v_mfma_f32_32x32x16_bf16 v[16:31], a[116:119], v[68:71], v[16:31]
    ds_read_b128 v[68:71], v4 offset:33792
    s_waitcnt lgkmcnt(3)
    v_mfma_f32_32x32x16_bf16 v[16:31], a[120:123], v[72:75], v[16:31]
    s_bfe_u32 s41, s28, 65539
    s_xor_b32 s41, s41, 1
    ds_read_b128 v[72:75], v4 offset:34816
    s_waitcnt lgkmcnt(3)
    v_mfma_f32_32x32x16_bf16 v[16:31], a[124:127], v[76:79], v[16:31]
    s_and_b32 s43, s36, 7
    s_mul_i32 s43, s43, 131072
    ds_read_b128 v[76:79], v4 offset:35840
    s_waitcnt lgkmcnt(3)
    v_mfma_f32_32x32x16_bf16 v[16:31], a[128:131], v[64:67], v[16:31]
    s_add_u32 s46, s43, s48
    s_add_u32 s47, s43, s49
    ds_read_b128 v[64:67], v4 offset:36864
    s_waitcnt lgkmcnt(3)
    v_mfma_f32_32x32x16_bf16 v[16:31], a[132:135], v[68:71], v[16:31]
    s_add_u32 s36, s36, 1
    s_sub_u32 s44, s44, s35
    ds_read_b128 v[68:71], v4 offset:37888
    s_waitcnt lgkmcnt(3)
    v_mfma_f32_32x32x16_bf16 v[16:31], a[136:139], v[72:75], v[16:31]
    s_sub_u32 s45, s45, s35
    s_sub_u32 s35, 57344, s35
    ds_read_b128 v[72:75], v4 offset:38912
    s_waitcnt lgkmcnt(3)
    v_mfma_f32_32x32x16_bf16 v[16:31], a[140:143], v[76:79], v[16:31]
    s_add_u32 s44, s44, s35
    s_add_u32 s45, s45, s35
    ds_read_b128 v[76:79], v4 offset:39936
    s_waitcnt lgkmcnt(3)
    v_mfma_f32_32x32x16_bf16 v[16:31], a[144:147], v[64:67], v[16:31]
    s_waitcnt vmcnt(0)
    v_cmp_gt_u32 vcc, s36, v3
    s_branch L_mid_173
L_tail0_174:
    ds_read_b128 v[68:71], v4 offset:41984
    s_waitcnt lgkmcnt(3)
    v_mfma_f32_32x32x16_bf16 v[16:31], a[152:155], v[72:75], v[16:31]
    ds_read_b128 v[72:75], v4 offset:43008
    s_waitcnt lgkmcnt(3)
    v_mfma_f32_32x32x16_bf16 v[16:31], a[156:159], v[76:79], v[16:31]
    ds_read_b128 v[76:79], v4 offset:44032
    s_waitcnt lgkmcnt(3)
    v_mfma_f32_32x32x16_bf16 v[16:31], a[160:163], v[64:67], v[16:31]
    ds_read_b128 v[64:67], v4 offset:45056
    s_waitcnt lgkmcnt(3)
    v_mfma_f32_32x32x16_bf16 v[16:31], a[164:167], v[68:71], v[16:31]
    ds_read_b128 v[68:71], v4 offset:46080
    s_waitcnt lgkmcnt(3)
    v_mfma_f32_32x32x16_bf16 v[16:31], a[168:171], v[72:75], v[16:31]
    ds_read_b128 v[72:75], v4 offset:47104
    s_waitcnt lgkmcnt(3)
    v_mfma_f32_32x32x16_bf16 v[16:31], a[172:175], v[76:79], v[16:31]
    ds_read_b128 v[76:79], v4 offset:48128
    s_waitcnt lgkmcnt(3)
    v_mfma_f32_32x32x16_bf16 v[16:31], a[176:179], v[64:67], v[16:31]
    ds_read_b128 v[64:67], v4 offset:49152
    s_waitcnt lgkmcnt(3)
    v_mfma_f32_32x32x16_bf16 v[16:31], a[180:183], v[68:71], v[16:31]
    ds_read_b128 v[68:71], v4 offset:50176
    s_waitcnt lgkmcnt(3)
    v_mfma_f32_32x32x16_bf16 v[16:31], a[184:187], v[72:75], v[16:31]
    ds_read_b128 v[72:75], v4 offset:51200
    s_waitcnt lgkmcnt(3)
    v_mfma_f32_32x32x16_bf16 v[16:31], a[188:191], v[76:79], v[16:31]
    ds_read_b128 v[76:79], v4 offset:52224
    s_waitcnt lgkmcnt(3)
    v_mfma_f32_32x32x16_bf16 v[16:31], a[192:195], v[64:67], v[16:31]
    ds_read_b128 v[64:67], v4 offset:53248
    s_waitcnt lgkmcnt(3)
    v_mfma_f32_32x32x16_bf16 v[16:31], a[196:199], v[68:71], v[16:31]
    s_add_u32 s43, s28, 1
    v_mov_b32 v7, s43
    ds_read_b128 v[68:71], v4 offset:54272
    s_waitcnt lgkmcnt(3)
    v_mfma_f32_32x32x16_bf16 v[16:31], a[200:203], v[72:75], v[16:31]
    buffer_store_dword v7, v2, s[8:11], s34 offen
    ds_read_b128 v[72:75], v4 offset:55296
    s_waitcnt lgkmcnt(3)
    v_mfma_f32_32x32x16_bf16 v[16:31], a[204:207], v[76:79], v[16:31]
    ds_read_b128 v[76:79], v4 offset:56320
    s_waitcnt lgkmcnt(3)
    v_mfma_f32_32x32x16_bf16 v[16:31], a[208:211], v[64:67], v[16:31]
    s_waitcnt lgkmcnt(2)
    v_mfma_f32_32x32x16_bf16 v[16:31], a[212:215], v[68:71], v[16:31]
    s_waitcnt lgkmcnt(1)
    v_mfma_f32_32x32x16_bf16 v[16:31], a[216:219], v[72:75], v[16:31]
    s_waitcnt lgkmcnt(0)
    v_mfma_f32_32x32x16_bf16 v[16:31], a[220:223], v[76:79], v[16:31]
    s_add_u32 s28, s28, 1
    v_add_u32 v4, s35, v0
    v_mov_b32 v7, s28
    s_nop 8
    v_cvt_pk_bf16_f32 v88, v16, v17
    v_cvt_pk_bf16_f32 v89, v18, v19
    v_cvt_pk_bf16_f32 v90, v20, v21
    v_cvt_pk_bf16_f32 v91, v22, v23
    v_and_or_b32 v88, v88, -2, s41
    buffer_store_dwordx4 v[88:91], v0, s[8:11], s30 offen offset:0
    v_cvt_pk_bf16_f32 v92, v24, v25
    v_cvt_pk_bf16_f32 v93, v26, v27
    v_cvt_pk_bf16_f32 v94, v28, v29
    v_cvt_pk_bf16_f32 v95, v30, v31
    v_and_or_b32 v92, v92, -2, s41
    buffer_store_dwordx4 v[92:95], v0, s[8:11], s30 offen offset:1024
    s_and_b32 s43, s28, 7
    s_mul_i32 s30, s43, 65536
    s_add_u32 s30, s30, s60
    buffer_load_dword v3, v1, s[8:11], s33 offen sc1
    s_waitcnt vmcnt(0)
    s_cmp_eq_u32 s28, 64
    s_cbranch_scc1 L_fin_171
    v_cmp_gt_u32 vcc, s36, v3
    s_cbranch_vccz L_dma_170
    s_branch L_item_169
L_fin_171:
    s_branch L_done
L_nonlocal_168:
    s_mov_b32 s28, 0
    s_mov_b32 s36, 1
    s_mov_b32 s35, 0
    s_lshl_b32 s44, s24, 11
    s_lshl_b32 s45, s24, 12
    s_add_u32 s46, s29, s44
    s_add_u32 s47, s29, s45
    s_mov_b32 s48, s46
    s_mov_b32 s49, s47
    s_mov_b32 s60, s30
    s_mov_b32 s61, s31
    s_mov_b32 s62, s32
    v_mov_b32 v4, v0
L_item_177:
L_poll_183:
    buffer_load_dword v3, v1, s[8:11], s33 offen sc1
    s_waitcnt vmcnt(0)
    v_cmp_gt_u32 vcc, s36, v3
    s_add_u32 s52, s52, 0x1000
    s_cmp_lt_u32 s52, 2147418112
    s_cbranch_vccz L_poll_183_ok
    s_cbranch_scc1 L_poll_183
    s_branch L_fail
L_poll_183_ok:
L_dma_178:
    s_add_u32 m0, s44, 0
    s_add_u32 s42, s46, 0
    buffer_load_dwordx4 v0, s[8:11], s42 offen offset:0 sc1  lds
    buffer_load_dwordx4 v0, s[8:11], s42 offen offset:1024 sc1  lds
    s_add_u32 m0, s44, 8192
    s_add_u32 s42, s46, 8192
    buffer_load_dwordx4 v0, s[8:11], s42 offen offset:0 sc1  lds
    buffer_load_dwordx4 v0, s[8:11], s42 offen offset:1024 sc1  lds
    s_add_u32 m0, s44, 16384
    s_add_u32 s42, s46, 16384
    buffer_load_dwordx4 v0, s[8:11], s42 offen offset:0 sc1  lds
    buffer_load_dwordx4 v0, s[8:11], s42 offen offset:1024 sc1  lds
L_rd_184:
    s_waitcnt vmcnt(4)
    s_barrier
    ds_read_b128 v[64:67], v4 offset:0
    ds_read_b128 v[68:71], v4 offset:1024
    ds_read_b128 v[72:75], v4 offset:2048
    ds_read_b128 v[76:79], v4 offset:3072
    s_waitcnt lgkmcnt(3)
    v_mfma_f32_32x32x16_bf16 v[16:31], a[0:3], v[64:67], 0
    s_add_u32 m0, s45, 24576
    s_add_u32 s42, s47, 24576
    buffer_load_dwordx4 v0, s[8:11], s42 offen offset:0 sc1  lds
    ds_read_b128 v[64:67], v4 offset:4096
    s_waitcnt lgkmcnt(3)
    v_mfma_f32_32x32x16_bf16 v[16:31], a[4:7], v[68:71], v[16:31]
    ds_read_b128 v[68:71], v4 offset:5120
    s_waitcnt lgkmcnt(3)
    v_mfma_f32_32x32x16_bf16 v[16:31], a[8:11], v[72:75], v[16:31]
    buffer_load_dwordx4 v0, s[8:11], s42 offen offset:1024 sc1  lds
    ds_read_b128 v[72:75], v4 offset:6144
    s_waitcnt lgkmcnt(3)
    v_mfma_f32_32x32x16_bf16 v[16:31], a[12:15], v[76:79], v[16:31]
    ds_read_b128 v[76:79], v4 offset:7168
    s_waitcnt lgkmcnt(3)
    v_mfma_f32_32x32x16_bf16 v[16:31], a[16:19], v[64:67], v[16:31]
    buffer_load_dwordx4 v0, s[8:11], s42 offen offset:2048 sc1  lds
    s_waitcnt vmcnt(5)
    s_barrier
    ds_read_b128 v[64:67], v4 offset:8192
    s_waitcnt lgkmcnt(3)
    v_mfma_f32_32x32x16_bf16 v[16:31], a[20:23], v[68:71], v[16:31]
    ds_read_b128 v[68:71], v4 offset:9216
    s_waitcnt lgkmcnt(3)
    v_mfma_f32_32x32x16_bf16 v[16:31], a[24:27], v[72:75], v[16:31]
    buffer_load_dwordx4 v0, s[8:11], s42 offen offset:3072 sc1  lds
    ds_read_b128 v[72:75], v4 offset:10240
    s_waitcnt lgkmcnt(3)
    v_mfma_f32_32x32x16_bf16 v[16:31], a[28:31], v[76:79], v[16:31]
    s_add_u32 m0, s45, 40960
    s_add_u32 s42, s47, 40960
    ds_read_b128 v[76:79], v4 offset:11264
    s_waitcnt lgkmcnt(3)
    v_mfma_f32_32x32x16_bf16 v[16:31], a[32:35], v[64:67], v[16:31]
    buffer_load_dwordx4 v0, s[8:11], s42 offen offset:0 sc1  lds
    ds_read_b128 v[64:67], v4 offset:12288
    s_waitcnt lgkmcnt(3)
    v_mfma_f32_32x32x16_bf16 v[16:31], a[36:39], v[68:71], v[16:31]
    ds_read_b128 v[68:71], v4 offset:13312
    s_waitcnt lgkmcnt(3)
    v_mfma_f32_32x32x16_bf16 v[16:31], a[40:43], v[72:75], v[16:31]
    buffer_load_dwordx4 v0, s[8:11], s42 offen offset:1024 sc1  lds
    ds_read_b128 v[72:75], v4 offset:14336
    s_waitcnt lgkmcnt(3)
    v_mfma_f32_32x32x16_bf16 v[16:31], a[44:47], v[76:79], v[16:31]
    ds_read_b128 v[76:79], v4 offset:15360
    s_waitcnt lgkmcnt(3)
    v_mfma_f32_32x32x16_bf16 v[16:31], a[48:51], v[64:67], v[16:31]
    buffer_load_dwordx4 v0, s[8:11], s42 offen offset:2048 sc1  lds
    s_waitcnt vmcnt(7)
    s_barrier
    ds_read_b128 v[64:67], v4 offset:16384
    s_waitcnt lgkmcnt(3)
    v_mfma_f32_32x32x16_bf16 v[16:31], a[52:55], v[68:71], v[16:31]
    ds_read_b128 v[68:71], v4 offset:17408
    s_waitcnt lgkmcnt(3)
    v_mfma_f32_32x32x16_bf16 v[16:31], a[56:59], v[72:75], v[16:31]
    buffer_load_dwordx4 v0, s[8:11], s42 offen offset:3072 sc1  lds
    ds_read_b128 v[72:75], v4 offset:18432
    s_waitcnt lgkmcnt(3)
    v_mfma_f32_32x32x16_bf16 v[16:31], a[60:63], v[76:79], v[16:31]
    ds_read_b128 v[76:79], v4 offset:19456
    s_waitcnt lgkmcnt(3)
    v_mfma_f32_32x32x16_bf16 v[16:31], a[64:67], v[64:67], v[16:31]
    ds_read_b128 v[64:67], v4 offset:20480
    s_waitcnt lgkmcnt(3)
    v_mfma_f32_32x32x16_bf16 v[16:31], a[68:71], v[68:71], v[16:31]
    ds_read_b128 v[68:71], v4 offset:21504
    s_waitcnt lgkmcnt(3)
    v_mfma_f32_32x32x16_bf16 v[16:31], a[72:75], v[72:75], v[16:31]
    ds_read_b128 v[72:75], v4 offset:22528
    s_waitcnt lgkmcnt(3)
    v_mfma_f32_32x32x16_bf16 v[16:31], a[76:79], v[76:79], v[16:31]
    ds_read_b128 v[76:79], v4 offset:23552
    s_waitcnt lgkmcnt(3)
    v_mfma_f32_32x32x16_bf16 v[16:31], a[80:83], v[64:67], v[16:31]
    s_waitcnt vmcnt(4)
    s_barrier
    ds_read_b128 v[64:67], v4 offset:24576
    s_waitcnt lgkmcnt(3)
    v_mfma_f32_32x32x16_bf16 v[16:31], a[84:87], v[68:71], v[16:31]
    ds_read_b128 v[68:71], v4 offset:25600
    s_waitcnt lgkmcnt(3)
    v_mfma_f32_32x32x16_bf16 v[16:31], a[88:91], v[72:75], v[16:31]
    ds_read_b128 v[72:75], v4 offset:26624
    s_waitcnt lgkmcnt(3)
    v_mfma_f32_32x32x16_bf16 v[16:31], a[92:95], v[76:79], v[16:31]
    ds_read_b128 v[76:79], v4 offset:27648
    s_waitcnt lgkmcnt(3)
    v_mfma_f32_32x32x16_bf16 v[16:31], a[96:99], v[64:67], v[16:31]
    buffer_load_dword v3, v1, s[8:11], s33 offen sc1
    ds_read_b128 v[64:67], v4 offset:28672
    s_waitcnt lgkmcnt(3)
    v_mfma_f32_32x32x16_bf16 v[16:31], a[100:103], v[68:71], v[16:31]
    ds_read_b128 v[68:71], v4 offset:29696
    s_waitcnt lgkmcnt(3)
    v_mfma_f32_32x32x16_bf16 v[16:31], a[104:107], v[72:75], v[16:31]
    ds_read_b128 v[72:75], v4 offset:30720
    s_waitcnt lgkmcnt(3)
    v_mfma_f32_32x32x16_bf16 v[16:31], a[108:111], v[76:79], v[16:31]
    ds_read_b128 v[76:79], v4 offset:31744
    s_waitcnt lgkmcnt(3)
    v_mfma_f32_32x32x16_bf16 v[16:31], a[112:115], v[64:67], v[16:31]
    ds_read_b128 v[64:67], v4 offset:32768
    s_waitcnt lgkmcnt(3)
    v_mfma_f32_32x32x16_bf16 v[16:31], a[116:119], v[68:71], v[16:31]
    ds_read_b128 v[68:71], v4 offset:33792
    s_waitcnt lgkmcnt(3)
    v_mfma_f32_32x32x16_bf16 v[16:31], a[120:123], v[72:75], v[16:31]
    s_bfe_u32 s41, s28, 65539
    s_xor_b32 s41, s41, 1
    ds_read_b128 v[72:75], v4 offset:34816
    s_waitcnt lgkmcnt(3)
    v_mfma_f32_32x32x16_bf16 v[16:31], a[124:127], v[76:79], v[16:31]
    s_and_b32 s43, s36, 7
    s_mul_i32 s43, s43, 131072
    ds_read_b128 v[76:79], v4 offset:35840
    s_waitcnt lgkmcnt(3)
    v_mfma_f32_32x32x16_bf16 v[16:31], a[128:131], v[64:67], v[16:31]
    s_add_u32 s46, s43, s48
    s_add_u32 s47, s43, s49
    ds_read_b128 v[64:67], v4 offset:36864
    s_waitcnt lgkmcnt(3)
    v_mfma_f32_32x32x16_bf16 v[16:31], a[132:135], v[68:71], v[16:31]
    s_add_u32 s36, s36, 1
    s_sub_u32 s44, s44, s35
    ds_read_b128 v[68:71], v4 offset:37888
    s_waitcnt lgkmcnt(3)
    v_mfma_f32_32x32x16_bf16 v[16:31], a[136:139], v[72:75], v[16:31]
    s_sub_u32 s45, s45, s35
    s_sub_u32 s35, 57344, s35
    ds_read_b128 v[72:75], v4 offset:38912
    s_waitcnt lgkmcnt(3)
    v_mfma_f32_32x32x16_bf16 v[16:31], a[140:143], v[76:79], v[16:31]
    s_add_u32 s44, s44, s35
    s_add_u32 s45, s45, s35
    ds_read_b128 v[76:79], v4 offset:39936
    s_waitcnt lgkmcnt(3)
    v_mfma_f32_32x32x16_bf16 v[16:31], a[144:147], v[64:67], v[16:31]
    s_waitcnt vmcnt(0)
    v_cmp_gt_u32 vcc, s36, v3
L_mid_181:
    s_barrier
    ds_read_b128 v[64:67], v4 offset:40960
    s_waitcnt lgkmcnt(3)
    v_mfma_f32_32x32x16_bf16 v[16:31], a[148:151], v[68:71], v[16:31]
    s_cbranch_vccnz L_tail0_182
    ds_read_b128 v[68:71], v4 offset:41984
    s_waitcnt lgkmcnt(3)
    v_mfma_f32_32x32x16_bf16 v[16:31], a[152:155], v[72:75], v[16:31]
    s_add_u32 m0, s44, 0
    s_add_u32 s42, s46, 0
    buffer_load_dwordx4 v0, s[8:11], s42 offen offset:0 sc1  lds
    ds_read_b128 v[72:75], v4 offset:43008
    s_waitcnt lgkmcnt(3)
    v_mfma_f32_32x32x16_bf16 v[16:31], a[156:159], v[76:79], v[16:31]
    ds_read_b128 v[76:79], v4 offset:44032
    s_waitcnt lgkmcnt(3)
    v_mfma_f32_32x32x16_bf16 v[16:31], a[160:163], v[64:67], v[16:31]
    buffer_load_dwordx4 v0, s[8:11], s42 offen offset:1024 sc1  lds
    ds_read_b128 v[64:67], v4 offset:45056
    s_waitcnt lgkmcnt(3)
    v_mfma_f32_32x32x16_bf16 v[16:31], a[164:167], v[68:71], v[16:31]
    s_add_u32 m0, s44, 8192
    s_add_u32 s42, s46, 8192
    ds_read_b128 v[68:71], v4 offset:46080
    s_waitcnt lgkmcnt(3)
    v_mfma_f32_32x32x16_bf16 v[16:31], a[168:171], v[72:75], v[16:31]
    buffer_load_dwordx4 v0, s[8:11], s42 offen offset:0 sc1  lds
    ds_read_b128 v[72:75], v4 offset:47104
    s_waitcnt lgkmcnt(3)
    v_mfma_f32_32x32x16_bf16 v[16:31], a[172:175], v[76:79], v[16:31]
    ds_read_b128 v[76:79], v4 offset:48128
    s_waitcnt lgkmcnt(3)
    v_mfma_f32_32x32x16_bf16 v[16:31], a[176:179], v[64:67], v[16:31]
    buffer_load_dwordx4 v0, s[8:11], s42 offen offset:1024 sc1  lds
    ds_read_b128 v[64:67], v4 offset:49152
    s_waitcnt lgkmcnt(3)
    v_mfma_f32_32x32x16_bf16 v[16:31], a[180:183], v[68:71], v[16:31]
    s_add_u32 m0, s44, 16384
    s_add_u32 s42, s46, 16384
    ds_read_b128 v[68:71], v4 offset:50176
    s_waitcnt lgkmcnt(3)
    v_mfma_f32_32x32x16_bf16 v[16:31], a[184:187], v[72:75], v[16:31]
    buffer_load_dwordx4 v0, s[8:11], s42 offen offset:0 sc1  lds
    ds_read_b128 v[72:75], v4 offset:51200
    s_waitcnt lgkmcnt(3)
    v_mfma_f32_32x32x16_bf16 v[16:31], a[188:191], v[76:79], v[16:31]
    ds_read_b128 v[76:79], v4 offset:52224
    s_waitcnt lgkmcnt(3)
    v_mfma_f32_32x32x16_bf16 v[16:31], a[192:195], v[64:67], v[16:31]
    buffer_load_dwordx4 v0, s[8:11], s42 offen offset:1024 sc1  lds
    ds_read_b128 v[64:67], v4 offset:53248
    s_waitcnt lgkmcnt(3)
    v_mfma_f32_32x32x16_bf16 v[16:31], a[196:199], v[68:71], v[16:31]
    s_add_u32 s43, s28, 1
    v_mov_b32 v7, s43
    s_add_u32 m0, s45, 24576
    s_add_u32 s42, s47, 24576
    ds_read_b128 v[68:71], v4 offset:54272
    s_waitcnt lgkmcnt(3)
    v_mfma_f32_32x32x16_bf16 v[16:31], a[200:203], v[72:75], v[16:31]
    buffer_store_dword v7, v2, s[8:11], s34 offen sc1
    buffer_load_dwordx4 v0, s[8:11], s42 offen offset:0 sc1  lds
    ds_read_b128 v[72:75], v4 offset:55296
    s_waitcnt lgkmcnt(3)
    v_mfma_f32_32x32x16_bf16 v[16:31], a[204:207], v[76:79], v[16:31]
    ds_read_b128 v[76:79], v4 offset:56320
    s_waitcnt lgkmcnt(3)
    v_mfma_f32_32x32x16_bf16 v[16:31], a[208:211], v[64:67], v[16:31]
    buffer_load_dwordx4 v0, s[8:11], s42 offen offset:1024 sc1  lds
    s_waitcnt lgkmcnt(2)
    v_mfma_f32_32x32x16_bf16 v[16:31], a[212:215], v[68:71], v[16:31]
    s_waitcnt lgkmcnt(1)
    v_mfma_f32_32x32x16_bf16 v[16:31], a[216:219], v[72:75], v[16:31]
    buffer_load_dwordx4 v0, s[8:11], s42 offen offset:2048 sc1  lds
    s_waitcnt lgkmcnt(0)
    v_mfma_f32_32x32x16_bf16 v[16:31], a[220:223], v[76:79], v[16:31]
    s_add_u32 s28, s28, 1
    v_add_u32 v4, s35, v0
    v_mov_b32 v7, s28
    s_nop 8
    v_cvt_pk_bf16_f32 v88, v16, v17
    v_cvt_pk_bf16_f32 v89, v18, v19
    v_cvt_pk_bf16_f32 v90, v20, v21
    v_cvt_pk_bf16_f32 v91, v22, v23
    v_and_or_b32 v88, v88, -2, s41
    buffer_store_dwordx4 v[88:91], v0, s[8:11], s30 offen offset:0 sc1
    v_cvt_pk_bf16_f32 v92, v24, v25
    v_cvt_pk_bf16_f32 v93, v26, v27
    v_cvt_pk_bf16_f32 v94, v28, v29
    v_cvt_pk_bf16_f32 v95, v30, v31
    v_and_or_b32 v92, v92, -2, s41
    buffer_store_dwordx4 v[92:95], v0, s[8:11], s30 offen offset:1024 sc1
    s_waitcnt vmcnt(10)
    s_barrier
    ds_read_b128 v[64:67], v4 offset:0
    ds_read_b128 v[68:71], v4 offset:1024
    ds_read_b128 v[72:75], v4 offset:2048
    ds_read_b128 v[76:79], v4 offset:3072
    s_waitcnt lgkmcnt(3)
    v_mfma_f32_32x32x16_bf16 v[16:31], a[0:3], v[64:67], 0
    buffer_load_dwordx4 v0, s[8:11], s42 offen offset:3072 sc1  lds
    ds_read_b128 v[64:67], v4 offset:4096
    s_waitcnt lgkmcnt(3)
    v_mfma_f32_32x32x16_bf16 v[16:31], a[4:7], v[68:71], v[16:31]
    s_and_b32 s43, s28, 7
    s_add_u32 m0, s45, 40960
    s_add_u32 s42, s47, 40960
    ds_read_b128 v[68:71], v4 offset:5120
    s_waitcnt lgkmcnt(3)
    v_mfma_f32_32x32x16_bf16 v[16:31], a[8:11], v[72:75], v[16:31]
    s_mul_i32 s30, s43, 65536
    buffer_load_dwordx4 v0, s[8:11], s42 offen offset:0 sc1  lds
    ds_read_b128 v[72:75], v4 offset:6144
    s_waitcnt lgkmcnt(3)
    v_mfma_f32_32x32x16_bf16 v[16:31], a[12:15], v[76:79], v[16:31]
    s_add_u32 s30, s30, s60
    ds_read_b128 v[76:79], v4 offset:7168
    s_waitcnt lgkmcnt(3)
    v_mfma_f32_32x32x16_bf16 v[16:31], a[16:19], v[64:67], v[16:31]
    buffer_load_dwordx4 v0, s[8:11], s42 offen offset:1024 sc1  lds
    s_waitcnt vmcnt(11)
    s_barrier
    ds_read_b128 v[64:67], v4 offset:8192
    s_waitcnt lgkmcnt(3)
    v_mfma_f32_32x32x16_bf16 v[16:31], a[20:23], v[68:71], v[16:31]
    ds_read_b128 v[68:71], v4 offset:9216
    s_waitcnt lgkmcnt(3)
    v_mfma_f32_32x32x16_bf16 v[16:31], a[24:27], v[72:75], v[16:31]
    buffer_load_dwordx4 v0, s[8:11], s42 offen offset:2048 sc1  lds
    ds_read_b128 v[72:75], v4 offset:10240
    s_waitcnt lgkmcnt(3)
    v_mfma_f32_32x32x16_bf16 v[16:31], a[28:31], v[76:79], v[16:31]
    ds_read_b128 v[76:79], v4 offset:11264
    s_waitcnt lgkmcnt(3)
    v_mfma_f32_32x32x16_bf16 v[16:31], a[32:35], v[64:67], v[16:31]
    buffer_load_dwordx4 v0, s[8:11], s42 offen offset:3072 sc1  lds
    ds_read_b128 v[64:67], v4 offset:12288
    s_waitcnt lgkmcnt(3)
    v_mfma_f32_32x32x16_bf16 v[16:31], a[36:39], v[68:71], v[16:31]
    ds_read_b128 v[68:71], v4 offset:13312
    s_waitcnt lgkmcnt(3)
    v_mfma_f32_32x32x16_bf16 v[16:31], a[40:43], v[72:75], v[16:31]
    ds_read_b128 v[72:75], v4 offset:14336
    s_waitcnt lgkmcnt(3)
    v_mfma_f32_32x32x16_bf16 v[16:31], a[44:47], v[76:79], v[16:31]
    ds_read_b128 v[76:79], v4 offset:15360
    s_waitcnt lgkmcnt(3)
    v_mfma_f32_32x32x16_bf16 v[16:31], a[48:51], v[64:67], v[16:31]
    s_waitcnt vmcnt(11)
    s_barrier
    ds_read_b128 v[64:67], v4 offset:16384
    s_waitcnt lgkmcnt(3)
    v_mfma_f32_32x32x16_bf16 v[16:31], a[52:55], v[68:71], v[16:31]
    ds_read_b128 v[68:71], v4 offset:17408
    s_waitcnt lgkmcnt(3)
    v_mfma_f32_32x32x16_bf16 v[16:31], a[56:59], v[72:75], v[16:31]
    ds_read_b128 v[72:75], v4 offset:18432
    s_waitcnt lgkmcnt(3)
    v_mfma_f32_32x32x16_bf16 v[16:31], a[60:63], v[76:79], v[16:31]
    ds_read_b128 v[76:79], v4 offset:19456
    s_waitcnt lgkmcnt(3)
    v_mfma_f32_32x32x16_bf16 v[16:31], a[64:67], v[64:67], v[16:31]
    ds_read_b128 v[64:67], v4 offset:20480
    s_waitcnt lgkmcnt(3)
    v_mfma_f32_32x32x16_bf16 v[16:31], a[68:71], v[68:71], v[16:31]
    ds_read_b128 v[68:71], v4 offset:21504
    s_waitcnt lgkmcnt(3)
    v_mfma_f32_32x32x16_bf16 v[16:31], a[72:75], v[72:75], v[16:31]
    ds_read_b128 v[72:75], v4 offset:22528
    s_waitcnt lgkmcnt(3)
    v_mfma_f32_32x32x16_bf16 v[16:31], a[76:79], v[76:79], v[16:31]
    ds_read_b128 v[76:79], v4 offset:23552
    s_waitcnt lgkmcnt(3)
    v_mfma_f32_32x32x16_bf16 v[16:31], a[80:83], v[64:67], v[16:31]
    s_waitcnt vmcnt(4)
    s_barrier
    ds_read_b128 v[64:67], v4 offset:24576
    s_waitcnt lgkmcnt(3)
    v_mfma_f32_32x32x16_bf16 v[16:31], a[84:87], v[68:71], v[16:31]
    ds_read_b128 v[68:71], v4 offset:25600
    s_waitcnt lgkmcnt(3)
    v_mfma_f32_32x32x16_bf16 v[16:31], a[88:91], v[72:75], v[16:31]
    ds_read_b128 v[72:75], v4 offset:26624
    s_waitcnt lgkmcnt(3)
    v_mfma_f32_32x32x16_bf16 v[16:31], a[92:95], v[76:79], v[16:31]
    ds_read_b128 v[76:79], v4 offset:27648
    s_waitcnt lgkmcnt(3)
    v_mfma_f32_32x32x16_bf16 v[16:31], a[96:99], v[64:67], v[16:31]
    buffer_load_dword v3, v1, s[8:11], s33 offen sc1
    ds_read_b128 v[64:67], v4 offset:28672
    s_waitcnt lgkmcnt(3)
    v_mfma_f32_32x32x16_bf16 v[16:31], a[100:103], v[68:71], v[16:31]
    ds_read_b128 v[68:71], v4 offset:29696
    s_waitcnt lgkmcnt(3)
    v_mfma_f32_32x32x16_bf16 v[16:31], a[104:107], v[72:75], v[16:31]
    ds_read_b128 v[72:75], v4 offset:30720
    s_waitcnt lgkmcnt(3)
    v_mfma_f32_32x32x16_bf16 v[16:31], a[108:111], v[76:79], v[16:31]
    ds_read_b128 v[76:79], v4 offset:31744
    s_waitcnt lgkmcnt(3)
    v_mfma_f32_32x32x16_bf16 v[16:31], a[112:115], v[64:67], v[16:31]
    ds_read_b128 v[64:67], v4 offset:32768
    s_waitcnt lgkmcnt(3)
    v_mfma_f32_32x32x16_bf16 v[16:31], a[116:119], v[68:71], v[16:31]
    ds_read_b128 v[68:71], v4 offset:33792
    s_waitcnt lgkmcnt(3)
    v_mfma_f32_32x32x16_bf16 v[16:31], a[120:123], v[72:75], v[16:31]
    s_bfe_u32 s41, s28, 65539
    s_xor_b32 s41, s41, 1
    ds_read_b128 v[72:75], v4 offset:34816
    s_waitcnt lgkmcnt(3)
    v_mfma_f32_32x32x16_bf16 v[16:31], a[124:127], v[76:79], v[16:31]
    s_and_b32 s43, s36, 7
    s_mul_i32 s43, s43, 131072
    ds_read_b128 v[76:79], v4 offset:35840
    s_waitcnt lgkmcnt(3)
    v_mfma_f32_32x32x16_bf16 v[16:31], a[128:131], v[64:67], v[16:31]
    s_add_u32 s46, s43, s48
    s_add_u32 s47, s43, s49
    ds_read_b128 v[64:67], v4 offset:36864
    s_waitcnt lgkmcnt(3)
    v_mfma_f32_32x32x16_bf16 v[16:31], a[132:135], v[68:71], v[16:31]
    s_add_u32 s36, s36, 1
    s_sub_u32 s44, s44, s35
    ds_read_b128 v[68:71], v4 offset:37888
    s_waitcnt lgkmcnt(3)
    v_mfma_f32_32x32x16_bf16 v[16:31], a[136:139], v[72:75], v[16:31]
    s_sub_u32 s45, s45, s35
    s_sub_u32 s35, 57344, s35
    ds_read_b128 v[72:75], v4 offset:38912
    s_waitcnt lgkmcnt(3)
    v_mfma_f32_32x32x16_bf16 v[16:31], a[140:143], v[76:79], v[16:31]
    s_add_u32 s44, s44, s35
    s_add_u32 s45, s45, s35
    ds_read_b128 v[76:79], v4 offset:39936
    s_waitcnt lgkmcnt(3)
    v_mfma_f32_32x32x16_bf16 v[16:31], a[144:147], v[64:67], v[16:31]
    s_waitcnt vmcnt(0)
    v_cmp_gt_u32 vcc, s36, v3
    s_branch L_mid_181
L_tail0_182:
    ds_read_b128 v[68:71], v4 offset:41984
    s_waitcnt lgkmcnt(3)
    v_mfma_f32_32x32x16_bf16 v[16:31], a[152:155], v[72:75], v[16:31]
    ds_read_b128 v[72:75], v4 offset:43008
    s_waitcnt lgkmcnt(3)
    v_mfma_f32_32x32x16_bf16 v[16:31], a[156:159], v[76:79], v[16:31]
    ds_read_b128 v[76:79], v4 offset:44032
    s_waitcnt lgkmcnt(3)
    v_mfma_f32_32x32x16_bf16 v[16:31], a[160:163], v[64:67], v[16:31]
    ds_read_b128 v[64:67], v4 offset:45056
    s_waitcnt lgkmcnt(3)
    v_mfma_f32_32x32x16_bf16 v[16:31], a[164:167], v[68:71], v[16:31]
    ds_read_b128 v[68:71], v4 offset:46080
    s_waitcnt lgkmcnt(3)
    v_mfma_f32_32x32x16_bf16 v[16:31], a[168:171], v[72:75], v[16:31]
    ds_read_b128 v[72:75], v4 offset:47104
    s_waitcnt lgkmcnt(3)
    v_mfma_f32_32x32x16_bf16 v[16:31], a[172:175], v[76:79], v[16:31]
    ds_read_b128 v[76:79], v4 offset:48128
    s_waitcnt lgkmcnt(3)
    v_mfma_f32_32x32x16_bf16 v[16:31], a[176:179], v[64:67], v[16:31]
    ds_read_b128 v[64:67], v4 offset:49152
    s_waitcnt lgkmcnt(3)
    v_mfma_f32_32x32x16_bf16 v[16:31], a[180:183], v[68:71], v[16:31]
    ds_read_b128 v[68:71], v4 offset:50176
    s_waitcnt lgkmcnt(3)
    v_mfma_f32_32x32x16_bf16 v[16:31], a[184:187], v[72:75], v[16:31]
    ds_read_b128 v[72:75], v4 offset:51200
    s_waitcnt lgkmcnt(3)
    v_mfma_f32_32x32x16_bf16 v[16:31], a[188:191], v[76:79], v[16:31]
    ds_read_b128 v[76:79], v4 offset:52224
    s_waitcnt lgkmcnt(3)
    v_mfma_f32_32x32x16_bf16 v[16:31], a[192:195], v[64:67], v[16:31]
    ds_read_b128 v[64:67], v4 offset:53248
    s_waitcnt lgkmcnt(3)
    v_mfma_f32_32x32x16_bf16 v[16:31], a[196:199], v[68:71], v[16:31]
    s_add_u32 s43, s28, 1
    v_mov_b32 v7, s43
    ds_read_b128 v[68:71], v4 offset:54272
    s_waitcnt lgkmcnt(3)
    v_mfma_f32_32x32x16_bf16 v[16:31], a[200:203], v[72:75], v[16:31]
    buffer_store_dword v7, v2, s[8:11], s34 offen sc1
    ds_read_b128 v[72:75], v4 offset:55296
    s_waitcnt lgkmcnt(3)
    v_mfma_f32_32x32x16_bf16 v[16:31], a[204:207], v[76:79], v[16:31]
    ds_read_b128 v[76:79], v4 offset:56320
    s_waitcnt lgkmcnt(3)
    v_mfma_f32_32x32x16_bf16 v[16:31], a[208:211], v[64:67], v[16:31]
    s_waitcnt lgkmcnt(2)
    v_mfma_f32_32x32x16_bf16 v[16:31], a[212:215], v[68:71], v[16:31]
    s_waitcnt lgkmcnt(1)
    v_mfma_f32_32x32x16_bf16 v[16:31], a[216:219], v[72:75], v[16:31]
    s_waitcnt lgkmcnt(0)
    v_mfma_f32_32x32x16_bf16 v[16:31], a[220:223], v[76:79], v[16:31]
    s_add_u32 s28, s28, 1
    v_add_u32 v4, s35, v0
    v_mov_b32 v7, s28
    s_nop 8
    v_cvt_pk_bf16_f32 v88, v16, v17
    v_cvt_pk_bf16_f32 v89, v18, v19
    v_cvt_pk_bf16_f32 v90, v20, v21
    v_cvt_pk_bf16_f32 v91, v22, v23
    v_and_or_b32 v88, v88, -2, s41
    buffer_store_dwordx4 v[88:91], v0, s[8:11], s30 offen offset:0 sc1
    v_cvt_pk_bf16_f32 v92, v24, v25
    v_cvt_pk_bf16_f32 v93, v26, v27
    v_cvt_pk_bf16_f32 v94, v28, v29
    v_cvt_pk_bf16_f32 v95, v30, v31
    v_and_or_b32 v92, v92, -2, s41
    buffer_store_dwordx4 v[92:95], v0, s[8:11], s30 offen offset:1024 sc1
    s_and_b32 s43, s28, 7
    s_mul_i32 s30, s43, 65536
    s_add_u32 s30, s30, s60
    buffer_load_dword v3, v1, s[8:11], s33 offen sc1
    s_waitcnt vmcnt(0)
    s_cmp_eq_u32 s28, 64
    s_cbranch_scc1 L_fin_179
    v_cmp_gt_u32 vcc, s36, v3
    s_cbranch_vccz L_dma_178
    s_branch L_item_177
L_fin_179:
    s_branch L_done

.section .rodata,"a"
.p2align 6
.amdhsa_kernel interleave_layers__memory_aug_recurrent_mem_tr__glu_gated_swiglu__prompt_kernel
  .amdhsa_next_free_vgpr 512
  .amdhsa_next_free_sgpr 102
  .amdhsa_accum_offset 256
  .amdhsa_group_segment_fixed_size 0
  .amdhsa_kernarg_size 112
  .amdhsa_user_sgpr_count 2
  .amdhsa_user_sgpr_kernarg_segment_ptr 1
  .amdhsa_system_sgpr_workgroup_id_x 1
  .amdhsa_float_denorm_mode_32 3
.end_amdhsa_kernel
```
